```python
import torch

def _softmax(x, axis=-1):
    return torch.softmax(x, dim=axis)
def _gelu(x):
    return torch.nn.functional.gelu(x, approximate="tanh")
def _silu(x):
    return torch.nn.functional.silu(x)
def _sigmoid(x):
    return torch.sigmoid(x)
def _layernorm(x, axis=-1, eps=1e-5):
    m = x.mean(dim=axis, keepdim=True)
    v = x.var(dim=axis, keepdim=True, unbiased=False)
    return (x - m) / torch.sqrt(v + eps)
def _scatter_add(tgt, idx, src, axis=0):
    return tgt.clone().index_add_(axis, idx, src)
def _segment_sum(src, seg, n):
    out = torch.zeros((n,) + src.shape[1:], dtype=src.dtype)
    return out.index_add_(0, seg, src)
def _pad(x, pw):
    flat = tuple(v for pair in reversed(pw) for v in pair)
    return torch.nn.functional.pad(x, flat)

kernel_name = 'gated_mix__compressed_kv_cla__ssm_conv_h3__prompt'

def setup_inputs():

    _w = (lambda a: (lambda t: t.to(torch.bfloat16) if t.is_floating_point() else t)(torch.as_tensor(a)))
    def _A_setup():
        B, H, Sq, Sk, D, M = 1, 32, 2048, 2048, 128, 640
        Dc = 4 * D
        return {
            "x": _w((lambda *s: torch.randn(*s, dtype=torch.bfloat16) * 0.05)(B, Sq, M)),
            "c_kv": _w((lambda *s: torch.randn(*s, dtype=torch.bfloat16) * 0.4)(B, Sk, Dc)),
            "w_q": _w((lambda *s: torch.randn(*s, dtype=torch.bfloat16) * 6.4)(M, H, D) * (M ** -0.5)),
            "w_uk": _w((lambda *s: torch.randn(*s, dtype=torch.bfloat16) * 6.4)(Dc, H, D) * (Dc ** -0.5)),
            "w_uv": _w((lambda *s: torch.randn(*s, dtype=torch.bfloat16) * 0.4)(Dc, H, D) * (Dc ** -0.5)),
            "w_o": _w((lambda *s: torch.randn(*s, dtype=torch.bfloat16) * 0.4)(H, D, M) * ((H * D) ** -0.5)),
        }
    _A_in = _A_setup()

    def _B_setup():
        B, S, D = 1, 2048, 640
        ks = 4
        return {
            "q": _w((lambda *s: torch.randn(*s, dtype=torch.bfloat16) * 0.05)(B, S, D)),
            "k": _w((lambda *s: torch.randn(*s, dtype=torch.bfloat16) * 0.4)(B, S, D)),
            "v": _w((lambda *s: torch.randn(*s, dtype=torch.bfloat16) * 0.4)(B, S, D)),
            "shift_k": _w((lambda *s: torch.randn(*s, dtype=torch.bfloat16) * 0.4)(D, ks) * 0.5),
            "ssm_k": _w((lambda *s: torch.randn(*s, dtype=torch.bfloat16) * 0.8)(D, S) * (1.0 / S ** 0.5)),
            "ssm_D": _w((lambda *s: torch.randn(*s, dtype=torch.bfloat16) * 0.4)(D)),
        }
    _B_in = _B_setup()

    return {
        "A_x": _A_in["x"],
        "A_c_kv": _A_in["c_kv"],
        "A_w_q": _A_in["w_q"],
        "A_w_uk": _A_in["w_uk"],
        "A_w_uv": _A_in["w_uv"],
        "A_w_o": _A_in["w_o"],
        "B_q": _B_in["q"],
        "B_k": _B_in["k"],
        "B_v": _B_in["v"],
        "B_shift_k": _B_in["shift_k"],
        "B_ssm_k": _B_in["ssm_k"],
        "B_ssm_D": _B_in["ssm_D"],
        "gate_w": _w((lambda *s: torch.randn(*s, dtype=torch.bfloat16) * 0.05)(640) * 16.0),
    }

def reference(A_x, A_c_kv, A_w_q, A_w_uk, A_w_uv, A_w_o, B_q, B_k, B_v, B_shift_k, B_ssm_k, B_ssm_D, gate_w):
    def _A_ref(x, c_kv, w_q, w_uk, w_uv, w_o):
        B, Sq, M = x.shape[0], x.shape[1], x.shape[2]
        Sk = c_kv.shape[1]
        H, D = w_q.shape[1], w_q.shape[2]
        q = torch.einsum("bqm,mhd->bhqd", x, w_q)
        k = torch.einsum("bkc,chd->bhkd", c_kv, w_uk)
        v = torch.einsum("bkc,chd->bhkd", c_kv, w_uv)
        scores = torch.einsum("bhqd,bhkd->bhqk", q, k) * (D ** -0.5)
        off = Sk - Sq
        qi = torch.arange(Sq)[:, None]
        kj = torch.arange(Sk)[None, :]
        cmask = kj <= (qi + off)
        scores = torch.where(cmask[None, None], scores, -1e9)
        p = _softmax(scores, axis=-1)
        ctx = torch.einsum("bhqk,bhkd->bhqd", p, v)
        return torch.einsum("bhqd,hdm->bqm", ctx, w_o)

    def _B_ref(q, k, v, shift_k, ssm_k, ssm_D):
        B, S, D = q.shape
        ks = shift_k.shape[-1]
        k_pad = _pad(k, ((0, 0), (ks - 1, 0), (0, 0)))
        k_shift = torch.zeros_like(k)
        for t in range(ks):
            k_shift = k_shift + k_pad[:, t:t + S, :] * shift_k[:, ks - 1 - t][None, None, :]
        kv = k_shift * v
        L = 2 * S
        kv_pad = _pad(kv, ((0, 0), (0, S), (0, 0)))
        kf_pad = _pad(ssm_k, ((0, 0), (0, S)))
        kv_f = (lambda x, axes=(-2,-1): torch.fft.rfft2(x.float(), dim=axes))(kv_pad[:, None, :, :], axes=(1, 2))
        kf_f = (lambda x, axes=(-2,-1): torch.fft.rfft2(x.float(), dim=axes))(kf_pad[:, None, :], axes=(1, 2))
        kf_f = (lambda x, *d: x.permute(*d))(kf_f, 1, 2, 0)
        y_f = kv_f * kf_f[None, :, :, :]
        y = (lambda x, s, axes=(-2,-1): torch.fft.irfft2(x, s=s, dim=axes).to(torch.bfloat16))(y_f, (1, L), axes=(1, 2))[:, 0, :S, :]
        y = y + kv * ssm_D[None, None, :]
        return q * y

    x = A_x
    g = _sigmoid((x * gate_w).sum(-1, keepdims=True))
    a = _A_ref(x, A_c_kv, A_w_q, A_w_uk, A_w_uv, A_w_o)
    b = _B_ref(x, B_k, B_v, B_shift_k, B_ssm_k, B_ssm_D)
    return g * a + (1 - g) * b
```

```asm
; @launch kernel=main_kernel grid=(256,1,1) block=(256,1,1) lds=163840
.amdgcn_target "amdgcn-amd-amdhsa--gfx950"
.text
.globl main_kernel
.p2align 8
.type main_kernel,@function
main_kernel:
    s_cmp_ge_u32 s2, 256
    s_cbranch_scc1 main_kernel_end
    s_getpc_b64 s[36:37]
main_kernel_pc:
    s_sub_u32 s36, s36, main_kernel_pc-main_kernel
    s_subb_u32 s37, s37, 0
    s_mov_b32 s38, all_code_end-main_kernel
    s_mov_b32 s39, 0x00020000
    s_lshr_b32 s58, s2, 3
    s_lshl_b32 s58, s58, 12
    v_lshlrev_b32 v16, 4, v0
    buffer_load_dwordx4 v[20:23], v16, s[36:39], s58 offen
    s_load_dwordx8 s[4:11], s[0:1], 0
    s_load_dwordx4 s[12:15], s[0:1], 32
    s_load_dwordx4 s[80:83], s[0:1], 56
    s_load_dwordx2 s[78:79], s[0:1], 72
    s_load_dwordx2 s[84:85], s[0:1], 112
    s_load_dwordx8 s[68:75], s[0:1], 96
    v_lshrrev_b32 v2, 6, v0
    v_and_b32 v1, 63, v0
    s_and_b32 s46, s2, 7
    v_readfirstlane_b32 s44, v2
    s_lshr_b32 s58, s2, 6
    s_lshl_b32 s58, s58, 3
    s_add_u32 s46, s46, s58
    s_lshr_b32 s47, s2, 3
    s_and_b32 s47, s47, 7
    s_lshl_b32 s45, s44, 12
    s_sub_u32 s58, 15, s47
    s_lshl_b32 s32, s58, 17
    s_lshl_b32 s33, s47, 17
    s_mul_i32 s34, s58, 163840
    s_mul_i32 s35, s47, 163840
    s_and_b32 s48, s44, 1
    s_lshl_b32 s48, s48, 17
    s_lshl_b32 s49, s44, 17
    s_lshl_b32 s59, s44, 5
    v_lshrrev_b32 v2, 3, v1
    v_and_b32 v3, 7, v1
    v_xor_b32 v3, v3, v2
    v_lshlrev_b32 v11, 4, v3
    v_add_u32 v7, s59, v2
    v_lshl_add_u32 v24, v7, 10, v11
    v_mul_u32_u24 v4, 0x500, v7
    v_add_u32 v4, v4, v11
    v_add_u32 v25, 7168, v24
    v_add_u32 v30, 14336, v24
    v_add_u32 v31, 21504, v24
    v_and_b32 v2, 15, v1
    v_lshrrev_b32 v3, 4, v1
    v_lshrrev_b32 v7, 1, v2
    v_xor_b32 v7, v7, v3
    v_lshlrev_b32 v7, 1, v7
    v_and_b32 v8, 1, v2
    v_or_b32 v7, v7, v8
    v_lshlrev_b32 v7, 4, v7
    v_lshl_add_u32 v7, v3, 13, v7
    s_lshl_b32 s59, s46, 8
    v_add_u32 v6, s59, v7
    v_add_u32 v27, 31744, v6
    v_xor_b32 v28, 0x80, v6
    v_add_u32 v28, 63488, v28
    v_add_u32 v29, 31744, v28
    s_cmp_lt_u32 s44, 2
    s_waitcnt lgkmcnt(0)
    s_cselect_b32 s28, s10, s12
    s_cselect_b32 s29, s11, s13
    s_mov_b32 s30, 0x400000
    s_mov_b32 s31, 0x00020000
    s_mov_b32 s20, s6
    s_mov_b32 s21, s7
    s_mov_b32 s22, 0x200000
    s_mov_b32 s23, 0x00020000
    s_add_u32 m0, s45, 65536
    s_add_u32 s65, s32, 0
    buffer_load_dwordx4 v24, s[20:23], s65 offen offset:0 lds
    buffer_load_dwordx4 v25, s[20:23], s65 offen offset:1024 lds
    buffer_load_dwordx4 v30, s[20:23], s65 offen offset:2048 lds
    buffer_load_dwordx4 v31, s[20:23], s65 offen offset:3072 lds
    s_add_u32 m0, s45, 81920
    s_add_u32 s65, s33, 0
    buffer_load_dwordx4 v24, s[20:23], s65 offen offset:0 lds
    buffer_load_dwordx4 v25, s[20:23], s65 offen offset:1024 lds
    buffer_load_dwordx4 v30, s[20:23], s65 offen offset:2048 lds
    buffer_load_dwordx4 v31, s[20:23], s65 offen offset:3072 lds
    s_add_u32 m0, s45, 49152
    s_add_u32 s65, s48, 0
    buffer_load_dwordx4 v6, s[28:31], s65 offen offset:0 lds
    buffer_load_dwordx4 v27, s[28:31], s65 offen offset:1024 lds
    buffer_load_dwordx4 v28, s[28:31], s65 offen offset:2048 lds
    buffer_load_dwordx4 v29, s[28:31], s65 offen offset:3072 lds
    s_add_u32 m0, s45, 16384
    s_add_u32 s65, s48, 262144
    buffer_load_dwordx4 v6, s[28:31], s65 offen offset:0 lds
    buffer_load_dwordx4 v27, s[28:31], s65 offen offset:1024 lds
    buffer_load_dwordx4 v28, s[28:31], s65 offen offset:2048 lds
    buffer_load_dwordx4 v29, s[28:31], s65 offen offset:3072 lds
    s_mov_b32 s16, s4
    s_mov_b32 s17, s5
    s_mov_b32 s18, 0x280000
    s_mov_b32 s19, 0x00020000
    s_mov_b32 s24, s8
    s_mov_b32 s25, s9
    s_mov_b32 s26, 0x500000
    s_mov_b32 s27, 0x00020000
    s_mov_b32 s36, s68
    s_mov_b32 s37, s69
    s_mov_b32 s38, 0x500
    s_mov_b32 s39, 0x00020000
    s_mov_b32 s40, s74
    s_mov_b32 s41, s75
    s_mov_b32 s42, 0x5000000
    s_mov_b32 s43, 0x00020000
    v_add_u32 v5, 9216, v4
    v_add_u32 v19, 18432, v4
    v_add_u32 v26, 27648, v4
    s_lshl_b32 s76, s2, 2
    s_add_u32 s76, s76, s44
    s_mov_b32 s50, 0xffff0000
    s_lshr_b32 s58, s44, 1
    s_lshl_b32 s58, s58, 14
    s_add_u32 s58, s58, 0x10000
    v_and_b32 v7, 7, v2
    v_xor_b32 v7, v7, v3
    v_lshlrev_b32 v7, 4, v7
    v_lshlrev_b32 v8, 7, v2
    v_add_u32 v8, v8, v7
    v_add_u32 v8, s58, v8
    v_xor_b32 v9, 64, v8
    v_add_u32 v10, 0x10000, v8
    v_add_u32 v11, 0x10000, v9
    v_lshrrev_b32 v7, 2, v2
    v_and_b32 v16, 1, v3
    v_lshlrev_b32 v16, 2, v16
    v_or_b32 v16, v16, v7
    v_lshlrev_b32 v240, 3, v3
    v_add_u32 v240, v240, v7
    v_lshlrev_b32 v240, 8, v240
    v_and_b32 v241, 3, v1
    v_lshlrev_b32 v241, 3, v241
    v_add_u32 v240, v240, v241
    s_and_b32 s59, s44, 1
    s_lshl_b32 s59, s59, 2
    s_add_u32 s58, s59, 0
    v_xor_b32 v242, s58, v16
    v_lshlrev_b32 v242, 5, v242
    v_add_u32 v12, v240, v242
    s_add_u32 s58, s59, 1
    v_xor_b32 v242, s58, v16
    v_lshlrev_b32 v242, 5, v242
    v_add_u32 v13, v240, v242
    s_add_u32 s58, s59, 2
    v_xor_b32 v242, s58, v16
    v_lshlrev_b32 v242, 5, v242
    v_add_u32 v14, v240, v242
    s_add_u32 s58, s59, 3
    v_xor_b32 v242, s58, v16
    v_lshlrev_b32 v242, 5, v242
    v_add_u32 v15, v240, v242
    s_lshl_b32 s58, s46, 2
    v_mov_b32 v7, s58
    s_add_u32 m0, s45, 98304
    s_add_u32 s65, s32, 128
    buffer_load_dwordx4 v24, s[20:23], s65 offen offset:0 lds
    buffer_load_dwordx4 v25, s[20:23], s65 offen offset:1024 lds
    buffer_load_dwordx4 v30, s[20:23], s65 offen offset:2048 lds
    buffer_load_dwordx4 v31, s[20:23], s65 offen offset:3072 lds
    s_add_u32 m0, s45, 114688
    s_add_u32 s65, s33, 128
    buffer_load_dwordx4 v24, s[20:23], s65 offen offset:0 lds
    buffer_load_dwordx4 v25, s[20:23], s65 offen offset:1024 lds
    buffer_load_dwordx4 v30, s[20:23], s65 offen offset:2048 lds
    buffer_load_dwordx4 v31, s[20:23], s65 offen offset:3072 lds
    s_add_u32 m0, s45, 32768
    s_add_u32 s65, s48, 524288
    buffer_load_dwordx4 v6, s[28:31], s65 offen offset:0 lds
    buffer_load_dwordx4 v27, s[28:31], s65 offen offset:1024 lds
    buffer_load_dwordx4 v28, s[28:31], s65 offen offset:2048 lds
    buffer_load_dwordx4 v29, s[28:31], s65 offen offset:3072 lds
    s_add_u32 m0, s45, 0
    s_add_u32 s65, s48, 786432
    buffer_load_dwordx4 v6, s[28:31], s65 offen offset:0 lds
    buffer_load_dwordx4 v27, s[28:31], s65 offen offset:1024 lds
    buffer_load_dwordx4 v28, s[28:31], s65 offen offset:2048 lds
    buffer_load_dwordx4 v29, s[28:31], s65 offen offset:3072 lds
    s_waitcnt vmcnt(20)
    s_barrier
    ds_read_b64_tr_b16 v[64:65], v12 offset:49152
    ds_read_b64_tr_b16 v[66:67], v12 offset:50176
    ds_read_b64_tr_b16 v[68:69], v13 offset:49152
    ds_read_b64_tr_b16 v[70:71], v13 offset:50176
    ds_read_b64_tr_b16 v[72:73], v14 offset:49152
    ds_read_b64_tr_b16 v[74:75], v14 offset:50176
    ds_read_b64_tr_b16 v[76:77], v15 offset:49152
    ds_read_b64_tr_b16 v[78:79], v15 offset:50176
    ds_read_b64_tr_b16 v[80:81], v12 offset:57344
    ds_read_b64_tr_b16 v[82:83], v12 offset:58368
    ds_read_b64_tr_b16 v[84:85], v13 offset:57344
    ds_read_b64_tr_b16 v[86:87], v13 offset:58368
    ds_read_b64_tr_b16 v[88:89], v14 offset:57344
    ds_read_b64_tr_b16 v[90:91], v14 offset:58368
    ds_read_b64_tr_b16 v[92:93], v15 offset:57344
    ds_read_b64_tr_b16 v[94:95], v15 offset:58368
    ds_read_b128 v[32:35], v8 offset:0
    ds_read_b128 v[36:39], v8 offset:2048
    ds_read_b128 v[40:43], v8 offset:4096
    ds_read_b128 v[44:47], v8 offset:6144
    ds_read_b128 v[48:51], v8 offset:8192
    ds_read_b128 v[52:55], v8 offset:10240
    ds_read_b128 v[56:59], v8 offset:12288
    ds_read_b128 v[60:63], v8 offset:14336
    s_waitcnt lgkmcnt(7)
    v_mfma_f32_16x16x32_bf16 a[0:3], v[64:67], v[32:35], 0
    s_lshl_b32 s58, s46, 7
    s_lshl_b32 s59, s47, 2
    s_add_u32 s58, s58, s59
    s_add_u32 s58, s58, 0x4820000
    v_mov_b32 v239, s58
    v_mov_b32 v238, 0
    s_cmp_lg_u32 s44, 0
    s_cbranch_scc1 main_kernel_nozf
    s_mov_b64 exec, 1
    buffer_store_dword v238, v239, s[40:43], 0 offen sc1
    s_lshl_b32 s58, s47, 2
    s_bfe_u32 s59, s46, 0x20001
    s_add_u32 s58, s58, s59
    s_lshl_b32 s58, s58, 5
    s_lshr_b32 s59, s46, 3
    s_lshl_b32 s59, s59, 1
    s_add_u32 s58, s58, s59
    s_and_b32 s59, s46, 1
    s_add_u32 s58, s58, s59
    s_lshl_b32 s58, s58, 2
    s_add_u32 s58, s58, 0x4830000
    buffer_store_dword v238, v238, s[40:43], s58 offen sc1
    s_and_b32 s58, s2, 1
    s_lshl_b32 s58, s58, 3
    s_add_u32 s58, s58, s47
    s_lshl_b32 s58, s58, 2
    s_lshr_b32 s59, s2, 6
    s_add_u32 s58, s58, s59
    s_lshl_b32 s58, s58, 5
    s_bfe_u32 s59, s2, 0x20001
    s_add_u32 s58, s58, s59
    s_lshl_b32 s58, s58, 2
    s_add_u32 s58, s58, 0x4811000
    buffer_store_dword v238, v238, s[40:43], s58 offen sc1
    s_mov_b64 exec, 15
    v_lshlrev_b32 v239, 2, v1
    s_lshl_b32 s58, s2, 4
    s_add_u32 s58, s58, 0x4810000
    buffer_store_dword v238, v239, s[40:43], s58 offen sc1
    s_mov_b64 exec, -1
main_kernel_nozf:
    v_mfma_f32_16x16x32_bf16 a[128:131], v[32:35], v[80:83], 0
    v_and_b32 v240, 7, v1
    v_mfma_f32_16x16x32_bf16 a[4:7], v[68:71], v[32:35], 0
    v_and_b32 v241, 8, v1
    v_mfma_f32_16x16x32_bf16 a[132:135], v[32:35], v[84:87], 0
    s_waitcnt vmcnt(16) lgkmcnt(0)
    s_barrier
    v_mfma_f32_16x16x32_bf16 a[8:11], v[72:75], v[32:35], 0
    ds_read_b64_tr_b16 v[96:97], v12 offset:16384
    v_mfma_f32_16x16x32_bf16 a[136:139], v[32:35], v[88:91], 0
    s_add_u32 m0, s45, 131072
    s_add_u32 s65, s32, 256
    buffer_load_dwordx4 v24, s[20:23], s65 offen offset:0 lds
    v_mfma_f32_16x16x32_bf16 a[12:15], v[76:79], v[32:35], 0
    ds_read_b64_tr_b16 v[98:99], v12 offset:17408
    v_mfma_f32_16x16x32_bf16 a[140:143], v[32:35], v[92:95], 0
    ds_read_b128 v[32:35], v9 offset:0
    v_mfma_f32_16x16x32_bf16 a[16:19], v[64:67], v[36:39], 0
    v_lshlrev_b32 v241, 1, v241
    v_mfma_f32_16x16x32_bf16 a[144:147], v[36:39], v[80:83], 0
    buffer_load_dwordx4 v25, s[20:23], s65 offen offset:1024 lds
    v_mfma_f32_16x16x32_bf16 a[20:23], v[68:71], v[36:39], 0
    ds_read_b64_tr_b16 v[100:101], v13 offset:16384
    v_or_b32 v240, v240, v241
    v_mfma_f32_16x16x32_bf16 a[148:151], v[36:39], v[84:87], 0
    v_and_b32 v241, 1, v3
    v_mfma_f32_16x16x32_bf16 a[24:27], v[72:75], v[36:39], 0
    ds_read_b64_tr_b16 v[102:103], v13 offset:17408
    v_mfma_f32_16x16x32_bf16 a[152:155], v[36:39], v[88:91], 0
    v_lshlrev_b32 v242, 5, v241
    v_add_u32 v240, v240, v242
    v_mfma_f32_16x16x32_bf16 a[28:31], v[76:79], v[36:39], 0
    buffer_load_dwordx4 v30, s[20:23], s65 offen offset:2048 lds
    v_mfma_f32_16x16x32_bf16 a[156:159], v[36:39], v[92:95], 0
    ds_read_b128 v[36:39], v9 offset:2048
    v_lshlrev_b32 v240, 4, v240
    v_mfma_f32_16x16x32_bf16 a[32:35], v[64:67], v[40:43], 0
    ds_read_b64_tr_b16 v[104:105], v14 offset:16384
    v_mfma_f32_16x16x32_bf16 a[160:163], v[40:43], v[80:83], 0
    v_lshrrev_b32 v243, 1, v3
    v_lshlrev_b32 v244, 10, v243
    v_mfma_f32_16x16x32_bf16 a[36:39], v[68:71], v[40:43], 0
    v_add_u32 v16, v240, v244
    v_mfma_f32_16x16x32_bf16 a[164:167], v[40:43], v[84:87], 0
    ds_read_b64_tr_b16 v[106:107], v14 offset:17408
    buffer_load_dwordx4 v31, s[20:23], s65 offen offset:3072 lds
    v_mfma_f32_16x16x32_bf16 a[40:43], v[72:75], v[40:43], 0
    s_lshl_b32 s58, s46, 5
    v_mfma_f32_16x16x32_bf16 a[168:171], v[40:43], v[88:91], 0
    ds_read_b64_tr_b16 v[108:109], v15 offset:16384
    v_mfma_f32_16x16x32_bf16 a[44:47], v[76:79], v[40:43], 0
    s_sub_u32 s59, 15, s47
    v_mfma_f32_16x16x32_bf16 a[172:175], v[40:43], v[92:95], 0
    ds_read_b128 v[40:43], v9 offset:4096
    s_cmp_lt_u32 s44, 2
    s_cselect_b32 s59, s59, s47
    v_mfma_f32_16x16x32_bf16 a[48:51], v[64:67], v[44:47], 0
    s_add_u32 m0, s45, 147456
    s_add_u32 s65, s33, 256
    buffer_load_dwordx4 v24, s[20:23], s65 offen offset:0 lds
    v_mfma_f32_16x16x32_bf16 a[176:179], v[44:47], v[80:83], 0
    ds_read_b64_tr_b16 v[110:111], v15 offset:17408
    v_mfma_f32_16x16x32_bf16 a[52:55], v[68:71], v[44:47], 0
    v_mfma_f32_16x16x32_bf16 a[180:183], v[44:47], v[84:87], 0
    s_lshl_b32 s59, s59, 1
    v_mfma_f32_16x16x32_bf16 a[56:59], v[72:75], v[44:47], 0
    ds_read_b64_tr_b16 v[112:113], v12 offset:24576
    v_mfma_f32_16x16x32_bf16 a[184:187], v[44:47], v[88:91], 0
    buffer_load_dwordx4 v25, s[20:23], s65 offen offset:1024 lds
    s_add_u32 s58, s58, s59
    v_mfma_f32_16x16x32_bf16 a[60:63], v[76:79], v[44:47], 0
    ds_read_b64_tr_b16 v[114:115], v12 offset:25600
    v_mfma_f32_16x16x32_bf16 a[188:191], v[44:47], v[92:95], 0
    ds_read_b128 v[44:47], v9 offset:6144
    s_lshl_b32 s58, s58, 15
    v_mfma_f32_16x16x32_bf16 a[64:67], v[64:67], v[48:51], 0
    s_add_u32 s58, s58, 0xf00000
    v_mfma_f32_16x16x32_bf16 a[192:195], v[48:51], v[80:83], 0
    s_mul_i32 s59, s46, 0
    v_mfma_f32_16x16x32_bf16 a[68:71], v[68:71], v[48:51], 0
    ds_read_b64_tr_b16 v[116:117], v13 offset:24576
    buffer_load_dwordx4 v30, s[20:23], s65 offen offset:2048 lds
    v_mfma_f32_16x16x32_bf16 a[196:199], v[48:51], v[84:87], 0
    s_add_u32 s58, s58, s59
    v_mfma_f32_16x16x32_bf16 a[72:75], v[72:75], v[48:51], 0
    ds_read_b64_tr_b16 v[118:119], v13 offset:25600
    s_and_b32 s3, s44, 1
    v_mfma_f32_16x16x32_bf16 a[200:203], v[48:51], v[88:91], 0
    s_lshl_b32 s59, s3, 12
    v_mfma_f32_16x16x32_bf16 a[76:79], v[76:79], v[48:51], 0
    s_add_u32 s59, s59, s58
    v_mfma_f32_16x16x32_bf16 a[204:207], v[48:51], v[92:95], 0
    ds_read_b128 v[48:51], v9 offset:8192
    buffer_load_dwordx4 v31, s[20:23], s65 offen offset:3072 lds
    v_mfma_f32_16x16x32_bf16 a[80:83], v[64:67], v[52:55], 0
    ds_read_b64_tr_b16 v[120:121], v14 offset:24576
    v_mfma_f32_16x16x32_bf16 a[208:211], v[52:55], v[80:83], 0
    v_add_u32 v16, s59, v16
    v_add_u32 v240, v2, v242
    v_mfma_f32_16x16x32_bf16 a[84:87], v[68:71], v[52:55], 0
    v_lshlrev_b32 v240, 4, v240
    v_mfma_f32_16x16x32_bf16 a[212:215], v[52:55], v[84:87], 0
    ds_read_b64_tr_b16 v[122:123], v14 offset:25600
    v_lshlrev_b32 v245, 12, v243
    v_mfma_f32_16x16x32_bf16 a[88:91], v[72:75], v[52:55], 0
    s_add_u32 m0, s45, 49152
    s_add_u32 s65, s48, 1048576
    buffer_load_dwordx4 v6, s[28:31], s65 offen offset:0 lds
    v_mfma_f32_16x16x32_bf16 a[216:219], v[52:55], v[88:91], 0
    ds_read_b64_tr_b16 v[124:125], v15 offset:24576
    v_mfma_f32_16x16x32_bf16 a[92:95], v[76:79], v[52:55], 0
    v_mfma_f32_16x16x32_bf16 a[220:223], v[52:55], v[92:95], 0
    ds_read_b128 v[52:55], v9 offset:10240
    v_mfma_f32_16x16x32_bf16 a[96:99], v[64:67], v[56:59], 0
    v_add_u32 v17, v240, v245
    s_lshl_b32 s59, s3, 11
    v_mfma_f32_16x16x32_bf16 a[224:227], v[56:59], v[80:83], 0
    ds_read_b64_tr_b16 v[126:127], v15 offset:25600
    buffer_load_dwordx4 v27, s[28:31], s65 offen offset:1024 lds
    v_mfma_f32_16x16x32_bf16 a[100:103], v[68:71], v[56:59], 0
    s_add_u32 s59, s59, s58
    v_mfma_f32_16x16x32_bf16 a[228:231], v[56:59], v[84:87], 0
    s_add_u32 s59, s59, 16384
    v_mfma_f32_16x16x32_bf16 a[104:107], v[72:75], v[56:59], 0
    v_add_u32 v17, s59, v17
    v_mfma_f32_16x16x32_bf16 a[232:235], v[56:59], v[88:91], 0
    v_add_u32 v18, v240, v244
    s_lshr_b32 s58, s44, 1
    v_mfma_f32_16x16x32_bf16 a[108:111], v[76:79], v[56:59], 0
    buffer_load_dwordx4 v28, s[28:31], s65 offen offset:2048 lds
    v_mfma_f32_16x16x32_bf16 a[236:239], v[56:59], v[92:95], 0
    ds_read_b128 v[56:59], v9 offset:12288
    s_mul_i32 s58, s58, 114688
    v_mfma_f32_16x16x32_bf16 a[112:115], v[64:67], v[60:63], 0
    s_sub_u32 s58, 131072, s58
    v_mfma_f32_16x16x32_bf16 a[240:243], v[60:63], v[80:83], 0
    s_lshl_b32 s59, s3, 12
    v_mfma_f32_16x16x32_bf16 a[116:119], v[68:71], v[60:63], 0
    s_add_u32 s58, s58, s59
    v_add_u32 v18, s58, v18
    v_mfma_f32_16x16x32_bf16 a[244:247], v[60:63], v[84:87], 0
    buffer_load_dwordx4 v29, s[28:31], s65 offen offset:3072 lds
    v_mfma_f32_16x16x32_bf16 a[120:123], v[72:75], v[60:63], 0
    s_mov_b32 s60, 0
    s_mov_b32 s61, 8192
    v_mfma_f32_16x16x32_bf16 a[248:251], v[60:63], v[88:91], 0
    s_mov_b32 s62, 32768
    v_mfma_f32_16x16x32_bf16 a[124:127], v[76:79], v[60:63], 0
    s_mov_b32 s63, 40960
    v_lshlrev_b32 v2, 4, v1
    v_mfma_f32_16x16x32_bf16 a[252:255], v[60:63], v[92:95], 0
    ds_read_b128 v[60:63], v9 offset:14336
    s_waitcnt lgkmcnt(2)
    v_mfma_f32_16x16x32_bf16 a[0:3], v[96:99], v[32:35], a[0:3]
    s_lshl_b32 s51, s2, 2
    v_mfma_f32_16x16x32_bf16 a[128:131], v[32:35], v[112:115], a[128:131]
    s_add_u32 s51, s51, s44
    v_mfma_f32_16x16x32_bf16 a[4:7], v[100:103], v[32:35], a[4:7]
    v_lshlrev_b32 v128, 2, v1
    v_mfma_f32_16x16x32_bf16 a[132:135], v[32:35], v[116:119], a[132:135]
    s_waitcnt vmcnt(16) lgkmcnt(0)
    s_barrier
    v_mfma_f32_16x16x32_bf16 a[8:11], v[104:107], v[32:35], a[8:11]
    ds_read_b64_tr_b16 v[64:65], v12 offset:32768
    v_mfma_f32_16x16x32_bf16 a[136:139], v[32:35], v[120:123], a[136:139]
    s_add_u32 m0, s45, 16384
    s_add_u32 s65, s48, 1310720
    buffer_load_dwordx4 v6, s[28:31], s65 offen offset:0 lds
    v_mfma_f32_16x16x32_bf16 a[12:15], v[108:111], v[32:35], a[12:15]
    ds_read_b64_tr_b16 v[66:67], v12 offset:33792
    v_mfma_f32_16x16x32_bf16 a[140:143], v[32:35], v[124:127], a[140:143]
    ds_read_b128 v[32:35], v8 offset:32768
    v_mfma_f32_16x16x32_bf16 a[16:19], v[96:99], v[36:39], a[16:19]
    v_mfma_f32_16x16x32_bf16 a[144:147], v[36:39], v[112:115], a[144:147]
    buffer_load_dwordx4 v27, s[28:31], s65 offen offset:1024 lds
    v_mfma_f32_16x16x32_bf16 a[20:23], v[100:103], v[36:39], a[20:23]
    ds_read_b64_tr_b16 v[68:69], v13 offset:32768
    v_mfma_f32_16x16x32_bf16 a[148:151], v[36:39], v[116:119], a[148:151]
    v_mfma_f32_16x16x32_bf16 a[24:27], v[104:107], v[36:39], a[24:27]
    ds_read_b64_tr_b16 v[70:71], v13 offset:33792
    v_mfma_f32_16x16x32_bf16 a[152:155], v[36:39], v[120:123], a[152:155]
    v_mov_b32 v129, s51
    v_mfma_f32_16x16x32_bf16 a[28:31], v[108:111], v[36:39], a[28:31]
    buffer_load_dwordx4 v28, s[28:31], s65 offen offset:2048 lds
    v_mfma_f32_16x16x32_bf16 a[156:159], v[36:39], v[124:127], a[156:159]
    ds_read_b128 v[36:39], v8 offset:34816
    v_mfma_f32_16x16x32_bf16 a[32:35], v[96:99], v[40:43], a[32:35]
    ds_read_b64_tr_b16 v[72:73], v14 offset:32768
    v_mfma_f32_16x16x32_bf16 a[160:163], v[40:43], v[112:115], a[160:163]
    v_cmp_eq_u32 vcc, 63, v1
    v_mfma_f32_16x16x32_bf16 a[36:39], v[100:103], v[40:43], a[36:39]
    s_mul_i32 s51, s51, 2560
    v_mfma_f32_16x16x32_bf16 a[164:167], v[40:43], v[116:119], a[164:167]
    ds_read_b64_tr_b16 v[74:75], v14 offset:33792
    buffer_load_dwordx4 v29, s[28:31], s65 offen offset:3072 lds
    v_mfma_f32_16x16x32_bf16 a[40:43], v[104:107], v[40:43], a[40:43]
    v_lshlrev_b32 v129, 3, v129
    v_mfma_f32_16x16x32_bf16 a[168:171], v[40:43], v[120:123], a[168:171]
    ds_read_b64_tr_b16 v[76:77], v15 offset:32768
    v_mfma_f32_16x16x32_bf16 a[44:47], v[108:111], v[40:43], a[44:47]
    v_mov_b32 v158, 0x7ffffff0
    v_mfma_f32_16x16x32_bf16 a[172:175], v[40:43], v[124:127], a[172:175]
    ds_read_b128 v[40:43], v8 offset:36864
    v_mfma_f32_16x16x32_bf16 a[48:51], v[96:99], v[44:47], a[48:51]
    s_add_u32 m0, s45, 65536
    s_add_u32 s65, s32, 384
    buffer_load_dwordx4 v24, s[20:23], s65 offen offset:0 lds
    v_mfma_f32_16x16x32_bf16 a[176:179], v[44:47], v[112:115], a[176:179]
    ds_read_b64_tr_b16 v[78:79], v15 offset:33792
    v_mfma_f32_16x16x32_bf16 a[52:55], v[100:103], v[44:47], a[52:55]
    v_mfma_f32_16x16x32_bf16 a[180:183], v[44:47], v[116:119], a[180:183]
    v_mfma_f32_16x16x32_bf16 a[56:59], v[104:107], v[44:47], a[56:59]
    ds_read_b64_tr_b16 v[80:81], v12 offset:40960
    v_mfma_f32_16x16x32_bf16 a[184:187], v[44:47], v[120:123], a[184:187]
    buffer_load_dwordx4 v25, s[20:23], s65 offen offset:1024 lds
    v_mfma_f32_16x16x32_bf16 a[60:63], v[108:111], v[44:47], a[60:63]
    ds_read_b64_tr_b16 v[82:83], v12 offset:41984
    v_mfma_f32_16x16x32_bf16 a[188:191], v[44:47], v[124:127], a[188:191]
    ds_read_b128 v[44:47], v8 offset:38912
    v_cndmask_b32 v129, v158, v129, vcc
    v_mfma_f32_16x16x32_bf16 a[64:67], v[96:99], v[48:51], a[64:67]
    buffer_load_dword v130, v128, s[36:39], 0 offen offset:0
    v_mfma_f32_16x16x32_bf16 a[192:195], v[48:51], v[112:115], a[192:195]
    buffer_load_dword v131, v128, s[36:39], 0 offen offset:256
    v_mfma_f32_16x16x32_bf16 a[68:71], v[100:103], v[48:51], a[68:71]
    ds_read_b64_tr_b16 v[84:85], v13 offset:40960
    buffer_load_dwordx4 v30, s[20:23], s65 offen offset:2048 lds
    v_mfma_f32_16x16x32_bf16 a[196:199], v[48:51], v[116:119], a[196:199]
    v_mfma_f32_16x16x32_bf16 a[72:75], v[104:107], v[48:51], a[72:75]
    ds_read_b64_tr_b16 v[86:87], v13 offset:41984
    v_mfma_f32_16x16x32_bf16 a[200:203], v[48:51], v[120:123], a[200:203]
    buffer_load_dword v132, v128, s[36:39], 0 offen offset:512
    v_mfma_f32_16x16x32_bf16 a[76:79], v[108:111], v[48:51], a[76:79]
    buffer_load_dword v133, v128, s[36:39], 0 offen offset:768
    v_mfma_f32_16x16x32_bf16 a[204:207], v[48:51], v[124:127], a[204:207]
    ds_read_b128 v[48:51], v8 offset:40960
    buffer_load_dwordx4 v31, s[20:23], s65 offen offset:3072 lds
    v_mfma_f32_16x16x32_bf16 a[80:83], v[96:99], v[52:55], a[80:83]
    ds_read_b64_tr_b16 v[88:89], v14 offset:40960
    v_mfma_f32_16x16x32_bf16 a[208:211], v[52:55], v[112:115], a[208:211]
    v_mfma_f32_16x16x32_bf16 a[84:87], v[100:103], v[52:55], a[84:87]
    buffer_load_dword v134, v128, s[36:39], 0 offen offset:1024
    v_mfma_f32_16x16x32_bf16 a[212:215], v[52:55], v[116:119], a[212:215]
    ds_read_b64_tr_b16 v[90:91], v14 offset:41984
    v_mfma_f32_16x16x32_bf16 a[88:91], v[104:107], v[52:55], a[88:91]
    s_add_u32 m0, s45, 81920
    s_add_u32 s65, s33, 384
    buffer_load_dwordx4 v24, s[20:23], s65 offen offset:0 lds
    v_mfma_f32_16x16x32_bf16 a[216:219], v[52:55], v[120:123], a[216:219]
    ds_read_b64_tr_b16 v[92:93], v15 offset:40960
    v_mfma_f32_16x16x32_bf16 a[92:95], v[108:111], v[52:55], a[92:95]
    v_mfma_f32_16x16x32_bf16 a[220:223], v[52:55], v[124:127], a[220:223]
    ds_read_b128 v[52:55], v8 offset:43008
    v_mfma_f32_16x16x32_bf16 a[96:99], v[96:99], v[56:59], a[96:99]
    buffer_load_dword v135, v128, s[16:19], s51 offen offset:0
    v_mfma_f32_16x16x32_bf16 a[224:227], v[56:59], v[112:115], a[224:227]
    ds_read_b64_tr_b16 v[94:95], v15 offset:41984
    buffer_load_dwordx4 v25, s[20:23], s65 offen offset:1024 lds
    v_mfma_f32_16x16x32_bf16 a[100:103], v[100:103], v[56:59], a[100:103]
    v_mfma_f32_16x16x32_bf16 a[228:231], v[56:59], v[116:119], a[228:231]
    buffer_load_dword v136, v128, s[16:19], s51 offen offset:256
    v_mfma_f32_16x16x32_bf16 a[104:107], v[104:107], v[56:59], a[104:107]
    buffer_load_dword v137, v128, s[16:19], s51 offen offset:512
    v_mfma_f32_16x16x32_bf16 a[232:235], v[56:59], v[120:123], a[232:235]
    buffer_load_dword v138, v128, s[16:19], s51 offen offset:768
    v_mfma_f32_16x16x32_bf16 a[108:111], v[108:111], v[56:59], a[108:111]
    buffer_load_dwordx4 v30, s[20:23], s65 offen offset:2048 lds
    v_mfma_f32_16x16x32_bf16 a[236:239], v[56:59], v[124:127], a[236:239]
    ds_read_b128 v[56:59], v8 offset:45056
    v_mfma_f32_16x16x32_bf16 a[112:115], v[96:99], v[60:63], a[112:115]
    buffer_load_dword v139, v128, s[16:19], s51 offen offset:1024
    v_mfma_f32_16x16x32_bf16 a[240:243], v[60:63], v[112:115], a[240:243]
    buffer_load_dword v140, v128, s[16:19], s51 offen offset:1280
    buffer_load_dword v141, v128, s[16:19], s51 offen offset:1536
    v_mfma_f32_16x16x32_bf16 a[116:119], v[100:103], v[60:63], a[116:119]
    buffer_load_dword v142, v128, s[16:19], s51 offen offset:1792
    v_mfma_f32_16x16x32_bf16 a[244:247], v[60:63], v[116:119], a[244:247]
    buffer_load_dwordx4 v31, s[20:23], s65 offen offset:3072 lds
    v_mfma_f32_16x16x32_bf16 a[120:123], v[104:107], v[60:63], a[120:123]
    buffer_load_dword v143, v128, s[16:19], s51 offen offset:2048
    v_mfma_f32_16x16x32_bf16 a[248:251], v[60:63], v[120:123], a[248:251]
    buffer_load_dword v144, v128, s[16:19], s51 offen offset:2304
    v_mfma_f32_16x16x32_bf16 a[124:127], v[108:111], v[60:63], a[124:127]
    v_add_u32 v129, 0x4800000, v129
    v_mfma_f32_16x16x32_bf16 a[252:255], v[60:63], v[124:127], a[252:255]
    ds_read_b128 v[60:63], v8 offset:47104
    s_waitcnt lgkmcnt(2)
    v_mfma_f32_16x16x32_bf16 a[0:3], v[64:67], v[32:35], a[0:3]
    s_mul_i32 s77, s76, 2560
    v_mfma_f32_16x16x32_bf16 a[128:131], v[32:35], v[80:83], a[128:131]
    v_mfma_f32_16x16x32_bf16 a[4:7], v[68:71], v[32:35], a[4:7]
    buffer_load_dwordx4 v[20:23], v2, s[16:19], s77 offen offset:0
    v_mfma_f32_16x16x32_bf16 a[132:135], v[32:35], v[84:87], a[132:135]
    s_waitcnt vmcnt(40) lgkmcnt(0)
    s_barrier
    v_mfma_f32_16x16x32_bf16 a[8:11], v[72:75], v[32:35], a[8:11]
    ds_read_b64_tr_b16 v[96:97], v12 offset:0
    v_mfma_f32_16x16x32_bf16 a[136:139], v[32:35], v[88:91], a[136:139]
    s_add_u32 m0, s45, 32768
    s_add_u32 s65, s48, 1572864
    buffer_load_dwordx4 v6, s[28:31], s65 offen offset:0 lds
    v_mfma_f32_16x16x32_bf16 a[12:15], v[76:79], v[32:35], a[12:15]
    ds_read_b64_tr_b16 v[98:99], v12 offset:1024
    v_mfma_f32_16x16x32_bf16 a[140:143], v[32:35], v[92:95], a[140:143]
    ds_read_b128 v[32:35], v9 offset:32768
    v_mfma_f32_16x16x32_bf16 a[16:19], v[64:67], v[36:39], a[16:19]
    v_mfma_f32_16x16x32_bf16 a[144:147], v[36:39], v[80:83], a[144:147]
    v_mfma_f32_16x16x32_bf16 a[20:23], v[68:71], v[36:39], a[20:23]
    ds_read_b64_tr_b16 v[100:101], v13 offset:0
    v_mfma_f32_16x16x32_bf16 a[148:151], v[36:39], v[84:87], a[148:151]
    v_mfma_f32_16x16x32_bf16 a[24:27], v[72:75], v[36:39], a[24:27]
    ds_read_b64_tr_b16 v[102:103], v13 offset:1024
    v_mfma_f32_16x16x32_bf16 a[152:155], v[36:39], v[88:91], a[152:155]
    v_mfma_f32_16x16x32_bf16 a[28:31], v[76:79], v[36:39], a[28:31]
    v_mfma_f32_16x16x32_bf16 a[156:159], v[36:39], v[92:95], a[156:159]
    ds_read_b128 v[36:39], v9 offset:34816
    v_mfma_f32_16x16x32_bf16 a[32:35], v[64:67], v[40:43], a[32:35]
    ds_read_b64_tr_b16 v[104:105], v14 offset:0
    v_mfma_f32_16x16x32_bf16 a[160:163], v[40:43], v[80:83], a[160:163]
    v_mfma_f32_16x16x32_bf16 a[36:39], v[68:71], v[40:43], a[36:39]
    v_mfma_f32_16x16x32_bf16 a[164:167], v[40:43], v[84:87], a[164:167]
    ds_read_b64_tr_b16 v[106:107], v14 offset:1024
    buffer_load_dwordx4 v27, s[28:31], s65 offen offset:1024 lds
    v_mfma_f32_16x16x32_bf16 a[40:43], v[72:75], v[40:43], a[40:43]
    v_mfma_f32_16x16x32_bf16 a[168:171], v[40:43], v[88:91], a[168:171]
    ds_read_b64_tr_b16 v[108:109], v15 offset:0
    v_mfma_f32_16x16x32_bf16 a[44:47], v[76:79], v[40:43], a[44:47]
    v_mfma_f32_16x16x32_bf16 a[172:175], v[40:43], v[92:95], a[172:175]
    ds_read_b128 v[40:43], v9 offset:36864
    v_mfma_f32_16x16x32_bf16 a[48:51], v[64:67], v[44:47], a[48:51]
    v_mfma_f32_16x16x32_bf16 a[176:179], v[44:47], v[80:83], a[176:179]
    ds_read_b64_tr_b16 v[110:111], v15 offset:1024
    v_mfma_f32_16x16x32_bf16 a[52:55], v[68:71], v[44:47], a[52:55]
    v_mfma_f32_16x16x32_bf16 a[180:183], v[44:47], v[84:87], a[180:183]
    v_mfma_f32_16x16x32_bf16 a[56:59], v[72:75], v[44:47], a[56:59]
    ds_read_b64_tr_b16 v[112:113], v12 offset:8192
    v_mfma_f32_16x16x32_bf16 a[184:187], v[44:47], v[88:91], a[184:187]
    v_mfma_f32_16x16x32_bf16 a[60:63], v[76:79], v[44:47], a[60:63]
    ds_read_b64_tr_b16 v[114:115], v12 offset:9216
    v_mfma_f32_16x16x32_bf16 a[188:191], v[44:47], v[92:95], a[188:191]
    ds_read_b128 v[44:47], v9 offset:38912
    v_mfma_f32_16x16x32_bf16 a[64:67], v[64:67], v[48:51], a[64:67]
    v_mfma_f32_16x16x32_bf16 a[192:195], v[48:51], v[80:83], a[192:195]
    v_mfma_f32_16x16x32_bf16 a[68:71], v[68:71], v[48:51], a[68:71]
    ds_read_b64_tr_b16 v[116:117], v13 offset:8192
    buffer_load_dwordx4 v28, s[28:31], s65 offen offset:2048 lds
    v_mfma_f32_16x16x32_bf16 a[196:199], v[48:51], v[84:87], a[196:199]
    v_mfma_f32_16x16x32_bf16 a[72:75], v[72:75], v[48:51], a[72:75]
    ds_read_b64_tr_b16 v[118:119], v13 offset:9216
    v_mfma_f32_16x16x32_bf16 a[200:203], v[48:51], v[88:91], a[200:203]
    v_mfma_f32_16x16x32_bf16 a[76:79], v[76:79], v[48:51], a[76:79]
    v_mfma_f32_16x16x32_bf16 a[204:207], v[48:51], v[92:95], a[204:207]
    ds_read_b128 v[48:51], v9 offset:40960
    v_mfma_f32_16x16x32_bf16 a[80:83], v[64:67], v[52:55], a[80:83]
    ds_read_b64_tr_b16 v[120:121], v14 offset:8192
    v_mfma_f32_16x16x32_bf16 a[208:211], v[52:55], v[80:83], a[208:211]
    v_mfma_f32_16x16x32_bf16 a[84:87], v[68:71], v[52:55], a[84:87]
    v_mfma_f32_16x16x32_bf16 a[212:215], v[52:55], v[84:87], a[212:215]
    ds_read_b64_tr_b16 v[122:123], v14 offset:9216
    v_mfma_f32_16x16x32_bf16 a[88:91], v[72:75], v[52:55], a[88:91]
    v_mfma_f32_16x16x32_bf16 a[216:219], v[52:55], v[88:91], a[216:219]
    ds_read_b64_tr_b16 v[124:125], v15 offset:8192
    v_mfma_f32_16x16x32_bf16 a[92:95], v[76:79], v[52:55], a[92:95]
    v_mfma_f32_16x16x32_bf16 a[220:223], v[52:55], v[92:95], a[220:223]
    ds_read_b128 v[52:55], v9 offset:43008
    v_mfma_f32_16x16x32_bf16 a[96:99], v[64:67], v[56:59], a[96:99]
    v_mfma_f32_16x16x32_bf16 a[224:227], v[56:59], v[80:83], a[224:227]
    ds_read_b64_tr_b16 v[126:127], v15 offset:9216
    buffer_load_dwordx4 v29, s[28:31], s65 offen offset:3072 lds
    v_mfma_f32_16x16x32_bf16 a[100:103], v[68:71], v[56:59], a[100:103]
    v_mfma_f32_16x16x32_bf16 a[228:231], v[56:59], v[84:87], a[228:231]
    v_mfma_f32_16x16x32_bf16 a[104:107], v[72:75], v[56:59], a[104:107]
    v_mfma_f32_16x16x32_bf16 a[232:235], v[56:59], v[88:91], a[232:235]
    v_mfma_f32_16x16x32_bf16 a[108:111], v[76:79], v[56:59], a[108:111]
    v_mfma_f32_16x16x32_bf16 a[236:239], v[56:59], v[92:95], a[236:239]
    ds_read_b128 v[56:59], v9 offset:45056
    v_mfma_f32_16x16x32_bf16 a[112:115], v[64:67], v[60:63], a[112:115]
    v_mfma_f32_16x16x32_bf16 a[240:243], v[60:63], v[80:83], a[240:243]
    v_mfma_f32_16x16x32_bf16 a[116:119], v[68:71], v[60:63], a[116:119]
    v_mfma_f32_16x16x32_bf16 a[244:247], v[60:63], v[84:87], a[244:247]
    v_mfma_f32_16x16x32_bf16 a[120:123], v[72:75], v[60:63], a[120:123]
    v_mfma_f32_16x16x32_bf16 a[248:251], v[60:63], v[88:91], a[248:251]
    v_mfma_f32_16x16x32_bf16 a[124:127], v[76:79], v[60:63], a[124:127]
    v_mfma_f32_16x16x32_bf16 a[252:255], v[60:63], v[92:95], a[252:255]
    ds_read_b128 v[60:63], v9 offset:47104
    s_waitcnt lgkmcnt(2)
    v_mfma_f32_16x16x32_bf16 a[0:3], v[96:99], v[32:35], a[0:3]
    buffer_load_dwordx4 v[20:23], v2, s[16:19], s77 offen offset:1024
    v_mfma_f32_16x16x32_bf16 a[128:131], v[32:35], v[112:115], a[128:131]
    v_mfma_f32_16x16x32_bf16 a[4:7], v[100:103], v[32:35], a[4:7]
    buffer_load_dwordx4 v[20:23], v2, s[16:19], s77 offen offset:1536
    v_mfma_f32_16x16x32_bf16 a[132:135], v[32:35], v[116:119], a[132:135]
    s_waitcnt vmcnt(34) lgkmcnt(0)
    s_barrier
    v_mfma_f32_16x16x32_bf16 a[8:11], v[104:107], v[32:35], a[8:11]
    ds_read_b64_tr_b16 v[64:65], v12 offset:49152
    v_mfma_f32_16x16x32_bf16 a[136:139], v[32:35], v[120:123], a[136:139]
    s_add_u32 m0, s45, 0
    s_add_u32 s65, s48, 1835008
    buffer_load_dwordx4 v6, s[28:31], s65 offen offset:0 lds
    v_mfma_f32_16x16x32_bf16 a[12:15], v[108:111], v[32:35], a[12:15]
    ds_read_b64_tr_b16 v[66:67], v12 offset:50176
    v_mfma_f32_16x16x32_bf16 a[140:143], v[32:35], v[124:127], a[140:143]
    ds_read_b128 v[32:35], v10 offset:0
    v_mfma_f32_16x16x32_bf16 a[16:19], v[96:99], v[36:39], a[16:19]
    v_mfma_f32_16x16x32_bf16 a[144:147], v[36:39], v[112:115], a[144:147]
    buffer_load_dwordx4 v27, s[28:31], s65 offen offset:1024 lds
    v_mfma_f32_16x16x32_bf16 a[20:23], v[100:103], v[36:39], a[20:23]
    ds_read_b64_tr_b16 v[68:69], v13 offset:49152
    v_mfma_f32_16x16x32_bf16 a[148:151], v[36:39], v[116:119], a[148:151]
    v_mfma_f32_16x16x32_bf16 a[24:27], v[104:107], v[36:39], a[24:27]
    ds_read_b64_tr_b16 v[70:71], v13 offset:50176
    v_mfma_f32_16x16x32_bf16 a[152:155], v[36:39], v[120:123], a[152:155]
    v_mfma_f32_16x16x32_bf16 a[28:31], v[108:111], v[36:39], a[28:31]
    buffer_load_dwordx4 v28, s[28:31], s65 offen offset:2048 lds
    v_mfma_f32_16x16x32_bf16 a[156:159], v[36:39], v[124:127], a[156:159]
    ds_read_b128 v[36:39], v10 offset:2048
    v_mfma_f32_16x16x32_bf16 a[32:35], v[96:99], v[40:43], a[32:35]
    ds_read_b64_tr_b16 v[72:73], v14 offset:49152
    v_mfma_f32_16x16x32_bf16 a[160:163], v[40:43], v[112:115], a[160:163]
    v_mfma_f32_16x16x32_bf16 a[36:39], v[100:103], v[40:43], a[36:39]
    v_mfma_f32_16x16x32_bf16 a[164:167], v[40:43], v[116:119], a[164:167]
    ds_read_b64_tr_b16 v[74:75], v14 offset:50176
    buffer_load_dwordx4 v29, s[28:31], s65 offen offset:3072 lds
    v_mfma_f32_16x16x32_bf16 a[40:43], v[104:107], v[40:43], a[40:43]
    v_mfma_f32_16x16x32_bf16 a[168:171], v[40:43], v[120:123], a[168:171]
    ds_read_b64_tr_b16 v[76:77], v15 offset:49152
    v_mfma_f32_16x16x32_bf16 a[44:47], v[108:111], v[40:43], a[44:47]
    v_mfma_f32_16x16x32_bf16 a[172:175], v[40:43], v[124:127], a[172:175]
    ds_read_b128 v[40:43], v10 offset:4096
    v_mfma_f32_16x16x32_bf16 a[48:51], v[96:99], v[44:47], a[48:51]
    s_add_u32 m0, s45, 98304
    s_add_u32 s65, s32, 512
    buffer_load_dwordx4 v24, s[20:23], s65 offen offset:0 lds
    v_mfma_f32_16x16x32_bf16 a[176:179], v[44:47], v[112:115], a[176:179]
    ds_read_b64_tr_b16 v[78:79], v15 offset:50176
    v_mfma_f32_16x16x32_bf16 a[52:55], v[100:103], v[44:47], a[52:55]
    v_mfma_f32_16x16x32_bf16 a[180:183], v[44:47], v[116:119], a[180:183]
    v_mfma_f32_16x16x32_bf16 a[56:59], v[104:107], v[44:47], a[56:59]
    ds_read_b64_tr_b16 v[80:81], v12 offset:57344
    v_mfma_f32_16x16x32_bf16 a[184:187], v[44:47], v[120:123], a[184:187]
    buffer_load_dwordx4 v25, s[20:23], s65 offen offset:1024 lds
    v_mfma_f32_16x16x32_bf16 a[60:63], v[108:111], v[44:47], a[60:63]
    ds_read_b64_tr_b16 v[82:83], v12 offset:58368
    v_mfma_f32_16x16x32_bf16 a[188:191], v[44:47], v[124:127], a[188:191]
    ds_read_b128 v[44:47], v10 offset:6144
    v_mfma_f32_16x16x32_bf16 a[64:67], v[96:99], v[48:51], a[64:67]
    v_mfma_f32_16x16x32_bf16 a[192:195], v[48:51], v[112:115], a[192:195]
    v_mfma_f32_16x16x32_bf16 a[68:71], v[100:103], v[48:51], a[68:71]
    ds_read_b64_tr_b16 v[84:85], v13 offset:57344
    buffer_load_dwordx4 v30, s[20:23], s65 offen offset:2048 lds
    v_mfma_f32_16x16x32_bf16 a[196:199], v[48:51], v[116:119], a[196:199]
    v_mfma_f32_16x16x32_bf16 a[72:75], v[104:107], v[48:51], a[72:75]
    ds_read_b64_tr_b16 v[86:87], v13 offset:58368
    v_mfma_f32_16x16x32_bf16 a[200:203], v[48:51], v[120:123], a[200:203]
    v_mfma_f32_16x16x32_bf16 a[76:79], v[108:111], v[48:51], a[76:79]
    v_mfma_f32_16x16x32_bf16 a[204:207], v[48:51], v[124:127], a[204:207]
    ds_read_b128 v[48:51], v10 offset:8192
    buffer_load_dwordx4 v31, s[20:23], s65 offen offset:3072 lds
    v_mfma_f32_16x16x32_bf16 a[80:83], v[96:99], v[52:55], a[80:83]
    ds_read_b64_tr_b16 v[88:89], v14 offset:57344
    v_mfma_f32_16x16x32_bf16 a[208:211], v[52:55], v[112:115], a[208:211]
    v_mfma_f32_16x16x32_bf16 a[84:87], v[100:103], v[52:55], a[84:87]
    v_mfma_f32_16x16x32_bf16 a[212:215], v[52:55], v[116:119], a[212:215]
    ds_read_b64_tr_b16 v[90:91], v14 offset:58368
    v_mfma_f32_16x16x32_bf16 a[88:91], v[104:107], v[52:55], a[88:91]
    s_add_u32 m0, s45, 114688
    s_add_u32 s65, s33, 512
    buffer_load_dwordx4 v24, s[20:23], s65 offen offset:0 lds
    v_mfma_f32_16x16x32_bf16 a[216:219], v[52:55], v[120:123], a[216:219]
    ds_read_b64_tr_b16 v[92:93], v15 offset:57344
    v_mfma_f32_16x16x32_bf16 a[92:95], v[108:111], v[52:55], a[92:95]
    v_mfma_f32_16x16x32_bf16 a[220:223], v[52:55], v[124:127], a[220:223]
    ds_read_b128 v[52:55], v10 offset:10240
    v_mfma_f32_16x16x32_bf16 a[96:99], v[96:99], v[56:59], a[96:99]
    v_mfma_f32_16x16x32_bf16 a[224:227], v[56:59], v[112:115], a[224:227]
    ds_read_b64_tr_b16 v[94:95], v15 offset:58368
    buffer_load_dwordx4 v25, s[20:23], s65 offen offset:1024 lds
    v_mfma_f32_16x16x32_bf16 a[100:103], v[100:103], v[56:59], a[100:103]
    v_mfma_f32_16x16x32_bf16 a[228:231], v[56:59], v[116:119], a[228:231]
    v_mfma_f32_16x16x32_bf16 a[104:107], v[104:107], v[56:59], a[104:107]
    v_mfma_f32_16x16x32_bf16 a[232:235], v[56:59], v[120:123], a[232:235]
    v_mfma_f32_16x16x32_bf16 a[108:111], v[108:111], v[56:59], a[108:111]
    buffer_load_dwordx4 v30, s[20:23], s65 offen offset:2048 lds
    v_mfma_f32_16x16x32_bf16 a[236:239], v[56:59], v[124:127], a[236:239]
    ds_read_b128 v[56:59], v10 offset:12288
    v_mfma_f32_16x16x32_bf16 a[112:115], v[96:99], v[60:63], a[112:115]
    v_mfma_f32_16x16x32_bf16 a[240:243], v[60:63], v[112:115], a[240:243]
    v_mfma_f32_16x16x32_bf16 a[116:119], v[100:103], v[60:63], a[116:119]
    v_mfma_f32_16x16x32_bf16 a[244:247], v[60:63], v[116:119], a[244:247]
    buffer_load_dwordx4 v31, s[20:23], s65 offen offset:3072 lds
    v_mfma_f32_16x16x32_bf16 a[120:123], v[104:107], v[60:63], a[120:123]
    v_mfma_f32_16x16x32_bf16 a[248:251], v[60:63], v[120:123], a[248:251]
    v_mfma_f32_16x16x32_bf16 a[124:127], v[108:111], v[60:63], a[124:127]
    v_mfma_f32_16x16x32_bf16 a[252:255], v[60:63], v[124:127], a[252:255]
    ds_read_b128 v[60:63], v10 offset:14336
    s_waitcnt lgkmcnt(2)
    v_mfma_f32_16x16x32_bf16 a[0:3], v[64:67], v[32:35], a[0:3]
    s_mul_i32 s77, s76, 5120
    v_mfma_f32_16x16x32_bf16 a[128:131], v[32:35], v[80:83], a[128:131]
    v_mfma_f32_16x16x32_bf16 a[4:7], v[68:71], v[32:35], a[4:7]
    buffer_load_dwordx4 v[20:23], v2, s[24:27], s77 offen offset:0
    v_mfma_f32_16x16x32_bf16 a[132:135], v[32:35], v[84:87], a[132:135]
    s_waitcnt vmcnt(43) lgkmcnt(0)
    s_barrier
    v_mfma_f32_16x16x32_bf16 a[8:11], v[72:75], v[32:35], a[8:11]
    ds_read_b64_tr_b16 v[96:97], v12 offset:16384
    v_mfma_f32_16x16x32_bf16 a[136:139], v[32:35], v[88:91], a[136:139]
    s_add_u32 m0, s45, 49152
    s_add_u32 s65, s48, 2097152
    buffer_load_dwordx4 v6, s[28:31], s65 offen offset:0 lds
    v_mfma_f32_16x16x32_bf16 a[12:15], v[76:79], v[32:35], a[12:15]
    ds_read_b64_tr_b16 v[98:99], v12 offset:17408
    v_mfma_f32_16x16x32_bf16 a[140:143], v[32:35], v[92:95], a[140:143]
    ds_read_b128 v[32:35], v11 offset:0
    v_mfma_f32_16x16x32_bf16 a[16:19], v[64:67], v[36:39], a[16:19]
    v_mfma_f32_16x16x32_bf16 a[144:147], v[36:39], v[80:83], a[144:147]
    v_mfma_f32_16x16x32_bf16 a[20:23], v[68:71], v[36:39], a[20:23]
    ds_read_b64_tr_b16 v[100:101], v13 offset:16384
    v_mfma_f32_16x16x32_bf16 a[148:151], v[36:39], v[84:87], a[148:151]
    v_mfma_f32_16x16x32_bf16 a[24:27], v[72:75], v[36:39], a[24:27]
    ds_read_b64_tr_b16 v[102:103], v13 offset:17408
    v_mfma_f32_16x16x32_bf16 a[152:155], v[36:39], v[88:91], a[152:155]
    v_mfma_f32_16x16x32_bf16 a[28:31], v[76:79], v[36:39], a[28:31]
    v_mfma_f32_16x16x32_bf16 a[156:159], v[36:39], v[92:95], a[156:159]
    ds_read_b128 v[36:39], v11 offset:2048
    v_mfma_f32_16x16x32_bf16 a[32:35], v[64:67], v[40:43], a[32:35]
    ds_read_b64_tr_b16 v[104:105], v14 offset:16384
    v_mfma_f32_16x16x32_bf16 a[160:163], v[40:43], v[80:83], a[160:163]
    v_mfma_f32_16x16x32_bf16 a[36:39], v[68:71], v[40:43], a[36:39]
    v_mfma_f32_16x16x32_bf16 a[164:167], v[40:43], v[84:87], a[164:167]
    ds_read_b64_tr_b16 v[106:107], v14 offset:17408
    buffer_load_dwordx4 v27, s[28:31], s65 offen offset:1024 lds
    v_mfma_f32_16x16x32_bf16 a[40:43], v[72:75], v[40:43], a[40:43]
    v_mfma_f32_16x16x32_bf16 a[168:171], v[40:43], v[88:91], a[168:171]
    ds_read_b64_tr_b16 v[108:109], v15 offset:16384
    v_mfma_f32_16x16x32_bf16 a[44:47], v[76:79], v[40:43], a[44:47]
    v_mfma_f32_16x16x32_bf16 a[172:175], v[40:43], v[92:95], a[172:175]
    ds_read_b128 v[40:43], v11 offset:4096
    v_mfma_f32_16x16x32_bf16 a[48:51], v[64:67], v[44:47], a[48:51]
    v_mfma_f32_16x16x32_bf16 a[176:179], v[44:47], v[80:83], a[176:179]
    ds_read_b64_tr_b16 v[110:111], v15 offset:17408
    v_mfma_f32_16x16x32_bf16 a[52:55], v[68:71], v[44:47], a[52:55]
    v_mfma_f32_16x16x32_bf16 a[180:183], v[44:47], v[84:87], a[180:183]
    v_mfma_f32_16x16x32_bf16 a[56:59], v[72:75], v[44:47], a[56:59]
    ds_read_b64_tr_b16 v[112:113], v12 offset:24576
    v_mfma_f32_16x16x32_bf16 a[184:187], v[44:47], v[88:91], a[184:187]
    v_mfma_f32_16x16x32_bf16 a[60:63], v[76:79], v[44:47], a[60:63]
    ds_read_b64_tr_b16 v[114:115], v12 offset:25600
    v_mfma_f32_16x16x32_bf16 a[188:191], v[44:47], v[92:95], a[188:191]
    ds_read_b128 v[44:47], v11 offset:6144
    v_mfma_f32_16x16x32_bf16 a[64:67], v[64:67], v[48:51], a[64:67]
    v_mfma_f32_16x16x32_bf16 a[192:195], v[48:51], v[80:83], a[192:195]
    v_mfma_f32_16x16x32_bf16 a[68:71], v[68:71], v[48:51], a[68:71]
    ds_read_b64_tr_b16 v[116:117], v13 offset:24576
    buffer_load_dwordx4 v28, s[28:31], s65 offen offset:2048 lds
    v_mfma_f32_16x16x32_bf16 a[196:199], v[48:51], v[84:87], a[196:199]
    v_mfma_f32_16x16x32_bf16 a[72:75], v[72:75], v[48:51], a[72:75]
    ds_read_b64_tr_b16 v[118:119], v13 offset:25600
    v_mfma_f32_16x16x32_bf16 a[200:203], v[48:51], v[88:91], a[200:203]
    v_mfma_f32_16x16x32_bf16 a[76:79], v[76:79], v[48:51], a[76:79]
    v_mfma_f32_16x16x32_bf16 a[204:207], v[48:51], v[92:95], a[204:207]
    ds_read_b128 v[48:51], v11 offset:8192
    v_mfma_f32_16x16x32_bf16 a[80:83], v[64:67], v[52:55], a[80:83]
    ds_read_b64_tr_b16 v[120:121], v14 offset:24576
    v_mfma_f32_16x16x32_bf16 a[208:211], v[52:55], v[80:83], a[208:211]
    v_mfma_f32_16x16x32_bf16 a[84:87], v[68:71], v[52:55], a[84:87]
    v_mfma_f32_16x16x32_bf16 a[212:215], v[52:55], v[84:87], a[212:215]
    ds_read_b64_tr_b16 v[122:123], v14 offset:25600
    v_mfma_f32_16x16x32_bf16 a[88:91], v[72:75], v[52:55], a[88:91]
    v_mfma_f32_16x16x32_bf16 a[216:219], v[52:55], v[88:91], a[216:219]
    ds_read_b64_tr_b16 v[124:125], v15 offset:24576
    v_mfma_f32_16x16x32_bf16 a[92:95], v[76:79], v[52:55], a[92:95]
    v_mfma_f32_16x16x32_bf16 a[220:223], v[52:55], v[92:95], a[220:223]
    ds_read_b128 v[52:55], v11 offset:10240
    v_mfma_f32_16x16x32_bf16 a[96:99], v[64:67], v[56:59], a[96:99]
    v_mfma_f32_16x16x32_bf16 a[224:227], v[56:59], v[80:83], a[224:227]
    ds_read_b64_tr_b16 v[126:127], v15 offset:25600
    buffer_load_dwordx4 v29, s[28:31], s65 offen offset:3072 lds
    v_mfma_f32_16x16x32_bf16 a[100:103], v[68:71], v[56:59], a[100:103]
    v_mfma_f32_16x16x32_bf16 a[228:231], v[56:59], v[84:87], a[228:231]
    v_mfma_f32_16x16x32_bf16 a[104:107], v[72:75], v[56:59], a[104:107]
    v_mfma_f32_16x16x32_bf16 a[232:235], v[56:59], v[88:91], a[232:235]
    v_mfma_f32_16x16x32_bf16 a[108:111], v[76:79], v[56:59], a[108:111]
    v_mfma_f32_16x16x32_bf16 a[236:239], v[56:59], v[92:95], a[236:239]
    ds_read_b128 v[56:59], v11 offset:12288
    v_mfma_f32_16x16x32_bf16 a[112:115], v[64:67], v[60:63], a[112:115]
    v_mfma_f32_16x16x32_bf16 a[240:243], v[60:63], v[80:83], a[240:243]
    v_mfma_f32_16x16x32_bf16 a[116:119], v[68:71], v[60:63], a[116:119]
    v_mfma_f32_16x16x32_bf16 a[244:247], v[60:63], v[84:87], a[244:247]
    v_mfma_f32_16x16x32_bf16 a[120:123], v[72:75], v[60:63], a[120:123]
    v_mfma_f32_16x16x32_bf16 a[248:251], v[60:63], v[88:91], a[248:251]
    v_mfma_f32_16x16x32_bf16 a[124:127], v[76:79], v[60:63], a[124:127]
    v_mfma_f32_16x16x32_bf16 a[252:255], v[60:63], v[92:95], a[252:255]
    ds_read_b128 v[60:63], v11 offset:14336
    s_waitcnt lgkmcnt(2)
    v_mfma_f32_16x16x32_bf16 a[0:3], v[96:99], v[32:35], a[0:3]
    v_mfma_f32_16x16x32_bf16 a[128:131], v[32:35], v[112:115], a[128:131]
    v_mov_b32 v238, 1
    s_cmp_lg_u32 s44, 0
    s_cbranch_scc1 main_kernel_noan
    s_mov_b64 exec, 1
    global_atomic_add v7, v238, s[72:73] sc1
    s_mov_b64 exec, -1
main_kernel_noan:
    v_mfma_f32_16x16x32_bf16 a[4:7], v[100:103], v[32:35], a[4:7]
    v_mfma_f32_16x16x32_bf16 a[132:135], v[32:35], v[116:119], a[132:135]
    s_waitcnt vmcnt(19) lgkmcnt(0)
    s_barrier
    v_mfma_f32_16x16x32_bf16 a[8:11], v[104:107], v[32:35], a[8:11]
    ds_read_b64_tr_b16 v[64:65], v12 offset:32768
    v_mfma_f32_16x16x32_bf16 a[136:139], v[32:35], v[120:123], a[136:139]
    s_add_u32 m0, s45, 16384
    s_add_u32 s65, s48, 2359296
    buffer_load_dwordx4 v6, s[28:31], s65 offen offset:0 lds
    v_mfma_f32_16x16x32_bf16 a[12:15], v[108:111], v[32:35], a[12:15]
    ds_read_b64_tr_b16 v[66:67], v12 offset:33792
    v_mfma_f32_16x16x32_bf16 a[140:143], v[32:35], v[124:127], a[140:143]
    ds_read_b128 v[32:35], v8 offset:0
    v_mfma_f32_16x16x32_bf16 a[16:19], v[96:99], v[36:39], a[16:19]
    v_mfma_f32_16x16x32_bf16 a[144:147], v[36:39], v[112:115], a[144:147]
    buffer_load_dwordx4 v27, s[28:31], s65 offen offset:1024 lds
    v_mfma_f32_16x16x32_bf16 a[20:23], v[100:103], v[36:39], a[20:23]
    ds_read_b64_tr_b16 v[68:69], v13 offset:32768
    v_mfma_f32_16x16x32_bf16 a[148:151], v[36:39], v[116:119], a[148:151]
    v_mfma_f32_16x16x32_bf16 a[24:27], v[104:107], v[36:39], a[24:27]
    ds_read_b64_tr_b16 v[70:71], v13 offset:33792
    v_mfma_f32_16x16x32_bf16 a[152:155], v[36:39], v[120:123], a[152:155]
    v_mfma_f32_16x16x32_bf16 a[28:31], v[108:111], v[36:39], a[28:31]
    buffer_load_dwordx4 v28, s[28:31], s65 offen offset:2048 lds
    v_mfma_f32_16x16x32_bf16 a[156:159], v[36:39], v[124:127], a[156:159]
    ds_read_b128 v[36:39], v8 offset:2048
    v_mfma_f32_16x16x32_bf16 a[32:35], v[96:99], v[40:43], a[32:35]
    ds_read_b64_tr_b16 v[72:73], v14 offset:32768
    v_mfma_f32_16x16x32_bf16 a[160:163], v[40:43], v[112:115], a[160:163]
    v_mfma_f32_16x16x32_bf16 a[36:39], v[100:103], v[40:43], a[36:39]
    v_mfma_f32_16x16x32_bf16 a[164:167], v[40:43], v[116:119], a[164:167]
    ds_read_b64_tr_b16 v[74:75], v14 offset:33792
    buffer_load_dwordx4 v29, s[28:31], s65 offen offset:3072 lds
    v_mfma_f32_16x16x32_bf16 a[40:43], v[104:107], v[40:43], a[40:43]
    v_mfma_f32_16x16x32_bf16 a[168:171], v[40:43], v[120:123], a[168:171]
    ds_read_b64_tr_b16 v[76:77], v15 offset:32768
    v_mfma_f32_16x16x32_bf16 a[44:47], v[108:111], v[40:43], a[44:47]
    v_mfma_f32_16x16x32_bf16 a[172:175], v[40:43], v[124:127], a[172:175]
    ds_read_b128 v[40:43], v8 offset:4096
    v_mfma_f32_16x16x32_bf16 a[48:51], v[96:99], v[44:47], a[48:51]
    s_add_u32 m0, s45, 131072
    s_add_u32 s65, s32, 640
    buffer_load_dwordx4 v24, s[20:23], s65 offen offset:0 lds
    v_mfma_f32_16x16x32_bf16 a[176:179], v[44:47], v[112:115], a[176:179]
    ds_read_b64_tr_b16 v[78:79], v15 offset:33792
    v_mfma_f32_16x16x32_bf16 a[52:55], v[100:103], v[44:47], a[52:55]
    v_mfma_f32_16x16x32_bf16 a[180:183], v[44:47], v[116:119], a[180:183]
    v_mfma_f32_16x16x32_bf16 a[56:59], v[104:107], v[44:47], a[56:59]
    ds_read_b64_tr_b16 v[80:81], v12 offset:40960
    v_mfma_f32_16x16x32_bf16 a[184:187], v[44:47], v[120:123], a[184:187]
    buffer_load_dwordx4 v25, s[20:23], s65 offen offset:1024 lds
    v_mfma_f32_16x16x32_bf16 a[60:63], v[108:111], v[44:47], a[60:63]
    ds_read_b64_tr_b16 v[82:83], v12 offset:41984
    v_mfma_f32_16x16x32_bf16 a[188:191], v[44:47], v[124:127], a[188:191]
    ds_read_b128 v[44:47], v8 offset:6144
    v_mfma_f32_16x16x32_bf16 a[64:67], v[96:99], v[48:51], a[64:67]
    v_mfma_f32_16x16x32_bf16 a[192:195], v[48:51], v[112:115], a[192:195]
    v_mfma_f32_16x16x32_bf16 a[68:71], v[100:103], v[48:51], a[68:71]
    ds_read_b64_tr_b16 v[84:85], v13 offset:40960
    buffer_load_dwordx4 v30, s[20:23], s65 offen offset:2048 lds
    v_mfma_f32_16x16x32_bf16 a[196:199], v[48:51], v[116:119], a[196:199]
    v_mfma_f32_16x16x32_bf16 a[72:75], v[104:107], v[48:51], a[72:75]
    ds_read_b64_tr_b16 v[86:87], v13 offset:41984
    v_mfma_f32_16x16x32_bf16 a[200:203], v[48:51], v[120:123], a[200:203]
    v_mfma_f32_16x16x32_bf16 a[76:79], v[108:111], v[48:51], a[76:79]
    v_mfma_f32_16x16x32_bf16 a[204:207], v[48:51], v[124:127], a[204:207]
    ds_read_b128 v[48:51], v8 offset:8192
    buffer_load_dwordx4 v31, s[20:23], s65 offen offset:3072 lds
    v_mfma_f32_16x16x32_bf16 a[80:83], v[96:99], v[52:55], a[80:83]
    ds_read_b64_tr_b16 v[88:89], v14 offset:40960
    v_mfma_f32_16x16x32_bf16 a[208:211], v[52:55], v[112:115], a[208:211]
    v_mfma_f32_16x16x32_bf16 a[84:87], v[100:103], v[52:55], a[84:87]
    v_mfma_f32_16x16x32_bf16 a[212:215], v[52:55], v[116:119], a[212:215]
    ds_read_b64_tr_b16 v[90:91], v14 offset:41984
    v_mfma_f32_16x16x32_bf16 a[88:91], v[104:107], v[52:55], a[88:91]
    s_add_u32 m0, s45, 147456
    s_add_u32 s65, s33, 640
    buffer_load_dwordx4 v24, s[20:23], s65 offen offset:0 lds
    v_mfma_f32_16x16x32_bf16 a[216:219], v[52:55], v[120:123], a[216:219]
    ds_read_b64_tr_b16 v[92:93], v15 offset:40960
    v_mfma_f32_16x16x32_bf16 a[92:95], v[108:111], v[52:55], a[92:95]
    v_mfma_f32_16x16x32_bf16 a[220:223], v[52:55], v[124:127], a[220:223]
    ds_read_b128 v[52:55], v8 offset:10240
    v_mfma_f32_16x16x32_bf16 a[96:99], v[96:99], v[56:59], a[96:99]
    v_mfma_f32_16x16x32_bf16 a[224:227], v[56:59], v[112:115], a[224:227]
    ds_read_b64_tr_b16 v[94:95], v15 offset:41984
    buffer_load_dwordx4 v25, s[20:23], s65 offen offset:1024 lds
    v_mfma_f32_16x16x32_bf16 a[100:103], v[100:103], v[56:59], a[100:103]
    v_mfma_f32_16x16x32_bf16 a[228:231], v[56:59], v[116:119], a[228:231]
    v_mfma_f32_16x16x32_bf16 a[104:107], v[104:107], v[56:59], a[104:107]
    v_mfma_f32_16x16x32_bf16 a[232:235], v[56:59], v[120:123], a[232:235]
    v_mfma_f32_16x16x32_bf16 a[108:111], v[108:111], v[56:59], a[108:111]
    buffer_load_dwordx4 v30, s[20:23], s65 offen offset:2048 lds
    v_mfma_f32_16x16x32_bf16 a[236:239], v[56:59], v[124:127], a[236:239]
    ds_read_b128 v[56:59], v8 offset:12288
    v_mfma_f32_16x16x32_bf16 a[112:115], v[96:99], v[60:63], a[112:115]
    v_mfma_f32_16x16x32_bf16 a[240:243], v[60:63], v[112:115], a[240:243]
    v_mfma_f32_16x16x32_bf16 a[116:119], v[100:103], v[60:63], a[116:119]
    v_mfma_f32_16x16x32_bf16 a[244:247], v[60:63], v[116:119], a[244:247]
    buffer_load_dwordx4 v31, s[20:23], s65 offen offset:3072 lds
    v_mfma_f32_16x16x32_bf16 a[120:123], v[104:107], v[60:63], a[120:123]
    buffer_load_dwordx4 v[20:23], v2, s[24:27], s77 offen offset:1024
    v_mfma_f32_16x16x32_bf16 a[248:251], v[60:63], v[120:123], a[248:251]
    buffer_load_dwordx4 v[20:23], v2, s[24:27], s77 offen offset:2048
    v_mfma_f32_16x16x32_bf16 a[124:127], v[108:111], v[60:63], a[124:127]
    v_mfma_f32_16x16x32_bf16 a[252:255], v[60:63], v[124:127], a[252:255]
    ds_read_b128 v[60:63], v8 offset:14336
    s_waitcnt lgkmcnt(2)
    v_mfma_f32_16x16x32_bf16 a[0:3], v[64:67], v[32:35], a[0:3]
    buffer_load_dwordx4 v[20:23], v2, s[24:27], s77 offen offset:3072
    v_mfma_f32_16x16x32_bf16 a[128:131], v[32:35], v[80:83], a[128:131]
    s_add_u32 s77, s77, 4096
    buffer_load_dwordx4 v[20:23], v2, s[24:27], s77 offen offset:0
    v_mfma_f32_16x16x32_bf16 a[4:7], v[68:71], v[32:35], a[4:7]
    v_lshlrev_b32 v145, 16, v130
    v_mfma_f32_16x16x32_bf16 a[132:135], v[32:35], v[84:87], a[132:135]
    s_waitcnt vmcnt(29) lgkmcnt(0)
    s_barrier
    v_mfma_f32_16x16x32_bf16 a[8:11], v[72:75], v[32:35], a[8:11]
    ds_read_b64_tr_b16 v[96:97], v12 offset:0
    v_mfma_f32_16x16x32_bf16 a[136:139], v[32:35], v[88:91], a[136:139]
    s_add_u32 m0, s45, 32768
    s_add_u32 s65, s48, 2621440
    buffer_load_dwordx4 v6, s[28:31], s65 offen offset:0 lds
    v_mfma_f32_16x16x32_bf16 a[12:15], v[76:79], v[32:35], a[12:15]
    ds_read_b64_tr_b16 v[98:99], v12 offset:1024
    v_mfma_f32_16x16x32_bf16 a[140:143], v[32:35], v[92:95], a[140:143]
    ds_read_b128 v[32:35], v9 offset:0
    v_mfma_f32_16x16x32_bf16 a[16:19], v[64:67], v[36:39], a[16:19]
    v_and_b32 v146, s50, v130
    v_mfma_f32_16x16x32_bf16 a[144:147], v[36:39], v[80:83], a[144:147]
    v_lshlrev_b32 v147, 16, v131
    v_mfma_f32_16x16x32_bf16 a[20:23], v[68:71], v[36:39], a[20:23]
    ds_read_b64_tr_b16 v[100:101], v13 offset:0
    v_and_b32 v148, s50, v131
    v_mfma_f32_16x16x32_bf16 a[148:151], v[36:39], v[84:87], a[148:151]
    v_lshlrev_b32 v149, 16, v132
    v_mfma_f32_16x16x32_bf16 a[24:27], v[72:75], v[36:39], a[24:27]
    ds_read_b64_tr_b16 v[102:103], v13 offset:1024
    v_and_b32 v150, s50, v132
    v_mfma_f32_16x16x32_bf16 a[152:155], v[36:39], v[88:91], a[152:155]
    v_lshlrev_b32 v151, 16, v133
    v_mfma_f32_16x16x32_bf16 a[28:31], v[76:79], v[36:39], a[28:31]
    v_and_b32 v152, s50, v133
    v_lshlrev_b32 v153, 16, v134
    v_mfma_f32_16x16x32_bf16 a[156:159], v[36:39], v[92:95], a[156:159]
    ds_read_b128 v[36:39], v9 offset:2048
    v_mfma_f32_16x16x32_bf16 a[32:35], v[64:67], v[40:43], a[32:35]
    ds_read_b64_tr_b16 v[104:105], v14 offset:0
    v_and_b32 v154, s50, v134
    v_mfma_f32_16x16x32_bf16 a[160:163], v[40:43], v[80:83], a[160:163]
    v_lshlrev_b32 v158, 16, v135
    v_mfma_f32_16x16x32_bf16 a[36:39], v[68:71], v[40:43], a[36:39]
    v_and_b32 v159, s50, v135
    v_mul_f32 v158, v158, v145
    v_mfma_f32_16x16x32_bf16 a[164:167], v[40:43], v[84:87], a[164:167]
    ds_read_b64_tr_b16 v[106:107], v14 offset:1024
    buffer_load_dwordx4 v27, s[28:31], s65 offen offset:1024 lds
    v_mfma_f32_16x16x32_bf16 a[40:43], v[72:75], v[40:43], a[40:43]
    v_mul_f32 v159, v159, v146
    v_mfma_f32_16x16x32_bf16 a[168:171], v[40:43], v[88:91], a[168:171]
    ds_read_b64_tr_b16 v[108:109], v15 offset:0
    v_mfma_f32_16x16x32_bf16 a[44:47], v[76:79], v[40:43], a[44:47]
    v_cvt_pk_bf16_f32 v160, v158, v159
    v_lshlrev_b32 v158, 16, v160
    v_mfma_f32_16x16x32_bf16 a[172:175], v[40:43], v[92:95], a[172:175]
    ds_read_b128 v[40:43], v9 offset:4096
    v_mfma_f32_16x16x32_bf16 a[48:51], v[64:67], v[44:47], a[48:51]
    v_and_b32 v159, s50, v160
    v_add_f32 v156, v158, v159
    v_mfma_f32_16x16x32_bf16 a[176:179], v[44:47], v[80:83], a[176:179]
    ds_read_b64_tr_b16 v[110:111], v15 offset:1024
    v_mfma_f32_16x16x32_bf16 a[52:55], v[68:71], v[44:47], a[52:55]
    v_lshlrev_b32 v158, 16, v136
    v_and_b32 v159, s50, v136
    v_mfma_f32_16x16x32_bf16 a[180:183], v[44:47], v[84:87], a[180:183]
    v_mul_f32 v158, v158, v147
    v_mfma_f32_16x16x32_bf16 a[56:59], v[72:75], v[44:47], a[56:59]
    ds_read_b64_tr_b16 v[112:113], v12 offset:8192
    v_mul_f32 v159, v159, v148
    v_mfma_f32_16x16x32_bf16 a[184:187], v[44:47], v[88:91], a[184:187]
    v_cvt_pk_bf16_f32 v160, v158, v159
    v_mfma_f32_16x16x32_bf16 a[60:63], v[76:79], v[44:47], a[60:63]
    ds_read_b64_tr_b16 v[114:115], v12 offset:9216
    v_lshlrev_b32 v158, 16, v160
    v_mfma_f32_16x16x32_bf16 a[188:191], v[44:47], v[92:95], a[188:191]
    ds_read_b128 v[44:47], v9 offset:6144
    v_mfma_f32_16x16x32_bf16 a[64:67], v[64:67], v[48:51], a[64:67]
    v_and_b32 v159, s50, v160
    v_add_f32 v156, v156, v158
    v_mfma_f32_16x16x32_bf16 a[192:195], v[48:51], v[80:83], a[192:195]
    v_add_f32 v156, v156, v159
    v_mfma_f32_16x16x32_bf16 a[68:71], v[68:71], v[48:51], a[68:71]
    ds_read_b64_tr_b16 v[116:117], v13 offset:8192
    buffer_load_dwordx4 v28, s[28:31], s65 offen offset:2048 lds
    v_mfma_f32_16x16x32_bf16 a[196:199], v[48:51], v[84:87], a[196:199]
    v_lshlrev_b32 v158, 16, v137
    v_mfma_f32_16x16x32_bf16 a[72:75], v[72:75], v[48:51], a[72:75]
    ds_read_b64_tr_b16 v[118:119], v13 offset:9216
    v_and_b32 v159, s50, v137
    v_mfma_f32_16x16x32_bf16 a[200:203], v[48:51], v[88:91], a[200:203]
    v_mul_f32 v158, v158, v149
    v_mfma_f32_16x16x32_bf16 a[76:79], v[76:79], v[48:51], a[76:79]
    v_mul_f32 v159, v159, v150
    v_cvt_pk_bf16_f32 v160, v158, v159
    v_mfma_f32_16x16x32_bf16 a[204:207], v[48:51], v[92:95], a[204:207]
    ds_read_b128 v[48:51], v9 offset:8192
    v_mfma_f32_16x16x32_bf16 a[80:83], v[64:67], v[52:55], a[80:83]
    ds_read_b64_tr_b16 v[120:121], v14 offset:8192
    v_lshlrev_b32 v158, 16, v160
    v_mfma_f32_16x16x32_bf16 a[208:211], v[52:55], v[80:83], a[208:211]
    v_and_b32 v159, s50, v160
    v_mfma_f32_16x16x32_bf16 a[84:87], v[68:71], v[52:55], a[84:87]
    v_add_f32 v156, v156, v158
    v_add_f32 v156, v156, v159
    v_mfma_f32_16x16x32_bf16 a[212:215], v[52:55], v[84:87], a[212:215]
    ds_read_b64_tr_b16 v[122:123], v14 offset:9216
    v_mfma_f32_16x16x32_bf16 a[88:91], v[72:75], v[52:55], a[88:91]
    v_lshlrev_b32 v158, 16, v138
    v_and_b32 v159, s50, v138
    v_mfma_f32_16x16x32_bf16 a[216:219], v[52:55], v[88:91], a[216:219]
    ds_read_b64_tr_b16 v[124:125], v15 offset:8192
    v_mfma_f32_16x16x32_bf16 a[92:95], v[76:79], v[52:55], a[92:95]
    v_mul_f32 v158, v158, v151
    v_mul_f32 v159, v159, v152
    v_mfma_f32_16x16x32_bf16 a[220:223], v[52:55], v[92:95], a[220:223]
    ds_read_b128 v[52:55], v9 offset:10240
    v_mfma_f32_16x16x32_bf16 a[96:99], v[64:67], v[56:59], a[96:99]
    v_cvt_pk_bf16_f32 v160, v158, v159
    v_lshlrev_b32 v158, 16, v160
    v_mfma_f32_16x16x32_bf16 a[224:227], v[56:59], v[80:83], a[224:227]
    ds_read_b64_tr_b16 v[126:127], v15 offset:9216
    buffer_load_dwordx4 v29, s[28:31], s65 offen offset:3072 lds
    v_mfma_f32_16x16x32_bf16 a[100:103], v[68:71], v[56:59], a[100:103]
    v_and_b32 v159, s50, v160
    v_mfma_f32_16x16x32_bf16 a[228:231], v[56:59], v[84:87], a[228:231]
    v_add_f32 v156, v156, v158
    v_mfma_f32_16x16x32_bf16 a[104:107], v[72:75], v[56:59], a[104:107]
    v_add_f32 v156, v156, v159
    v_lshlrev_b32 v158, 16, v139
    v_mfma_f32_16x16x32_bf16 a[232:235], v[56:59], v[88:91], a[232:235]
    v_and_b32 v159, s50, v139
    v_mfma_f32_16x16x32_bf16 a[108:111], v[76:79], v[56:59], a[108:111]
    v_mul_f32 v158, v158, v153
    v_mul_f32 v159, v159, v154
    v_mfma_f32_16x16x32_bf16 a[236:239], v[56:59], v[92:95], a[236:239]
    ds_read_b128 v[56:59], v9 offset:12288
    v_mfma_f32_16x16x32_bf16 a[112:115], v[64:67], v[60:63], a[112:115]
    v_cvt_pk_bf16_f32 v160, v158, v159
    v_lshlrev_b32 v158, 16, v160
    v_mfma_f32_16x16x32_bf16 a[240:243], v[60:63], v[80:83], a[240:243]
    v_and_b32 v159, s50, v160
    v_mfma_f32_16x16x32_bf16 a[116:119], v[68:71], v[60:63], a[116:119]
    v_add_f32 v156, v156, v158
    v_add_f32 v156, v156, v159
    v_mfma_f32_16x16x32_bf16 a[244:247], v[60:63], v[84:87], a[244:247]
    v_lshlrev_b32 v158, 16, v140
    v_mfma_f32_16x16x32_bf16 a[120:123], v[72:75], v[60:63], a[120:123]
    v_and_b32 v159, s50, v140
    v_mul_f32 v158, v158, v145
    v_mfma_f32_16x16x32_bf16 a[248:251], v[60:63], v[88:91], a[248:251]
    v_mul_f32 v159, v159, v146
    v_mfma_f32_16x16x32_bf16 a[124:127], v[76:79], v[60:63], a[124:127]
    v_cvt_pk_bf16_f32 v160, v158, v159
    v_lshlrev_b32 v158, 16, v160
    v_mfma_f32_16x16x32_bf16 a[252:255], v[60:63], v[92:95], a[252:255]
    ds_read_b128 v[60:63], v9 offset:14336
    s_waitcnt lgkmcnt(2)
    v_mfma_f32_16x16x32_bf16 a[0:3], v[96:99], v[32:35], a[0:3]
    v_and_b32 v159, s50, v160
    v_add_f32 v157, v158, v159
    v_mfma_f32_16x16x32_bf16 a[128:131], v[32:35], v[112:115], a[128:131]
    v_lshlrev_b32 v158, 16, v141
    v_and_b32 v159, s50, v141
    v_mfma_f32_16x16x32_bf16 a[4:7], v[100:103], v[32:35], a[4:7]
    v_mul_f32 v158, v158, v147
    v_mfma_f32_16x16x32_bf16 a[132:135], v[32:35], v[116:119], a[132:135]
    s_waitcnt vmcnt(20) lgkmcnt(0)
    s_barrier
    v_mfma_f32_16x16x32_bf16 a[8:11], v[104:107], v[32:35], a[8:11]
    ds_read_b64_tr_b16 v[64:65], v12 offset:49152
    v_mul_f32 v159, v159, v148
    v_mfma_f32_16x16x32_bf16 a[136:139], v[32:35], v[120:123], a[136:139]
    s_add_u32 m0, s45, 0
    s_add_u32 s65, s48, 2883584
    buffer_load_dwordx4 v6, s[28:31], s65 offen offset:0 lds
    v_mfma_f32_16x16x32_bf16 a[12:15], v[108:111], v[32:35], a[12:15]
    ds_read_b64_tr_b16 v[66:67], v12 offset:50176
    v_mfma_f32_16x16x32_bf16 a[140:143], v[32:35], v[124:127], a[140:143]
    ds_read_b128 v[32:35], v8 offset:32768
    v_cvt_pk_bf16_f32 v160, v158, v159
    v_mfma_f32_16x16x32_bf16 a[16:19], v[96:99], v[36:39], a[16:19]
    v_lshlrev_b32 v158, 16, v160
    v_mfma_f32_16x16x32_bf16 a[144:147], v[36:39], v[112:115], a[144:147]
    buffer_load_dwordx4 v27, s[28:31], s65 offen offset:1024 lds
    v_and_b32 v159, s50, v160
    v_mfma_f32_16x16x32_bf16 a[20:23], v[100:103], v[36:39], a[20:23]
    ds_read_b64_tr_b16 v[68:69], v13 offset:49152
    v_add_f32 v157, v157, v158
    v_mfma_f32_16x16x32_bf16 a[148:151], v[36:39], v[116:119], a[148:151]
    v_add_f32 v157, v157, v159
    v_lshlrev_b32 v158, 16, v142
    v_mfma_f32_16x16x32_bf16 a[24:27], v[104:107], v[36:39], a[24:27]
    ds_read_b64_tr_b16 v[70:71], v13 offset:50176
    v_and_b32 v159, s50, v142
    v_mfma_f32_16x16x32_bf16 a[152:155], v[36:39], v[120:123], a[152:155]
    v_mul_f32 v158, v158, v149
    v_mul_f32 v159, v159, v150
    v_mfma_f32_16x16x32_bf16 a[28:31], v[108:111], v[36:39], a[28:31]
    buffer_load_dwordx4 v28, s[28:31], s65 offen offset:2048 lds
    v_mfma_f32_16x16x32_bf16 a[156:159], v[36:39], v[124:127], a[156:159]
    ds_read_b128 v[36:39], v8 offset:34816
    v_cvt_pk_bf16_f32 v160, v158, v159
    v_mfma_f32_16x16x32_bf16 a[32:35], v[96:99], v[40:43], a[32:35]
    ds_read_b64_tr_b16 v[72:73], v14 offset:49152
    v_lshlrev_b32 v158, 16, v160
    v_mfma_f32_16x16x32_bf16 a[160:163], v[40:43], v[112:115], a[160:163]
    v_and_b32 v159, s50, v160
    v_add_f32 v157, v157, v158
    v_mfma_f32_16x16x32_bf16 a[36:39], v[100:103], v[40:43], a[36:39]
    v_add_f32 v157, v157, v159
    v_lshlrev_b32 v158, 16, v143
    v_mfma_f32_16x16x32_bf16 a[164:167], v[40:43], v[116:119], a[164:167]
    ds_read_b64_tr_b16 v[74:75], v14 offset:50176
    buffer_load_dwordx4 v29, s[28:31], s65 offen offset:3072 lds
    v_mfma_f32_16x16x32_bf16 a[40:43], v[104:107], v[40:43], a[40:43]
    v_and_b32 v159, s50, v143
    v_mfma_f32_16x16x32_bf16 a[168:171], v[40:43], v[120:123], a[168:171]
    ds_read_b64_tr_b16 v[76:77], v15 offset:49152
    v_mul_f32 v158, v158, v151
    v_mfma_f32_16x16x32_bf16 a[44:47], v[108:111], v[40:43], a[44:47]
    v_mul_f32 v159, v159, v152
    v_cvt_pk_bf16_f32 v160, v158, v159
    v_mfma_f32_16x16x32_bf16 a[172:175], v[40:43], v[124:127], a[172:175]
    ds_read_b128 v[40:43], v8 offset:36864
    v_lshlrev_b32 v158, 16, v160
    v_mfma_f32_16x16x32_bf16 a[48:51], v[96:99], v[44:47], a[48:51]
    s_add_u32 m0, s45, 65536
    s_add_u32 s65, s32, 768
    buffer_load_dwordx4 v24, s[20:23], s65 offen offset:0 lds
    v_mfma_f32_16x16x32_bf16 a[176:179], v[44:47], v[112:115], a[176:179]
    ds_read_b64_tr_b16 v[78:79], v15 offset:50176
    v_mfma_f32_16x16x32_bf16 a[52:55], v[100:103], v[44:47], a[52:55]
    v_and_b32 v159, s50, v160
    v_mfma_f32_16x16x32_bf16 a[180:183], v[44:47], v[116:119], a[180:183]
    v_add_f32 v157, v157, v158
    v_add_f32 v157, v157, v159
    v_mfma_f32_16x16x32_bf16 a[56:59], v[104:107], v[44:47], a[56:59]
    ds_read_b64_tr_b16 v[80:81], v12 offset:57344
    v_lshlrev_b32 v158, 16, v144
    v_mfma_f32_16x16x32_bf16 a[184:187], v[44:47], v[120:123], a[184:187]
    buffer_load_dwordx4 v25, s[20:23], s65 offen offset:1024 lds
    v_and_b32 v159, s50, v144
    v_mfma_f32_16x16x32_bf16 a[60:63], v[108:111], v[44:47], a[60:63]
    ds_read_b64_tr_b16 v[82:83], v12 offset:58368
    v_mul_f32 v158, v158, v153
    v_mfma_f32_16x16x32_bf16 a[188:191], v[44:47], v[124:127], a[188:191]
    ds_read_b128 v[44:47], v8 offset:38912
    v_mul_f32 v159, v159, v154
    v_mfma_f32_16x16x32_bf16 a[64:67], v[96:99], v[48:51], a[64:67]
    v_cvt_pk_bf16_f32 v160, v158, v159
    v_mfma_f32_16x16x32_bf16 a[192:195], v[48:51], v[112:115], a[192:195]
    v_lshlrev_b32 v158, 16, v160
    v_and_b32 v159, s50, v160
    v_mfma_f32_16x16x32_bf16 a[68:71], v[100:103], v[48:51], a[68:71]
    ds_read_b64_tr_b16 v[84:85], v13 offset:57344
    buffer_load_dwordx4 v30, s[20:23], s65 offen offset:2048 lds
    v_mfma_f32_16x16x32_bf16 a[196:199], v[48:51], v[116:119], a[196:199]
    v_add_f32 v157, v157, v158
    v_add_f32 v157, v157, v159
    v_mfma_f32_16x16x32_bf16 a[72:75], v[104:107], v[48:51], a[72:75]
    ds_read_b64_tr_b16 v[86:87], v13 offset:58368
    v_mfma_f32_16x16x32_bf16 a[200:203], v[48:51], v[120:123], a[200:203]
    s_nop 1
    v_add_f32_dpp v156, v156, v156 row_shr:1 bound_ctrl:0
    v_add_f32_dpp v157, v157, v157 row_shr:1 bound_ctrl:0
    v_mfma_f32_16x16x32_bf16 a[76:79], v[108:111], v[48:51], a[76:79]
    v_mfma_f32_16x16x32_bf16 a[204:207], v[48:51], v[124:127], a[204:207]
    ds_read_b128 v[48:51], v8 offset:40960
    buffer_load_dwordx4 v31, s[20:23], s65 offen offset:3072 lds
    v_mfma_f32_16x16x32_bf16 a[80:83], v[96:99], v[52:55], a[80:83]
    ds_read_b64_tr_b16 v[88:89], v14 offset:57344
    s_nop 1
    v_add_f32_dpp v156, v156, v156 row_shr:2 bound_ctrl:0
    v_add_f32_dpp v157, v157, v157 row_shr:2 bound_ctrl:0
    v_mfma_f32_16x16x32_bf16 a[208:211], v[52:55], v[112:115], a[208:211]
    v_mfma_f32_16x16x32_bf16 a[84:87], v[100:103], v[52:55], a[84:87]
    s_nop 1
    v_add_f32_dpp v156, v156, v156 row_shr:4 bound_ctrl:0
    v_add_f32_dpp v157, v157, v157 row_shr:4 bound_ctrl:0
    v_mfma_f32_16x16x32_bf16 a[212:215], v[52:55], v[116:119], a[212:215]
    ds_read_b64_tr_b16 v[90:91], v14 offset:58368
    v_mfma_f32_16x16x32_bf16 a[88:91], v[104:107], v[52:55], a[88:91]
    s_add_u32 m0, s45, 81920
    s_add_u32 s65, s33, 768
    buffer_load_dwordx4 v24, s[20:23], s65 offen offset:0 lds
    v_mfma_f32_16x16x32_bf16 a[216:219], v[52:55], v[120:123], a[216:219]
    ds_read_b64_tr_b16 v[92:93], v15 offset:57344
    v_mfma_f32_16x16x32_bf16 a[92:95], v[108:111], v[52:55], a[92:95]
    s_nop 1
    v_add_f32_dpp v156, v156, v156 row_shr:8 bound_ctrl:0
    v_add_f32_dpp v157, v157, v157 row_shr:8 bound_ctrl:0
    v_mfma_f32_16x16x32_bf16 a[220:223], v[52:55], v[124:127], a[220:223]
    ds_read_b128 v[52:55], v8 offset:43008
    v_mfma_f32_16x16x32_bf16 a[96:99], v[96:99], v[56:59], a[96:99]
    s_nop 1
    v_add_f32_dpp v156, v156, v156 row_bcast:15 row_mask:0xa
    v_add_f32_dpp v157, v157, v157 row_bcast:15 row_mask:0xa
    v_mfma_f32_16x16x32_bf16 a[224:227], v[56:59], v[112:115], a[224:227]
    ds_read_b64_tr_b16 v[94:95], v15 offset:58368
    buffer_load_dwordx4 v25, s[20:23], s65 offen offset:1024 lds
    v_mfma_f32_16x16x32_bf16 a[100:103], v[100:103], v[56:59], a[100:103]
    v_mfma_f32_16x16x32_bf16 a[228:231], v[56:59], v[116:119], a[228:231]
    s_nop 1
    v_add_f32_dpp v156, v156, v156 row_bcast:31 row_mask:0xc
    v_add_f32_dpp v157, v157, v157 row_bcast:31 row_mask:0xc
    v_mfma_f32_16x16x32_bf16 a[104:107], v[104:107], v[56:59], a[104:107]
    v_cvt_pk_bf16_f32 v158, v156, v157
    v_mfma_f32_16x16x32_bf16 a[232:235], v[56:59], v[120:123], a[232:235]
    v_lshlrev_b32 v156, 16, v158
    v_and_b32 v157, s50, v158
    v_mfma_f32_16x16x32_bf16 a[108:111], v[108:111], v[56:59], a[108:111]
    buffer_load_dwordx4 v30, s[20:23], s65 offen offset:2048 lds
    v_mul_f32 v156, 0xbfb8aa3b, v156
    v_mfma_f32_16x16x32_bf16 a[236:239], v[56:59], v[124:127], a[236:239]
    ds_read_b128 v[56:59], v8 offset:45056
    v_mfma_f32_16x16x32_bf16 a[112:115], v[96:99], v[60:63], a[112:115]
    v_mul_f32 v157, 0xbfb8aa3b, v157
    v_exp_f32 v156, v156
    v_mfma_f32_16x16x32_bf16 a[240:243], v[60:63], v[112:115], a[240:243]
    v_exp_f32 v157, v157
    s_nop 0
    v_mfma_f32_16x16x32_bf16 a[116:119], v[100:103], v[60:63], a[116:119]
    v_add_f32 v156, 1.0, v156
    v_add_f32 v157, 1.0, v157
    v_mfma_f32_16x16x32_bf16 a[244:247], v[60:63], v[116:119], a[244:247]
    buffer_load_dwordx4 v31, s[20:23], s65 offen offset:3072 lds
    v_rcp_f32 v156, v156
    v_mfma_f32_16x16x32_bf16 a[120:123], v[104:107], v[60:63], a[120:123]
    v_rcp_f32 v157, v157
    s_nop 0
    v_mfma_f32_16x16x32_bf16 a[248:251], v[60:63], v[120:123], a[248:251]
    v_cvt_pk_bf16_f32 v158, v156, v157
    v_mfma_f32_16x16x32_bf16 a[124:127], v[108:111], v[60:63], a[124:127]
    v_lshlrev_b32 v156, 16, v158
    v_and_b32 v157, s50, v158
    v_mfma_f32_16x16x32_bf16 a[252:255], v[60:63], v[124:127], a[252:255]
    ds_read_b128 v[60:63], v8 offset:47104
    buffer_store_dwordx2 v[156:157], v129, s[40:43], 0 offen sc1
    s_waitcnt lgkmcnt(2)
    v_mfma_f32_16x16x32_bf16 a[0:3], v[64:67], v[32:35], a[0:3]
    v_mfma_f32_16x16x32_bf16 a[128:131], v[32:35], v[80:83], a[128:131]
    v_mfma_f32_16x16x32_bf16 a[4:7], v[68:71], v[32:35], a[4:7]
    v_mfma_f32_16x16x32_bf16 a[132:135], v[32:35], v[84:87], a[132:135]
    s_waitcnt vmcnt(29) lgkmcnt(0)
    s_barrier
    v_mfma_f32_16x16x32_bf16 a[8:11], v[72:75], v[32:35], a[8:11]
    ds_read_b64_tr_b16 v[96:97], v12 offset:16384
    v_mfma_f32_16x16x32_bf16 a[136:139], v[32:35], v[88:91], a[136:139]
    s_add_u32 m0, s45, 49152
    s_add_u32 s65, s48, 3145728
    buffer_load_dwordx4 v6, s[28:31], s65 offen offset:0 lds
    v_mfma_f32_16x16x32_bf16 a[12:15], v[76:79], v[32:35], a[12:15]
    ds_read_b64_tr_b16 v[98:99], v12 offset:17408
    v_mfma_f32_16x16x32_bf16 a[140:143], v[32:35], v[92:95], a[140:143]
    ds_read_b128 v[32:35], v9 offset:32768
    v_mfma_f32_16x16x32_bf16 a[16:19], v[64:67], v[36:39], a[16:19]
    v_mfma_f32_16x16x32_bf16 a[144:147], v[36:39], v[80:83], a[144:147]
    v_mfma_f32_16x16x32_bf16 a[20:23], v[68:71], v[36:39], a[20:23]
    ds_read_b64_tr_b16 v[100:101], v13 offset:16384
    v_mfma_f32_16x16x32_bf16 a[148:151], v[36:39], v[84:87], a[148:151]
    v_mfma_f32_16x16x32_bf16 a[24:27], v[72:75], v[36:39], a[24:27]
    ds_read_b64_tr_b16 v[102:103], v13 offset:17408
    v_mfma_f32_16x16x32_bf16 a[152:155], v[36:39], v[88:91], a[152:155]
    v_mfma_f32_16x16x32_bf16 a[28:31], v[76:79], v[36:39], a[28:31]
    v_mfma_f32_16x16x32_bf16 a[156:159], v[36:39], v[92:95], a[156:159]
    ds_read_b128 v[36:39], v9 offset:34816
    v_mfma_f32_16x16x32_bf16 a[32:35], v[64:67], v[40:43], a[32:35]
    ds_read_b64_tr_b16 v[104:105], v14 offset:16384
    v_mfma_f32_16x16x32_bf16 a[160:163], v[40:43], v[80:83], a[160:163]
    v_mfma_f32_16x16x32_bf16 a[36:39], v[68:71], v[40:43], a[36:39]
    v_mfma_f32_16x16x32_bf16 a[164:167], v[40:43], v[84:87], a[164:167]
    ds_read_b64_tr_b16 v[106:107], v14 offset:17408
    buffer_load_dwordx4 v27, s[28:31], s65 offen offset:1024 lds
    v_mfma_f32_16x16x32_bf16 a[40:43], v[72:75], v[40:43], a[40:43]
    v_mfma_f32_16x16x32_bf16 a[168:171], v[40:43], v[88:91], a[168:171]
    ds_read_b64_tr_b16 v[108:109], v15 offset:16384
    v_mfma_f32_16x16x32_bf16 a[44:47], v[76:79], v[40:43], a[44:47]
    v_mfma_f32_16x16x32_bf16 a[172:175], v[40:43], v[92:95], a[172:175]
    ds_read_b128 v[40:43], v9 offset:36864
    v_mfma_f32_16x16x32_bf16 a[48:51], v[64:67], v[44:47], a[48:51]
    v_mfma_f32_16x16x32_bf16 a[176:179], v[44:47], v[80:83], a[176:179]
    ds_read_b64_tr_b16 v[110:111], v15 offset:17408
    v_mfma_f32_16x16x32_bf16 a[52:55], v[68:71], v[44:47], a[52:55]
    v_mfma_f32_16x16x32_bf16 a[180:183], v[44:47], v[84:87], a[180:183]
    v_mfma_f32_16x16x32_bf16 a[56:59], v[72:75], v[44:47], a[56:59]
    ds_read_b64_tr_b16 v[112:113], v12 offset:24576
    v_mfma_f32_16x16x32_bf16 a[184:187], v[44:47], v[88:91], a[184:187]
    v_mfma_f32_16x16x32_bf16 a[60:63], v[76:79], v[44:47], a[60:63]
    ds_read_b64_tr_b16 v[114:115], v12 offset:25600
    v_mfma_f32_16x16x32_bf16 a[188:191], v[44:47], v[92:95], a[188:191]
    ds_read_b128 v[44:47], v9 offset:38912
    v_mfma_f32_16x16x32_bf16 a[64:67], v[64:67], v[48:51], a[64:67]
    v_mfma_f32_16x16x32_bf16 a[192:195], v[48:51], v[80:83], a[192:195]
    v_mfma_f32_16x16x32_bf16 a[68:71], v[68:71], v[48:51], a[68:71]
    ds_read_b64_tr_b16 v[116:117], v13 offset:24576
    buffer_load_dwordx4 v28, s[28:31], s65 offen offset:2048 lds
    v_mfma_f32_16x16x32_bf16 a[196:199], v[48:51], v[84:87], a[196:199]
    v_mfma_f32_16x16x32_bf16 a[72:75], v[72:75], v[48:51], a[72:75]
    ds_read_b64_tr_b16 v[118:119], v13 offset:25600
    v_mfma_f32_16x16x32_bf16 a[200:203], v[48:51], v[88:91], a[200:203]
    v_mfma_f32_16x16x32_bf16 a[76:79], v[76:79], v[48:51], a[76:79]
    v_mfma_f32_16x16x32_bf16 a[204:207], v[48:51], v[92:95], a[204:207]
    ds_read_b128 v[48:51], v9 offset:40960
    v_mfma_f32_16x16x32_bf16 a[80:83], v[64:67], v[52:55], a[80:83]
    ds_read_b64_tr_b16 v[120:121], v14 offset:24576
    v_mfma_f32_16x16x32_bf16 a[208:211], v[52:55], v[80:83], a[208:211]
    v_mfma_f32_16x16x32_bf16 a[84:87], v[68:71], v[52:55], a[84:87]
    v_mfma_f32_16x16x32_bf16 a[212:215], v[52:55], v[84:87], a[212:215]
    ds_read_b64_tr_b16 v[122:123], v14 offset:25600
    v_mfma_f32_16x16x32_bf16 a[88:91], v[72:75], v[52:55], a[88:91]
    v_mfma_f32_16x16x32_bf16 a[216:219], v[52:55], v[88:91], a[216:219]
    ds_read_b64_tr_b16 v[124:125], v15 offset:24576
    v_mfma_f32_16x16x32_bf16 a[92:95], v[76:79], v[52:55], a[92:95]
    v_mfma_f32_16x16x32_bf16 a[220:223], v[52:55], v[92:95], a[220:223]
    ds_read_b128 v[52:55], v9 offset:43008
    v_mfma_f32_16x16x32_bf16 a[96:99], v[64:67], v[56:59], a[96:99]
    v_mfma_f32_16x16x32_bf16 a[224:227], v[56:59], v[80:83], a[224:227]
    ds_read_b64_tr_b16 v[126:127], v15 offset:25600
    buffer_load_dwordx4 v29, s[28:31], s65 offen offset:3072 lds
    v_mfma_f32_16x16x32_bf16 a[100:103], v[68:71], v[56:59], a[100:103]
    v_mfma_f32_16x16x32_bf16 a[228:231], v[56:59], v[84:87], a[228:231]
    v_mfma_f32_16x16x32_bf16 a[104:107], v[72:75], v[56:59], a[104:107]
    v_mfma_f32_16x16x32_bf16 a[232:235], v[56:59], v[88:91], a[232:235]
    v_mfma_f32_16x16x32_bf16 a[108:111], v[76:79], v[56:59], a[108:111]
    v_mfma_f32_16x16x32_bf16 a[236:239], v[56:59], v[92:95], a[236:239]
    ds_read_b128 v[56:59], v9 offset:45056
    v_mfma_f32_16x16x32_bf16 a[112:115], v[64:67], v[60:63], a[112:115]
    v_mfma_f32_16x16x32_bf16 a[240:243], v[60:63], v[80:83], a[240:243]
    v_mfma_f32_16x16x32_bf16 a[116:119], v[68:71], v[60:63], a[116:119]
    v_mfma_f32_16x16x32_bf16 a[244:247], v[60:63], v[84:87], a[244:247]
    v_mfma_f32_16x16x32_bf16 a[120:123], v[72:75], v[60:63], a[120:123]
    v_mfma_f32_16x16x32_bf16 a[248:251], v[60:63], v[88:91], a[248:251]
    v_mfma_f32_16x16x32_bf16 a[124:127], v[76:79], v[60:63], a[124:127]
    v_mfma_f32_16x16x32_bf16 a[252:255], v[60:63], v[92:95], a[252:255]
    ds_read_b128 v[60:63], v9 offset:47104
    s_waitcnt lgkmcnt(2)
    v_mfma_f32_16x16x32_bf16 a[0:3], v[96:99], v[32:35], a[0:3]
    v_mfma_f32_16x16x32_bf16 a[128:131], v[32:35], v[112:115], a[128:131]
    v_mfma_f32_16x16x32_bf16 a[4:7], v[100:103], v[32:35], a[4:7]
    v_mfma_f32_16x16x32_bf16 a[132:135], v[32:35], v[116:119], a[132:135]
    s_waitcnt vmcnt(17) lgkmcnt(0)
    s_barrier
    v_mfma_f32_16x16x32_bf16 a[8:11], v[104:107], v[32:35], a[8:11]
    ds_read_b64_tr_b16 v[64:65], v12 offset:32768
    v_mfma_f32_16x16x32_bf16 a[136:139], v[32:35], v[120:123], a[136:139]
    s_add_u32 m0, s45, 16384
    s_add_u32 s65, s48, 3407872
    buffer_load_dwordx4 v6, s[28:31], s65 offen offset:0 lds
    v_mfma_f32_16x16x32_bf16 a[12:15], v[108:111], v[32:35], a[12:15]
    ds_read_b64_tr_b16 v[66:67], v12 offset:33792
    v_mfma_f32_16x16x32_bf16 a[140:143], v[32:35], v[124:127], a[140:143]
    ds_read_b128 v[32:35], v10 offset:0
    v_mfma_f32_16x16x32_bf16 a[16:19], v[96:99], v[36:39], a[16:19]
    v_mfma_f32_16x16x32_bf16 a[144:147], v[36:39], v[112:115], a[144:147]
    buffer_load_dwordx4 v27, s[28:31], s65 offen offset:1024 lds
    v_mfma_f32_16x16x32_bf16 a[20:23], v[100:103], v[36:39], a[20:23]
    ds_read_b64_tr_b16 v[68:69], v13 offset:32768
    v_mfma_f32_16x16x32_bf16 a[148:151], v[36:39], v[116:119], a[148:151]
    v_mfma_f32_16x16x32_bf16 a[24:27], v[104:107], v[36:39], a[24:27]
    ds_read_b64_tr_b16 v[70:71], v13 offset:33792
    v_mfma_f32_16x16x32_bf16 a[152:155], v[36:39], v[120:123], a[152:155]
    v_mfma_f32_16x16x32_bf16 a[28:31], v[108:111], v[36:39], a[28:31]
    buffer_load_dwordx4 v28, s[28:31], s65 offen offset:2048 lds
    v_mfma_f32_16x16x32_bf16 a[156:159], v[36:39], v[124:127], a[156:159]
    ds_read_b128 v[36:39], v10 offset:2048
    v_mfma_f32_16x16x32_bf16 a[32:35], v[96:99], v[40:43], a[32:35]
    ds_read_b64_tr_b16 v[72:73], v14 offset:32768
    v_mfma_f32_16x16x32_bf16 a[160:163], v[40:43], v[112:115], a[160:163]
    v_mfma_f32_16x16x32_bf16 a[36:39], v[100:103], v[40:43], a[36:39]
    v_mfma_f32_16x16x32_bf16 a[164:167], v[40:43], v[116:119], a[164:167]
    ds_read_b64_tr_b16 v[74:75], v14 offset:33792
    buffer_load_dwordx4 v29, s[28:31], s65 offen offset:3072 lds
    v_mfma_f32_16x16x32_bf16 a[40:43], v[104:107], v[40:43], a[40:43]
    v_mfma_f32_16x16x32_bf16 a[168:171], v[40:43], v[120:123], a[168:171]
    ds_read_b64_tr_b16 v[76:77], v15 offset:32768
    v_mfma_f32_16x16x32_bf16 a[44:47], v[108:111], v[40:43], a[44:47]
    v_mfma_f32_16x16x32_bf16 a[172:175], v[40:43], v[124:127], a[172:175]
    ds_read_b128 v[40:43], v10 offset:4096
    v_mfma_f32_16x16x32_bf16 a[48:51], v[96:99], v[44:47], a[48:51]
    s_add_u32 m0, s45, 98304
    s_add_u32 s65, s32, 896
    buffer_load_dwordx4 v24, s[20:23], s65 offen offset:0 lds
    v_mfma_f32_16x16x32_bf16 a[176:179], v[44:47], v[112:115], a[176:179]
    ds_read_b64_tr_b16 v[78:79], v15 offset:33792
    v_mfma_f32_16x16x32_bf16 a[52:55], v[100:103], v[44:47], a[52:55]
    v_mfma_f32_16x16x32_bf16 a[180:183], v[44:47], v[116:119], a[180:183]
    v_mfma_f32_16x16x32_bf16 a[56:59], v[104:107], v[44:47], a[56:59]
    ds_read_b64_tr_b16 v[80:81], v12 offset:40960
    v_mfma_f32_16x16x32_bf16 a[184:187], v[44:47], v[120:123], a[184:187]
    buffer_load_dwordx4 v25, s[20:23], s65 offen offset:1024 lds
    v_mfma_f32_16x16x32_bf16 a[60:63], v[108:111], v[44:47], a[60:63]
    ds_read_b64_tr_b16 v[82:83], v12 offset:41984
    v_mfma_f32_16x16x32_bf16 a[188:191], v[44:47], v[124:127], a[188:191]
    ds_read_b128 v[44:47], v10 offset:6144
    v_mfma_f32_16x16x32_bf16 a[64:67], v[96:99], v[48:51], a[64:67]
    v_mfma_f32_16x16x32_bf16 a[192:195], v[48:51], v[112:115], a[192:195]
    v_mfma_f32_16x16x32_bf16 a[68:71], v[100:103], v[48:51], a[68:71]
    ds_read_b64_tr_b16 v[84:85], v13 offset:40960
    buffer_load_dwordx4 v30, s[20:23], s65 offen offset:2048 lds
    v_mfma_f32_16x16x32_bf16 a[196:199], v[48:51], v[116:119], a[196:199]
    v_mfma_f32_16x16x32_bf16 a[72:75], v[104:107], v[48:51], a[72:75]
    ds_read_b64_tr_b16 v[86:87], v13 offset:41984
    v_mfma_f32_16x16x32_bf16 a[200:203], v[48:51], v[120:123], a[200:203]
    v_mfma_f32_16x16x32_bf16 a[76:79], v[108:111], v[48:51], a[76:79]
    v_mfma_f32_16x16x32_bf16 a[204:207], v[48:51], v[124:127], a[204:207]
    ds_read_b128 v[48:51], v10 offset:8192
    buffer_load_dwordx4 v31, s[20:23], s65 offen offset:3072 lds
    v_mfma_f32_16x16x32_bf16 a[80:83], v[96:99], v[52:55], a[80:83]
    ds_read_b64_tr_b16 v[88:89], v14 offset:40960
    v_mfma_f32_16x16x32_bf16 a[208:211], v[52:55], v[112:115], a[208:211]
    v_mfma_f32_16x16x32_bf16 a[84:87], v[100:103], v[52:55], a[84:87]
    v_mfma_f32_16x16x32_bf16 a[212:215], v[52:55], v[116:119], a[212:215]
    ds_read_b64_tr_b16 v[90:91], v14 offset:41984
    v_mfma_f32_16x16x32_bf16 a[88:91], v[104:107], v[52:55], a[88:91]
    s_add_u32 m0, s45, 114688
    s_add_u32 s65, s33, 896
    buffer_load_dwordx4 v24, s[20:23], s65 offen offset:0 lds
    v_mfma_f32_16x16x32_bf16 a[216:219], v[52:55], v[120:123], a[216:219]
    ds_read_b64_tr_b16 v[92:93], v15 offset:40960
    v_mfma_f32_16x16x32_bf16 a[92:95], v[108:111], v[52:55], a[92:95]
    v_mfma_f32_16x16x32_bf16 a[220:223], v[52:55], v[124:127], a[220:223]
    ds_read_b128 v[52:55], v10 offset:10240
    v_mfma_f32_16x16x32_bf16 a[96:99], v[96:99], v[56:59], a[96:99]
    v_mfma_f32_16x16x32_bf16 a[224:227], v[56:59], v[112:115], a[224:227]
    ds_read_b64_tr_b16 v[94:95], v15 offset:41984
    buffer_load_dwordx4 v25, s[20:23], s65 offen offset:1024 lds
    v_mfma_f32_16x16x32_bf16 a[100:103], v[100:103], v[56:59], a[100:103]
    v_mfma_f32_16x16x32_bf16 a[228:231], v[56:59], v[116:119], a[228:231]
    v_mfma_f32_16x16x32_bf16 a[104:107], v[104:107], v[56:59], a[104:107]
    v_mfma_f32_16x16x32_bf16 a[232:235], v[56:59], v[120:123], a[232:235]
    v_mfma_f32_16x16x32_bf16 a[108:111], v[108:111], v[56:59], a[108:111]
    buffer_load_dwordx4 v30, s[20:23], s65 offen offset:2048 lds
    v_mfma_f32_16x16x32_bf16 a[236:239], v[56:59], v[124:127], a[236:239]
    ds_read_b128 v[56:59], v10 offset:12288
    v_mfma_f32_16x16x32_bf16 a[112:115], v[96:99], v[60:63], a[112:115]
    v_mfma_f32_16x16x32_bf16 a[240:243], v[60:63], v[112:115], a[240:243]
    v_mfma_f32_16x16x32_bf16 a[116:119], v[100:103], v[60:63], a[116:119]
    v_mfma_f32_16x16x32_bf16 a[244:247], v[60:63], v[116:119], a[244:247]
    buffer_load_dwordx4 v31, s[20:23], s65 offen offset:3072 lds
    v_mfma_f32_16x16x32_bf16 a[120:123], v[104:107], v[60:63], a[120:123]
    v_mfma_f32_16x16x32_bf16 a[248:251], v[60:63], v[120:123], a[248:251]
    v_mfma_f32_16x16x32_bf16 a[124:127], v[108:111], v[60:63], a[124:127]
    v_mfma_f32_16x16x32_bf16 a[252:255], v[60:63], v[124:127], a[252:255]
    ds_read_b128 v[60:63], v10 offset:14336
    s_waitcnt lgkmcnt(2)
    v_mfma_f32_16x16x32_bf16 a[0:3], v[64:67], v[32:35], a[0:3]
    v_mfma_f32_16x16x32_bf16 a[128:131], v[32:35], v[80:83], a[128:131]
    v_mfma_f32_16x16x32_bf16 a[4:7], v[68:71], v[32:35], a[4:7]
    v_mfma_f32_16x16x32_bf16 a[132:135], v[32:35], v[84:87], a[132:135]
    s_waitcnt vmcnt(25) lgkmcnt(0)
    s_barrier
    v_mfma_f32_16x16x32_bf16 a[8:11], v[72:75], v[32:35], a[8:11]
    ds_read_b64_tr_b16 v[96:97], v12 offset:0
    v_mfma_f32_16x16x32_bf16 a[136:139], v[32:35], v[88:91], a[136:139]
    s_add_u32 m0, s45, 32768
    s_add_u32 s65, s48, 3670016
    buffer_load_dwordx4 v6, s[28:31], s65 offen offset:0 lds
    v_mfma_f32_16x16x32_bf16 a[12:15], v[76:79], v[32:35], a[12:15]
    ds_read_b64_tr_b16 v[98:99], v12 offset:1024
    v_mfma_f32_16x16x32_bf16 a[140:143], v[32:35], v[92:95], a[140:143]
    ds_read_b128 v[32:35], v11 offset:0
    v_mfma_f32_16x16x32_bf16 a[16:19], v[64:67], v[36:39], a[16:19]
    v_mfma_f32_16x16x32_bf16 a[144:147], v[36:39], v[80:83], a[144:147]
    v_mfma_f32_16x16x32_bf16 a[20:23], v[68:71], v[36:39], a[20:23]
    ds_read_b64_tr_b16 v[100:101], v13 offset:0
    v_mfma_f32_16x16x32_bf16 a[148:151], v[36:39], v[84:87], a[148:151]
    v_mfma_f32_16x16x32_bf16 a[24:27], v[72:75], v[36:39], a[24:27]
    ds_read_b64_tr_b16 v[102:103], v13 offset:1024
    v_mfma_f32_16x16x32_bf16 a[152:155], v[36:39], v[88:91], a[152:155]
    v_mfma_f32_16x16x32_bf16 a[28:31], v[76:79], v[36:39], a[28:31]
    v_mfma_f32_16x16x32_bf16 a[156:159], v[36:39], v[92:95], a[156:159]
    ds_read_b128 v[36:39], v11 offset:2048
    v_mfma_f32_16x16x32_bf16 a[32:35], v[64:67], v[40:43], a[32:35]
    ds_read_b64_tr_b16 v[104:105], v14 offset:0
    v_mfma_f32_16x16x32_bf16 a[160:163], v[40:43], v[80:83], a[160:163]
    v_mfma_f32_16x16x32_bf16 a[36:39], v[68:71], v[40:43], a[36:39]
    v_mfma_f32_16x16x32_bf16 a[164:167], v[40:43], v[84:87], a[164:167]
    ds_read_b64_tr_b16 v[106:107], v14 offset:1024
    buffer_load_dwordx4 v27, s[28:31], s65 offen offset:1024 lds
    v_mfma_f32_16x16x32_bf16 a[40:43], v[72:75], v[40:43], a[40:43]
    v_mfma_f32_16x16x32_bf16 a[168:171], v[40:43], v[88:91], a[168:171]
    ds_read_b64_tr_b16 v[108:109], v15 offset:0
    v_mfma_f32_16x16x32_bf16 a[44:47], v[76:79], v[40:43], a[44:47]
    v_mfma_f32_16x16x32_bf16 a[172:175], v[40:43], v[92:95], a[172:175]
    ds_read_b128 v[40:43], v11 offset:4096
    v_mfma_f32_16x16x32_bf16 a[48:51], v[64:67], v[44:47], a[48:51]
    v_mfma_f32_16x16x32_bf16 a[176:179], v[44:47], v[80:83], a[176:179]
    ds_read_b64_tr_b16 v[110:111], v15 offset:1024
    v_mfma_f32_16x16x32_bf16 a[52:55], v[68:71], v[44:47], a[52:55]
    v_mfma_f32_16x16x32_bf16 a[180:183], v[44:47], v[84:87], a[180:183]
    v_mfma_f32_16x16x32_bf16 a[56:59], v[72:75], v[44:47], a[56:59]
    ds_read_b64_tr_b16 v[112:113], v12 offset:8192
    v_mfma_f32_16x16x32_bf16 a[184:187], v[44:47], v[88:91], a[184:187]
    v_mfma_f32_16x16x32_bf16 a[60:63], v[76:79], v[44:47], a[60:63]
    ds_read_b64_tr_b16 v[114:115], v12 offset:9216
    v_mfma_f32_16x16x32_bf16 a[188:191], v[44:47], v[92:95], a[188:191]
    ds_read_b128 v[44:47], v11 offset:6144
    v_mfma_f32_16x16x32_bf16 a[64:67], v[64:67], v[48:51], a[64:67]
    v_mfma_f32_16x16x32_bf16 a[192:195], v[48:51], v[80:83], a[192:195]
    v_mfma_f32_16x16x32_bf16 a[68:71], v[68:71], v[48:51], a[68:71]
    ds_read_b64_tr_b16 v[116:117], v13 offset:8192
    buffer_load_dwordx4 v28, s[28:31], s65 offen offset:2048 lds
    v_mfma_f32_16x16x32_bf16 a[196:199], v[48:51], v[84:87], a[196:199]
    v_mfma_f32_16x16x32_bf16 a[72:75], v[72:75], v[48:51], a[72:75]
    ds_read_b64_tr_b16 v[118:119], v13 offset:9216
    v_mfma_f32_16x16x32_bf16 a[200:203], v[48:51], v[88:91], a[200:203]
    v_mfma_f32_16x16x32_bf16 a[76:79], v[76:79], v[48:51], a[76:79]
    v_mfma_f32_16x16x32_bf16 a[204:207], v[48:51], v[92:95], a[204:207]
    ds_read_b128 v[48:51], v11 offset:8192
    v_mfma_f32_16x16x32_bf16 a[80:83], v[64:67], v[52:55], a[80:83]
    ds_read_b64_tr_b16 v[120:121], v14 offset:8192
    v_mfma_f32_16x16x32_bf16 a[208:211], v[52:55], v[80:83], a[208:211]
    v_mfma_f32_16x16x32_bf16 a[84:87], v[68:71], v[52:55], a[84:87]
    v_mfma_f32_16x16x32_bf16 a[212:215], v[52:55], v[84:87], a[212:215]
    ds_read_b64_tr_b16 v[122:123], v14 offset:9216
    v_mfma_f32_16x16x32_bf16 a[88:91], v[72:75], v[52:55], a[88:91]
    v_mfma_f32_16x16x32_bf16 a[216:219], v[52:55], v[88:91], a[216:219]
    ds_read_b64_tr_b16 v[124:125], v15 offset:8192
    v_mfma_f32_16x16x32_bf16 a[92:95], v[76:79], v[52:55], a[92:95]
    v_mfma_f32_16x16x32_bf16 a[220:223], v[52:55], v[92:95], a[220:223]
    ds_read_b128 v[52:55], v11 offset:10240
    v_mfma_f32_16x16x32_bf16 a[96:99], v[64:67], v[56:59], a[96:99]
    v_mfma_f32_16x16x32_bf16 a[224:227], v[56:59], v[80:83], a[224:227]
    ds_read_b64_tr_b16 v[126:127], v15 offset:9216
    buffer_load_dwordx4 v29, s[28:31], s65 offen offset:3072 lds
    v_mfma_f32_16x16x32_bf16 a[100:103], v[68:71], v[56:59], a[100:103]
    v_mfma_f32_16x16x32_bf16 a[228:231], v[56:59], v[84:87], a[228:231]
    v_mfma_f32_16x16x32_bf16 a[104:107], v[72:75], v[56:59], a[104:107]
    v_mfma_f32_16x16x32_bf16 a[232:235], v[56:59], v[88:91], a[232:235]
    v_mfma_f32_16x16x32_bf16 a[108:111], v[76:79], v[56:59], a[108:111]
    v_mfma_f32_16x16x32_bf16 a[236:239], v[56:59], v[92:95], a[236:239]
    ds_read_b128 v[56:59], v11 offset:12288
    v_mfma_f32_16x16x32_bf16 a[112:115], v[64:67], v[60:63], a[112:115]
    v_mfma_f32_16x16x32_bf16 a[240:243], v[60:63], v[80:83], a[240:243]
    v_mfma_f32_16x16x32_bf16 a[116:119], v[68:71], v[60:63], a[116:119]
    v_mfma_f32_16x16x32_bf16 a[244:247], v[60:63], v[84:87], a[244:247]
    v_mfma_f32_16x16x32_bf16 a[120:123], v[72:75], v[60:63], a[120:123]
    v_mfma_f32_16x16x32_bf16 a[248:251], v[60:63], v[88:91], a[248:251]
    v_mfma_f32_16x16x32_bf16 a[124:127], v[76:79], v[60:63], a[124:127]
    v_mfma_f32_16x16x32_bf16 a[252:255], v[60:63], v[92:95], a[252:255]
    ds_read_b128 v[60:63], v11 offset:14336
    s_waitcnt lgkmcnt(2)
    v_mfma_f32_16x16x32_bf16 a[0:3], v[96:99], v[32:35], a[0:3]
    v_mfma_f32_16x16x32_bf16 a[128:131], v[32:35], v[112:115], a[128:131]
    v_mfma_f32_16x16x32_bf16 a[4:7], v[100:103], v[32:35], a[4:7]
    s_getpc_b64 s[36:37]
main_kernel_pc1:
    s_sub_u32 s36, s36, main_kernel_pc1-main_kernel
    s_subb_u32 s37, s37, 0
    v_mfma_f32_16x16x32_bf16 a[132:135], v[32:35], v[116:119], a[132:135]
    s_waitcnt vmcnt(16) lgkmcnt(0)
    s_barrier
    v_mfma_f32_16x16x32_bf16 a[8:11], v[104:107], v[32:35], a[8:11]
    ds_read_b64_tr_b16 v[64:65], v12 offset:49152
    v_mfma_f32_16x16x32_bf16 a[136:139], v[32:35], v[120:123], a[136:139]
    s_add_u32 m0, s45, 0
    s_add_u32 s65, s48, 3932160
    buffer_load_dwordx4 v6, s[28:31], s65 offen offset:0 lds
    v_mfma_f32_16x16x32_bf16 a[12:15], v[108:111], v[32:35], a[12:15]
    ds_read_b64_tr_b16 v[66:67], v12 offset:50176
    v_mfma_f32_16x16x32_bf16 a[140:143], v[32:35], v[124:127], a[140:143]
    ds_read_b128 v[32:35], v8 offset:0
    v_mfma_f32_16x16x32_bf16 a[16:19], v[96:99], v[36:39], a[16:19]
    v_mfma_f32_16x16x32_bf16 a[144:147], v[36:39], v[112:115], a[144:147]
    buffer_load_dwordx4 v27, s[28:31], s65 offen offset:1024 lds
    v_mfma_f32_16x16x32_bf16 a[20:23], v[100:103], v[36:39], a[20:23]
    ds_read_b64_tr_b16 v[68:69], v13 offset:49152
    v_mfma_f32_16x16x32_bf16 a[148:151], v[36:39], v[116:119], a[148:151]
    v_mfma_f32_16x16x32_bf16 a[24:27], v[104:107], v[36:39], a[24:27]
    ds_read_b64_tr_b16 v[70:71], v13 offset:50176
    v_mfma_f32_16x16x32_bf16 a[152:155], v[36:39], v[120:123], a[152:155]
    v_mfma_f32_16x16x32_bf16 a[28:31], v[108:111], v[36:39], a[28:31]
    buffer_load_dwordx4 v28, s[28:31], s65 offen offset:2048 lds
    v_mfma_f32_16x16x32_bf16 a[156:159], v[36:39], v[124:127], a[156:159]
    ds_read_b128 v[36:39], v8 offset:2048
    v_mfma_f32_16x16x32_bf16 a[32:35], v[96:99], v[40:43], a[32:35]
    ds_read_b64_tr_b16 v[72:73], v14 offset:49152
    v_mfma_f32_16x16x32_bf16 a[160:163], v[40:43], v[112:115], a[160:163]
    v_mfma_f32_16x16x32_bf16 a[36:39], v[100:103], v[40:43], a[36:39]
    v_mfma_f32_16x16x32_bf16 a[164:167], v[40:43], v[116:119], a[164:167]
    ds_read_b64_tr_b16 v[74:75], v14 offset:50176
    buffer_load_dwordx4 v29, s[28:31], s65 offen offset:3072 lds
    v_mfma_f32_16x16x32_bf16 a[40:43], v[104:107], v[40:43], a[40:43]
    v_mfma_f32_16x16x32_bf16 a[168:171], v[40:43], v[120:123], a[168:171]
    ds_read_b64_tr_b16 v[76:77], v15 offset:49152
    v_mfma_f32_16x16x32_bf16 a[44:47], v[108:111], v[40:43], a[44:47]
    v_mfma_f32_16x16x32_bf16 a[172:175], v[40:43], v[124:127], a[172:175]
    ds_read_b128 v[40:43], v8 offset:4096
    v_mfma_f32_16x16x32_bf16 a[48:51], v[96:99], v[44:47], a[48:51]
    s_add_u32 m0, s45, 131072
    s_add_u32 s65, s34, 0
    buffer_load_dwordx4 v4, s[16:19], s65 offen offset:0 lds
    v_mfma_f32_16x16x32_bf16 a[176:179], v[44:47], v[112:115], a[176:179]
    ds_read_b64_tr_b16 v[78:79], v15 offset:50176
    v_mfma_f32_16x16x32_bf16 a[52:55], v[100:103], v[44:47], a[52:55]
    v_mfma_f32_16x16x32_bf16 a[180:183], v[44:47], v[116:119], a[180:183]
    v_mfma_f32_16x16x32_bf16 a[56:59], v[104:107], v[44:47], a[56:59]
    ds_read_b64_tr_b16 v[80:81], v12 offset:57344
    v_mfma_f32_16x16x32_bf16 a[184:187], v[44:47], v[120:123], a[184:187]
    buffer_load_dwordx4 v5, s[16:19], s65 offen offset:1024 lds
    v_mfma_f32_16x16x32_bf16 a[60:63], v[108:111], v[44:47], a[60:63]
    ds_read_b64_tr_b16 v[82:83], v12 offset:58368
    v_mfma_f32_16x16x32_bf16 a[188:191], v[44:47], v[124:127], a[188:191]
    ds_read_b128 v[44:47], v8 offset:6144
    v_mfma_f32_16x16x32_bf16 a[64:67], v[96:99], v[48:51], a[64:67]
    v_mfma_f32_16x16x32_bf16 a[192:195], v[48:51], v[112:115], a[192:195]
    v_mfma_f32_16x16x32_bf16 a[68:71], v[100:103], v[48:51], a[68:71]
    ds_read_b64_tr_b16 v[84:85], v13 offset:57344
    buffer_load_dwordx4 v19, s[16:19], s65 offen offset:2048 lds
    v_mfma_f32_16x16x32_bf16 a[196:199], v[48:51], v[116:119], a[196:199]
    v_mfma_f32_16x16x32_bf16 a[72:75], v[104:107], v[48:51], a[72:75]
    ds_read_b64_tr_b16 v[86:87], v13 offset:58368
    v_mfma_f32_16x16x32_bf16 a[200:203], v[48:51], v[120:123], a[200:203]
    v_mfma_f32_16x16x32_bf16 a[76:79], v[108:111], v[48:51], a[76:79]
    v_mfma_f32_16x16x32_bf16 a[204:207], v[48:51], v[124:127], a[204:207]
    ds_read_b128 v[48:51], v8 offset:8192
    buffer_load_dwordx4 v26, s[16:19], s65 offen offset:3072 lds
    v_mfma_f32_16x16x32_bf16 a[80:83], v[96:99], v[52:55], a[80:83]
    ds_read_b64_tr_b16 v[88:89], v14 offset:57344
    v_mfma_f32_16x16x32_bf16 a[208:211], v[52:55], v[112:115], a[208:211]
    v_mfma_f32_16x16x32_bf16 a[84:87], v[100:103], v[52:55], a[84:87]
    v_mfma_f32_16x16x32_bf16 a[212:215], v[52:55], v[116:119], a[212:215]
    ds_read_b64_tr_b16 v[90:91], v14 offset:58368
    v_mfma_f32_16x16x32_bf16 a[88:91], v[104:107], v[52:55], a[88:91]
    s_add_u32 m0, s45, 147456
    s_add_u32 s65, s35, 0
    buffer_load_dwordx4 v4, s[16:19], s65 offen offset:0 lds
    v_mfma_f32_16x16x32_bf16 a[216:219], v[52:55], v[120:123], a[216:219]
    ds_read_b64_tr_b16 v[92:93], v15 offset:57344
    v_mfma_f32_16x16x32_bf16 a[92:95], v[108:111], v[52:55], a[92:95]
    v_mfma_f32_16x16x32_bf16 a[220:223], v[52:55], v[124:127], a[220:223]
    ds_read_b128 v[52:55], v8 offset:10240
    v_mfma_f32_16x16x32_bf16 a[96:99], v[96:99], v[56:59], a[96:99]
    v_mfma_f32_16x16x32_bf16 a[224:227], v[56:59], v[112:115], a[224:227]
    ds_read_b64_tr_b16 v[94:95], v15 offset:58368
    buffer_load_dwordx4 v5, s[16:19], s65 offen offset:1024 lds
    v_mfma_f32_16x16x32_bf16 a[100:103], v[100:103], v[56:59], a[100:103]
    v_mfma_f32_16x16x32_bf16 a[228:231], v[56:59], v[116:119], a[228:231]
    v_mfma_f32_16x16x32_bf16 a[104:107], v[104:107], v[56:59], a[104:107]
    v_mfma_f32_16x16x32_bf16 a[232:235], v[56:59], v[120:123], a[232:235]
    s_mov_b32 s38, all_code_end-main_kernel
    s_mov_b32 s39, 0x00020000
    v_mfma_f32_16x16x32_bf16 a[108:111], v[108:111], v[56:59], a[108:111]
    buffer_load_dwordx4 v19, s[16:19], s65 offen offset:2048 lds
    v_mfma_f32_16x16x32_bf16 a[236:239], v[56:59], v[124:127], a[236:239]
    ds_read_b128 v[56:59], v8 offset:12288
    v_mfma_f32_16x16x32_bf16 a[112:115], v[96:99], v[60:63], a[112:115]
    v_mfma_f32_16x16x32_bf16 a[240:243], v[60:63], v[112:115], a[240:243]
    v_mfma_f32_16x16x32_bf16 a[116:119], v[100:103], v[60:63], a[116:119]
    s_lshr_b32 s58, s2, 3
    s_lshl_b32 s58, s58, 12
    v_mfma_f32_16x16x32_bf16 a[244:247], v[60:63], v[116:119], a[244:247]
    buffer_load_dwordx4 v26, s[16:19], s65 offen offset:3072 lds
    v_mfma_f32_16x16x32_bf16 a[120:123], v[104:107], v[60:63], a[120:123]
    v_mfma_f32_16x16x32_bf16 a[248:251], v[60:63], v[120:123], a[248:251]
    v_lshlrev_b32 v2, 4, v0
    v_mfma_f32_16x16x32_bf16 a[124:127], v[108:111], v[60:63], a[124:127]
    buffer_load_dwordx4 v[20:23], v2, s[36:39], s58 offen
    v_mfma_f32_16x16x32_bf16 a[252:255], v[60:63], v[124:127], a[252:255]
    ds_read_b128 v[60:63], v8 offset:14336
    s_waitcnt lgkmcnt(2)
    v_mfma_f32_16x16x32_bf16 a[0:3], v[64:67], v[32:35], a[0:3]
    v_mfma_f32_16x16x32_bf16 a[128:131], v[32:35], v[80:83], a[128:131]
    v_mfma_f32_16x16x32_bf16 a[4:7], v[68:71], v[32:35], a[4:7]
    v_mfma_f32_16x16x32_bf16 a[132:135], v[32:35], v[84:87], a[132:135]
    s_waitcnt vmcnt(25) lgkmcnt(0)
    s_barrier
    v_mfma_f32_16x16x32_bf16 a[8:11], v[72:75], v[32:35], a[8:11]
    ds_read_b64_tr_b16 v[96:97], v12 offset:16384
    v_mfma_f32_16x16x32_bf16 a[136:139], v[32:35], v[88:91], a[136:139]
    s_add_u32 m0, s45, 49152
    s_add_u32 s65, s49, 0
    buffer_load_dwordx4 v6, s[24:27], s65 offen offset:0 lds
    v_mfma_f32_16x16x32_bf16 a[12:15], v[76:79], v[32:35], a[12:15]
    ds_read_b64_tr_b16 v[98:99], v12 offset:17408
    v_mfma_f32_16x16x32_bf16 a[140:143], v[32:35], v[92:95], a[140:143]
    ds_read_b128 v[32:35], v9 offset:0
    v_mfma_f32_16x16x32_bf16 a[16:19], v[64:67], v[36:39], a[16:19]
    v_mfma_f32_16x16x32_bf16 a[144:147], v[36:39], v[80:83], a[144:147]
    v_mfma_f32_16x16x32_bf16 a[20:23], v[68:71], v[36:39], a[20:23]
    ds_read_b64_tr_b16 v[100:101], v13 offset:16384
    v_mfma_f32_16x16x32_bf16 a[148:151], v[36:39], v[84:87], a[148:151]
    v_mfma_f32_16x16x32_bf16 a[24:27], v[72:75], v[36:39], a[24:27]
    ds_read_b64_tr_b16 v[102:103], v13 offset:17408
    v_mfma_f32_16x16x32_bf16 a[152:155], v[36:39], v[88:91], a[152:155]
    v_mfma_f32_16x16x32_bf16 a[28:31], v[76:79], v[36:39], a[28:31]
    v_mfma_f32_16x16x32_bf16 a[156:159], v[36:39], v[92:95], a[156:159]
    ds_read_b128 v[36:39], v9 offset:2048
    v_mfma_f32_16x16x32_bf16 a[32:35], v[64:67], v[40:43], a[32:35]
    ds_read_b64_tr_b16 v[104:105], v14 offset:16384
    v_mfma_f32_16x16x32_bf16 a[160:163], v[40:43], v[80:83], a[160:163]
    v_mfma_f32_16x16x32_bf16 a[36:39], v[68:71], v[40:43], a[36:39]
    v_mfma_f32_16x16x32_bf16 a[164:167], v[40:43], v[84:87], a[164:167]
    ds_read_b64_tr_b16 v[106:107], v14 offset:17408
    buffer_load_dwordx4 v27, s[24:27], s65 offen offset:1024 lds
    v_mfma_f32_16x16x32_bf16 a[40:43], v[72:75], v[40:43], a[40:43]
    v_mfma_f32_16x16x32_bf16 a[168:171], v[40:43], v[88:91], a[168:171]
    ds_read_b64_tr_b16 v[108:109], v15 offset:16384
    v_mfma_f32_16x16x32_bf16 a[44:47], v[76:79], v[40:43], a[44:47]
    v_mfma_f32_16x16x32_bf16 a[172:175], v[40:43], v[92:95], a[172:175]
    ds_read_b128 v[40:43], v9 offset:4096
    v_mfma_f32_16x16x32_bf16 a[48:51], v[64:67], v[44:47], a[48:51]
    v_mfma_f32_16x16x32_bf16 a[176:179], v[44:47], v[80:83], a[176:179]
    ds_read_b64_tr_b16 v[110:111], v15 offset:17408
    v_mfma_f32_16x16x32_bf16 a[52:55], v[68:71], v[44:47], a[52:55]
    v_mfma_f32_16x16x32_bf16 a[180:183], v[44:47], v[84:87], a[180:183]
    v_mfma_f32_16x16x32_bf16 a[56:59], v[72:75], v[44:47], a[56:59]
    ds_read_b64_tr_b16 v[112:113], v12 offset:24576
    v_mfma_f32_16x16x32_bf16 a[184:187], v[44:47], v[88:91], a[184:187]
    v_mfma_f32_16x16x32_bf16 a[60:63], v[76:79], v[44:47], a[60:63]
    ds_read_b64_tr_b16 v[114:115], v12 offset:25600
    v_mfma_f32_16x16x32_bf16 a[188:191], v[44:47], v[92:95], a[188:191]
    ds_read_b128 v[44:47], v9 offset:6144
    v_mfma_f32_16x16x32_bf16 a[64:67], v[64:67], v[48:51], a[64:67]
    v_mfma_f32_16x16x32_bf16 a[192:195], v[48:51], v[80:83], a[192:195]
    v_mfma_f32_16x16x32_bf16 a[68:71], v[68:71], v[48:51], a[68:71]
    ds_read_b64_tr_b16 v[116:117], v13 offset:24576
    buffer_load_dwordx4 v28, s[24:27], s65 offen offset:2048 lds
    v_mfma_f32_16x16x32_bf16 a[196:199], v[48:51], v[84:87], a[196:199]
    v_mfma_f32_16x16x32_bf16 a[72:75], v[72:75], v[48:51], a[72:75]
    ds_read_b64_tr_b16 v[118:119], v13 offset:25600
    v_mfma_f32_16x16x32_bf16 a[200:203], v[48:51], v[88:91], a[200:203]
    v_mfma_f32_16x16x32_bf16 a[76:79], v[76:79], v[48:51], a[76:79]
    v_mfma_f32_16x16x32_bf16 a[204:207], v[48:51], v[92:95], a[204:207]
    ds_read_b128 v[48:51], v9 offset:8192
    v_mfma_f32_16x16x32_bf16 a[80:83], v[64:67], v[52:55], a[80:83]
    ds_read_b64_tr_b16 v[120:121], v14 offset:24576
    v_mfma_f32_16x16x32_bf16 a[208:211], v[52:55], v[80:83], a[208:211]
    v_mfma_f32_16x16x32_bf16 a[84:87], v[68:71], v[52:55], a[84:87]
    v_mfma_f32_16x16x32_bf16 a[212:215], v[52:55], v[84:87], a[212:215]
    ds_read_b64_tr_b16 v[122:123], v14 offset:25600
    v_mfma_f32_16x16x32_bf16 a[88:91], v[72:75], v[52:55], a[88:91]
    v_mfma_f32_16x16x32_bf16 a[216:219], v[52:55], v[88:91], a[216:219]
    ds_read_b64_tr_b16 v[124:125], v15 offset:24576
    v_mfma_f32_16x16x32_bf16 a[92:95], v[76:79], v[52:55], a[92:95]
    v_mfma_f32_16x16x32_bf16 a[220:223], v[52:55], v[92:95], a[220:223]
    ds_read_b128 v[52:55], v9 offset:10240
    v_mfma_f32_16x16x32_bf16 a[96:99], v[64:67], v[56:59], a[96:99]
    v_mfma_f32_16x16x32_bf16 a[224:227], v[56:59], v[80:83], a[224:227]
    ds_read_b64_tr_b16 v[126:127], v15 offset:25600
    buffer_load_dwordx4 v29, s[24:27], s65 offen offset:3072 lds
    v_mfma_f32_16x16x32_bf16 a[100:103], v[68:71], v[56:59], a[100:103]
    v_mfma_f32_16x16x32_bf16 a[228:231], v[56:59], v[84:87], a[228:231]
    v_mfma_f32_16x16x32_bf16 a[104:107], v[72:75], v[56:59], a[104:107]
    v_mfma_f32_16x16x32_bf16 a[232:235], v[56:59], v[88:91], a[232:235]
    v_mfma_f32_16x16x32_bf16 a[108:111], v[76:79], v[56:59], a[108:111]
    v_mfma_f32_16x16x32_bf16 a[236:239], v[56:59], v[92:95], a[236:239]
    ds_read_b128 v[56:59], v9 offset:12288
    v_mfma_f32_16x16x32_bf16 a[112:115], v[64:67], v[60:63], a[112:115]
    v_mfma_f32_16x16x32_bf16 a[240:243], v[60:63], v[80:83], a[240:243]
    v_mfma_f32_16x16x32_bf16 a[116:119], v[68:71], v[60:63], a[116:119]
    v_mfma_f32_16x16x32_bf16 a[244:247], v[60:63], v[84:87], a[244:247]
    v_mfma_f32_16x16x32_bf16 a[120:123], v[72:75], v[60:63], a[120:123]
    v_mfma_f32_16x16x32_bf16 a[248:251], v[60:63], v[88:91], a[248:251]
    v_mfma_f32_16x16x32_bf16 a[124:127], v[76:79], v[60:63], a[124:127]
    v_mfma_f32_16x16x32_bf16 a[252:255], v[60:63], v[92:95], a[252:255]
    ds_read_b128 v[60:63], v9 offset:14336
    s_waitcnt lgkmcnt(2)
    v_mfma_f32_16x16x32_bf16 a[0:3], v[96:99], v[32:35], a[0:3]
    v_mfma_f32_16x16x32_bf16 a[128:131], v[32:35], v[112:115], a[128:131]
    s_cmp_lg_u32 s44, 0
    s_cbranch_scc1 main_kernel_noco
    global_load_dword v3, v7, s[72:73] sc1
main_kernel_noco:
    v_mfma_f32_16x16x32_bf16 a[4:7], v[100:103], v[32:35], a[4:7]
    v_mfma_f32_16x16x32_bf16 a[132:135], v[32:35], v[116:119], a[132:135]
    s_waitcnt vmcnt(17) lgkmcnt(0)
    s_barrier
    v_mfma_f32_16x16x32_bf16 a[8:11], v[104:107], v[32:35], a[8:11]
    ds_read_b64_tr_b16 v[64:65], v12 offset:32768
    v_mfma_f32_16x16x32_bf16 a[136:139], v[32:35], v[120:123], a[136:139]
    s_add_u32 m0, s45, 65536
    s_add_u32 s65, s34, 128
    buffer_load_dwordx4 v4, s[16:19], s65 offen offset:0 lds
    v_mfma_f32_16x16x32_bf16 a[12:15], v[108:111], v[32:35], a[12:15]
    ds_read_b64_tr_b16 v[66:67], v12 offset:33792
    v_mfma_f32_16x16x32_bf16 a[140:143], v[32:35], v[124:127], a[140:143]
    ds_read_b128 v[32:35], v8 offset:32768
    v_mfma_f32_16x16x32_bf16 a[16:19], v[96:99], v[36:39], a[16:19]
    v_mfma_f32_16x16x32_bf16 a[144:147], v[36:39], v[112:115], a[144:147]
    buffer_load_dwordx4 v5, s[16:19], s65 offen offset:1024 lds
    v_mfma_f32_16x16x32_bf16 a[20:23], v[100:103], v[36:39], a[20:23]
    ds_read_b64_tr_b16 v[68:69], v13 offset:32768
    v_mfma_f32_16x16x32_bf16 a[148:151], v[36:39], v[116:119], a[148:151]
    v_mfma_f32_16x16x32_bf16 a[24:27], v[104:107], v[36:39], a[24:27]
    ds_read_b64_tr_b16 v[70:71], v13 offset:33792
    v_mfma_f32_16x16x32_bf16 a[152:155], v[36:39], v[120:123], a[152:155]
    v_mfma_f32_16x16x32_bf16 a[28:31], v[108:111], v[36:39], a[28:31]
    buffer_load_dwordx4 v19, s[16:19], s65 offen offset:2048 lds
    v_mfma_f32_16x16x32_bf16 a[156:159], v[36:39], v[124:127], a[156:159]
    ds_read_b128 v[36:39], v8 offset:34816
    v_mfma_f32_16x16x32_bf16 a[32:35], v[96:99], v[40:43], a[32:35]
    ds_read_b64_tr_b16 v[72:73], v14 offset:32768
    v_mfma_f32_16x16x32_bf16 a[160:163], v[40:43], v[112:115], a[160:163]
    v_mfma_f32_16x16x32_bf16 a[36:39], v[100:103], v[40:43], a[36:39]
    v_mfma_f32_16x16x32_bf16 a[164:167], v[40:43], v[116:119], a[164:167]
    ds_read_b64_tr_b16 v[74:75], v14 offset:33792
    buffer_load_dwordx4 v26, s[16:19], s65 offen offset:3072 lds
    v_mfma_f32_16x16x32_bf16 a[40:43], v[104:107], v[40:43], a[40:43]
    v_mfma_f32_16x16x32_bf16 a[168:171], v[40:43], v[120:123], a[168:171]
    ds_read_b64_tr_b16 v[76:77], v15 offset:32768
    v_mfma_f32_16x16x32_bf16 a[44:47], v[108:111], v[40:43], a[44:47]
    v_mfma_f32_16x16x32_bf16 a[172:175], v[40:43], v[124:127], a[172:175]
    ds_read_b128 v[40:43], v8 offset:36864
    v_mfma_f32_16x16x32_bf16 a[48:51], v[96:99], v[44:47], a[48:51]
    s_add_u32 m0, s45, 81920
    s_add_u32 s65, s35, 128
    buffer_load_dwordx4 v4, s[16:19], s65 offen offset:0 lds
    v_mfma_f32_16x16x32_bf16 a[176:179], v[44:47], v[112:115], a[176:179]
    ds_read_b64_tr_b16 v[78:79], v15 offset:33792
    v_mfma_f32_16x16x32_bf16 a[52:55], v[100:103], v[44:47], a[52:55]
    v_mfma_f32_16x16x32_bf16 a[180:183], v[44:47], v[116:119], a[180:183]
    v_mfma_f32_16x16x32_bf16 a[56:59], v[104:107], v[44:47], a[56:59]
    ds_read_b64_tr_b16 v[80:81], v12 offset:40960
    v_mfma_f32_16x16x32_bf16 a[184:187], v[44:47], v[120:123], a[184:187]
    buffer_load_dwordx4 v5, s[16:19], s65 offen offset:1024 lds
    v_mfma_f32_16x16x32_bf16 a[60:63], v[108:111], v[44:47], a[60:63]
    ds_read_b64_tr_b16 v[82:83], v12 offset:41984
    v_mfma_f32_16x16x32_bf16 a[188:191], v[44:47], v[124:127], a[188:191]
    ds_read_b128 v[44:47], v8 offset:38912
    v_mfma_f32_16x16x32_bf16 a[64:67], v[96:99], v[48:51], a[64:67]
    v_mfma_f32_16x16x32_bf16 a[192:195], v[48:51], v[112:115], a[192:195]
    v_mfma_f32_16x16x32_bf16 a[68:71], v[100:103], v[48:51], a[68:71]
    ds_read_b64_tr_b16 v[84:85], v13 offset:40960
    buffer_load_dwordx4 v19, s[16:19], s65 offen offset:2048 lds
    v_mfma_f32_16x16x32_bf16 a[196:199], v[48:51], v[116:119], a[196:199]
    v_mfma_f32_16x16x32_bf16 a[72:75], v[104:107], v[48:51], a[72:75]
    ds_read_b64_tr_b16 v[86:87], v13 offset:41984
    v_mfma_f32_16x16x32_bf16 a[200:203], v[48:51], v[120:123], a[200:203]
    v_mfma_f32_16x16x32_bf16 a[76:79], v[108:111], v[48:51], a[76:79]
    v_mfma_f32_16x16x32_bf16 a[204:207], v[48:51], v[124:127], a[204:207]
    ds_read_b128 v[48:51], v8 offset:40960
    buffer_load_dwordx4 v26, s[16:19], s65 offen offset:3072 lds
    v_mfma_f32_16x16x32_bf16 a[80:83], v[96:99], v[52:55], a[80:83]
    ds_read_b64_tr_b16 v[88:89], v14 offset:40960
    v_mfma_f32_16x16x32_bf16 a[208:211], v[52:55], v[112:115], a[208:211]
    v_mfma_f32_16x16x32_bf16 a[84:87], v[100:103], v[52:55], a[84:87]
    v_mfma_f32_16x16x32_bf16 a[212:215], v[52:55], v[116:119], a[212:215]
    ds_read_b64_tr_b16 v[90:91], v14 offset:41984
    v_mfma_f32_16x16x32_bf16 a[88:91], v[104:107], v[52:55], a[88:91]
    s_add_u32 m0, s45, 16384
    s_add_u32 s65, s49, 524288
    buffer_load_dwordx4 v6, s[24:27], s65 offen offset:0 lds
    v_mfma_f32_16x16x32_bf16 a[216:219], v[52:55], v[120:123], a[216:219]
    ds_read_b64_tr_b16 v[92:93], v15 offset:40960
    v_mfma_f32_16x16x32_bf16 a[92:95], v[108:111], v[52:55], a[92:95]
    v_mfma_f32_16x16x32_bf16 a[220:223], v[52:55], v[124:127], a[220:223]
    ds_read_b128 v[52:55], v8 offset:43008
    v_mfma_f32_16x16x32_bf16 a[96:99], v[96:99], v[56:59], a[96:99]
    v_mfma_f32_16x16x32_bf16 a[224:227], v[56:59], v[112:115], a[224:227]
    ds_read_b64_tr_b16 v[94:95], v15 offset:41984
    buffer_load_dwordx4 v27, s[24:27], s65 offen offset:1024 lds
    v_mfma_f32_16x16x32_bf16 a[100:103], v[100:103], v[56:59], a[100:103]
    v_mfma_f32_16x16x32_bf16 a[228:231], v[56:59], v[116:119], a[228:231]
    v_mfma_f32_16x16x32_bf16 a[104:107], v[104:107], v[56:59], a[104:107]
    v_mfma_f32_16x16x32_bf16 a[232:235], v[56:59], v[120:123], a[232:235]
    v_mfma_f32_16x16x32_bf16 a[108:111], v[108:111], v[56:59], a[108:111]
    buffer_load_dwordx4 v28, s[24:27], s65 offen offset:2048 lds
    v_mfma_f32_16x16x32_bf16 a[236:239], v[56:59], v[124:127], a[236:239]
    ds_read_b128 v[56:59], v8 offset:45056
    v_mfma_f32_16x16x32_bf16 a[112:115], v[96:99], v[60:63], a[112:115]
    v_mfma_f32_16x16x32_bf16 a[240:243], v[60:63], v[112:115], a[240:243]
    v_mfma_f32_16x16x32_bf16 a[116:119], v[100:103], v[60:63], a[116:119]
    v_mfma_f32_16x16x32_bf16 a[244:247], v[60:63], v[116:119], a[244:247]
    buffer_load_dwordx4 v29, s[24:27], s65 offen offset:3072 lds
    v_mfma_f32_16x16x32_bf16 a[120:123], v[104:107], v[60:63], a[120:123]
    v_mfma_f32_16x16x32_bf16 a[248:251], v[60:63], v[120:123], a[248:251]
    v_mfma_f32_16x16x32_bf16 a[124:127], v[108:111], v[60:63], a[124:127]
    v_mfma_f32_16x16x32_bf16 a[252:255], v[60:63], v[124:127], a[252:255]
    ds_read_b128 v[60:63], v8 offset:47104
    s_waitcnt lgkmcnt(2)
    v_mfma_f32_16x16x32_bf16 a[0:3], v[64:67], v[32:35], a[0:3]
    v_mfma_f32_16x16x32_bf16 a[128:131], v[32:35], v[80:83], a[128:131]
    v_mfma_f32_16x16x32_bf16 a[4:7], v[68:71], v[32:35], a[4:7]
    v_mfma_f32_16x16x32_bf16 a[132:135], v[32:35], v[84:87], a[132:135]
    s_waitcnt vmcnt(25) lgkmcnt(0)
    s_barrier
    v_mfma_f32_16x16x32_bf16 a[8:11], v[72:75], v[32:35], a[8:11]
    ds_read_b64_tr_b16 v[96:97], v12 offset:0
    v_mfma_f32_16x16x32_bf16 a[136:139], v[32:35], v[88:91], a[136:139]
    s_add_u32 m0, s45, 32768
    s_add_u32 s65, s49, 1048576
    buffer_load_dwordx4 v6, s[24:27], s65 offen offset:0 lds
    v_mfma_f32_16x16x32_bf16 a[12:15], v[76:79], v[32:35], a[12:15]
    ds_read_b64_tr_b16 v[98:99], v12 offset:1024
    v_mfma_f32_16x16x32_bf16 a[140:143], v[32:35], v[92:95], a[140:143]
    ds_read_b128 v[32:35], v9 offset:32768
    v_mfma_f32_16x16x32_bf16 a[16:19], v[64:67], v[36:39], a[16:19]
    v_mfma_f32_16x16x32_bf16 a[144:147], v[36:39], v[80:83], a[144:147]
    v_mfma_f32_16x16x32_bf16 a[20:23], v[68:71], v[36:39], a[20:23]
    ds_read_b64_tr_b16 v[100:101], v13 offset:0
    v_mfma_f32_16x16x32_bf16 a[148:151], v[36:39], v[84:87], a[148:151]
    v_mfma_f32_16x16x32_bf16 a[24:27], v[72:75], v[36:39], a[24:27]
    ds_read_b64_tr_b16 v[102:103], v13 offset:1024
    v_mfma_f32_16x16x32_bf16 a[152:155], v[36:39], v[88:91], a[152:155]
    v_mfma_f32_16x16x32_bf16 a[28:31], v[76:79], v[36:39], a[28:31]
    v_mfma_f32_16x16x32_bf16 a[156:159], v[36:39], v[92:95], a[156:159]
    ds_read_b128 v[36:39], v9 offset:34816
    v_mfma_f32_16x16x32_bf16 a[32:35], v[64:67], v[40:43], a[32:35]
    ds_read_b64_tr_b16 v[104:105], v14 offset:0
    v_mfma_f32_16x16x32_bf16 a[160:163], v[40:43], v[80:83], a[160:163]
    v_mfma_f32_16x16x32_bf16 a[36:39], v[68:71], v[40:43], a[36:39]
    v_mfma_f32_16x16x32_bf16 a[164:167], v[40:43], v[84:87], a[164:167]
    ds_read_b64_tr_b16 v[106:107], v14 offset:1024
    buffer_load_dwordx4 v27, s[24:27], s65 offen offset:1024 lds
    v_mfma_f32_16x16x32_bf16 a[40:43], v[72:75], v[40:43], a[40:43]
    v_mfma_f32_16x16x32_bf16 a[168:171], v[40:43], v[88:91], a[168:171]
    ds_read_b64_tr_b16 v[108:109], v15 offset:0
    v_mfma_f32_16x16x32_bf16 a[44:47], v[76:79], v[40:43], a[44:47]
    v_mfma_f32_16x16x32_bf16 a[172:175], v[40:43], v[92:95], a[172:175]
    ds_read_b128 v[40:43], v9 offset:36864
    v_mfma_f32_16x16x32_bf16 a[48:51], v[64:67], v[44:47], a[48:51]
    v_mfma_f32_16x16x32_bf16 a[176:179], v[44:47], v[80:83], a[176:179]
    ds_read_b64_tr_b16 v[110:111], v15 offset:1024
    v_mfma_f32_16x16x32_bf16 a[52:55], v[68:71], v[44:47], a[52:55]
    v_mfma_f32_16x16x32_bf16 a[180:183], v[44:47], v[84:87], a[180:183]
    v_mfma_f32_16x16x32_bf16 a[56:59], v[72:75], v[44:47], a[56:59]
    ds_read_b64_tr_b16 v[112:113], v12 offset:8192
    v_mfma_f32_16x16x32_bf16 a[184:187], v[44:47], v[88:91], a[184:187]
    v_mfma_f32_16x16x32_bf16 a[60:63], v[76:79], v[44:47], a[60:63]
    ds_read_b64_tr_b16 v[114:115], v12 offset:9216
    v_mfma_f32_16x16x32_bf16 a[188:191], v[44:47], v[92:95], a[188:191]
    ds_read_b128 v[44:47], v9 offset:38912
    v_mfma_f32_16x16x32_bf16 a[64:67], v[64:67], v[48:51], a[64:67]
    v_mfma_f32_16x16x32_bf16 a[192:195], v[48:51], v[80:83], a[192:195]
    v_mfma_f32_16x16x32_bf16 a[68:71], v[68:71], v[48:51], a[68:71]
    ds_read_b64_tr_b16 v[116:117], v13 offset:8192
    buffer_load_dwordx4 v28, s[24:27], s65 offen offset:2048 lds
    v_mfma_f32_16x16x32_bf16 a[196:199], v[48:51], v[84:87], a[196:199]
    v_mfma_f32_16x16x32_bf16 a[72:75], v[72:75], v[48:51], a[72:75]
    ds_read_b64_tr_b16 v[118:119], v13 offset:9216
    v_mfma_f32_16x16x32_bf16 a[200:203], v[48:51], v[88:91], a[200:203]
    v_mfma_f32_16x16x32_bf16 a[76:79], v[76:79], v[48:51], a[76:79]
    v_mfma_f32_16x16x32_bf16 a[204:207], v[48:51], v[92:95], a[204:207]
    ds_read_b128 v[48:51], v9 offset:40960
    v_mfma_f32_16x16x32_bf16 a[80:83], v[64:67], v[52:55], a[80:83]
    ds_read_b64_tr_b16 v[120:121], v14 offset:8192
    v_mfma_f32_16x16x32_bf16 a[208:211], v[52:55], v[80:83], a[208:211]
    v_mfma_f32_16x16x32_bf16 a[84:87], v[68:71], v[52:55], a[84:87]
    v_mfma_f32_16x16x32_bf16 a[212:215], v[52:55], v[84:87], a[212:215]
    ds_read_b64_tr_b16 v[122:123], v14 offset:9216
    v_mfma_f32_16x16x32_bf16 a[88:91], v[72:75], v[52:55], a[88:91]
    v_mfma_f32_16x16x32_bf16 a[216:219], v[52:55], v[88:91], a[216:219]
    ds_read_b64_tr_b16 v[124:125], v15 offset:8192
    v_mfma_f32_16x16x32_bf16 a[92:95], v[76:79], v[52:55], a[92:95]
    v_mfma_f32_16x16x32_bf16 a[220:223], v[52:55], v[92:95], a[220:223]
    ds_read_b128 v[52:55], v9 offset:43008
    v_mfma_f32_16x16x32_bf16 a[96:99], v[64:67], v[56:59], a[96:99]
    v_mfma_f32_16x16x32_bf16 a[224:227], v[56:59], v[80:83], a[224:227]
    ds_read_b64_tr_b16 v[126:127], v15 offset:9216
    buffer_load_dwordx4 v29, s[24:27], s65 offen offset:3072 lds
    v_mfma_f32_16x16x32_bf16 a[100:103], v[68:71], v[56:59], a[100:103]
    v_mfma_f32_16x16x32_bf16 a[228:231], v[56:59], v[84:87], a[228:231]
    v_mfma_f32_16x16x32_bf16 a[104:107], v[72:75], v[56:59], a[104:107]
    v_mfma_f32_16x16x32_bf16 a[232:235], v[56:59], v[88:91], a[232:235]
    v_mfma_f32_16x16x32_bf16 a[108:111], v[76:79], v[56:59], a[108:111]
    v_mfma_f32_16x16x32_bf16 a[236:239], v[56:59], v[92:95], a[236:239]
    ds_read_b128 v[56:59], v9 offset:45056
    v_mfma_f32_16x16x32_bf16 a[112:115], v[64:67], v[60:63], a[112:115]
    v_mfma_f32_16x16x32_bf16 a[240:243], v[60:63], v[80:83], a[240:243]
    v_mfma_f32_16x16x32_bf16 a[116:119], v[68:71], v[60:63], a[116:119]
    v_mfma_f32_16x16x32_bf16 a[244:247], v[60:63], v[84:87], a[244:247]
    v_mfma_f32_16x16x32_bf16 a[120:123], v[72:75], v[60:63], a[120:123]
    v_mfma_f32_16x16x32_bf16 a[248:251], v[60:63], v[88:91], a[248:251]
    v_mfma_f32_16x16x32_bf16 a[124:127], v[76:79], v[60:63], a[124:127]
    v_mfma_f32_16x16x32_bf16 a[252:255], v[60:63], v[92:95], a[252:255]
    ds_read_b128 v[60:63], v9 offset:47104
    s_waitcnt lgkmcnt(2)
    v_mfma_f32_16x16x32_bf16 a[0:3], v[96:99], v[32:35], a[0:3]
    v_mfma_f32_16x16x32_bf16 a[128:131], v[32:35], v[112:115], a[128:131]
    v_mfma_f32_16x16x32_bf16 a[4:7], v[100:103], v[32:35], a[4:7]
    v_mfma_f32_16x16x32_bf16 a[132:135], v[32:35], v[116:119], a[132:135]
    s_waitcnt vmcnt(16) lgkmcnt(0)
    s_barrier
    v_mfma_f32_16x16x32_bf16 a[8:11], v[104:107], v[32:35], a[8:11]
    ds_read_b64_tr_b16 v[64:65], v12 offset:49152
    v_mfma_f32_16x16x32_bf16 a[136:139], v[32:35], v[120:123], a[136:139]
    s_add_u32 m0, s45, 98304
    s_add_u32 s65, s34, 256
    buffer_load_dwordx4 v4, s[16:19], s65 offen offset:0 lds
    v_mfma_f32_16x16x32_bf16 a[12:15], v[108:111], v[32:35], a[12:15]
    v_mfma_f32_16x16x32_bf16 a[140:143], v[32:35], v[124:127], a[140:143]
    ds_read_b128 v[32:35], v10 offset:0
    v_mfma_f32_16x16x32_bf16 a[16:19], v[96:99], v[36:39], a[16:19]
    v_mfma_f32_16x16x32_bf16 a[144:147], v[36:39], v[112:115], a[144:147]
    buffer_load_dwordx4 v5, s[16:19], s65 offen offset:1024 lds
    v_mfma_f32_16x16x32_bf16 a[20:23], v[100:103], v[36:39], a[20:23]
    ds_read_b64_tr_b16 v[66:67], v12 offset:50176
    v_mfma_f32_16x16x32_bf16 a[148:151], v[36:39], v[116:119], a[148:151]
    v_mfma_f32_16x16x32_bf16 a[24:27], v[104:107], v[36:39], a[24:27]
    v_mfma_f32_16x16x32_bf16 a[152:155], v[36:39], v[120:123], a[152:155]
    v_mfma_f32_16x16x32_bf16 a[28:31], v[108:111], v[36:39], a[28:31]
    buffer_load_dwordx4 v19, s[16:19], s65 offen offset:2048 lds
    v_mfma_f32_16x16x32_bf16 a[156:159], v[36:39], v[124:127], a[156:159]
    ds_read_b128 v[36:39], v10 offset:2048
    v_mfma_f32_16x16x32_bf16 a[32:35], v[96:99], v[40:43], a[32:35]
    ds_read_b64_tr_b16 v[68:69], v13 offset:49152
    v_mfma_f32_16x16x32_bf16 a[160:163], v[40:43], v[112:115], a[160:163]
    v_mfma_f32_16x16x32_bf16 a[36:39], v[100:103], v[40:43], a[36:39]
    v_mfma_f32_16x16x32_bf16 a[164:167], v[40:43], v[116:119], a[164:167]
    buffer_load_dwordx4 v26, s[16:19], s65 offen offset:3072 lds
    v_mfma_f32_16x16x32_bf16 a[40:43], v[104:107], v[40:43], a[40:43]
    v_mfma_f32_16x16x32_bf16 a[168:171], v[40:43], v[120:123], a[168:171]
    ds_read_b64_tr_b16 v[70:71], v13 offset:50176
    v_mfma_f32_16x16x32_bf16 a[44:47], v[108:111], v[40:43], a[44:47]
    v_mfma_f32_16x16x32_bf16 a[172:175], v[40:43], v[124:127], a[172:175]
    ds_read_b128 v[40:43], v10 offset:4096
    v_mfma_f32_16x16x32_bf16 a[48:51], v[96:99], v[44:47], a[48:51]
    s_add_u32 m0, s45, 114688
    s_add_u32 s65, s35, 256
    buffer_load_dwordx4 v4, s[16:19], s65 offen offset:0 lds
    v_mfma_f32_16x16x32_bf16 a[176:179], v[44:47], v[112:115], a[176:179]
    v_mfma_f32_16x16x32_bf16 a[52:55], v[100:103], v[44:47], a[52:55]
    v_mfma_f32_16x16x32_bf16 a[180:183], v[44:47], v[116:119], a[180:183]
    v_mfma_f32_16x16x32_bf16 a[56:59], v[104:107], v[44:47], a[56:59]
    ds_read_b64_tr_b16 v[72:73], v14 offset:49152
    v_mfma_f32_16x16x32_bf16 a[184:187], v[44:47], v[120:123], a[184:187]
    buffer_load_dwordx4 v5, s[16:19], s65 offen offset:1024 lds
    v_mfma_f32_16x16x32_bf16 a[60:63], v[108:111], v[44:47], a[60:63]
    v_mfma_f32_16x16x32_bf16 a[188:191], v[44:47], v[124:127], a[188:191]
    ds_read_b128 v[44:47], v10 offset:6144
    v_mfma_f32_16x16x32_bf16 a[64:67], v[96:99], v[48:51], a[64:67]
    v_mfma_f32_16x16x32_bf16 a[192:195], v[48:51], v[112:115], a[192:195]
    v_mfma_f32_16x16x32_bf16 a[68:71], v[100:103], v[48:51], a[68:71]
    ds_read_b64_tr_b16 v[74:75], v14 offset:50176
    buffer_load_dwordx4 v19, s[16:19], s65 offen offset:2048 lds
    v_mfma_f32_16x16x32_bf16 a[196:199], v[48:51], v[116:119], a[196:199]
    v_mfma_f32_16x16x32_bf16 a[72:75], v[104:107], v[48:51], a[72:75]
    v_mfma_f32_16x16x32_bf16 a[200:203], v[48:51], v[120:123], a[200:203]
    v_mfma_f32_16x16x32_bf16 a[76:79], v[108:111], v[48:51], a[76:79]
    v_mfma_f32_16x16x32_bf16 a[204:207], v[48:51], v[124:127], a[204:207]
    ds_read_b128 v[48:51], v10 offset:8192
    buffer_load_dwordx4 v26, s[16:19], s65 offen offset:3072 lds
    v_mfma_f32_16x16x32_bf16 a[80:83], v[96:99], v[52:55], a[80:83]
    ds_read_b64_tr_b16 v[76:77], v15 offset:49152
    v_mfma_f32_16x16x32_bf16 a[208:211], v[52:55], v[112:115], a[208:211]
    v_mfma_f32_16x16x32_bf16 a[84:87], v[100:103], v[52:55], a[84:87]
    v_mfma_f32_16x16x32_bf16 a[212:215], v[52:55], v[116:119], a[212:215]
    v_mfma_f32_16x16x32_bf16 a[88:91], v[104:107], v[52:55], a[88:91]
    s_add_u32 m0, s45, 0
    s_add_u32 s65, s49, 1572864
    buffer_load_dwordx4 v6, s[24:27], s65 offen offset:0 lds
    v_mfma_f32_16x16x32_bf16 a[216:219], v[52:55], v[120:123], a[216:219]
    ds_read_b64_tr_b16 v[78:79], v15 offset:50176
    v_mfma_f32_16x16x32_bf16 a[92:95], v[108:111], v[52:55], a[92:95]
    v_mfma_f32_16x16x32_bf16 a[220:223], v[52:55], v[124:127], a[220:223]
    ds_read_b128 v[52:55], v10 offset:10240
    v_mfma_f32_16x16x32_bf16 a[96:99], v[96:99], v[56:59], a[96:99]
    v_mfma_f32_16x16x32_bf16 a[224:227], v[56:59], v[112:115], a[224:227]
    buffer_load_dwordx4 v27, s[24:27], s65 offen offset:1024 lds
    v_mfma_f32_16x16x32_bf16 a[100:103], v[100:103], v[56:59], a[100:103]
    v_mfma_f32_16x16x32_bf16 a[228:231], v[56:59], v[116:119], a[228:231]
    v_mfma_f32_16x16x32_bf16 a[104:107], v[104:107], v[56:59], a[104:107]
    v_mfma_f32_16x16x32_bf16 a[232:235], v[56:59], v[120:123], a[232:235]
    v_mfma_f32_16x16x32_bf16 a[108:111], v[108:111], v[56:59], a[108:111]
    buffer_load_dwordx4 v28, s[24:27], s65 offen offset:2048 lds
    v_mfma_f32_16x16x32_bf16 a[236:239], v[56:59], v[124:127], a[236:239]
    ds_read_b128 v[56:59], v10 offset:12288
    v_mfma_f32_16x16x32_bf16 a[112:115], v[96:99], v[60:63], a[112:115]
    v_mfma_f32_16x16x32_bf16 a[240:243], v[60:63], v[112:115], a[240:243]
    v_mfma_f32_16x16x32_bf16 a[116:119], v[100:103], v[60:63], a[116:119]
    v_mfma_f32_16x16x32_bf16 a[244:247], v[60:63], v[116:119], a[244:247]
    buffer_load_dwordx4 v29, s[24:27], s65 offen offset:3072 lds
    v_mfma_f32_16x16x32_bf16 a[120:123], v[104:107], v[60:63], a[120:123]
    v_mfma_f32_16x16x32_bf16 a[248:251], v[60:63], v[120:123], a[248:251]
    v_mfma_f32_16x16x32_bf16 a[124:127], v[108:111], v[60:63], a[124:127]
    v_mfma_f32_16x16x32_bf16 a[252:255], v[60:63], v[124:127], a[252:255]
    ds_read_b128 v[60:63], v10 offset:14336
    s_waitcnt lgkmcnt(3)
    v_mfma_f32_16x16x32_bf16 v[128:131], v[64:67], v[32:35], 0
    ds_read_b64_tr_b16 v[96:97], v12 offset:57344
    v_mfma_f32_16x16x32_bf16 v[132:135], v[68:71], v[32:35], 0
    v_mfma_f32_16x16x32_bf16 v[136:139], v[72:75], v[32:35], 0
    ds_read_b64_tr_b16 v[98:99], v12 offset:58368
    v_mfma_f32_16x16x32_bf16 v[140:143], v[76:79], v[32:35], 0
    ds_read_b128 v[32:35], v11 offset:0
    v_mfma_f32_16x16x32_bf16 v[144:147], v[64:67], v[36:39], 0
    v_accvgpr_read_b32 v24, a4
    v_mfma_f32_16x16x32_bf16 v[148:151], v[68:71], v[36:39], 0
    v_accvgpr_read_b32 v25, a5
    v_accvgpr_read_b32 v30, a6
    v_mfma_f32_16x16x32_bf16 v[152:155], v[72:75], v[36:39], 0
    ds_read_b64_tr_b16 v[100:101], v13 offset:57344
    v_mfma_f32_16x16x32_bf16 v[156:159], v[76:79], v[36:39], 0
    ds_read_b128 v[36:39], v11 offset:2048
    v_accvgpr_read_b32 v31, a7
    v_mfma_f32_16x16x32_bf16 v[160:163], v[64:67], v[40:43], 0
    v_accvgpr_read_b32 v20, a0
    v_mfma_f32_16x16x32_bf16 v[164:167], v[68:71], v[40:43], 0
    ds_read_b64_tr_b16 v[102:103], v13 offset:58368
    v_mfma_f32_16x16x32_bf16 v[168:171], v[72:75], v[40:43], 0
    v_accvgpr_read_b32 v21, a1
    v_accvgpr_read_b32 v22, a2
    v_mfma_f32_16x16x32_bf16 v[172:175], v[76:79], v[40:43], 0
    ds_read_b128 v[40:43], v11 offset:4096
    v_mfma_f32_16x16x32_bf16 v[176:179], v[64:67], v[44:47], 0
    v_accvgpr_read_b32 v23, a3
    v_cvt_pk_bf16_f32 v20, v20, v21
    v_mfma_f32_16x16x32_bf16 v[180:183], v[68:71], v[44:47], 0
    ds_read_b64_tr_b16 v[104:105], v14 offset:57344
    v_mfma_f32_16x16x32_bf16 v[184:187], v[72:75], v[44:47], 0
    v_cvt_pk_bf16_f32 v21, v22, v23
    v_mfma_f32_16x16x32_bf16 v[188:191], v[76:79], v[44:47], 0
    ds_read_b128 v[44:47], v11 offset:6144
    v_cvt_pk_bf16_f32 v22, v24, v25
    v_mfma_f32_16x16x32_bf16 v[192:195], v[64:67], v[48:51], 0
    ds_read_b64_tr_b16 v[106:107], v14 offset:58368
    v_mfma_f32_16x16x32_bf16 v[196:199], v[68:71], v[48:51], 0
    v_cvt_pk_bf16_f32 v23, v30, v31
    buffer_store_dwordx4 v[20:23], v16, s[40:43], s60 offen offset:0 sc1
    v_mfma_f32_16x16x32_bf16 v[200:203], v[72:75], v[48:51], 0
    v_accvgpr_read_b32 v24, a12
    v_mfma_f32_16x16x32_bf16 v[204:207], v[76:79], v[48:51], 0
    ds_read_b128 v[48:51], v11 offset:8192
    s_waitcnt lgkmcnt(13)
    v_mfma_f32_16x16x32_bf16 v[208:211], v[64:67], v[52:55], 0
    ds_read_b64_tr_b16 v[108:109], v15 offset:57344
    v_accvgpr_read_b32 v25, a13
    v_mfma_f32_16x16x32_bf16 v[212:215], v[68:71], v[52:55], 0
    v_accvgpr_read_b32 v30, a14
    v_mfma_f32_16x16x32_bf16 v[216:219], v[72:75], v[52:55], 0
    ds_read_b64_tr_b16 v[110:111], v15 offset:58368
    v_mfma_f32_16x16x32_bf16 v[220:223], v[76:79], v[52:55], 0
    ds_read_b128 v[52:55], v11 offset:10240
    v_accvgpr_read_b32 v31, a15
    s_waitcnt lgkmcnt(15)
    v_mfma_f32_16x16x32_bf16 v[224:227], v[64:67], v[56:59], 0
    v_accvgpr_read_b32 v20, a8
    v_mfma_f32_16x16x32_bf16 v[228:231], v[68:71], v[56:59], 0
    v_accvgpr_read_b32 v21, a9
    v_accvgpr_read_b32 v22, a10
    v_mfma_f32_16x16x32_bf16 v[232:235], v[72:75], v[56:59], 0
    v_accvgpr_read_b32 v23, a11
    v_mfma_f32_16x16x32_bf16 v[236:239], v[76:79], v[56:59], 0
    ds_read_b128 v[56:59], v11 offset:12288
    s_waitcnt lgkmcnt(15)
    v_mfma_f32_16x16x32_bf16 v[240:243], v[64:67], v[60:63], 0
    v_cvt_pk_bf16_f32 v20, v20, v21
    v_cvt_pk_bf16_f32 v21, v22, v23
    v_mfma_f32_16x16x32_bf16 v[244:247], v[68:71], v[60:63], 0
    v_cvt_pk_bf16_f32 v22, v24, v25
    v_mfma_f32_16x16x32_bf16 v[248:251], v[72:75], v[60:63], 0
    v_cvt_pk_bf16_f32 v23, v30, v31
    buffer_store_dwordx4 v[20:23], v16, s[40:43], s60 offen offset:2048 sc1
    v_mfma_f32_16x16x32_bf16 v[252:255], v[76:79], v[60:63], 0
    ds_read_b128 v[60:63], v11 offset:14336
    s_waitcnt lgkmcnt(3)
    v_mfma_f32_16x16x32_bf16 v[128:131], v[96:99], v[32:35], v[128:131]
    v_accvgpr_read_b32 v24, a20
    v_accvgpr_read_b32 v25, a21
    v_mfma_f32_16x16x32_bf16 v[132:135], v[100:103], v[32:35], v[132:135]
    v_accvgpr_read_b32 v30, a22
    v_accvgpr_read_b32 v31, a23
    v_mfma_f32_16x16x32_bf16 v[136:139], v[104:107], v[32:35], v[136:139]
    v_accvgpr_read_b32 v20, a16
    v_mfma_f32_16x16x32_bf16 v[140:143], v[108:111], v[32:35], v[140:143]
    s_waitcnt vmcnt(18) lgkmcnt(0)
    s_barrier
    v_mfma_f32_16x16x32_bf16 v[144:147], v[96:99], v[36:39], v[144:147]
    ds_read_b128 v[32:35], v8 offset:0
    v_accvgpr_read_b32 v21, a17
    v_mfma_f32_16x16x32_bf16 v[148:151], v[100:103], v[36:39], v[148:151]
    ds_read_b64_tr_b16 v[64:65], v12 offset:16384
    s_add_u32 m0, s45, 131072
    s_add_u32 s65, s34, 384
    buffer_load_dwordx4 v4, s[16:19], s65 offen offset:0 lds
    v_mfma_f32_16x16x32_bf16 v[152:155], v[104:107], v[36:39], v[152:155]
    v_mfma_f32_16x16x32_bf16 v[156:159], v[108:111], v[36:39], v[156:159]
    ds_read_b128 v[36:39], v8 offset:2048
    v_mfma_f32_16x16x32_bf16 v[160:163], v[96:99], v[40:43], v[160:163]
    ds_read_b64_tr_b16 v[66:67], v12 offset:17408
    buffer_load_dwordx4 v5, s[16:19], s65 offen offset:1024 lds
    v_mfma_f32_16x16x32_bf16 v[164:167], v[100:103], v[40:43], v[164:167]
    v_accvgpr_read_b32 v22, a18
    v_accvgpr_read_b32 v23, a19
    v_mfma_f32_16x16x32_bf16 v[168:171], v[104:107], v[40:43], v[168:171]
    ds_read_b64_tr_b16 v[68:69], v13 offset:16384
    v_mfma_f32_16x16x32_bf16 v[172:175], v[108:111], v[40:43], v[172:175]
    ds_read_b128 v[40:43], v8 offset:4096
    buffer_load_dwordx4 v19, s[16:19], s65 offen offset:2048 lds
    v_mfma_f32_16x16x32_bf16 v[176:179], v[96:99], v[44:47], v[176:179]
    v_cvt_pk_bf16_f32 v20, v20, v21
    v_cvt_pk_bf16_f32 v21, v22, v23
    v_mfma_f32_16x16x32_bf16 v[180:183], v[100:103], v[44:47], v[180:183]
    ds_read_b64_tr_b16 v[70:71], v13 offset:17408
    v_cvt_pk_bf16_f32 v22, v24, v25
    v_mfma_f32_16x16x32_bf16 v[184:187], v[104:107], v[44:47], v[184:187]
    v_cvt_pk_bf16_f32 v23, v30, v31
    v_mfma_f32_16x16x32_bf16 v[188:191], v[108:111], v[44:47], v[188:191]
    ds_read_b128 v[44:47], v8 offset:6144
    buffer_load_dwordx4 v26, s[16:19], s65 offen offset:3072 lds
    v_mfma_f32_16x16x32_bf16 v[192:195], v[96:99], v[48:51], v[192:195]
    ds_read_b64_tr_b16 v[72:73], v14 offset:16384
    buffer_store_dwordx4 v[20:23], v16, s[40:43], s60 offen offset:128 sc1
    v_mfma_f32_16x16x32_bf16 v[196:199], v[100:103], v[48:51], v[196:199]
    v_accvgpr_read_b32 v24, a28
    v_accvgpr_read_b32 v25, a29
    v_mfma_f32_16x16x32_bf16 v[200:203], v[104:107], v[48:51], v[200:203]
    ds_read_b64_tr_b16 v[74:75], v14 offset:17408
    s_add_u32 m0, s45, 147456
    s_add_u32 s65, s35, 384
    buffer_load_dwordx4 v4, s[16:19], s65 offen offset:0 lds
    v_mfma_f32_16x16x32_bf16 v[204:207], v[108:111], v[48:51], v[204:207]
    ds_read_b128 v[48:51], v8 offset:8192
    v_mfma_f32_16x16x32_bf16 v[208:211], v[96:99], v[52:55], v[208:211]
    v_mfma_f32_16x16x32_bf16 v[212:215], v[100:103], v[52:55], v[212:215]
    ds_read_b64_tr_b16 v[76:77], v15 offset:16384
    buffer_load_dwordx4 v5, s[16:19], s65 offen offset:1024 lds
    v_mfma_f32_16x16x32_bf16 v[216:219], v[104:107], v[52:55], v[216:219]
    v_accvgpr_read_b32 v30, a30
    v_mfma_f32_16x16x32_bf16 v[220:223], v[108:111], v[52:55], v[220:223]
    ds_read_b128 v[52:55], v8 offset:10240
    v_accvgpr_read_b32 v31, a31
    v_mfma_f32_16x16x32_bf16 v[224:227], v[96:99], v[56:59], v[224:227]
    ds_read_b64_tr_b16 v[78:79], v15 offset:17408
    v_accvgpr_read_b32 v20, a24
    v_mfma_f32_16x16x32_bf16 v[228:231], v[100:103], v[56:59], v[228:231]
    buffer_load_dwordx4 v19, s[16:19], s65 offen offset:2048 lds
    v_accvgpr_read_b32 v21, a25
    v_mfma_f32_16x16x32_bf16 v[232:235], v[104:107], v[56:59], v[232:235]
    v_accvgpr_read_b32 v22, a26
    v_mfma_f32_16x16x32_bf16 v[236:239], v[108:111], v[56:59], v[236:239]
    ds_read_b128 v[56:59], v8 offset:12288
    v_accvgpr_read_b32 v23, a27
    v_mfma_f32_16x16x32_bf16 v[240:243], v[96:99], v[60:63], v[240:243]
    buffer_load_dwordx4 v26, s[16:19], s65 offen offset:3072 lds
    v_cvt_pk_bf16_f32 v20, v20, v21
    v_mfma_f32_16x16x32_bf16 v[244:247], v[100:103], v[60:63], v[244:247]
    v_cvt_pk_bf16_f32 v21, v22, v23
    v_cvt_pk_bf16_f32 v22, v24, v25
    v_mfma_f32_16x16x32_bf16 v[248:251], v[104:107], v[60:63], v[248:251]
    v_cvt_pk_bf16_f32 v23, v30, v31
    v_mfma_f32_16x16x32_bf16 v[252:255], v[108:111], v[60:63], v[252:255]
    ds_read_b128 v[60:63], v8 offset:14336
    buffer_store_dwordx4 v[20:23], v16, s[40:43], s60 offen offset:2176 sc1
    s_waitcnt lgkmcnt(2)
    v_mfma_f32_16x16x32_bf16 v[128:131], v[64:67], v[32:35], v[128:131]
    ds_read_b64_tr_b16 v[96:97], v12 offset:24576
    v_accvgpr_read_b32 v24, a36
    v_mfma_f32_16x16x32_bf16 v[132:135], v[68:71], v[32:35], v[132:135]
    s_add_u32 m0, s45, 49152
    s_add_u32 s65, s49, 2097152
    buffer_load_dwordx4 v6, s[24:27], s65 offen offset:0 lds
    v_mfma_f32_16x16x32_bf16 v[136:139], v[72:75], v[32:35], v[136:139]
    ds_read_b64_tr_b16 v[98:99], v12 offset:25600
    v_mfma_f32_16x16x32_bf16 v[140:143], v[76:79], v[32:35], v[140:143]
    ds_read_b128 v[32:35], v9 offset:0
    v_mfma_f32_16x16x32_bf16 v[144:147], v[64:67], v[36:39], v[144:147]
    v_accvgpr_read_b32 v25, a37
    v_mfma_f32_16x16x32_bf16 v[148:151], v[68:71], v[36:39], v[148:151]
    v_accvgpr_read_b32 v30, a38
    v_mfma_f32_16x16x32_bf16 v[152:155], v[72:75], v[36:39], v[152:155]
    ds_read_b64_tr_b16 v[100:101], v13 offset:24576
    v_accvgpr_read_b32 v31, a39
    v_mfma_f32_16x16x32_bf16 v[156:159], v[76:79], v[36:39], v[156:159]
    ds_read_b128 v[36:39], v9 offset:2048
    v_mfma_f32_16x16x32_bf16 v[160:163], v[64:67], v[40:43], v[160:163]
    buffer_load_dwordx4 v27, s[24:27], s65 offen offset:1024 lds
    v_accvgpr_read_b32 v20, a32
    v_mfma_f32_16x16x32_bf16 v[164:167], v[68:71], v[40:43], v[164:167]
    ds_read_b64_tr_b16 v[102:103], v13 offset:25600
    v_mfma_f32_16x16x32_bf16 v[168:171], v[72:75], v[40:43], v[168:171]
    v_accvgpr_read_b32 v21, a33
    v_accvgpr_read_b32 v22, a34
    v_mfma_f32_16x16x32_bf16 v[172:175], v[76:79], v[40:43], v[172:175]
    ds_read_b128 v[40:43], v9 offset:4096
    v_mfma_f32_16x16x32_bf16 v[176:179], v[64:67], v[44:47], v[176:179]
    v_accvgpr_read_b32 v23, a35
    v_cvt_pk_bf16_f32 v20, v20, v21
    v_mfma_f32_16x16x32_bf16 v[180:183], v[68:71], v[44:47], v[180:183]
    ds_read_b64_tr_b16 v[104:105], v14 offset:24576
    v_mfma_f32_16x16x32_bf16 v[184:187], v[72:75], v[44:47], v[184:187]
    v_cvt_pk_bf16_f32 v21, v22, v23
    v_cvt_pk_bf16_f32 v22, v24, v25
    v_mfma_f32_16x16x32_bf16 v[188:191], v[76:79], v[44:47], v[188:191]
    ds_read_b128 v[44:47], v9 offset:6144
    v_mfma_f32_16x16x32_bf16 v[192:195], v[64:67], v[48:51], v[192:195]
    ds_read_b64_tr_b16 v[106:107], v14 offset:25600
    buffer_load_dwordx4 v28, s[24:27], s65 offen offset:2048 lds
    v_mfma_f32_16x16x32_bf16 v[196:199], v[68:71], v[48:51], v[196:199]
    v_cvt_pk_bf16_f32 v23, v30, v31
    v_mfma_f32_16x16x32_bf16 v[200:203], v[72:75], v[48:51], v[200:203]
    buffer_store_dwordx4 v[20:23], v16, s[40:43], s61 offen offset:0 sc1
    v_accvgpr_read_b32 v24, a44
    v_mfma_f32_16x16x32_bf16 v[204:207], v[76:79], v[48:51], v[204:207]
    ds_read_b128 v[48:51], v9 offset:8192
    v_mfma_f32_16x16x32_bf16 v[208:211], v[64:67], v[52:55], v[208:211]
    ds_read_b64_tr_b16 v[108:109], v15 offset:24576
    v_accvgpr_read_b32 v25, a45
    v_mfma_f32_16x16x32_bf16 v[212:215], v[68:71], v[52:55], v[212:215]
    v_accvgpr_read_b32 v30, a46
    v_mfma_f32_16x16x32_bf16 v[216:219], v[72:75], v[52:55], v[216:219]
    ds_read_b64_tr_b16 v[110:111], v15 offset:25600
    v_accvgpr_read_b32 v31, a47
    v_mfma_f32_16x16x32_bf16 v[220:223], v[76:79], v[52:55], v[220:223]
    ds_read_b128 v[52:55], v9 offset:10240
    s_waitcnt lgkmcnt(15)
    v_mfma_f32_16x16x32_bf16 v[224:227], v[64:67], v[56:59], v[224:227]
    buffer_load_dwordx4 v29, s[24:27], s65 offen offset:3072 lds
    v_accvgpr_read_b32 v20, a40
    v_mfma_f32_16x16x32_bf16 v[228:231], v[68:71], v[56:59], v[228:231]
    v_accvgpr_read_b32 v21, a41
    v_mfma_f32_16x16x32_bf16 v[232:235], v[72:75], v[56:59], v[232:235]
    v_accvgpr_read_b32 v22, a42
    v_accvgpr_read_b32 v23, a43
    v_mfma_f32_16x16x32_bf16 v[236:239], v[76:79], v[56:59], v[236:239]
    ds_read_b128 v[56:59], v9 offset:12288
    s_waitcnt lgkmcnt(15)
    v_mfma_f32_16x16x32_bf16 v[240:243], v[64:67], v[60:63], v[240:243]
    v_cvt_pk_bf16_f32 v20, v20, v21
    v_cvt_pk_bf16_f32 v21, v22, v23
    v_mfma_f32_16x16x32_bf16 v[244:247], v[68:71], v[60:63], v[244:247]
    v_cvt_pk_bf16_f32 v22, v24, v25
    v_mfma_f32_16x16x32_bf16 v[248:251], v[72:75], v[60:63], v[248:251]
    v_cvt_pk_bf16_f32 v23, v30, v31
    buffer_store_dwordx4 v[20:23], v16, s[40:43], s61 offen offset:2048 sc1
    v_mfma_f32_16x16x32_bf16 v[252:255], v[76:79], v[60:63], v[252:255]
    ds_read_b128 v[60:63], v9 offset:14336
    s_waitcnt lgkmcnt(3)
    v_mfma_f32_16x16x32_bf16 v[128:131], v[96:99], v[32:35], v[128:131]
    v_accvgpr_read_b32 v24, a52
    v_accvgpr_read_b32 v25, a53
    v_mfma_f32_16x16x32_bf16 v[132:135], v[100:103], v[32:35], v[132:135]
    v_accvgpr_read_b32 v30, a54
    v_accvgpr_read_b32 v31, a55
    v_mfma_f32_16x16x32_bf16 v[136:139], v[104:107], v[32:35], v[136:139]
    v_accvgpr_read_b32 v20, a48
    v_mfma_f32_16x16x32_bf16 v[140:143], v[108:111], v[32:35], v[140:143]
    s_waitcnt vmcnt(22) lgkmcnt(0)
    s_barrier
    v_mfma_f32_16x16x32_bf16 v[144:147], v[96:99], v[36:39], v[144:147]
    ds_read_b128 v[32:35], v8 offset:32768
    v_accvgpr_read_b32 v21, a49
    v_mfma_f32_16x16x32_bf16 v[148:151], v[100:103], v[36:39], v[148:151]
    ds_read_b64_tr_b16 v[64:65], v12 offset:32768
    s_add_u32 m0, s45, 65536
    s_add_u32 s65, s34, 512
    buffer_load_dwordx4 v4, s[16:19], s65 offen offset:0 lds
    v_mfma_f32_16x16x32_bf16 v[152:155], v[104:107], v[36:39], v[152:155]
    v_mfma_f32_16x16x32_bf16 v[156:159], v[108:111], v[36:39], v[156:159]
    ds_read_b128 v[36:39], v8 offset:34816
    v_mfma_f32_16x16x32_bf16 v[160:163], v[96:99], v[40:43], v[160:163]
    ds_read_b64_tr_b16 v[66:67], v12 offset:33792
    buffer_load_dwordx4 v5, s[16:19], s65 offen offset:1024 lds
    v_mfma_f32_16x16x32_bf16 v[164:167], v[100:103], v[40:43], v[164:167]
    v_accvgpr_read_b32 v22, a50
    v_accvgpr_read_b32 v23, a51
    v_mfma_f32_16x16x32_bf16 v[168:171], v[104:107], v[40:43], v[168:171]
    ds_read_b64_tr_b16 v[68:69], v13 offset:32768
    v_mfma_f32_16x16x32_bf16 v[172:175], v[108:111], v[40:43], v[172:175]
    ds_read_b128 v[40:43], v8 offset:36864
    buffer_load_dwordx4 v19, s[16:19], s65 offen offset:2048 lds
    v_mfma_f32_16x16x32_bf16 v[176:179], v[96:99], v[44:47], v[176:179]
    v_cvt_pk_bf16_f32 v20, v20, v21
    v_cvt_pk_bf16_f32 v21, v22, v23
    v_mfma_f32_16x16x32_bf16 v[180:183], v[100:103], v[44:47], v[180:183]
    ds_read_b64_tr_b16 v[70:71], v13 offset:33792
    v_cvt_pk_bf16_f32 v22, v24, v25
    v_mfma_f32_16x16x32_bf16 v[184:187], v[104:107], v[44:47], v[184:187]
    v_cvt_pk_bf16_f32 v23, v30, v31
    v_mfma_f32_16x16x32_bf16 v[188:191], v[108:111], v[44:47], v[188:191]
    ds_read_b128 v[44:47], v8 offset:38912
    buffer_load_dwordx4 v26, s[16:19], s65 offen offset:3072 lds
    v_mfma_f32_16x16x32_bf16 v[192:195], v[96:99], v[48:51], v[192:195]
    ds_read_b64_tr_b16 v[72:73], v14 offset:32768
    buffer_store_dwordx4 v[20:23], v16, s[40:43], s61 offen offset:128 sc1
    v_mfma_f32_16x16x32_bf16 v[196:199], v[100:103], v[48:51], v[196:199]
    v_accvgpr_read_b32 v24, a60
    v_accvgpr_read_b32 v25, a61
    v_mfma_f32_16x16x32_bf16 v[200:203], v[104:107], v[48:51], v[200:203]
    ds_read_b64_tr_b16 v[74:75], v14 offset:33792
    s_add_u32 m0, s45, 81920
    s_add_u32 s65, s35, 512
    buffer_load_dwordx4 v4, s[16:19], s65 offen offset:0 lds
    v_mfma_f32_16x16x32_bf16 v[204:207], v[108:111], v[48:51], v[204:207]
    ds_read_b128 v[48:51], v8 offset:40960
    v_mfma_f32_16x16x32_bf16 v[208:211], v[96:99], v[52:55], v[208:211]
    v_mfma_f32_16x16x32_bf16 v[212:215], v[100:103], v[52:55], v[212:215]
    ds_read_b64_tr_b16 v[76:77], v15 offset:32768
    buffer_load_dwordx4 v5, s[16:19], s65 offen offset:1024 lds
    v_mfma_f32_16x16x32_bf16 v[216:219], v[104:107], v[52:55], v[216:219]
    v_accvgpr_read_b32 v30, a62
    v_mfma_f32_16x16x32_bf16 v[220:223], v[108:111], v[52:55], v[220:223]
    ds_read_b128 v[52:55], v8 offset:43008
    v_accvgpr_read_b32 v31, a63
    v_mfma_f32_16x16x32_bf16 v[224:227], v[96:99], v[56:59], v[224:227]
    ds_read_b64_tr_b16 v[78:79], v15 offset:33792
    v_accvgpr_read_b32 v20, a56
    v_mfma_f32_16x16x32_bf16 v[228:231], v[100:103], v[56:59], v[228:231]
    buffer_load_dwordx4 v19, s[16:19], s65 offen offset:2048 lds
    v_accvgpr_read_b32 v21, a57
    v_mfma_f32_16x16x32_bf16 v[232:235], v[104:107], v[56:59], v[232:235]
    v_accvgpr_read_b32 v22, a58
    v_mfma_f32_16x16x32_bf16 v[236:239], v[108:111], v[56:59], v[236:239]
    ds_read_b128 v[56:59], v8 offset:45056
    v_accvgpr_read_b32 v23, a59
    v_mfma_f32_16x16x32_bf16 v[240:243], v[96:99], v[60:63], v[240:243]
    buffer_load_dwordx4 v26, s[16:19], s65 offen offset:3072 lds
    v_cvt_pk_bf16_f32 v20, v20, v21
    v_mfma_f32_16x16x32_bf16 v[244:247], v[100:103], v[60:63], v[244:247]
    v_cvt_pk_bf16_f32 v21, v22, v23
    v_cvt_pk_bf16_f32 v22, v24, v25
    v_mfma_f32_16x16x32_bf16 v[248:251], v[104:107], v[60:63], v[248:251]
    v_cvt_pk_bf16_f32 v23, v30, v31
    v_mfma_f32_16x16x32_bf16 v[252:255], v[108:111], v[60:63], v[252:255]
    ds_read_b128 v[60:63], v8 offset:47104
    buffer_store_dwordx4 v[20:23], v16, s[40:43], s61 offen offset:2176 sc1
    s_waitcnt lgkmcnt(2)
    v_mfma_f32_16x16x32_bf16 v[128:131], v[64:67], v[32:35], v[128:131]
    ds_read_b64_tr_b16 v[96:97], v12 offset:40960
    v_accvgpr_read_b32 v24, a68
    v_mfma_f32_16x16x32_bf16 v[132:135], v[68:71], v[32:35], v[132:135]
    s_add_u32 m0, s45, 16384
    s_add_u32 s65, s49, 2621440
    buffer_load_dwordx4 v6, s[24:27], s65 offen offset:0 lds
    v_mfma_f32_16x16x32_bf16 v[136:139], v[72:75], v[32:35], v[136:139]
    ds_read_b64_tr_b16 v[98:99], v12 offset:41984
    v_mfma_f32_16x16x32_bf16 v[140:143], v[76:79], v[32:35], v[140:143]
    ds_read_b128 v[32:35], v9 offset:32768
    v_mfma_f32_16x16x32_bf16 v[144:147], v[64:67], v[36:39], v[144:147]
    v_accvgpr_read_b32 v25, a69
    v_mfma_f32_16x16x32_bf16 v[148:151], v[68:71], v[36:39], v[148:151]
    v_accvgpr_read_b32 v30, a70
    v_mfma_f32_16x16x32_bf16 v[152:155], v[72:75], v[36:39], v[152:155]
    ds_read_b64_tr_b16 v[100:101], v13 offset:40960
    v_accvgpr_read_b32 v31, a71
    v_mfma_f32_16x16x32_bf16 v[156:159], v[76:79], v[36:39], v[156:159]
    ds_read_b128 v[36:39], v9 offset:34816
    v_mfma_f32_16x16x32_bf16 v[160:163], v[64:67], v[40:43], v[160:163]
    buffer_load_dwordx4 v27, s[24:27], s65 offen offset:1024 lds
    v_accvgpr_read_b32 v20, a64
    v_mfma_f32_16x16x32_bf16 v[164:167], v[68:71], v[40:43], v[164:167]
    ds_read_b64_tr_b16 v[102:103], v13 offset:41984
    v_mfma_f32_16x16x32_bf16 v[168:171], v[72:75], v[40:43], v[168:171]
    v_accvgpr_read_b32 v21, a65
    v_accvgpr_read_b32 v22, a66
    v_mfma_f32_16x16x32_bf16 v[172:175], v[76:79], v[40:43], v[172:175]
    ds_read_b128 v[40:43], v9 offset:36864
    v_mfma_f32_16x16x32_bf16 v[176:179], v[64:67], v[44:47], v[176:179]
    v_accvgpr_read_b32 v23, a67
    v_cvt_pk_bf16_f32 v20, v20, v21
    v_mfma_f32_16x16x32_bf16 v[180:183], v[68:71], v[44:47], v[180:183]
    ds_read_b64_tr_b16 v[104:105], v14 offset:40960
    v_mfma_f32_16x16x32_bf16 v[184:187], v[72:75], v[44:47], v[184:187]
    v_cvt_pk_bf16_f32 v21, v22, v23
    v_cvt_pk_bf16_f32 v22, v24, v25
    v_mfma_f32_16x16x32_bf16 v[188:191], v[76:79], v[44:47], v[188:191]
    ds_read_b128 v[44:47], v9 offset:38912
    v_mfma_f32_16x16x32_bf16 v[192:195], v[64:67], v[48:51], v[192:195]
    ds_read_b64_tr_b16 v[106:107], v14 offset:41984
    buffer_load_dwordx4 v28, s[24:27], s65 offen offset:2048 lds
    v_mfma_f32_16x16x32_bf16 v[196:199], v[68:71], v[48:51], v[196:199]
    v_cvt_pk_bf16_f32 v23, v30, v31
    v_mfma_f32_16x16x32_bf16 v[200:203], v[72:75], v[48:51], v[200:203]
    buffer_store_dwordx4 v[20:23], v16, s[40:43], s62 offen offset:0 sc1
    v_accvgpr_read_b32 v24, a76
    v_mfma_f32_16x16x32_bf16 v[204:207], v[76:79], v[48:51], v[204:207]
    ds_read_b128 v[48:51], v9 offset:40960
    v_mfma_f32_16x16x32_bf16 v[208:211], v[64:67], v[52:55], v[208:211]
    ds_read_b64_tr_b16 v[108:109], v15 offset:40960
    v_accvgpr_read_b32 v25, a77
    v_mfma_f32_16x16x32_bf16 v[212:215], v[68:71], v[52:55], v[212:215]
    v_accvgpr_read_b32 v30, a78
    v_mfma_f32_16x16x32_bf16 v[216:219], v[72:75], v[52:55], v[216:219]
    ds_read_b64_tr_b16 v[110:111], v15 offset:41984
    v_accvgpr_read_b32 v31, a79
    v_mfma_f32_16x16x32_bf16 v[220:223], v[76:79], v[52:55], v[220:223]
    ds_read_b128 v[52:55], v9 offset:43008
    s_waitcnt lgkmcnt(15)
    v_mfma_f32_16x16x32_bf16 v[224:227], v[64:67], v[56:59], v[224:227]
    buffer_load_dwordx4 v29, s[24:27], s65 offen offset:3072 lds
    v_accvgpr_read_b32 v20, a72
    v_mfma_f32_16x16x32_bf16 v[228:231], v[68:71], v[56:59], v[228:231]
    v_accvgpr_read_b32 v21, a73
    v_mfma_f32_16x16x32_bf16 v[232:235], v[72:75], v[56:59], v[232:235]
    v_accvgpr_read_b32 v22, a74
    v_accvgpr_read_b32 v23, a75
    v_mfma_f32_16x16x32_bf16 v[236:239], v[76:79], v[56:59], v[236:239]
    ds_read_b128 v[56:59], v9 offset:45056
    s_waitcnt lgkmcnt(15)
    v_mfma_f32_16x16x32_bf16 v[240:243], v[64:67], v[60:63], v[240:243]
    v_cvt_pk_bf16_f32 v20, v20, v21
    v_cvt_pk_bf16_f32 v21, v22, v23
    v_mfma_f32_16x16x32_bf16 v[244:247], v[68:71], v[60:63], v[244:247]
    v_cvt_pk_bf16_f32 v22, v24, v25
    v_mfma_f32_16x16x32_bf16 v[248:251], v[72:75], v[60:63], v[248:251]
    v_cvt_pk_bf16_f32 v23, v30, v31
    buffer_store_dwordx4 v[20:23], v16, s[40:43], s62 offen offset:2048 sc1
    v_mfma_f32_16x16x32_bf16 v[252:255], v[76:79], v[60:63], v[252:255]
    ds_read_b128 v[60:63], v9 offset:47104
    s_waitcnt lgkmcnt(3)
    v_mfma_f32_16x16x32_bf16 v[128:131], v[96:99], v[32:35], v[128:131]
    v_accvgpr_read_b32 v24, a84
    v_accvgpr_read_b32 v25, a85
    v_mfma_f32_16x16x32_bf16 v[132:135], v[100:103], v[32:35], v[132:135]
    v_accvgpr_read_b32 v30, a86
    v_accvgpr_read_b32 v31, a87
    v_mfma_f32_16x16x32_bf16 v[136:139], v[104:107], v[32:35], v[136:139]
    v_accvgpr_read_b32 v20, a80
    v_mfma_f32_16x16x32_bf16 v[140:143], v[108:111], v[32:35], v[140:143]
    s_waitcnt vmcnt(23) lgkmcnt(0)
    s_barrier
    v_mfma_f32_16x16x32_bf16 v[144:147], v[96:99], v[36:39], v[144:147]
    ds_read_b128 v[32:35], v10 offset:0
    v_accvgpr_read_b32 v21, a81
    v_mfma_f32_16x16x32_bf16 v[148:151], v[100:103], v[36:39], v[148:151]
    ds_read_b64_tr_b16 v[64:65], v12 offset:0
    s_add_u32 m0, s45, 98304
    s_add_u32 s65, s34, 640
    buffer_load_dwordx4 v4, s[16:19], s65 offen offset:0 lds
    v_mfma_f32_16x16x32_bf16 v[152:155], v[104:107], v[36:39], v[152:155]
    v_mfma_f32_16x16x32_bf16 v[156:159], v[108:111], v[36:39], v[156:159]
    ds_read_b128 v[36:39], v10 offset:2048
    v_mfma_f32_16x16x32_bf16 v[160:163], v[96:99], v[40:43], v[160:163]
    ds_read_b64_tr_b16 v[66:67], v12 offset:1024
    buffer_load_dwordx4 v5, s[16:19], s65 offen offset:1024 lds
    v_mfma_f32_16x16x32_bf16 v[164:167], v[100:103], v[40:43], v[164:167]
    v_accvgpr_read_b32 v22, a82
    v_accvgpr_read_b32 v23, a83
    v_mfma_f32_16x16x32_bf16 v[168:171], v[104:107], v[40:43], v[168:171]
    ds_read_b64_tr_b16 v[68:69], v13 offset:0
    v_mfma_f32_16x16x32_bf16 v[172:175], v[108:111], v[40:43], v[172:175]
    ds_read_b128 v[40:43], v10 offset:4096
    buffer_load_dwordx4 v19, s[16:19], s65 offen offset:2048 lds
    v_mfma_f32_16x16x32_bf16 v[176:179], v[96:99], v[44:47], v[176:179]
    v_cvt_pk_bf16_f32 v20, v20, v21
    v_cvt_pk_bf16_f32 v21, v22, v23
    v_mfma_f32_16x16x32_bf16 v[180:183], v[100:103], v[44:47], v[180:183]
    ds_read_b64_tr_b16 v[70:71], v13 offset:1024
    v_cvt_pk_bf16_f32 v22, v24, v25
    v_mfma_f32_16x16x32_bf16 v[184:187], v[104:107], v[44:47], v[184:187]
    v_cvt_pk_bf16_f32 v23, v30, v31
    v_mfma_f32_16x16x32_bf16 v[188:191], v[108:111], v[44:47], v[188:191]
    ds_read_b128 v[44:47], v10 offset:6144
    buffer_load_dwordx4 v26, s[16:19], s65 offen offset:3072 lds
    v_mfma_f32_16x16x32_bf16 v[192:195], v[96:99], v[48:51], v[192:195]
    ds_read_b64_tr_b16 v[72:73], v14 offset:0
    buffer_store_dwordx4 v[20:23], v16, s[40:43], s62 offen offset:128 sc1
    v_mfma_f32_16x16x32_bf16 v[196:199], v[100:103], v[48:51], v[196:199]
    v_accvgpr_read_b32 v24, a92
    v_accvgpr_read_b32 v25, a93
    v_mfma_f32_16x16x32_bf16 v[200:203], v[104:107], v[48:51], v[200:203]
    ds_read_b64_tr_b16 v[74:75], v14 offset:1024
    s_add_u32 m0, s45, 114688
    s_add_u32 s65, s35, 640
    buffer_load_dwordx4 v4, s[16:19], s65 offen offset:0 lds
    v_mfma_f32_16x16x32_bf16 v[204:207], v[108:111], v[48:51], v[204:207]
    ds_read_b128 v[48:51], v10 offset:8192
    v_mfma_f32_16x16x32_bf16 v[208:211], v[96:99], v[52:55], v[208:211]
    v_mfma_f32_16x16x32_bf16 v[212:215], v[100:103], v[52:55], v[212:215]
    ds_read_b64_tr_b16 v[76:77], v15 offset:0
    buffer_load_dwordx4 v5, s[16:19], s65 offen offset:1024 lds
    v_mfma_f32_16x16x32_bf16 v[216:219], v[104:107], v[52:55], v[216:219]
    v_accvgpr_read_b32 v30, a94
    v_mfma_f32_16x16x32_bf16 v[220:223], v[108:111], v[52:55], v[220:223]
    ds_read_b128 v[52:55], v10 offset:10240
    v_accvgpr_read_b32 v31, a95
    v_mfma_f32_16x16x32_bf16 v[224:227], v[96:99], v[56:59], v[224:227]
    ds_read_b64_tr_b16 v[78:79], v15 offset:1024
    v_accvgpr_read_b32 v20, a88
    v_mfma_f32_16x16x32_bf16 v[228:231], v[100:103], v[56:59], v[228:231]
    buffer_load_dwordx4 v19, s[16:19], s65 offen offset:2048 lds
    v_accvgpr_read_b32 v21, a89
    v_mfma_f32_16x16x32_bf16 v[232:235], v[104:107], v[56:59], v[232:235]
    v_accvgpr_read_b32 v22, a90
    v_mfma_f32_16x16x32_bf16 v[236:239], v[108:111], v[56:59], v[236:239]
    ds_read_b128 v[56:59], v10 offset:12288
    v_accvgpr_read_b32 v23, a91
    v_mfma_f32_16x16x32_bf16 v[240:243], v[96:99], v[60:63], v[240:243]
    buffer_load_dwordx4 v26, s[16:19], s65 offen offset:3072 lds
    v_cvt_pk_bf16_f32 v20, v20, v21
    v_mfma_f32_16x16x32_bf16 v[244:247], v[100:103], v[60:63], v[244:247]
    v_cvt_pk_bf16_f32 v21, v22, v23
    v_cvt_pk_bf16_f32 v22, v24, v25
    v_mfma_f32_16x16x32_bf16 v[248:251], v[104:107], v[60:63], v[248:251]
    v_cvt_pk_bf16_f32 v23, v30, v31
    v_mfma_f32_16x16x32_bf16 v[252:255], v[108:111], v[60:63], v[252:255]
    ds_read_b128 v[60:63], v10 offset:14336
    buffer_store_dwordx4 v[20:23], v16, s[40:43], s62 offen offset:2176 sc1
    s_waitcnt lgkmcnt(2)
    v_mfma_f32_16x16x32_bf16 v[128:131], v[64:67], v[32:35], v[128:131]
    ds_read_b64_tr_b16 v[96:97], v12 offset:8192
    v_accvgpr_read_b32 v24, a100
    v_mfma_f32_16x16x32_bf16 v[132:135], v[68:71], v[32:35], v[132:135]
    s_add_u32 m0, s45, 32768
    s_add_u32 s65, s49, 3145728
    buffer_load_dwordx4 v6, s[24:27], s65 offen offset:0 lds
    v_mfma_f32_16x16x32_bf16 v[136:139], v[72:75], v[32:35], v[136:139]
    ds_read_b64_tr_b16 v[98:99], v12 offset:9216
    v_mfma_f32_16x16x32_bf16 v[140:143], v[76:79], v[32:35], v[140:143]
    ds_read_b128 v[32:35], v11 offset:0
    v_mfma_f32_16x16x32_bf16 v[144:147], v[64:67], v[36:39], v[144:147]
    v_accvgpr_read_b32 v25, a101
    v_mfma_f32_16x16x32_bf16 v[148:151], v[68:71], v[36:39], v[148:151]
    v_accvgpr_read_b32 v30, a102
    v_mfma_f32_16x16x32_bf16 v[152:155], v[72:75], v[36:39], v[152:155]
    ds_read_b64_tr_b16 v[100:101], v13 offset:8192
    v_accvgpr_read_b32 v31, a103
    v_mfma_f32_16x16x32_bf16 v[156:159], v[76:79], v[36:39], v[156:159]
    ds_read_b128 v[36:39], v11 offset:2048
    v_mfma_f32_16x16x32_bf16 v[160:163], v[64:67], v[40:43], v[160:163]
    buffer_load_dwordx4 v27, s[24:27], s65 offen offset:1024 lds
    v_accvgpr_read_b32 v20, a96
    v_mfma_f32_16x16x32_bf16 v[164:167], v[68:71], v[40:43], v[164:167]
    ds_read_b64_tr_b16 v[102:103], v13 offset:9216
    v_mfma_f32_16x16x32_bf16 v[168:171], v[72:75], v[40:43], v[168:171]
    v_accvgpr_read_b32 v21, a97
    v_accvgpr_read_b32 v22, a98
    v_mfma_f32_16x16x32_bf16 v[172:175], v[76:79], v[40:43], v[172:175]
    ds_read_b128 v[40:43], v11 offset:4096
    v_mfma_f32_16x16x32_bf16 v[176:179], v[64:67], v[44:47], v[176:179]
    v_accvgpr_read_b32 v23, a99
    v_cvt_pk_bf16_f32 v20, v20, v21
    v_mfma_f32_16x16x32_bf16 v[180:183], v[68:71], v[44:47], v[180:183]
    ds_read_b64_tr_b16 v[104:105], v14 offset:8192
    v_mfma_f32_16x16x32_bf16 v[184:187], v[72:75], v[44:47], v[184:187]
    v_cvt_pk_bf16_f32 v21, v22, v23
    v_cvt_pk_bf16_f32 v22, v24, v25
    v_mfma_f32_16x16x32_bf16 v[188:191], v[76:79], v[44:47], v[188:191]
    ds_read_b128 v[44:47], v11 offset:6144
    v_mfma_f32_16x16x32_bf16 v[192:195], v[64:67], v[48:51], v[192:195]
    ds_read_b64_tr_b16 v[106:107], v14 offset:9216
    buffer_load_dwordx4 v28, s[24:27], s65 offen offset:2048 lds
    v_mfma_f32_16x16x32_bf16 v[196:199], v[68:71], v[48:51], v[196:199]
    v_cvt_pk_bf16_f32 v23, v30, v31
    v_mfma_f32_16x16x32_bf16 v[200:203], v[72:75], v[48:51], v[200:203]
    buffer_store_dwordx4 v[20:23], v16, s[40:43], s63 offen offset:0 sc1
    v_accvgpr_read_b32 v24, a108
    v_mfma_f32_16x16x32_bf16 v[204:207], v[76:79], v[48:51], v[204:207]
    ds_read_b128 v[48:51], v11 offset:8192
    v_mfma_f32_16x16x32_bf16 v[208:211], v[64:67], v[52:55], v[208:211]
    ds_read_b64_tr_b16 v[108:109], v15 offset:8192
    v_accvgpr_read_b32 v25, a109
    v_mfma_f32_16x16x32_bf16 v[212:215], v[68:71], v[52:55], v[212:215]
    v_accvgpr_read_b32 v30, a110
    v_mfma_f32_16x16x32_bf16 v[216:219], v[72:75], v[52:55], v[216:219]
    ds_read_b64_tr_b16 v[110:111], v15 offset:9216
    v_accvgpr_read_b32 v31, a111
    v_mfma_f32_16x16x32_bf16 v[220:223], v[76:79], v[52:55], v[220:223]
    ds_read_b128 v[52:55], v11 offset:10240
    s_waitcnt lgkmcnt(15)
    v_mfma_f32_16x16x32_bf16 v[224:227], v[64:67], v[56:59], v[224:227]
    buffer_load_dwordx4 v29, s[24:27], s65 offen offset:3072 lds
    v_accvgpr_read_b32 v20, a104
    v_mfma_f32_16x16x32_bf16 v[228:231], v[68:71], v[56:59], v[228:231]
    v_accvgpr_read_b32 v21, a105
    v_mfma_f32_16x16x32_bf16 v[232:235], v[72:75], v[56:59], v[232:235]
    v_accvgpr_read_b32 v22, a106
    v_accvgpr_read_b32 v23, a107
    v_mfma_f32_16x16x32_bf16 v[236:239], v[76:79], v[56:59], v[236:239]
    ds_read_b128 v[56:59], v11 offset:12288
    s_waitcnt lgkmcnt(15)
    v_mfma_f32_16x16x32_bf16 v[240:243], v[64:67], v[60:63], v[240:243]
    v_cvt_pk_bf16_f32 v20, v20, v21
    v_cvt_pk_bf16_f32 v21, v22, v23
    v_mfma_f32_16x16x32_bf16 v[244:247], v[68:71], v[60:63], v[244:247]
    v_cvt_pk_bf16_f32 v22, v24, v25
    v_mfma_f32_16x16x32_bf16 v[248:251], v[72:75], v[60:63], v[248:251]
    v_cvt_pk_bf16_f32 v23, v30, v31
    buffer_store_dwordx4 v[20:23], v16, s[40:43], s63 offen offset:2048 sc1
    v_mfma_f32_16x16x32_bf16 v[252:255], v[76:79], v[60:63], v[252:255]
    ds_read_b128 v[60:63], v11 offset:14336
    s_waitcnt lgkmcnt(3)
    v_mfma_f32_16x16x32_bf16 v[128:131], v[96:99], v[32:35], v[128:131]
    v_accvgpr_read_b32 v24, a116
    v_accvgpr_read_b32 v25, a117
    v_mfma_f32_16x16x32_bf16 v[132:135], v[100:103], v[32:35], v[132:135]
    v_accvgpr_read_b32 v30, a118
    v_accvgpr_read_b32 v31, a119
    v_mfma_f32_16x16x32_bf16 v[136:139], v[104:107], v[32:35], v[136:139]
    v_accvgpr_read_b32 v20, a112
    v_mfma_f32_16x16x32_bf16 v[140:143], v[108:111], v[32:35], v[140:143]
    s_waitcnt vmcnt(23) lgkmcnt(0)
    s_barrier
    v_mfma_f32_16x16x32_bf16 v[144:147], v[96:99], v[36:39], v[144:147]
    ds_read_b128 v[32:35], v8 offset:0
    v_accvgpr_read_b32 v21, a113
    v_mfma_f32_16x16x32_bf16 v[148:151], v[100:103], v[36:39], v[148:151]
    ds_read_b64_tr_b16 v[64:65], v12 offset:49152
    s_add_u32 m0, s45, 131072
    s_add_u32 s65, s34, 768
    buffer_load_dwordx4 v4, s[16:19], s65 offen offset:0 lds
    v_mfma_f32_16x16x32_bf16 v[152:155], v[104:107], v[36:39], v[152:155]
    v_mfma_f32_16x16x32_bf16 v[156:159], v[108:111], v[36:39], v[156:159]
    ds_read_b128 v[36:39], v8 offset:2048
    v_mfma_f32_16x16x32_bf16 v[160:163], v[96:99], v[40:43], v[160:163]
    ds_read_b64_tr_b16 v[66:67], v12 offset:50176
    buffer_load_dwordx4 v5, s[16:19], s65 offen offset:1024 lds
    v_mfma_f32_16x16x32_bf16 v[164:167], v[100:103], v[40:43], v[164:167]
    v_accvgpr_read_b32 v22, a114
    v_accvgpr_read_b32 v23, a115
    v_mfma_f32_16x16x32_bf16 v[168:171], v[104:107], v[40:43], v[168:171]
    ds_read_b64_tr_b16 v[68:69], v13 offset:49152
    v_mfma_f32_16x16x32_bf16 v[172:175], v[108:111], v[40:43], v[172:175]
    ds_read_b128 v[40:43], v8 offset:4096
    buffer_load_dwordx4 v19, s[16:19], s65 offen offset:2048 lds
    v_mfma_f32_16x16x32_bf16 v[176:179], v[96:99], v[44:47], v[176:179]
    v_cvt_pk_bf16_f32 v20, v20, v21
    v_cvt_pk_bf16_f32 v21, v22, v23
    v_mfma_f32_16x16x32_bf16 v[180:183], v[100:103], v[44:47], v[180:183]
    ds_read_b64_tr_b16 v[70:71], v13 offset:50176
    v_cvt_pk_bf16_f32 v22, v24, v25
    v_mfma_f32_16x16x32_bf16 v[184:187], v[104:107], v[44:47], v[184:187]
    v_cvt_pk_bf16_f32 v23, v30, v31
    v_mfma_f32_16x16x32_bf16 v[188:191], v[108:111], v[44:47], v[188:191]
    ds_read_b128 v[44:47], v8 offset:6144
    buffer_load_dwordx4 v26, s[16:19], s65 offen offset:3072 lds
    v_mfma_f32_16x16x32_bf16 v[192:195], v[96:99], v[48:51], v[192:195]
    ds_read_b64_tr_b16 v[72:73], v14 offset:49152
    buffer_store_dwordx4 v[20:23], v16, s[40:43], s63 offen offset:128 sc1
    v_mfma_f32_16x16x32_bf16 v[196:199], v[100:103], v[48:51], v[196:199]
    v_accvgpr_read_b32 v24, a124
    v_accvgpr_read_b32 v25, a125
    v_mfma_f32_16x16x32_bf16 v[200:203], v[104:107], v[48:51], v[200:203]
    ds_read_b64_tr_b16 v[74:75], v14 offset:50176
    s_add_u32 m0, s45, 147456
    s_add_u32 s65, s35, 768
    buffer_load_dwordx4 v4, s[16:19], s65 offen offset:0 lds
    v_mfma_f32_16x16x32_bf16 v[204:207], v[108:111], v[48:51], v[204:207]
    ds_read_b128 v[48:51], v8 offset:8192
    v_mfma_f32_16x16x32_bf16 v[208:211], v[96:99], v[52:55], v[208:211]
    v_mfma_f32_16x16x32_bf16 v[212:215], v[100:103], v[52:55], v[212:215]
    ds_read_b64_tr_b16 v[76:77], v15 offset:49152
    buffer_load_dwordx4 v5, s[16:19], s65 offen offset:1024 lds
    v_mfma_f32_16x16x32_bf16 v[216:219], v[104:107], v[52:55], v[216:219]
    v_accvgpr_read_b32 v30, a126
    v_mfma_f32_16x16x32_bf16 v[220:223], v[108:111], v[52:55], v[220:223]
    ds_read_b128 v[52:55], v8 offset:10240
    v_accvgpr_read_b32 v31, a127
    v_mfma_f32_16x16x32_bf16 v[224:227], v[96:99], v[56:59], v[224:227]
    ds_read_b64_tr_b16 v[78:79], v15 offset:50176
    v_accvgpr_read_b32 v20, a120
    v_mfma_f32_16x16x32_bf16 v[228:231], v[100:103], v[56:59], v[228:231]
    buffer_load_dwordx4 v19, s[16:19], s65 offen offset:2048 lds
    v_accvgpr_read_b32 v21, a121
    v_mfma_f32_16x16x32_bf16 v[232:235], v[104:107], v[56:59], v[232:235]
    v_accvgpr_read_b32 v22, a122
    v_mfma_f32_16x16x32_bf16 v[236:239], v[108:111], v[56:59], v[236:239]
    ds_read_b128 v[56:59], v8 offset:12288
    v_accvgpr_read_b32 v23, a123
    v_mfma_f32_16x16x32_bf16 v[240:243], v[96:99], v[60:63], v[240:243]
    buffer_load_dwordx4 v26, s[16:19], s65 offen offset:3072 lds
    v_cvt_pk_bf16_f32 v20, v20, v21
    v_mfma_f32_16x16x32_bf16 v[244:247], v[100:103], v[60:63], v[244:247]
    v_cvt_pk_bf16_f32 v21, v22, v23
    v_cvt_pk_bf16_f32 v22, v24, v25
    v_mfma_f32_16x16x32_bf16 v[248:251], v[104:107], v[60:63], v[248:251]
    v_cvt_pk_bf16_f32 v23, v30, v31
    v_mfma_f32_16x16x32_bf16 v[252:255], v[108:111], v[60:63], v[252:255]
    ds_read_b128 v[60:63], v8 offset:14336
    buffer_store_dwordx4 v[20:23], v16, s[40:43], s63 offen offset:2176 sc1
    s_waitcnt lgkmcnt(2)
    v_mfma_f32_16x16x32_bf16 v[128:131], v[64:67], v[32:35], v[128:131]
    ds_read_b64_tr_b16 v[96:97], v12 offset:57344
    v_accvgpr_read_b32 v24, a144
    v_mfma_f32_16x16x32_bf16 v[132:135], v[68:71], v[32:35], v[132:135]
    s_add_u32 m0, s45, 0
    s_add_u32 s65, s49, 3670016
    buffer_load_dwordx4 v6, s[24:27], s65 offen offset:0 lds
    v_mfma_f32_16x16x32_bf16 v[136:139], v[72:75], v[32:35], v[136:139]
    ds_read_b64_tr_b16 v[98:99], v12 offset:58368
    v_mfma_f32_16x16x32_bf16 v[140:143], v[76:79], v[32:35], v[140:143]
    ds_read_b128 v[32:35], v9 offset:0
    v_mfma_f32_16x16x32_bf16 v[144:147], v[64:67], v[36:39], v[144:147]
    v_accvgpr_read_b32 v25, a145
    v_mfma_f32_16x16x32_bf16 v[148:151], v[68:71], v[36:39], v[148:151]
    v_accvgpr_read_b32 v30, a146
    v_mfma_f32_16x16x32_bf16 v[152:155], v[72:75], v[36:39], v[152:155]
    ds_read_b64_tr_b16 v[100:101], v13 offset:57344
    v_accvgpr_read_b32 v31, a147
    v_mfma_f32_16x16x32_bf16 v[156:159], v[76:79], v[36:39], v[156:159]
    ds_read_b128 v[36:39], v9 offset:2048
    v_mfma_f32_16x16x32_bf16 v[160:163], v[64:67], v[40:43], v[160:163]
    buffer_load_dwordx4 v27, s[24:27], s65 offen offset:1024 lds
    v_accvgpr_read_b32 v20, a128
    v_mfma_f32_16x16x32_bf16 v[164:167], v[68:71], v[40:43], v[164:167]
    ds_read_b64_tr_b16 v[102:103], v13 offset:58368
    v_mfma_f32_16x16x32_bf16 v[168:171], v[72:75], v[40:43], v[168:171]
    v_accvgpr_read_b32 v21, a129
    v_accvgpr_read_b32 v22, a130
    v_mfma_f32_16x16x32_bf16 v[172:175], v[76:79], v[40:43], v[172:175]
    ds_read_b128 v[40:43], v9 offset:4096
    v_mfma_f32_16x16x32_bf16 v[176:179], v[64:67], v[44:47], v[176:179]
    v_accvgpr_read_b32 v23, a131
    v_cvt_pk_bf16_f32 v20, v20, v21
    v_mfma_f32_16x16x32_bf16 v[180:183], v[68:71], v[44:47], v[180:183]
    ds_read_b64_tr_b16 v[104:105], v14 offset:57344
    v_mfma_f32_16x16x32_bf16 v[184:187], v[72:75], v[44:47], v[184:187]
    v_cvt_pk_bf16_f32 v21, v22, v23
    v_cvt_pk_bf16_f32 v22, v24, v25
    v_mfma_f32_16x16x32_bf16 v[188:191], v[76:79], v[44:47], v[188:191]
    ds_read_b128 v[44:47], v9 offset:6144
    v_mfma_f32_16x16x32_bf16 v[192:195], v[64:67], v[48:51], v[192:195]
    ds_read_b64_tr_b16 v[106:107], v14 offset:58368
    buffer_load_dwordx4 v28, s[24:27], s65 offen offset:2048 lds
    v_mfma_f32_16x16x32_bf16 v[196:199], v[68:71], v[48:51], v[196:199]
    v_cvt_pk_bf16_f32 v23, v30, v31
    v_mfma_f32_16x16x32_bf16 v[200:203], v[72:75], v[48:51], v[200:203]
    buffer_store_dwordx4 v[20:23], v17, s[40:43], s60 offen offset:0 sc1
    v_accvgpr_read_b32 v24, a148
    v_mfma_f32_16x16x32_bf16 v[204:207], v[76:79], v[48:51], v[204:207]
    ds_read_b128 v[48:51], v9 offset:8192
    v_mfma_f32_16x16x32_bf16 v[208:211], v[64:67], v[52:55], v[208:211]
    ds_read_b64_tr_b16 v[108:109], v15 offset:57344
    v_accvgpr_read_b32 v25, a149
    v_mfma_f32_16x16x32_bf16 v[212:215], v[68:71], v[52:55], v[212:215]
    v_accvgpr_read_b32 v30, a150
    v_mfma_f32_16x16x32_bf16 v[216:219], v[72:75], v[52:55], v[216:219]
    ds_read_b64_tr_b16 v[110:111], v15 offset:58368
    v_accvgpr_read_b32 v31, a151
    v_mfma_f32_16x16x32_bf16 v[220:223], v[76:79], v[52:55], v[220:223]
    ds_read_b128 v[52:55], v9 offset:10240
    s_waitcnt lgkmcnt(15)
    v_mfma_f32_16x16x32_bf16 v[224:227], v[64:67], v[56:59], v[224:227]
    buffer_load_dwordx4 v29, s[24:27], s65 offen offset:3072 lds
    v_accvgpr_read_b32 v20, a132
    v_mfma_f32_16x16x32_bf16 v[228:231], v[68:71], v[56:59], v[228:231]
    v_accvgpr_read_b32 v21, a133
    v_mfma_f32_16x16x32_bf16 v[232:235], v[72:75], v[56:59], v[232:235]
    v_accvgpr_read_b32 v22, a134
    v_accvgpr_read_b32 v23, a135
    v_mfma_f32_16x16x32_bf16 v[236:239], v[76:79], v[56:59], v[236:239]
    ds_read_b128 v[56:59], v9 offset:12288
    s_waitcnt lgkmcnt(15)
    v_mfma_f32_16x16x32_bf16 v[240:243], v[64:67], v[60:63], v[240:243]
    v_cvt_pk_bf16_f32 v20, v20, v21
    v_cvt_pk_bf16_f32 v21, v22, v23
    v_mfma_f32_16x16x32_bf16 v[244:247], v[68:71], v[60:63], v[244:247]
    v_cvt_pk_bf16_f32 v22, v24, v25
    v_mfma_f32_16x16x32_bf16 v[248:251], v[72:75], v[60:63], v[248:251]
    v_cvt_pk_bf16_f32 v23, v30, v31
    buffer_store_dwordx4 v[20:23], v17, s[40:43], s60 offen offset:256 sc1
    v_mfma_f32_16x16x32_bf16 v[252:255], v[76:79], v[60:63], v[252:255]
    ds_read_b128 v[60:63], v9 offset:14336
    s_waitcnt lgkmcnt(3)
    v_mfma_f32_16x16x32_bf16 v[128:131], v[96:99], v[32:35], v[128:131]
    v_accvgpr_read_b32 v24, a152
    v_accvgpr_read_b32 v25, a153
    v_mfma_f32_16x16x32_bf16 v[132:135], v[100:103], v[32:35], v[132:135]
    v_accvgpr_read_b32 v30, a154
    v_accvgpr_read_b32 v31, a155
    v_mfma_f32_16x16x32_bf16 v[136:139], v[104:107], v[32:35], v[136:139]
    v_accvgpr_read_b32 v20, a136
    v_mfma_f32_16x16x32_bf16 v[140:143], v[108:111], v[32:35], v[140:143]
    s_waitcnt vmcnt(23) lgkmcnt(0)
    s_barrier
    v_mfma_f32_16x16x32_bf16 v[144:147], v[96:99], v[36:39], v[144:147]
    ds_read_b128 v[32:35], v8 offset:32768
    v_accvgpr_read_b32 v21, a137
    v_mfma_f32_16x16x32_bf16 v[148:151], v[100:103], v[36:39], v[148:151]
    ds_read_b64_tr_b16 v[64:65], v12 offset:16384
    s_add_u32 m0, s45, 65536
    s_add_u32 s65, s34, 896
    buffer_load_dwordx4 v4, s[16:19], s65 offen offset:0 lds
    v_mfma_f32_16x16x32_bf16 v[152:155], v[104:107], v[36:39], v[152:155]
    v_mfma_f32_16x16x32_bf16 v[156:159], v[108:111], v[36:39], v[156:159]
    ds_read_b128 v[36:39], v8 offset:34816
    v_mfma_f32_16x16x32_bf16 v[160:163], v[96:99], v[40:43], v[160:163]
    ds_read_b64_tr_b16 v[66:67], v12 offset:17408
    buffer_load_dwordx4 v5, s[16:19], s65 offen offset:1024 lds
    v_mfma_f32_16x16x32_bf16 v[164:167], v[100:103], v[40:43], v[164:167]
    v_accvgpr_read_b32 v22, a138
    v_accvgpr_read_b32 v23, a139
    v_mfma_f32_16x16x32_bf16 v[168:171], v[104:107], v[40:43], v[168:171]
    ds_read_b64_tr_b16 v[68:69], v13 offset:16384
    v_mfma_f32_16x16x32_bf16 v[172:175], v[108:111], v[40:43], v[172:175]
    ds_read_b128 v[40:43], v8 offset:36864
    buffer_load_dwordx4 v19, s[16:19], s65 offen offset:2048 lds
    v_mfma_f32_16x16x32_bf16 v[176:179], v[96:99], v[44:47], v[176:179]
    v_cvt_pk_bf16_f32 v20, v20, v21
    v_cvt_pk_bf16_f32 v21, v22, v23
    v_mfma_f32_16x16x32_bf16 v[180:183], v[100:103], v[44:47], v[180:183]
    ds_read_b64_tr_b16 v[70:71], v13 offset:17408
    v_cvt_pk_bf16_f32 v22, v24, v25
    v_mfma_f32_16x16x32_bf16 v[184:187], v[104:107], v[44:47], v[184:187]
    v_cvt_pk_bf16_f32 v23, v30, v31
    v_mfma_f32_16x16x32_bf16 v[188:191], v[108:111], v[44:47], v[188:191]
    ds_read_b128 v[44:47], v8 offset:38912
    buffer_load_dwordx4 v26, s[16:19], s65 offen offset:3072 lds
    v_mfma_f32_16x16x32_bf16 v[192:195], v[96:99], v[48:51], v[192:195]
    ds_read_b64_tr_b16 v[72:73], v14 offset:16384
    buffer_store_dwordx4 v[20:23], v17, s[40:43], s60 offen offset:1024 sc1
    v_mfma_f32_16x16x32_bf16 v[196:199], v[100:103], v[48:51], v[196:199]
    v_accvgpr_read_b32 v24, a156
    v_accvgpr_read_b32 v25, a157
    v_mfma_f32_16x16x32_bf16 v[200:203], v[104:107], v[48:51], v[200:203]
    ds_read_b64_tr_b16 v[74:75], v14 offset:17408
    s_add_u32 m0, s45, 81920
    s_add_u32 s65, s35, 896
    buffer_load_dwordx4 v4, s[16:19], s65 offen offset:0 lds
    v_mfma_f32_16x16x32_bf16 v[204:207], v[108:111], v[48:51], v[204:207]
    ds_read_b128 v[48:51], v8 offset:40960
    v_mfma_f32_16x16x32_bf16 v[208:211], v[96:99], v[52:55], v[208:211]
    v_mfma_f32_16x16x32_bf16 v[212:215], v[100:103], v[52:55], v[212:215]
    ds_read_b64_tr_b16 v[76:77], v15 offset:16384
    buffer_load_dwordx4 v5, s[16:19], s65 offen offset:1024 lds
    v_mfma_f32_16x16x32_bf16 v[216:219], v[104:107], v[52:55], v[216:219]
    v_accvgpr_read_b32 v30, a158
    v_mfma_f32_16x16x32_bf16 v[220:223], v[108:111], v[52:55], v[220:223]
    ds_read_b128 v[52:55], v8 offset:43008
    v_accvgpr_read_b32 v31, a159
    v_mfma_f32_16x16x32_bf16 v[224:227], v[96:99], v[56:59], v[224:227]
    ds_read_b64_tr_b16 v[78:79], v15 offset:17408
    v_accvgpr_read_b32 v20, a140
    v_mfma_f32_16x16x32_bf16 v[228:231], v[100:103], v[56:59], v[228:231]
    buffer_load_dwordx4 v19, s[16:19], s65 offen offset:2048 lds
    v_accvgpr_read_b32 v21, a141
    v_mfma_f32_16x16x32_bf16 v[232:235], v[104:107], v[56:59], v[232:235]
    v_accvgpr_read_b32 v22, a142
    v_mfma_f32_16x16x32_bf16 v[236:239], v[108:111], v[56:59], v[236:239]
    ds_read_b128 v[56:59], v8 offset:45056
    v_accvgpr_read_b32 v23, a143
    v_mfma_f32_16x16x32_bf16 v[240:243], v[96:99], v[60:63], v[240:243]
    buffer_load_dwordx4 v26, s[16:19], s65 offen offset:3072 lds
    v_cvt_pk_bf16_f32 v20, v20, v21
    v_mfma_f32_16x16x32_bf16 v[244:247], v[100:103], v[60:63], v[244:247]
    v_cvt_pk_bf16_f32 v21, v22, v23
    v_cvt_pk_bf16_f32 v22, v24, v25
    v_mfma_f32_16x16x32_bf16 v[248:251], v[104:107], v[60:63], v[248:251]
    v_cvt_pk_bf16_f32 v23, v30, v31
    v_mfma_f32_16x16x32_bf16 v[252:255], v[108:111], v[60:63], v[252:255]
    ds_read_b128 v[60:63], v8 offset:47104
    buffer_store_dwordx4 v[20:23], v17, s[40:43], s60 offen offset:1280 sc1
    s_waitcnt lgkmcnt(2)
    v_mfma_f32_16x16x32_bf16 v[128:131], v[64:67], v[32:35], v[128:131]
    ds_read_b64_tr_b16 v[96:97], v12 offset:24576
    v_accvgpr_read_b32 v24, a176
    v_mfma_f32_16x16x32_bf16 v[132:135], v[68:71], v[32:35], v[132:135]
    s_add_u32 m0, s45, 49152
    s_add_u32 s65, s49, 4194304
    buffer_load_dwordx4 v6, s[24:27], s65 offen offset:0 lds
    v_mfma_f32_16x16x32_bf16 v[136:139], v[72:75], v[32:35], v[136:139]
    ds_read_b64_tr_b16 v[98:99], v12 offset:25600
    v_mfma_f32_16x16x32_bf16 v[140:143], v[76:79], v[32:35], v[140:143]
    ds_read_b128 v[32:35], v9 offset:32768
    v_mfma_f32_16x16x32_bf16 v[144:147], v[64:67], v[36:39], v[144:147]
    v_accvgpr_read_b32 v25, a177
    v_mfma_f32_16x16x32_bf16 v[148:151], v[68:71], v[36:39], v[148:151]
    v_accvgpr_read_b32 v30, a178
    v_mfma_f32_16x16x32_bf16 v[152:155], v[72:75], v[36:39], v[152:155]
    ds_read_b64_tr_b16 v[100:101], v13 offset:24576
    v_accvgpr_read_b32 v31, a179
    v_mfma_f32_16x16x32_bf16 v[156:159], v[76:79], v[36:39], v[156:159]
    ds_read_b128 v[36:39], v9 offset:34816
    v_mfma_f32_16x16x32_bf16 v[160:163], v[64:67], v[40:43], v[160:163]
    buffer_load_dwordx4 v27, s[24:27], s65 offen offset:1024 lds
    v_accvgpr_read_b32 v20, a160
    v_mfma_f32_16x16x32_bf16 v[164:167], v[68:71], v[40:43], v[164:167]
    ds_read_b64_tr_b16 v[102:103], v13 offset:25600
    v_mfma_f32_16x16x32_bf16 v[168:171], v[72:75], v[40:43], v[168:171]
    v_accvgpr_read_b32 v21, a161
    v_accvgpr_read_b32 v22, a162
    v_mfma_f32_16x16x32_bf16 v[172:175], v[76:79], v[40:43], v[172:175]
    ds_read_b128 v[40:43], v9 offset:36864
    v_mfma_f32_16x16x32_bf16 v[176:179], v[64:67], v[44:47], v[176:179]
    v_accvgpr_read_b32 v23, a163
    v_cvt_pk_bf16_f32 v20, v20, v21
    v_mfma_f32_16x16x32_bf16 v[180:183], v[68:71], v[44:47], v[180:183]
    ds_read_b64_tr_b16 v[104:105], v14 offset:24576
    v_mfma_f32_16x16x32_bf16 v[184:187], v[72:75], v[44:47], v[184:187]
    v_cvt_pk_bf16_f32 v21, v22, v23
    v_cvt_pk_bf16_f32 v22, v24, v25
    v_mfma_f32_16x16x32_bf16 v[188:191], v[76:79], v[44:47], v[188:191]
    ds_read_b128 v[44:47], v9 offset:38912
    v_mfma_f32_16x16x32_bf16 v[192:195], v[64:67], v[48:51], v[192:195]
    ds_read_b64_tr_b16 v[106:107], v14 offset:25600
    buffer_load_dwordx4 v28, s[24:27], s65 offen offset:2048 lds
    v_mfma_f32_16x16x32_bf16 v[196:199], v[68:71], v[48:51], v[196:199]
    v_cvt_pk_bf16_f32 v23, v30, v31
    v_mfma_f32_16x16x32_bf16 v[200:203], v[72:75], v[48:51], v[200:203]
    buffer_store_dwordx4 v[20:23], v17, s[40:43], s61 offen offset:0 sc1
    v_accvgpr_read_b32 v24, a180
    v_mfma_f32_16x16x32_bf16 v[204:207], v[76:79], v[48:51], v[204:207]
    ds_read_b128 v[48:51], v9 offset:40960
    v_mfma_f32_16x16x32_bf16 v[208:211], v[64:67], v[52:55], v[208:211]
    ds_read_b64_tr_b16 v[108:109], v15 offset:24576
    v_accvgpr_read_b32 v25, a181
    v_mfma_f32_16x16x32_bf16 v[212:215], v[68:71], v[52:55], v[212:215]
    v_accvgpr_read_b32 v30, a182
    v_mfma_f32_16x16x32_bf16 v[216:219], v[72:75], v[52:55], v[216:219]
    ds_read_b64_tr_b16 v[110:111], v15 offset:25600
    v_accvgpr_read_b32 v31, a183
    v_mfma_f32_16x16x32_bf16 v[220:223], v[76:79], v[52:55], v[220:223]
    ds_read_b128 v[52:55], v9 offset:43008
    s_waitcnt lgkmcnt(15)
    v_mfma_f32_16x16x32_bf16 v[224:227], v[64:67], v[56:59], v[224:227]
    buffer_load_dwordx4 v29, s[24:27], s65 offen offset:3072 lds
    v_accvgpr_read_b32 v20, a164
    v_mfma_f32_16x16x32_bf16 v[228:231], v[68:71], v[56:59], v[228:231]
    v_accvgpr_read_b32 v21, a165
    v_mfma_f32_16x16x32_bf16 v[232:235], v[72:75], v[56:59], v[232:235]
    v_accvgpr_read_b32 v22, a166
    v_accvgpr_read_b32 v23, a167
    v_mfma_f32_16x16x32_bf16 v[236:239], v[76:79], v[56:59], v[236:239]
    ds_read_b128 v[56:59], v9 offset:45056
    s_waitcnt lgkmcnt(15)
    v_mfma_f32_16x16x32_bf16 v[240:243], v[64:67], v[60:63], v[240:243]
    v_cvt_pk_bf16_f32 v20, v20, v21
    v_cvt_pk_bf16_f32 v21, v22, v23
    v_mfma_f32_16x16x32_bf16 v[244:247], v[68:71], v[60:63], v[244:247]
    v_cvt_pk_bf16_f32 v22, v24, v25
    v_mfma_f32_16x16x32_bf16 v[248:251], v[72:75], v[60:63], v[248:251]
    v_cvt_pk_bf16_f32 v23, v30, v31
    buffer_store_dwordx4 v[20:23], v17, s[40:43], s61 offen offset:256 sc1
    v_mfma_f32_16x16x32_bf16 v[252:255], v[76:79], v[60:63], v[252:255]
    ds_read_b128 v[60:63], v9 offset:47104
    s_waitcnt lgkmcnt(3)
    v_mfma_f32_16x16x32_bf16 v[128:131], v[96:99], v[32:35], v[128:131]
    v_accvgpr_read_b32 v24, a184
    v_accvgpr_read_b32 v25, a185
    v_mfma_f32_16x16x32_bf16 v[132:135], v[100:103], v[32:35], v[132:135]
    v_accvgpr_read_b32 v30, a186
    v_accvgpr_read_b32 v31, a187
    v_mfma_f32_16x16x32_bf16 v[136:139], v[104:107], v[32:35], v[136:139]
    v_accvgpr_read_b32 v20, a168
    v_mfma_f32_16x16x32_bf16 v[140:143], v[108:111], v[32:35], v[140:143]
    s_waitcnt vmcnt(23) lgkmcnt(0)
    s_barrier
    v_mfma_f32_16x16x32_bf16 v[144:147], v[96:99], v[36:39], v[144:147]
    ds_read_b128 v[32:35], v10 offset:0
    v_accvgpr_read_b32 v21, a169
    v_mfma_f32_16x16x32_bf16 v[148:151], v[100:103], v[36:39], v[148:151]
    ds_read_b64_tr_b16 v[64:65], v12 offset:32768
    s_add_u32 m0, s45, 98304
    s_add_u32 s65, s34, 1024
    buffer_load_dwordx4 v4, s[16:19], s65 offen offset:0 lds
    v_mfma_f32_16x16x32_bf16 v[152:155], v[104:107], v[36:39], v[152:155]
    v_mfma_f32_16x16x32_bf16 v[156:159], v[108:111], v[36:39], v[156:159]
    ds_read_b128 v[36:39], v10 offset:2048
    v_mfma_f32_16x16x32_bf16 v[160:163], v[96:99], v[40:43], v[160:163]
    ds_read_b64_tr_b16 v[66:67], v12 offset:33792
    buffer_load_dwordx4 v5, s[16:19], s65 offen offset:1024 lds
    v_mfma_f32_16x16x32_bf16 v[164:167], v[100:103], v[40:43], v[164:167]
    v_accvgpr_read_b32 v22, a170
    v_accvgpr_read_b32 v23, a171
    v_mfma_f32_16x16x32_bf16 v[168:171], v[104:107], v[40:43], v[168:171]
    ds_read_b64_tr_b16 v[68:69], v13 offset:32768
    v_mfma_f32_16x16x32_bf16 v[172:175], v[108:111], v[40:43], v[172:175]
    ds_read_b128 v[40:43], v10 offset:4096
    buffer_load_dwordx4 v19, s[16:19], s65 offen offset:2048 lds
    v_mfma_f32_16x16x32_bf16 v[176:179], v[96:99], v[44:47], v[176:179]
    v_cvt_pk_bf16_f32 v20, v20, v21
    v_cvt_pk_bf16_f32 v21, v22, v23
    v_mfma_f32_16x16x32_bf16 v[180:183], v[100:103], v[44:47], v[180:183]
    ds_read_b64_tr_b16 v[70:71], v13 offset:33792
    v_cvt_pk_bf16_f32 v22, v24, v25
    v_mfma_f32_16x16x32_bf16 v[184:187], v[104:107], v[44:47], v[184:187]
    v_cvt_pk_bf16_f32 v23, v30, v31
    v_mfma_f32_16x16x32_bf16 v[188:191], v[108:111], v[44:47], v[188:191]
    ds_read_b128 v[44:47], v10 offset:6144
    buffer_load_dwordx4 v26, s[16:19], s65 offen offset:3072 lds
    v_mfma_f32_16x16x32_bf16 v[192:195], v[96:99], v[48:51], v[192:195]
    ds_read_b64_tr_b16 v[72:73], v14 offset:32768
    buffer_store_dwordx4 v[20:23], v17, s[40:43], s61 offen offset:1024 sc1
    v_mfma_f32_16x16x32_bf16 v[196:199], v[100:103], v[48:51], v[196:199]
    v_accvgpr_read_b32 v24, a188
    v_accvgpr_read_b32 v25, a189
    v_mfma_f32_16x16x32_bf16 v[200:203], v[104:107], v[48:51], v[200:203]
    ds_read_b64_tr_b16 v[74:75], v14 offset:33792
    s_add_u32 m0, s45, 114688
    s_add_u32 s65, s35, 1024
    buffer_load_dwordx4 v4, s[16:19], s65 offen offset:0 lds
    v_mfma_f32_16x16x32_bf16 v[204:207], v[108:111], v[48:51], v[204:207]
    ds_read_b128 v[48:51], v10 offset:8192
    v_mfma_f32_16x16x32_bf16 v[208:211], v[96:99], v[52:55], v[208:211]
    v_mfma_f32_16x16x32_bf16 v[212:215], v[100:103], v[52:55], v[212:215]
    ds_read_b64_tr_b16 v[76:77], v15 offset:32768
    buffer_load_dwordx4 v5, s[16:19], s65 offen offset:1024 lds
    v_mfma_f32_16x16x32_bf16 v[216:219], v[104:107], v[52:55], v[216:219]
    v_accvgpr_read_b32 v30, a190
    v_mfma_f32_16x16x32_bf16 v[220:223], v[108:111], v[52:55], v[220:223]
    ds_read_b128 v[52:55], v10 offset:10240
    v_accvgpr_read_b32 v31, a191
    v_mfma_f32_16x16x32_bf16 v[224:227], v[96:99], v[56:59], v[224:227]
    ds_read_b64_tr_b16 v[78:79], v15 offset:33792
    v_accvgpr_read_b32 v20, a172
    v_mfma_f32_16x16x32_bf16 v[228:231], v[100:103], v[56:59], v[228:231]
    buffer_load_dwordx4 v19, s[16:19], s65 offen offset:2048 lds
    v_accvgpr_read_b32 v21, a173
    v_mfma_f32_16x16x32_bf16 v[232:235], v[104:107], v[56:59], v[232:235]
    v_accvgpr_read_b32 v22, a174
    v_mfma_f32_16x16x32_bf16 v[236:239], v[108:111], v[56:59], v[236:239]
    ds_read_b128 v[56:59], v10 offset:12288
    v_accvgpr_read_b32 v23, a175
    v_mfma_f32_16x16x32_bf16 v[240:243], v[96:99], v[60:63], v[240:243]
    buffer_load_dwordx4 v26, s[16:19], s65 offen offset:3072 lds
    v_cvt_pk_bf16_f32 v20, v20, v21
    v_mfma_f32_16x16x32_bf16 v[244:247], v[100:103], v[60:63], v[244:247]
    v_cvt_pk_bf16_f32 v21, v22, v23
    v_cvt_pk_bf16_f32 v22, v24, v25
    v_mfma_f32_16x16x32_bf16 v[248:251], v[104:107], v[60:63], v[248:251]
    v_cvt_pk_bf16_f32 v23, v30, v31
    v_mfma_f32_16x16x32_bf16 v[252:255], v[108:111], v[60:63], v[252:255]
    ds_read_b128 v[60:63], v10 offset:14336
    buffer_store_dwordx4 v[20:23], v17, s[40:43], s61 offen offset:1280 sc1
    s_waitcnt lgkmcnt(2)
    v_mfma_f32_16x16x32_bf16 v[128:131], v[64:67], v[32:35], v[128:131]
    ds_read_b64_tr_b16 v[96:97], v12 offset:40960
    v_accvgpr_read_b32 v24, a208
    v_mfma_f32_16x16x32_bf16 v[132:135], v[68:71], v[32:35], v[132:135]
    s_add_u32 m0, s45, 16384
    s_add_u32 s65, s49, 4718592
    buffer_load_dwordx4 v6, s[24:27], s65 offen offset:0 lds
    v_mfma_f32_16x16x32_bf16 v[136:139], v[72:75], v[32:35], v[136:139]
    ds_read_b64_tr_b16 v[98:99], v12 offset:41984
    v_mfma_f32_16x16x32_bf16 v[140:143], v[76:79], v[32:35], v[140:143]
    ds_read_b128 v[32:35], v11 offset:0
    v_mfma_f32_16x16x32_bf16 v[144:147], v[64:67], v[36:39], v[144:147]
    v_accvgpr_read_b32 v25, a209
    v_mfma_f32_16x16x32_bf16 v[148:151], v[68:71], v[36:39], v[148:151]
    v_accvgpr_read_b32 v30, a210
    v_mfma_f32_16x16x32_bf16 v[152:155], v[72:75], v[36:39], v[152:155]
    ds_read_b64_tr_b16 v[100:101], v13 offset:40960
    v_accvgpr_read_b32 v31, a211
    v_mfma_f32_16x16x32_bf16 v[156:159], v[76:79], v[36:39], v[156:159]
    ds_read_b128 v[36:39], v11 offset:2048
    v_mfma_f32_16x16x32_bf16 v[160:163], v[64:67], v[40:43], v[160:163]
    buffer_load_dwordx4 v27, s[24:27], s65 offen offset:1024 lds
    v_accvgpr_read_b32 v20, a192
    v_mfma_f32_16x16x32_bf16 v[164:167], v[68:71], v[40:43], v[164:167]
    ds_read_b64_tr_b16 v[102:103], v13 offset:41984
    v_mfma_f32_16x16x32_bf16 v[168:171], v[72:75], v[40:43], v[168:171]
    v_accvgpr_read_b32 v21, a193
    v_accvgpr_read_b32 v22, a194
    v_mfma_f32_16x16x32_bf16 v[172:175], v[76:79], v[40:43], v[172:175]
    ds_read_b128 v[40:43], v11 offset:4096
    v_mfma_f32_16x16x32_bf16 v[176:179], v[64:67], v[44:47], v[176:179]
    v_accvgpr_read_b32 v23, a195
    v_cvt_pk_bf16_f32 v20, v20, v21
    v_mfma_f32_16x16x32_bf16 v[180:183], v[68:71], v[44:47], v[180:183]
    ds_read_b64_tr_b16 v[104:105], v14 offset:40960
    v_mfma_f32_16x16x32_bf16 v[184:187], v[72:75], v[44:47], v[184:187]
    v_cvt_pk_bf16_f32 v21, v22, v23
    v_cvt_pk_bf16_f32 v22, v24, v25
    v_mfma_f32_16x16x32_bf16 v[188:191], v[76:79], v[44:47], v[188:191]
    ds_read_b128 v[44:47], v11 offset:6144
    v_mfma_f32_16x16x32_bf16 v[192:195], v[64:67], v[48:51], v[192:195]
    ds_read_b64_tr_b16 v[106:107], v14 offset:41984
    buffer_load_dwordx4 v28, s[24:27], s65 offen offset:2048 lds
    v_mfma_f32_16x16x32_bf16 v[196:199], v[68:71], v[48:51], v[196:199]
    v_cvt_pk_bf16_f32 v23, v30, v31
    v_mfma_f32_16x16x32_bf16 v[200:203], v[72:75], v[48:51], v[200:203]
    buffer_store_dwordx4 v[20:23], v17, s[40:43], s62 offen offset:0 sc1
    v_accvgpr_read_b32 v24, a212
    v_mfma_f32_16x16x32_bf16 v[204:207], v[76:79], v[48:51], v[204:207]
    ds_read_b128 v[48:51], v11 offset:8192
    v_mfma_f32_16x16x32_bf16 v[208:211], v[64:67], v[52:55], v[208:211]
    ds_read_b64_tr_b16 v[108:109], v15 offset:40960
    v_accvgpr_read_b32 v25, a213
    v_mfma_f32_16x16x32_bf16 v[212:215], v[68:71], v[52:55], v[212:215]
    v_accvgpr_read_b32 v30, a214
    v_mfma_f32_16x16x32_bf16 v[216:219], v[72:75], v[52:55], v[216:219]
    ds_read_b64_tr_b16 v[110:111], v15 offset:41984
    v_accvgpr_read_b32 v31, a215
    v_mfma_f32_16x16x32_bf16 v[220:223], v[76:79], v[52:55], v[220:223]
    ds_read_b128 v[52:55], v11 offset:10240
    s_waitcnt lgkmcnt(15)
    v_mfma_f32_16x16x32_bf16 v[224:227], v[64:67], v[56:59], v[224:227]
    buffer_load_dwordx4 v29, s[24:27], s65 offen offset:3072 lds
    v_accvgpr_read_b32 v20, a196
    v_mfma_f32_16x16x32_bf16 v[228:231], v[68:71], v[56:59], v[228:231]
    v_accvgpr_read_b32 v21, a197
    v_mfma_f32_16x16x32_bf16 v[232:235], v[72:75], v[56:59], v[232:235]
    v_accvgpr_read_b32 v22, a198
    v_accvgpr_read_b32 v23, a199
    v_mfma_f32_16x16x32_bf16 v[236:239], v[76:79], v[56:59], v[236:239]
    ds_read_b128 v[56:59], v11 offset:12288
    s_waitcnt lgkmcnt(15)
    v_mfma_f32_16x16x32_bf16 v[240:243], v[64:67], v[60:63], v[240:243]
    v_cvt_pk_bf16_f32 v20, v20, v21
    v_cvt_pk_bf16_f32 v21, v22, v23
    v_mfma_f32_16x16x32_bf16 v[244:247], v[68:71], v[60:63], v[244:247]
    v_cvt_pk_bf16_f32 v22, v24, v25
    v_mfma_f32_16x16x32_bf16 v[248:251], v[72:75], v[60:63], v[248:251]
    v_cvt_pk_bf16_f32 v23, v30, v31
    buffer_store_dwordx4 v[20:23], v17, s[40:43], s62 offen offset:256 sc1
    v_mfma_f32_16x16x32_bf16 v[252:255], v[76:79], v[60:63], v[252:255]
    ds_read_b128 v[60:63], v11 offset:14336
    s_waitcnt lgkmcnt(3)
    v_mfma_f32_16x16x32_bf16 v[128:131], v[96:99], v[32:35], v[128:131]
    s_getpc_b64 s[36:37]
main_kernel_pc2:
    s_sub_u32 s36, s36, main_kernel_pc2-main_kernel
    s_subb_u32 s37, s37, 0
    v_mfma_f32_16x16x32_bf16 v[132:135], v[100:103], v[32:35], v[132:135]
    v_mfma_f32_16x16x32_bf16 v[136:139], v[104:107], v[32:35], v[136:139]
    s_mov_b32 s38, all_code_end-main_kernel
    s_mov_b32 s39, 0x00020000
    v_mfma_f32_16x16x32_bf16 v[140:143], v[108:111], v[32:35], v[140:143]
    s_waitcnt vmcnt(23) lgkmcnt(0)
    s_barrier
    v_mfma_f32_16x16x32_bf16 v[144:147], v[96:99], v[36:39], v[144:147]
    ds_read_b128 v[32:35], v8 offset:0
    s_lshr_b32 s58, s2, 3
    s_lshl_b32 s58, s58, 12
    v_mfma_f32_16x16x32_bf16 v[148:151], v[100:103], v[36:39], v[148:151]
    ds_read_b64_tr_b16 v[64:65], v12 offset:0
    s_add_u32 m0, s45, 131072
    s_add_u32 s65, s34, 1152
    buffer_load_dwordx4 v4, s[16:19], s65 offen offset:0 lds
    v_mfma_f32_16x16x32_bf16 v[152:155], v[104:107], v[36:39], v[152:155]
    v_mfma_f32_16x16x32_bf16 v[156:159], v[108:111], v[36:39], v[156:159]
    ds_read_b128 v[36:39], v8 offset:2048
    v_lshlrev_b32 v2, 4, v0
    v_mfma_f32_16x16x32_bf16 v[160:163], v[96:99], v[40:43], v[160:163]
    ds_read_b64_tr_b16 v[66:67], v12 offset:1024
    buffer_load_dwordx4 v5, s[16:19], s65 offen offset:1024 lds
    v_mfma_f32_16x16x32_bf16 v[164:167], v[100:103], v[40:43], v[164:167]
    buffer_load_dwordx4 a[0:3], v2, s[36:39], s58 offen
    v_accvgpr_read_b32 v24, a216
    v_mfma_f32_16x16x32_bf16 v[168:171], v[104:107], v[40:43], v[168:171]
    ds_read_b64_tr_b16 v[68:69], v13 offset:0
    v_accvgpr_read_b32 v25, a217
    v_mfma_f32_16x16x32_bf16 v[172:175], v[108:111], v[40:43], v[172:175]
    ds_read_b128 v[40:43], v8 offset:4096
    buffer_load_dwordx4 v19, s[16:19], s65 offen offset:2048 lds
    v_mfma_f32_16x16x32_bf16 v[176:179], v[96:99], v[44:47], v[176:179]
    v_accvgpr_read_b32 v30, a218
    v_accvgpr_read_b32 v31, a219
    v_mfma_f32_16x16x32_bf16 v[180:183], v[100:103], v[44:47], v[180:183]
    ds_read_b64_tr_b16 v[70:71], v13 offset:1024
    v_accvgpr_read_b32 v20, a200
    v_mfma_f32_16x16x32_bf16 v[184:187], v[104:107], v[44:47], v[184:187]
    v_accvgpr_read_b32 v21, a201
    v_accvgpr_read_b32 v22, a202
    v_mfma_f32_16x16x32_bf16 v[188:191], v[108:111], v[44:47], v[188:191]
    ds_read_b128 v[44:47], v8 offset:6144
    buffer_load_dwordx4 v26, s[16:19], s65 offen offset:3072 lds
    v_mfma_f32_16x16x32_bf16 v[192:195], v[96:99], v[48:51], v[192:195]
    ds_read_b64_tr_b16 v[72:73], v14 offset:0
    v_accvgpr_read_b32 v23, a203
    v_mfma_f32_16x16x32_bf16 v[196:199], v[100:103], v[48:51], v[196:199]
    v_cvt_pk_bf16_f32 v20, v20, v21
    v_cvt_pk_bf16_f32 v21, v22, v23
    v_mfma_f32_16x16x32_bf16 v[200:203], v[104:107], v[48:51], v[200:203]
    ds_read_b64_tr_b16 v[74:75], v14 offset:1024
    s_add_u32 m0, s45, 147456
    s_add_u32 s65, s35, 1152
    buffer_load_dwordx4 v4, s[16:19], s65 offen offset:0 lds
    v_mfma_f32_16x16x32_bf16 v[204:207], v[108:111], v[48:51], v[204:207]
    ds_read_b128 v[48:51], v8 offset:8192
    v_mfma_f32_16x16x32_bf16 v[208:211], v[96:99], v[52:55], v[208:211]
    v_cvt_pk_bf16_f32 v22, v24, v25
    v_mfma_f32_16x16x32_bf16 v[212:215], v[100:103], v[52:55], v[212:215]
    ds_read_b64_tr_b16 v[76:77], v15 offset:0
    buffer_load_dwordx4 v5, s[16:19], s65 offen offset:1024 lds
    v_mfma_f32_16x16x32_bf16 v[216:219], v[104:107], v[52:55], v[216:219]
    v_cvt_pk_bf16_f32 v23, v30, v31
    buffer_store_dwordx4 v[20:23], v17, s[40:43], s62 offen offset:1024 sc1
    v_mfma_f32_16x16x32_bf16 v[220:223], v[108:111], v[52:55], v[220:223]
    ds_read_b128 v[52:55], v8 offset:10240
    v_accvgpr_read_b32 v24, a220
    v_accvgpr_read_b32 v25, a221
    v_mfma_f32_16x16x32_bf16 v[224:227], v[96:99], v[56:59], v[224:227]
    ds_read_b64_tr_b16 v[78:79], v15 offset:1024
    v_accvgpr_read_b32 v30, a222
    v_mfma_f32_16x16x32_bf16 v[228:231], v[100:103], v[56:59], v[228:231]
    buffer_load_dwordx4 v19, s[16:19], s65 offen offset:2048 lds
    v_accvgpr_read_b32 v31, a223
    v_mfma_f32_16x16x32_bf16 v[232:235], v[104:107], v[56:59], v[232:235]
    v_accvgpr_read_b32 v20, a204
    v_accvgpr_read_b32 v21, a205
    v_mfma_f32_16x16x32_bf16 v[236:239], v[108:111], v[56:59], v[236:239]
    ds_read_b128 v[56:59], v8 offset:12288
    v_accvgpr_read_b32 v22, a206
    v_mfma_f32_16x16x32_bf16 v[240:243], v[96:99], v[60:63], v[240:243]
    buffer_load_dwordx4 v26, s[16:19], s65 offen offset:3072 lds
    v_accvgpr_read_b32 v23, a207
    v_mfma_f32_16x16x32_bf16 v[244:247], v[100:103], v[60:63], v[244:247]
    v_cvt_pk_bf16_f32 v20, v20, v21
    v_cvt_pk_bf16_f32 v21, v22, v23
    v_mfma_f32_16x16x32_bf16 v[248:251], v[104:107], v[60:63], v[248:251]
    v_cvt_pk_bf16_f32 v22, v24, v25
    v_cvt_pk_bf16_f32 v23, v30, v31
    v_mfma_f32_16x16x32_bf16 v[252:255], v[108:111], v[60:63], v[252:255]
    ds_read_b128 v[60:63], v8 offset:14336
    buffer_store_dwordx4 v[20:23], v17, s[40:43], s62 offen offset:1280 sc1
    s_waitcnt lgkmcnt(2)
    v_mfma_f32_16x16x32_bf16 v[128:131], v[64:67], v[32:35], v[128:131]
    ds_read_b64_tr_b16 v[96:97], v12 offset:8192
    v_mfma_f32_16x16x32_bf16 v[132:135], v[68:71], v[32:35], v[132:135]
    v_accvgpr_read_b32 v24, a240
    v_accvgpr_read_b32 v25, a241
    v_mfma_f32_16x16x32_bf16 v[136:139], v[72:75], v[32:35], v[136:139]
    ds_read_b64_tr_b16 v[98:99], v12 offset:9216
    v_mfma_f32_16x16x32_bf16 v[140:143], v[76:79], v[32:35], v[140:143]
    ds_read_b128 v[32:35], v9 offset:0
    v_mfma_f32_16x16x32_bf16 v[144:147], v[64:67], v[36:39], v[144:147]
    v_accvgpr_read_b32 v30, a242
    v_accvgpr_read_b32 v31, a243
    v_mfma_f32_16x16x32_bf16 v[148:151], v[68:71], v[36:39], v[148:151]
    v_accvgpr_read_b32 v20, a224
    v_mfma_f32_16x16x32_bf16 v[152:155], v[72:75], v[36:39], v[152:155]
    ds_read_b64_tr_b16 v[100:101], v13 offset:8192
    v_mfma_f32_16x16x32_bf16 v[156:159], v[76:79], v[36:39], v[156:159]
    ds_read_b128 v[36:39], v9 offset:2048
    v_accvgpr_read_b32 v21, a225
    v_mfma_f32_16x16x32_bf16 v[160:163], v[64:67], v[40:43], v[160:163]
    v_accvgpr_read_b32 v22, a226
    v_mfma_f32_16x16x32_bf16 v[164:167], v[68:71], v[40:43], v[164:167]
    ds_read_b64_tr_b16 v[102:103], v13 offset:9216
    v_mfma_f32_16x16x32_bf16 v[168:171], v[72:75], v[40:43], v[168:171]
    v_accvgpr_read_b32 v23, a227
    v_mfma_f32_16x16x32_bf16 v[172:175], v[76:79], v[40:43], v[172:175]
    ds_read_b128 v[40:43], v9 offset:4096
    v_cvt_pk_bf16_f32 v20, v20, v21
    v_mfma_f32_16x16x32_bf16 v[176:179], v[64:67], v[44:47], v[176:179]
    v_cvt_pk_bf16_f32 v21, v22, v23
    v_mfma_f32_16x16x32_bf16 v[180:183], v[68:71], v[44:47], v[180:183]
    ds_read_b64_tr_b16 v[104:105], v14 offset:8192
    v_mfma_f32_16x16x32_bf16 v[184:187], v[72:75], v[44:47], v[184:187]
    v_cvt_pk_bf16_f32 v22, v24, v25
    v_cvt_pk_bf16_f32 v23, v30, v31
    v_mfma_f32_16x16x32_bf16 v[188:191], v[76:79], v[44:47], v[188:191]
    ds_read_b128 v[44:47], v9 offset:6144
    v_mfma_f32_16x16x32_bf16 v[192:195], v[64:67], v[48:51], v[192:195]
    ds_read_b64_tr_b16 v[106:107], v14 offset:9216
    v_mfma_f32_16x16x32_bf16 v[196:199], v[68:71], v[48:51], v[196:199]
    buffer_store_dwordx4 v[20:23], v17, s[40:43], s63 offen offset:0 sc1
    v_accvgpr_read_b32 v24, a244
    v_mfma_f32_16x16x32_bf16 v[200:203], v[72:75], v[48:51], v[200:203]
    v_accvgpr_read_b32 v25, a245
    v_mfma_f32_16x16x32_bf16 v[204:207], v[76:79], v[48:51], v[204:207]
    ds_read_b128 v[48:51], v9 offset:8192
    v_mfma_f32_16x16x32_bf16 v[208:211], v[64:67], v[52:55], v[208:211]
    ds_read_b64_tr_b16 v[108:109], v15 offset:8192
    v_accvgpr_read_b32 v30, a246
    v_mfma_f32_16x16x32_bf16 v[212:215], v[68:71], v[52:55], v[212:215]
    v_accvgpr_read_b32 v31, a247
    v_mfma_f32_16x16x32_bf16 v[216:219], v[72:75], v[52:55], v[216:219]
    ds_read_b64_tr_b16 v[110:111], v15 offset:9216
    v_mfma_f32_16x16x32_bf16 v[220:223], v[76:79], v[52:55], v[220:223]
    ds_read_b128 v[52:55], v9 offset:10240
    v_accvgpr_read_b32 v20, a228
    s_waitcnt lgkmcnt(15)
    v_mfma_f32_16x16x32_bf16 v[224:227], v[64:67], v[56:59], v[224:227]
    v_accvgpr_read_b32 v21, a229
    v_mfma_f32_16x16x32_bf16 v[228:231], v[68:71], v[56:59], v[228:231]
    v_accvgpr_read_b32 v22, a230
    v_mfma_f32_16x16x32_bf16 v[232:235], v[72:75], v[56:59], v[232:235]
    v_accvgpr_read_b32 v23, a231
    v_mfma_f32_16x16x32_bf16 v[236:239], v[76:79], v[56:59], v[236:239]
    ds_read_b128 v[56:59], v9 offset:12288
    v_cvt_pk_bf16_f32 v20, v20, v21
    s_waitcnt lgkmcnt(15)
    v_mfma_f32_16x16x32_bf16 v[240:243], v[64:67], v[60:63], v[240:243]
    v_cvt_pk_bf16_f32 v21, v22, v23
    v_mfma_f32_16x16x32_bf16 v[244:247], v[68:71], v[60:63], v[244:247]
    v_cvt_pk_bf16_f32 v22, v24, v25
    v_mfma_f32_16x16x32_bf16 v[248:251], v[72:75], v[60:63], v[248:251]
    v_cvt_pk_bf16_f32 v23, v30, v31
    buffer_store_dwordx4 v[20:23], v17, s[40:43], s63 offen offset:256 sc1
    v_mfma_f32_16x16x32_bf16 v[252:255], v[76:79], v[60:63], v[252:255]
    ds_read_b128 v[60:63], v9 offset:14336
    s_waitcnt lgkmcnt(3)
    v_mfma_f32_16x16x32_bf16 v[128:131], v[96:99], v[32:35], v[128:131]
    v_accvgpr_read_b32 v24, a248
    v_mfma_f32_16x16x32_bf16 v[132:135], v[100:103], v[32:35], v[132:135]
    v_accvgpr_read_b32 v25, a249
    v_accvgpr_read_b32 v30, a250
    v_mfma_f32_16x16x32_bf16 v[136:139], v[104:107], v[32:35], v[136:139]
    v_accvgpr_read_b32 v31, a251
    v_mfma_f32_16x16x32_bf16 v[140:143], v[108:111], v[32:35], v[140:143]
    s_waitcnt vmcnt(20) lgkmcnt(0)
    s_barrier
    v_mfma_f32_16x16x32_bf16 v[144:147], v[96:99], v[36:39], v[144:147]
    ds_read_b128 v[32:35], v8 offset:32768
    v_mfma_f32_16x16x32_bf16 v[148:151], v[100:103], v[36:39], v[148:151]
    ds_read_b64_tr_b16 v[64:65], v12 offset:49152
    v_mfma_f32_16x16x32_bf16 v[152:155], v[104:107], v[36:39], v[152:155]
    v_accvgpr_read_b32 v20, a232
    v_accvgpr_read_b32 v21, a233
    v_mfma_f32_16x16x32_bf16 v[156:159], v[108:111], v[36:39], v[156:159]
    ds_read_b128 v[36:39], v8 offset:34816
    v_mfma_f32_16x16x32_bf16 v[160:163], v[96:99], v[40:43], v[160:163]
    ds_read_b64_tr_b16 v[66:67], v12 offset:50176
    v_mfma_f32_16x16x32_bf16 v[164:167], v[100:103], v[40:43], v[164:167]
    v_accvgpr_read_b32 v22, a234
    v_accvgpr_read_b32 v23, a235
    v_mfma_f32_16x16x32_bf16 v[168:171], v[104:107], v[40:43], v[168:171]
    ds_read_b64_tr_b16 v[68:69], v13 offset:49152
    v_mfma_f32_16x16x32_bf16 v[172:175], v[108:111], v[40:43], v[172:175]
    ds_read_b128 v[40:43], v8 offset:36864
    v_cvt_pk_bf16_f32 v20, v20, v21
    v_mfma_f32_16x16x32_bf16 v[176:179], v[96:99], v[44:47], v[176:179]
    v_cvt_pk_bf16_f32 v21, v22, v23
    v_mfma_f32_16x16x32_bf16 v[180:183], v[100:103], v[44:47], v[180:183]
    ds_read_b64_tr_b16 v[70:71], v13 offset:50176
    v_mfma_f32_16x16x32_bf16 v[184:187], v[104:107], v[44:47], v[184:187]
    v_cvt_pk_bf16_f32 v22, v24, v25
    v_cvt_pk_bf16_f32 v23, v30, v31
    v_mfma_f32_16x16x32_bf16 v[188:191], v[108:111], v[44:47], v[188:191]
    ds_read_b128 v[44:47], v8 offset:38912
    v_mfma_f32_16x16x32_bf16 v[192:195], v[96:99], v[48:51], v[192:195]
    ds_read_b64_tr_b16 v[72:73], v14 offset:49152
    v_mfma_f32_16x16x32_bf16 v[196:199], v[100:103], v[48:51], v[196:199]
    buffer_store_dwordx4 v[20:23], v17, s[40:43], s63 offen offset:1024 sc1
    v_accvgpr_read_b32 v24, a252
    v_mfma_f32_16x16x32_bf16 v[200:203], v[104:107], v[48:51], v[200:203]
    ds_read_b64_tr_b16 v[74:75], v14 offset:50176
    v_mfma_f32_16x16x32_bf16 v[204:207], v[108:111], v[48:51], v[204:207]
    ds_read_b128 v[48:51], v8 offset:40960
    v_accvgpr_read_b32 v25, a253
    v_mfma_f32_16x16x32_bf16 v[208:211], v[96:99], v[52:55], v[208:211]
    v_accvgpr_read_b32 v30, a254
    v_mfma_f32_16x16x32_bf16 v[212:215], v[100:103], v[52:55], v[212:215]
    ds_read_b64_tr_b16 v[76:77], v15 offset:49152
    v_mfma_f32_16x16x32_bf16 v[216:219], v[104:107], v[52:55], v[216:219]
    v_accvgpr_read_b32 v31, a255
    v_accvgpr_read_b32 v20, a236
    v_mfma_f32_16x16x32_bf16 v[220:223], v[108:111], v[52:55], v[220:223]
    ds_read_b128 v[52:55], v8 offset:43008
    v_mfma_f32_16x16x32_bf16 v[224:227], v[96:99], v[56:59], v[224:227]
    ds_read_b64_tr_b16 v[78:79], v15 offset:50176
    v_mfma_f32_16x16x32_bf16 v[228:231], v[100:103], v[56:59], v[228:231]
    v_accvgpr_read_b32 v21, a237
    v_accvgpr_read_b32 v22, a238
    v_mfma_f32_16x16x32_bf16 v[232:235], v[104:107], v[56:59], v[232:235]
    v_accvgpr_read_b32 v23, a239
    v_mfma_f32_16x16x32_bf16 v[236:239], v[108:111], v[56:59], v[236:239]
    ds_read_b128 v[56:59], v8 offset:45056
    v_cvt_pk_bf16_f32 v20, v20, v21
    v_mfma_f32_16x16x32_bf16 v[240:243], v[96:99], v[60:63], v[240:243]
    v_cvt_pk_bf16_f32 v21, v22, v23
    v_mfma_f32_16x16x32_bf16 v[244:247], v[100:103], v[60:63], v[244:247]
    v_cvt_pk_bf16_f32 v22, v24, v25
    v_mfma_f32_16x16x32_bf16 v[248:251], v[104:107], v[60:63], v[248:251]
    v_cvt_pk_bf16_f32 v23, v30, v31
    buffer_store_dwordx4 v[20:23], v17, s[40:43], s63 offen offset:1280 sc1
    v_mfma_f32_16x16x32_bf16 v[252:255], v[108:111], v[60:63], v[252:255]
    ds_read_b128 v[60:63], v8 offset:47104
    s_waitcnt lgkmcnt(2)
    v_mfma_f32_16x16x32_bf16 v[128:131], v[64:67], v[32:35], v[128:131]
    ds_read_b64_tr_b16 v[96:97], v12 offset:57344
    s_lshl_b32 s48, s47, 1
    v_mfma_f32_16x16x32_bf16 v[132:135], v[68:71], v[32:35], v[132:135]
    s_add_u32 s48, s48, 2
    s_and_b32 s67, s44, 1
    v_mfma_f32_16x16x32_bf16 v[136:139], v[72:75], v[32:35], v[136:139]
    ds_read_b64_tr_b16 v[98:99], v12 offset:58368
    s_mul_i32 s68, s46, 1048576
    v_mfma_f32_16x16x32_bf16 v[140:143], v[76:79], v[32:35], v[140:143]
    ds_read_b128 v[32:35], v9 offset:32768
    s_add_u32 s68, s68, 0xf00000
    v_mfma_f32_16x16x32_bf16 v[144:147], v[64:67], v[36:39], v[144:147]
    s_add_u32 s68, s68, s45
    s_sub_u32 s56, 15, s47
    v_mfma_f32_16x16x32_bf16 v[148:151], v[68:71], v[36:39], v[148:151]
    s_lshl_b32 s56, s56, 2
    v_mfma_f32_16x16x32_bf16 v[152:155], v[72:75], v[36:39], v[152:155]
    ds_read_b64_tr_b16 v[100:101], v13 offset:57344
    s_add_u32 s56, s56, s44
    v_mfma_f32_16x16x32_bf16 v[156:159], v[76:79], v[36:39], v[156:159]
    ds_read_b128 v[36:39], v9 offset:34816
    s_lshl_b32 s57, s47, 2
    v_mfma_f32_16x16x32_bf16 v[160:163], v[64:67], v[40:43], v[160:163]
    s_add_u32 s57, s57, s44
    s_mov_b32 s28, s40
    v_mfma_f32_16x16x32_bf16 v[164:167], v[68:71], v[40:43], v[164:167]
    ds_read_b64_tr_b16 v[102:103], v13 offset:58368
    s_mov_b32 s29, s41
    v_mfma_f32_16x16x32_bf16 v[168:171], v[72:75], v[40:43], v[168:171]
    s_mov_b32 s30, 0x5000000
    s_mov_b32 s31, 0x00020000
    v_mfma_f32_16x16x32_bf16 v[172:175], v[76:79], v[40:43], v[172:175]
    ds_read_b128 v[40:43], v9 offset:36864
    s_mov_b32 s32, s40
    v_mfma_f32_16x16x32_bf16 v[176:179], v[64:67], v[44:47], v[176:179]
    s_mov_b32 s33, s41
    s_mov_b32 s34, 0x5000000
    v_mfma_f32_16x16x32_bf16 v[180:183], v[68:71], v[44:47], v[180:183]
    ds_read_b64_tr_b16 v[104:105], v14 offset:57344
    s_mov_b32 s35, 0x00020000
    v_mfma_f32_16x16x32_bf16 v[184:187], v[72:75], v[44:47], v[184:187]
    s_sub_u32 s64, s48, 2
    s_lshl_b32 s58, s64, 15
    v_mfma_f32_16x16x32_bf16 v[188:191], v[76:79], v[44:47], v[188:191]
    ds_read_b128 v[44:47], v9 offset:38912
    s_add_u32 s51, s68, s58
    v_mfma_f32_16x16x32_bf16 v[192:195], v[64:67], v[48:51], v[192:195]
    ds_read_b64_tr_b16 v[106:107], v14 offset:58368
    v_mfma_f32_16x16x32_bf16 v[196:199], v[68:71], v[48:51], v[196:199]
    s_add_u32 s53, s51, 0x8000
    s_add_u32 s52, s51, 0x10000
    v_mfma_f32_16x16x32_bf16 v[200:203], v[72:75], v[48:51], v[200:203]
    s_cmp_eq_u32 s48, 2
    s_cselect_b32 s52, s52, s68
    v_mfma_f32_16x16x32_bf16 v[204:207], v[76:79], v[48:51], v[204:207]
    ds_read_b128 v[48:51], v9 offset:40960
    s_add_u32 s55, s45, 0x10000
    v_mfma_f32_16x16x32_bf16 v[208:211], v[64:67], v[52:55], v[208:211]
    ds_read_b64_tr_b16 v[108:109], v15 offset:57344
    s_sub_i32 s71, s48, 3
    v_mfma_f32_16x16x32_bf16 v[212:215], v[68:71], v[52:55], v[212:215]
    s_lshl_b32 s69, 9, s48
    s_lshr_b32 s69, s69, 3
    v_mfma_f32_16x16x32_bf16 v[216:219], v[72:75], v[52:55], v[216:219]
    ds_read_b64_tr_b16 v[110:111], v15 offset:58368
    s_or_b32 s69, s69, 0x10002
    v_mfma_f32_16x16x32_bf16 v[220:223], v[76:79], v[52:55], v[220:223]
    ds_read_b128 v[52:55], v9 offset:43008
    s_sub_u32 s58, s48, 1
    s_waitcnt lgkmcnt(15)
    v_mfma_f32_16x16x32_bf16 v[224:227], v[64:67], v[56:59], v[224:227]
    s_lshl_b32 s70, 1, s58
    s_or_b32 s70, s70, 49476
    v_mfma_f32_16x16x32_bf16 v[228:231], v[68:71], v[56:59], v[228:231]
    s_lshl_b32 s77, s67, 14
    s_or_b32 s77, s77, 0x10000
    v_mfma_f32_16x16x32_bf16 v[232:235], v[72:75], v[56:59], v[232:235]
    s_lshl_b32 s58, s46, 7
    v_mfma_f32_16x16x32_bf16 v[236:239], v[76:79], v[56:59], v[236:239]
    ds_read_b128 v[56:59], v9 offset:45056
    s_lshl_b32 s59, s47, 2
    s_waitcnt lgkmcnt(15)
    v_mfma_f32_16x16x32_bf16 v[240:243], v[64:67], v[60:63], v[240:243]
    s_add_u32 s58, s58, s59
    s_add_u32 s58, s58, 0x4820000
    v_mfma_f32_16x16x32_bf16 v[244:247], v[68:71], v[60:63], v[244:247]
    v_mov_b32 v31, s58
    v_mov_b32 v23, 1
    v_mfma_f32_16x16x32_bf16 v[248:251], v[72:75], v[60:63], v[248:251]
    v_lshlrev_b32 v24, 4, v1
    v_add_u32 v25, 0x8000, v24
    v_mfma_f32_16x16x32_bf16 v[252:255], v[76:79], v[60:63], v[252:255]
    ds_read_b128 v[60:63], v9 offset:47104
    v_add_u32 v30, 0x4000, v24
    s_waitcnt lgkmcnt(3)
    v_mfma_f32_16x16x32_bf16 v[128:131], v[96:99], v[32:35], v[128:131]
    v_accvgpr_write_b32 a0, 0
    v_accvgpr_write_b32 a1, 0
    v_mfma_f32_16x16x32_bf16 v[132:135], v[100:103], v[32:35], v[132:135]
    v_accvgpr_write_b32 a2, 0
    v_accvgpr_write_b32 a3, 0
    v_accvgpr_write_b32 a4, 0
    v_mfma_f32_16x16x32_bf16 v[136:139], v[104:107], v[32:35], v[136:139]
    v_accvgpr_write_b32 a5, 0
    v_accvgpr_write_b32 a6, 0
    v_mfma_f32_16x16x32_bf16 v[140:143], v[108:111], v[32:35], v[140:143]
    s_waitcnt vmcnt(0)
    s_waitcnt lgkmcnt(0)
    s_barrier
    s_cmp_lg_u32 s44, 0
    s_cbranch_scc1 main_kernel_noat
    v_readfirstlane_b32 s58, v3
    s_mov_b64 exec, 1
    buffer_store_dword v23, v31, s[40:43], 0 offen sc1
    s_mov_b64 exec, -1
    s_cmp_lt_u32 s58, 8
    s_cbranch_scc1 main_kernel_slowpub
main_kernel_noat:
    v_mfma_f32_16x16x32_bf16 v[144:147], v[96:99], v[36:39], v[144:147]
    ds_read_b128 v[32:35], v10 offset:0
    v_accvgpr_write_b32 a7, 0
    v_mfma_f32_16x16x32_bf16 v[148:151], v[100:103], v[36:39], v[148:151]
    ds_read_b64_tr_b16 v[64:65], v12 offset:16384
    s_add_u32 m0, s45, 0x10000
    s_nop 0
    buffer_load_dwordx4 v24, s[40:43], s51 offen sc1 lds
    v_mfma_f32_16x16x32_bf16 v[152:155], v[104:107], v[36:39], v[152:155]
    v_accvgpr_write_b32 a8, 0
    v_mfma_f32_16x16x32_bf16 v[156:159], v[108:111], v[36:39], v[156:159]
    ds_read_b128 v[36:39], v10 offset:2048
    v_accvgpr_write_b32 a9, 0
    v_mfma_f32_16x16x32_bf16 v[160:163], v[96:99], v[40:43], v[160:163]
    ds_read_b64_tr_b16 v[66:67], v12 offset:17408
    buffer_load_dwordx4 v24, s[40:43], s51 offen offset:1024 sc1 lds
    v_accvgpr_write_b32 a10, 0
    v_mfma_f32_16x16x32_bf16 v[164:167], v[100:103], v[40:43], v[164:167]
    v_accvgpr_write_b32 a11, 0
    v_accvgpr_write_b32 a12, 0
    v_mfma_f32_16x16x32_bf16 v[168:171], v[104:107], v[40:43], v[168:171]
    ds_read_b64_tr_b16 v[68:69], v13 offset:16384
    v_accvgpr_write_b32 a13, 0
    v_mfma_f32_16x16x32_bf16 v[172:175], v[108:111], v[40:43], v[172:175]
    ds_read_b128 v[40:43], v10 offset:4096
    buffer_load_dwordx4 v24, s[40:43], s51 offen offset:2048 sc1 lds
    v_mfma_f32_16x16x32_bf16 v[176:179], v[96:99], v[44:47], v[176:179]
    v_accvgpr_write_b32 a14, 0
    v_accvgpr_write_b32 a15, 0
    v_accvgpr_write_b32 a16, 0
    v_mfma_f32_16x16x32_bf16 v[180:183], v[100:103], v[44:47], v[180:183]
    ds_read_b64_tr_b16 v[70:71], v13 offset:17408
    v_accvgpr_write_b32 a17, 0
    v_mfma_f32_16x16x32_bf16 v[184:187], v[104:107], v[44:47], v[184:187]
    v_accvgpr_write_b32 a18, 0
    v_accvgpr_write_b32 a19, 0
    v_mfma_f32_16x16x32_bf16 v[188:191], v[108:111], v[44:47], v[188:191]
    ds_read_b128 v[44:47], v10 offset:6144
    buffer_load_dwordx4 v24, s[40:43], s51 offen offset:3072 sc1 lds
    v_accvgpr_write_b32 a20, 0
    v_mfma_f32_16x16x32_bf16 v[192:195], v[96:99], v[48:51], v[192:195]
    ds_read_b64_tr_b16 v[72:73], v14 offset:16384
    v_accvgpr_write_b32 a21, 0
    v_mfma_f32_16x16x32_bf16 v[196:199], v[100:103], v[48:51], v[196:199]
    v_accvgpr_write_b32 a22, 0
    v_accvgpr_write_b32 a23, 0
    v_mfma_f32_16x16x32_bf16 v[200:203], v[104:107], v[48:51], v[200:203]
    ds_read_b64_tr_b16 v[74:75], v14 offset:17408
    s_mov_b32 m0, s45
    s_nop 0
    buffer_load_dwordx4 v25, s[40:43], s51 offen sc1 lds
    v_mfma_f32_16x16x32_bf16 v[204:207], v[108:111], v[48:51], v[204:207]
    ds_read_b128 v[48:51], v10 offset:8192
    v_mfma_f32_16x16x32_bf16 v[208:211], v[96:99], v[52:55], v[208:211]
    v_accvgpr_write_b32 a24, 0
    v_accvgpr_write_b32 a25, 0
    v_mfma_f32_16x16x32_bf16 v[212:215], v[100:103], v[52:55], v[212:215]
    ds_read_b64_tr_b16 v[76:77], v15 offset:16384
    buffer_load_dwordx4 v25, s[40:43], s51 offen offset:1024 sc1 lds
    v_mfma_f32_16x16x32_bf16 v[216:219], v[104:107], v[52:55], v[216:219]
    v_accvgpr_write_b32 a26, 0
    v_accvgpr_write_b32 a27, 0
    v_mfma_f32_16x16x32_bf16 v[220:223], v[108:111], v[52:55], v[220:223]
    ds_read_b128 v[52:55], v10 offset:10240
    v_accvgpr_write_b32 a28, 0
    v_accvgpr_write_b32 a29, 0
    v_mfma_f32_16x16x32_bf16 v[224:227], v[96:99], v[56:59], v[224:227]
    ds_read_b64_tr_b16 v[78:79], v15 offset:17408
    v_accvgpr_write_b32 a30, 0
    v_mfma_f32_16x16x32_bf16 v[228:231], v[100:103], v[56:59], v[228:231]
    buffer_load_dwordx4 v25, s[40:43], s51 offen offset:2048 sc1 lds
    v_accvgpr_write_b32 a31, 0
    v_mfma_f32_16x16x32_bf16 v[232:235], v[104:107], v[56:59], v[232:235]
    v_accvgpr_write_b32 a32, 0
    v_accvgpr_write_b32 a33, 0
    v_accvgpr_write_b32 a34, 0
    v_mfma_f32_16x16x32_bf16 v[236:239], v[108:111], v[56:59], v[236:239]
    ds_read_b128 v[56:59], v10 offset:12288
    v_accvgpr_write_b32 a35, 0
    v_mfma_f32_16x16x32_bf16 v[240:243], v[96:99], v[60:63], v[240:243]
    buffer_load_dwordx4 v25, s[40:43], s51 offen offset:3072 sc1 lds
    v_accvgpr_write_b32 a36, 0
    v_mfma_f32_16x16x32_bf16 v[244:247], v[100:103], v[60:63], v[244:247]
    v_accvgpr_write_b32 a37, 0
    v_accvgpr_write_b32 a38, 0
    v_mfma_f32_16x16x32_bf16 v[248:251], v[104:107], v[60:63], v[248:251]
    v_accvgpr_write_b32 a39, 0
    v_accvgpr_write_b32 a40, 0
    v_accvgpr_write_b32 a41, 0
    v_mfma_f32_16x16x32_bf16 v[252:255], v[108:111], v[60:63], v[252:255]
    ds_read_b128 v[60:63], v10 offset:14336
    v_accvgpr_write_b32 a42, 0
    s_waitcnt lgkmcnt(2)
    v_mfma_f32_16x16x32_bf16 v[128:131], v[64:67], v[32:35], v[128:131]
    ds_read_b64_tr_b16 v[96:97], v12 offset:24576
    v_accvgpr_write_b32 a43, 0
    v_mfma_f32_16x16x32_bf16 v[132:135], v[68:71], v[32:35], v[132:135]
    s_add_u32 m0, s45, 0x8000
    s_nop 0
    buffer_load_dwordx4 v30, s[40:43], s51 offen sc1 lds
    v_mfma_f32_16x16x32_bf16 v[136:139], v[72:75], v[32:35], v[136:139]
    ds_read_b64_tr_b16 v[98:99], v12 offset:25600
    v_accvgpr_write_b32 a44, 0
    v_mfma_f32_16x16x32_bf16 v[140:143], v[76:79], v[32:35], v[140:143]
    ds_read_b128 v[32:35], v11 offset:0
    v_accvgpr_write_b32 a45, 0
    v_mfma_f32_16x16x32_bf16 v[144:147], v[64:67], v[36:39], v[144:147]
    buffer_load_dwordx4 v30, s[40:43], s51 offen offset:1024 sc1 lds
    v_accvgpr_write_b32 a46, 0
    v_mfma_f32_16x16x32_bf16 v[148:151], v[68:71], v[36:39], v[148:151]
    v_accvgpr_write_b32 a47, 0
    v_accvgpr_write_b32 a48, 0
    v_mfma_f32_16x16x32_bf16 v[152:155], v[72:75], v[36:39], v[152:155]
    ds_read_b64_tr_b16 v[100:101], v13 offset:24576
    v_accvgpr_write_b32 a49, 0
    v_accvgpr_write_b32 a50, 0
    v_mfma_f32_16x16x32_bf16 v[156:159], v[76:79], v[36:39], v[156:159]
    ds_read_b128 v[36:39], v11 offset:2048
    v_accvgpr_write_b32 a51, 0
    v_mfma_f32_16x16x32_bf16 v[160:163], v[64:67], v[40:43], v[160:163]
    buffer_load_dwordx4 v30, s[40:43], s51 offen offset:2048 sc1 lds
    v_accvgpr_write_b32 a52, 0
    v_mfma_f32_16x16x32_bf16 v[164:167], v[68:71], v[40:43], v[164:167]
    ds_read_b64_tr_b16 v[102:103], v13 offset:25600
    v_accvgpr_write_b32 a53, 0
    v_mfma_f32_16x16x32_bf16 v[168:171], v[72:75], v[40:43], v[168:171]
    v_accvgpr_write_b32 a54, 0
    v_accvgpr_write_b32 a55, 0
    v_mfma_f32_16x16x32_bf16 v[172:175], v[76:79], v[40:43], v[172:175]
    ds_read_b128 v[40:43], v11 offset:4096
    v_accvgpr_write_b32 a56, 0
    v_accvgpr_write_b32 a57, 0
    v_mfma_f32_16x16x32_bf16 v[176:179], v[64:67], v[44:47], v[176:179]
    buffer_load_dwordx4 v30, s[40:43], s51 offen offset:3072 sc1 lds
    v_accvgpr_write_b32 a58, 0
    v_mfma_f32_16x16x32_bf16 v[180:183], v[68:71], v[44:47], v[180:183]
    ds_read_b64_tr_b16 v[104:105], v14 offset:24576
    v_accvgpr_write_b32 a59, 0
    v_mfma_f32_16x16x32_bf16 v[184:187], v[72:75], v[44:47], v[184:187]
    v_accvgpr_write_b32 a60, 0
    v_accvgpr_write_b32 a61, 0
    v_mfma_f32_16x16x32_bf16 v[188:191], v[76:79], v[44:47], v[188:191]
    ds_read_b128 v[44:47], v11 offset:6144
    v_accvgpr_write_b32 a62, 0
    v_accvgpr_write_b32 a63, 0
    v_mfma_f32_16x16x32_bf16 v[192:195], v[64:67], v[48:51], v[192:195]
    ds_read_b64_tr_b16 v[106:107], v14 offset:25600
    s_add_u32 m0, s45, 0x18000
    s_nop 0
    buffer_load_dwordx4 v30, s[40:43], s53 offen sc1 lds
    v_mfma_f32_16x16x32_bf16 v[196:199], v[68:71], v[48:51], v[196:199]
    v_mfma_f32_16x16x32_bf16 v[200:203], v[72:75], v[48:51], v[200:203]
    v_accvgpr_write_b32 a64, 0
    v_accvgpr_write_b32 a65, 0
    v_mfma_f32_16x16x32_bf16 v[204:207], v[76:79], v[48:51], v[204:207]
    ds_read_b128 v[48:51], v11 offset:8192
    v_accvgpr_write_b32 a66, 0
    v_mfma_f32_16x16x32_bf16 v[208:211], v[64:67], v[52:55], v[208:211]
    ds_read_b64_tr_b16 v[108:109], v15 offset:24576
    buffer_load_dwordx4 v30, s[40:43], s53 offen offset:1024 sc1 lds
    v_accvgpr_write_b32 a67, 0
    v_mfma_f32_16x16x32_bf16 v[212:215], v[68:71], v[52:55], v[212:215]
    v_accvgpr_write_b32 a68, 0
    v_accvgpr_write_b32 a69, 0
    v_mfma_f32_16x16x32_bf16 v[216:219], v[72:75], v[52:55], v[216:219]
    ds_read_b64_tr_b16 v[110:111], v15 offset:25600
    v_accvgpr_write_b32 a70, 0
    v_mfma_f32_16x16x32_bf16 v[220:223], v[76:79], v[52:55], v[220:223]
    ds_read_b128 v[52:55], v11 offset:10240
    v_accvgpr_write_b32 a71, 0
    s_waitcnt lgkmcnt(15)
    v_mfma_f32_16x16x32_bf16 v[224:227], v[64:67], v[56:59], v[224:227]
    buffer_load_dwordx4 v30, s[40:43], s53 offen offset:2048 sc1 lds
    v_accvgpr_write_b32 a72, 0
    v_mfma_f32_16x16x32_bf16 v[228:231], v[68:71], v[56:59], v[228:231]
    v_accvgpr_write_b32 a73, 0
    v_accvgpr_write_b32 a74, 0
    v_accvgpr_write_b32 a75, 0
    v_mfma_f32_16x16x32_bf16 v[232:235], v[72:75], v[56:59], v[232:235]
    v_accvgpr_write_b32 a76, 0
    v_accvgpr_write_b32 a77, 0
    v_mfma_f32_16x16x32_bf16 v[236:239], v[76:79], v[56:59], v[236:239]
    ds_read_b128 v[56:59], v11 offset:12288
    v_accvgpr_write_b32 a78, 0
    s_waitcnt lgkmcnt(15)
    v_mfma_f32_16x16x32_bf16 v[240:243], v[64:67], v[60:63], v[240:243]
    buffer_load_dwordx4 v30, s[40:43], s53 offen offset:3072 sc1 lds
    v_accvgpr_write_b32 a79, 0
    v_mfma_f32_16x16x32_bf16 v[244:247], v[68:71], v[60:63], v[244:247]
    v_accvgpr_write_b32 a80, 0
    v_accvgpr_write_b32 a81, 0
    v_accvgpr_write_b32 a82, 0
    v_mfma_f32_16x16x32_bf16 v[248:251], v[72:75], v[60:63], v[248:251]
    v_accvgpr_write_b32 a83, 0
    v_accvgpr_write_b32 a84, 0
    v_mfma_f32_16x16x32_bf16 v[252:255], v[76:79], v[60:63], v[252:255]
    ds_read_b128 v[60:63], v11 offset:14336
    v_accvgpr_write_b32 a85, 0
    s_waitcnt lgkmcnt(3)
    v_mfma_f32_16x16x32_bf16 v[128:131], v[96:99], v[32:35], v[128:131]
    v_accvgpr_write_b32 a86, 0
    v_mfma_f32_16x16x32_bf16 v[132:135], v[100:103], v[32:35], v[132:135]
    v_accvgpr_write_b32 a87, 0
    v_accvgpr_write_b32 a88, 0
    v_mfma_f32_16x16x32_bf16 v[136:139], v[104:107], v[32:35], v[136:139]
    v_accvgpr_write_b32 a89, 0
    v_mfma_f32_16x16x32_bf16 v[140:143], v[108:111], v[32:35], v[140:143]
    s_waitcnt lgkmcnt(0)
    s_barrier
    v_mfma_f32_16x16x32_bf16 v[144:147], v[96:99], v[36:39], v[144:147]
    v_accvgpr_write_b32 a90, 0
    v_mfma_f32_16x16x32_bf16 v[148:151], v[100:103], v[36:39], v[148:151]
    v_accvgpr_write_b32 a91, 0
    v_mfma_f32_16x16x32_bf16 v[152:155], v[104:107], v[36:39], v[152:155]
    v_accvgpr_write_b32 a92, 0
    v_accvgpr_write_b32 a93, 0
    v_mfma_f32_16x16x32_bf16 v[156:159], v[108:111], v[36:39], v[156:159]
    v_accvgpr_write_b32 a94, 0
    v_mfma_f32_16x16x32_bf16 v[160:163], v[96:99], v[40:43], v[160:163]
    v_accvgpr_write_b32 a95, 0
    v_mfma_f32_16x16x32_bf16 v[164:167], v[100:103], v[40:43], v[164:167]
    v_accvgpr_write_b32 a96, 0
    v_accvgpr_write_b32 a97, 0
    v_mfma_f32_16x16x32_bf16 v[168:171], v[104:107], v[40:43], v[168:171]
    v_accvgpr_write_b32 a98, 0
    v_mfma_f32_16x16x32_bf16 v[172:175], v[108:111], v[40:43], v[172:175]
    v_accvgpr_write_b32 a99, 0
    v_accvgpr_write_b32 a100, 0
    v_mfma_f32_16x16x32_bf16 v[176:179], v[96:99], v[44:47], v[176:179]
    v_accvgpr_write_b32 a101, 0
    v_mfma_f32_16x16x32_bf16 v[180:183], v[100:103], v[44:47], v[180:183]
    v_accvgpr_write_b32 a102, 0
    v_mfma_f32_16x16x32_bf16 v[184:187], v[104:107], v[44:47], v[184:187]
    v_accvgpr_write_b32 a103, 0
    v_accvgpr_write_b32 a104, 0
    v_mfma_f32_16x16x32_bf16 v[188:191], v[108:111], v[44:47], v[188:191]
    v_accvgpr_write_b32 a105, 0
    v_mfma_f32_16x16x32_bf16 v[192:195], v[96:99], v[48:51], v[192:195]
    v_accvgpr_write_b32 a106, 0
    v_mfma_f32_16x16x32_bf16 v[196:199], v[100:103], v[48:51], v[196:199]
    v_accvgpr_write_b32 a107, 0
    v_accvgpr_write_b32 a108, 0
    v_mfma_f32_16x16x32_bf16 v[200:203], v[104:107], v[48:51], v[200:203]
    v_accvgpr_write_b32 a109, 0
    v_mfma_f32_16x16x32_bf16 v[204:207], v[108:111], v[48:51], v[204:207]
    v_accvgpr_write_b32 a110, 0
    v_accvgpr_write_b32 a111, 0
    v_mfma_f32_16x16x32_bf16 v[208:211], v[96:99], v[52:55], v[208:211]
    v_accvgpr_write_b32 a112, 0
    v_mfma_f32_16x16x32_bf16 v[212:215], v[100:103], v[52:55], v[212:215]
    v_accvgpr_write_b32 a113, 0
    v_mfma_f32_16x16x32_bf16 v[216:219], v[104:107], v[52:55], v[216:219]
    v_accvgpr_write_b32 a114, 0
    v_accvgpr_write_b32 a115, 0
    v_mfma_f32_16x16x32_bf16 v[220:223], v[108:111], v[52:55], v[220:223]
    v_accvgpr_write_b32 a116, 0
    v_mfma_f32_16x16x32_bf16 v[224:227], v[96:99], v[56:59], v[224:227]
    v_accvgpr_write_b32 a117, 0
    v_mfma_f32_16x16x32_bf16 v[228:231], v[100:103], v[56:59], v[228:231]
    v_accvgpr_write_b32 a118, 0
    v_accvgpr_write_b32 a119, 0
    v_mfma_f32_16x16x32_bf16 v[232:235], v[104:107], v[56:59], v[232:235]
    v_accvgpr_write_b32 a120, 0
    v_mfma_f32_16x16x32_bf16 v[236:239], v[108:111], v[56:59], v[236:239]
    v_accvgpr_write_b32 a121, 0
    v_accvgpr_write_b32 a122, 0
    v_mfma_f32_16x16x32_bf16 v[240:243], v[96:99], v[60:63], v[240:243]
    v_accvgpr_write_b32 a123, 0
    v_mfma_f32_16x16x32_bf16 v[244:247], v[100:103], v[60:63], v[244:247]
    v_accvgpr_write_b32 a124, 0
    v_mfma_f32_16x16x32_bf16 v[248:251], v[104:107], v[60:63], v[248:251]
    v_accvgpr_write_b32 a125, 0
    v_accvgpr_write_b32 a126, 0
    v_mfma_f32_16x16x32_bf16 v[252:255], v[108:111], v[60:63], v[252:255]
    v_accvgpr_write_b32 a127, 0
    s_lshl_b32 s58, s46, 7
    s_add_u32 s58, s58, 0x4820000
    v_min_u32 v2, 7, v1
    v_lshlrev_b32 v2, 2, v2
    v_add_u32 v2, s58, v2
    v_mov_b32 v4, v24
    v_mov_b32 v5, v25
    v_mov_b32 v6, v30
    v_add_u32 v7, 0xc000, v24
    buffer_load_dword v3, v2, s[40:43], 0 offen sc1
    s_lshr_b32 s58, s44, 1
    s_lshl_b32 s58, s58, 14
    v_add_u32 v103, s58, v18
    v_mov_b32 v104, v18
    v_mov_b32 v18, 0x3e0293ee
    v_mov_b32 v19, v18
    v_pk_mul_f32 v[128:129], v[128:129], v[18:19]
    v_pk_mul_f32 v[130:131], v[130:131], v[18:19]
    v_pk_mul_f32 v[132:133], v[132:133], v[18:19]
    v_pk_mul_f32 v[134:135], v[134:135], v[18:19]
    v_cvt_pk_bf16_f32 v64, v128, v129
    v_cvt_pk_bf16_f32 v65, v130, v131
    v_cvt_pk_bf16_f32 v66, v132, v133
    v_cvt_pk_bf16_f32 v67, v134, v135
    ds_write_b128 v104, v[64:67] offset:0
    v_pk_mul_f32 v[136:137], v[136:137], v[18:19]
    v_pk_mul_f32 v[138:139], v[138:139], v[18:19]
    v_pk_mul_f32 v[140:141], v[140:141], v[18:19]
    v_pk_mul_f32 v[142:143], v[142:143], v[18:19]
    v_cvt_pk_bf16_f32 v68, v136, v137
    v_cvt_pk_bf16_f32 v69, v138, v139
    v_cvt_pk_bf16_f32 v70, v140, v141
    v_cvt_pk_bf16_f32 v71, v142, v143
    ds_write_b128 v104, v[68:71] offset:2048
    v_pk_mul_f32 v[144:145], v[144:145], v[18:19]
    v_pk_mul_f32 v[146:147], v[146:147], v[18:19]
    v_pk_mul_f32 v[148:149], v[148:149], v[18:19]
    v_pk_mul_f32 v[150:151], v[150:151], v[18:19]
    v_cvt_pk_bf16_f32 v72, v144, v145
    v_cvt_pk_bf16_f32 v73, v146, v147
    v_cvt_pk_bf16_f32 v74, v148, v149
    v_cvt_pk_bf16_f32 v75, v150, v151
    ds_write_b128 v104, v[72:75] offset:256
    v_pk_mul_f32 v[152:153], v[152:153], v[18:19]
    v_pk_mul_f32 v[154:155], v[154:155], v[18:19]
    v_pk_mul_f32 v[156:157], v[156:157], v[18:19]
    v_pk_mul_f32 v[158:159], v[158:159], v[18:19]
    v_cvt_pk_bf16_f32 v76, v152, v153
    v_cvt_pk_bf16_f32 v77, v154, v155
    v_cvt_pk_bf16_f32 v78, v156, v157
    v_cvt_pk_bf16_f32 v79, v158, v159
    ds_write_b128 v104, v[76:79] offset:2304
    v_pk_mul_f32 v[160:161], v[160:161], v[18:19]
    v_pk_mul_f32 v[162:163], v[162:163], v[18:19]
    v_pk_mul_f32 v[164:165], v[164:165], v[18:19]
    v_pk_mul_f32 v[166:167], v[166:167], v[18:19]
    v_cvt_pk_bf16_f32 v64, v160, v161
    v_cvt_pk_bf16_f32 v65, v162, v163
    v_cvt_pk_bf16_f32 v66, v164, v165
    v_cvt_pk_bf16_f32 v67, v166, v167
    ds_write_b128 v104, v[64:67] offset:8192
    v_pk_mul_f32 v[168:169], v[168:169], v[18:19]
    v_pk_mul_f32 v[170:171], v[170:171], v[18:19]
    v_pk_mul_f32 v[172:173], v[172:173], v[18:19]
    v_pk_mul_f32 v[174:175], v[174:175], v[18:19]
    v_cvt_pk_bf16_f32 v68, v168, v169
    v_cvt_pk_bf16_f32 v69, v170, v171
    v_cvt_pk_bf16_f32 v70, v172, v173
    v_cvt_pk_bf16_f32 v71, v174, v175
    ds_write_b128 v104, v[68:71] offset:10240
    v_pk_mul_f32 v[176:177], v[176:177], v[18:19]
    v_pk_mul_f32 v[178:179], v[178:179], v[18:19]
    v_pk_mul_f32 v[180:181], v[180:181], v[18:19]
    v_pk_mul_f32 v[182:183], v[182:183], v[18:19]
    v_cvt_pk_bf16_f32 v72, v176, v177
    v_cvt_pk_bf16_f32 v73, v178, v179
    v_cvt_pk_bf16_f32 v74, v180, v181
    v_cvt_pk_bf16_f32 v75, v182, v183
    ds_write_b128 v104, v[72:75] offset:8448
    v_pk_mul_f32 v[184:185], v[184:185], v[18:19]
    v_pk_mul_f32 v[186:187], v[186:187], v[18:19]
    v_pk_mul_f32 v[188:189], v[188:189], v[18:19]
    v_pk_mul_f32 v[190:191], v[190:191], v[18:19]
    v_cvt_pk_bf16_f32 v76, v184, v185
    v_cvt_pk_bf16_f32 v77, v186, v187
    v_cvt_pk_bf16_f32 v78, v188, v189
    v_cvt_pk_bf16_f32 v79, v190, v191
    ds_write_b128 v104, v[76:79] offset:10496
    v_pk_mul_f32 v[192:193], v[192:193], v[18:19]
    v_pk_mul_f32 v[194:195], v[194:195], v[18:19]
    v_pk_mul_f32 v[196:197], v[196:197], v[18:19]
    v_pk_mul_f32 v[198:199], v[198:199], v[18:19]
    v_cvt_pk_bf16_f32 v64, v192, v193
    v_cvt_pk_bf16_f32 v65, v194, v195
    v_cvt_pk_bf16_f32 v66, v196, v197
    v_cvt_pk_bf16_f32 v67, v198, v199
    ds_write_b128 v103, v[64:67] offset:16384
    v_pk_mul_f32 v[200:201], v[200:201], v[18:19]
    v_pk_mul_f32 v[202:203], v[202:203], v[18:19]
    v_pk_mul_f32 v[204:205], v[204:205], v[18:19]
    v_pk_mul_f32 v[206:207], v[206:207], v[18:19]
    v_cvt_pk_bf16_f32 v68, v200, v201
    v_cvt_pk_bf16_f32 v69, v202, v203
    v_cvt_pk_bf16_f32 v70, v204, v205
    v_cvt_pk_bf16_f32 v71, v206, v207
    ds_write_b128 v103, v[68:71] offset:18432
    v_pk_mul_f32 v[208:209], v[208:209], v[18:19]
    v_pk_mul_f32 v[210:211], v[210:211], v[18:19]
    v_pk_mul_f32 v[212:213], v[212:213], v[18:19]
    v_pk_mul_f32 v[214:215], v[214:215], v[18:19]
    v_cvt_pk_bf16_f32 v72, v208, v209
    v_cvt_pk_bf16_f32 v73, v210, v211
    v_cvt_pk_bf16_f32 v74, v212, v213
    v_cvt_pk_bf16_f32 v75, v214, v215
    ds_write_b128 v103, v[72:75] offset:16640
    v_pk_mul_f32 v[216:217], v[216:217], v[18:19]
    v_pk_mul_f32 v[218:219], v[218:219], v[18:19]
    v_pk_mul_f32 v[220:221], v[220:221], v[18:19]
    v_pk_mul_f32 v[222:223], v[222:223], v[18:19]
    v_cvt_pk_bf16_f32 v76, v216, v217
    v_cvt_pk_bf16_f32 v77, v218, v219
    v_cvt_pk_bf16_f32 v78, v220, v221
    v_cvt_pk_bf16_f32 v79, v222, v223
    ds_write_b128 v103, v[76:79] offset:18688
    v_pk_mul_f32 v[224:225], v[224:225], v[18:19]
    v_pk_mul_f32 v[226:227], v[226:227], v[18:19]
    v_pk_mul_f32 v[228:229], v[228:229], v[18:19]
    v_pk_mul_f32 v[230:231], v[230:231], v[18:19]
    v_cvt_pk_bf16_f32 v64, v224, v225
    v_cvt_pk_bf16_f32 v65, v226, v227
    v_cvt_pk_bf16_f32 v66, v228, v229
    v_cvt_pk_bf16_f32 v67, v230, v231
    ds_write_b128 v103, v[64:67] offset:24576
    v_pk_mul_f32 v[232:233], v[232:233], v[18:19]
    v_pk_mul_f32 v[234:235], v[234:235], v[18:19]
    v_pk_mul_f32 v[236:237], v[236:237], v[18:19]
    v_pk_mul_f32 v[238:239], v[238:239], v[18:19]
    v_cvt_pk_bf16_f32 v68, v232, v233
    v_cvt_pk_bf16_f32 v69, v234, v235
    v_cvt_pk_bf16_f32 v70, v236, v237
    v_cvt_pk_bf16_f32 v71, v238, v239
    ds_write_b128 v103, v[68:71] offset:26624
    v_pk_mul_f32 v[240:241], v[240:241], v[18:19]
    v_pk_mul_f32 v[242:243], v[242:243], v[18:19]
    v_pk_mul_f32 v[244:245], v[244:245], v[18:19]
    v_pk_mul_f32 v[246:247], v[246:247], v[18:19]
    v_cvt_pk_bf16_f32 v72, v240, v241
    v_cvt_pk_bf16_f32 v73, v242, v243
    v_cvt_pk_bf16_f32 v74, v244, v245
    v_cvt_pk_bf16_f32 v75, v246, v247
    ds_write_b128 v103, v[72:75] offset:24832
    v_pk_mul_f32 v[248:249], v[248:249], v[18:19]
    v_pk_mul_f32 v[250:251], v[250:251], v[18:19]
    v_pk_mul_f32 v[252:253], v[252:253], v[18:19]
    v_pk_mul_f32 v[254:255], v[254:255], v[18:19]
    v_cvt_pk_bf16_f32 v76, v248, v249
    v_cvt_pk_bf16_f32 v77, v250, v251
    v_cvt_pk_bf16_f32 v78, v252, v253
    v_cvt_pk_bf16_f32 v79, v254, v255
    ds_write_b128 v103, v[76:79] offset:26880
    v_and_b32 v105, 31, v1
    v_lshrrev_b32 v106, 5, v1
    v_lshlrev_b32 v14, 2, v106
    v_sub_u32 v14, v105, v14
    v_lshrrev_b32 v20, 4, v105
    v_lshlrev_b32 v20, 17, v20
    v_lshlrev_b32 v21, 8, v106
    v_add_u32 v20, v20, v21
    v_and_b32 v21, 15, v105
    v_lshlrev_b32 v21, 4, v21
    v_add_u32 v20, v20, v21
    s_lshl_b32 s58, s46, 12
    s_add_u32 s58, s58, 0x3000000
    v_add_u32 v10, s58, v20
    v_mov_b32 v15, 0xf149f2ca
    v_mov_b32 v12, 0
    v_mov_b32 v13, 0
    v_add_u32 v8, 0x10000, v4
    v_add_u32 v9, 0x10000, v4
    s_lshl_b32 s58, s44, 13
    s_add_u32 s59, s58, 131072
    v_add_u32 v20, s59, v4
    s_lshr_b32 s59, s44, 1
    s_lshl_b32 s59, s59, 14
    s_add_u32 s58, s58, s59
    v_add_u32 v21, s58, v4
    s_waitcnt vmcnt(13)
    s_waitcnt lgkmcnt(0)
    s_barrier
    ds_read_b128 a[128:131], v20 offset:0
    ds_read_b128 v[192:195], v8 offset:0
    ds_read_b128 a[132:135], v20 offset:1024
    ds_read_b128 v[196:199], v8 offset:1024
    ds_read_b128 a[136:139], v20 offset:2048
    ds_read_b128 v[200:203], v8 offset:2048
    ds_read_b128 a[140:143], v20 offset:3072
    ds_read_b128 v[204:207], v8 offset:3072
    ds_read_b128 a[144:147], v20 offset:4096
    ds_read_b128 v[208:211], v8 offset:4096
    ds_read_b128 a[148:151], v20 offset:5120
    ds_read_b128 v[212:215], v8 offset:5120
    ds_read_b128 a[152:155], v20 offset:6144
    ds_read_b128 v[216:219], v8 offset:6144
    ds_read_b128 a[156:159], v20 offset:7168
    ds_read_b128 v[220:223], v8 offset:7168
    ds_read_b128 v[224:227], v8 offset:8192
    ds_read_b128 v[228:231], v8 offset:9216
    ds_read_b128 v[232:235], v8 offset:10240
    ds_read_b128 v[236:239], v8 offset:11264
    ds_read_b128 v[240:243], v8 offset:12288
    ds_read_b128 v[244:247], v8 offset:13312
    ds_read_b128 v[248:251], v8 offset:14336
    ds_read_b128 v[252:255], v8 offset:15360
    ds_read_b128 a[160:163], v21 offset:16384
    ds_read_b128 a[164:167], v21 offset:17408
    ds_read_b128 a[168:171], v21 offset:18432
    ds_read_b128 a[172:175], v21 offset:19456
    ds_read_b128 a[176:179], v21 offset:20480
    ds_read_b128 a[180:183], v21 offset:21504
    ds_read_b128 a[184:187], v21 offset:22528
    ds_read_b128 a[188:191], v21 offset:23552
    v_xor_b32 v20, 0x2000, v20
    v_cmp_le_i32 s[4:5], 0, v14
    v_cmp_le_i32 s[6:7], 1, v14
    v_cmp_le_i32 s[8:9], 2, v14
    v_cmp_le_i32 s[10:11], 3, v14
    v_cmp_le_i32 s[12:13], 16, v14
    v_cmp_le_i32 s[14:15], 17, v14
    v_cmp_le_i32 s[16:17], 18, v14
    v_cmp_le_i32 s[18:19], 19, v14
    v_cmp_le_i32 s[20:21], 8, v14
    v_cmp_le_i32 s[22:23], 9, v14
    v_cmp_le_i32 s[24:25], 10, v14
    v_cmp_le_i32 s[26:27], 11, v14
    v_cmp_le_i32 s[36:37], 24, v14
    v_cmp_le_i32 s[38:39], 25, v14
    v_cmp_le_i32 s[60:61], 26, v14
    v_cmp_le_i32 s[62:63], 27, v14
    s_waitcnt lgkmcnt(8)
    v_mfma_f32_32x32x16_bf16 v[128:143], v[192:195], a[128:131], 0
    v_mfma_f32_32x32x16_bf16 v[128:143], v[196:199], a[132:135], v[128:143]
    ds_read_b128 v[32:35], v20 offset:0
    v_mfma_f32_32x32x16_bf16 v[128:143], v[200:203], a[136:139], v[128:143]
    ds_read_b128 v[36:39], v20 offset:1024
    v_mfma_f32_32x32x16_bf16 v[128:143], v[204:207], a[140:143], v[128:143]
    ds_read_b128 v[40:43], v20 offset:2048
    v_mfma_f32_32x32x16_bf16 v[128:143], v[208:211], a[144:147], v[128:143]
    ds_read_b128 v[44:47], v20 offset:3072
    v_mfma_f32_32x32x16_bf16 v[128:143], v[212:215], a[148:151], v[128:143]
    ds_read_b128 v[48:51], v20 offset:4096
    v_mfma_f32_32x32x16_bf16 v[128:143], v[216:219], a[152:155], v[128:143]
    ds_read_b128 v[52:55], v20 offset:5120
    v_mfma_f32_32x32x16_bf16 v[128:143], v[220:223], a[156:159], v[128:143]
    ds_read_b128 v[56:59], v20 offset:6144
    v_mfma_f32_32x32x16_bf16 v[144:159], v[224:227], a[128:131], 0
    ds_read_b128 v[60:63], v20 offset:7168
    v_mfma_f32_32x32x16_bf16 v[144:159], v[228:231], a[132:135], v[144:159]
    v_mfma_f32_32x32x16_bf16 v[144:159], v[232:235], a[136:139], v[144:159]
    v_mfma_f32_32x32x16_bf16 v[144:159], v[236:239], a[140:143], v[144:159]
    v_mfma_f32_32x32x16_bf16 v[144:159], v[240:243], a[144:147], v[144:159]
    v_mfma_f32_32x32x16_bf16 v[144:159], v[244:247], a[148:151], v[144:159]
    v_mfma_f32_32x32x16_bf16 v[144:159], v[248:251], a[152:155], v[144:159]
    v_mfma_f32_32x32x16_bf16 v[144:159], v[252:255], a[156:159], v[144:159]
    s_waitcnt vmcnt(0) lgkmcnt(0)
    s_barrier
    v_cmp_ne_u32 vcc, 1, v3
    s_mov_b32 s53, s52
    s_cmp_eq_u32 s48, 2
    s_cselect_b32 s58, 2, 1
    s_lshl_b32 s58, s58, 15
    s_add_u32 s52, s52, s58
    s_mov_b32 s49, 0
    s_mov_b32 s3, 1
    s_cbranch_vccnz main_kernel_late
    s_mov_b32 s3, 0
    s_mov_b32 m0, s55
    s_nop 0
    buffer_load_dwordx4 v4, s[28:31], s53 offen sc1 lds
    buffer_load_dwordx4 v4, s[28:31], s53 offen offset:1024 sc1 lds
    buffer_load_dwordx4 v4, s[28:31], s53 offen offset:2048 sc1 lds
    buffer_load_dwordx4 v4, s[28:31], s53 offen offset:3072 sc1 lds
    s_cmp_lg_u32 s48, 2
    s_cbranch_scc1 main_kernel_nok2a
    s_add_u32 m0, s55, 0x4000
    s_nop 0
    buffer_load_dwordx4 v5, s[28:31], s53 offen sc1 lds
    buffer_load_dwordx4 v5, s[28:31], s53 offen offset:1024 sc1 lds
    buffer_load_dwordx4 v5, s[28:31], s53 offen offset:2048 sc1 lds
    buffer_load_dwordx4 v5, s[28:31], s53 offen offset:3072 sc1 lds
main_kernel_nok2a:
main_kernel_late:
    v_mfma_f32_32x32x16_bf16 v[160:175], v[192:195], a[160:163], 0
    v_xor_b32 v8, 0x10000, v8
    v_xor_b32 v9, 0x10000, v9
    v_mfma_f32_32x32x16_bf16 v[160:175], v[196:199], a[164:167], v[160:175]
    v_mfma_f32_32x32x16_bf16 v[160:175], v[200:203], a[168:171], v[160:175]
    ds_read_b128 v[192:195], v8 offset:0
    v_max3_f32 v18, v128, v129, v130
    v_max3_f32 v19, v131, v132, v133
    v_max3_f32 v18, v18, v134, v135
    v_max3_f32 v19, v19, v136, v137
    v_max3_f32 v18, v18, v138, v139
    v_mfma_f32_32x32x16_bf16 v[160:175], v[204:207], a[172:175], v[160:175]
    ds_read_b128 v[196:199], v8 offset:1024
    v_max3_f32 v19, v19, v140, v141
    v_max3_f32 v18, v18, v142, v143
    v_max3_f32 v19, v19, v144, v145
    v_max3_f32 v18, v18, v146, v147
    v_max3_f32 v19, v19, v148, v149
    v_mfma_f32_32x32x16_bf16 v[160:175], v[208:211], a[176:179], v[160:175]
    ds_read_b128 v[200:203], v8 offset:2048
    v_max3_f32 v18, v18, v150, v151
    v_max3_f32 v19, v19, v152, v153
    v_max3_f32 v18, v18, v154, v155
    v_max3_f32 v19, v19, v156, v157
    v_max3_f32 v18, v18, v158, v159
    v_mfma_f32_32x32x16_bf16 v[160:175], v[212:215], a[180:183], v[160:175]
    ds_read_b128 v[204:207], v8 offset:3072
    v_max_f32 v18, v18, v19
    v_mfma_f32_32x32x16_bf16 v[160:175], v[216:219], a[184:187], v[160:175]
    ds_read_b128 v[208:211], v8 offset:4096
    v_mov_b32 v19, v18
    s_nop 1
    v_permlane32_swap_b32 v19, v18
    s_nop 1
    v_max_f32 v18, v18, v19
    v_mfma_f32_32x32x16_bf16 v[160:175], v[220:223], a[188:191], v[160:175]
    ds_read_b128 v[212:215], v8 offset:5120
    v_sub_f32 v64, 0, v18
    v_sub_f32 v65, 0, v18
    v_add_f32 v128, v128, v64
    v_add_f32 v129, v129, v64
    v_add_f32 v130, v130, v64
    v_mfma_f32_32x32x16_bf16 v[176:191], v[224:227], a[160:163], 0
    ds_read_b128 v[216:219], v8 offset:6144
    v_add_f32 v131, v131, v64
    v_add_f32 v132, v132, v64
    v_add_f32 v133, v133, v64
    v_add_f32 v134, v134, v64
    v_add_f32 v135, v135, v64
    v_mfma_f32_32x32x16_bf16 v[176:191], v[228:231], a[164:167], v[176:191]
    ds_read_b128 v[220:223], v8 offset:7168
    v_add_f32 v136, v136, v64
    v_add_f32 v137, v137, v64
    v_add_f32 v138, v138, v64
    v_add_f32 v139, v139, v64
    v_add_f32 v140, v140, v64
    v_mfma_f32_32x32x16_bf16 v[176:191], v[232:235], a[168:171], v[176:191]
    ds_read_b128 v[224:227], v8 offset:8192
    v_add_f32 v141, v141, v64
    v_add_f32 v142, v142, v64
    v_add_f32 v143, v143, v64
    v_add_f32 v144, v144, v64
    v_add_f32 v145, v145, v64
    v_mfma_f32_32x32x16_bf16 v[176:191], v[236:239], a[172:175], v[176:191]
    ds_read_b128 v[228:231], v8 offset:9216
    v_add_f32 v146, v146, v64
    v_add_f32 v147, v147, v64
    v_add_f32 v148, v148, v64
    v_add_f32 v149, v149, v64
    v_add_f32 v150, v150, v64
    v_mfma_f32_32x32x16_bf16 v[176:191], v[240:243], a[176:179], v[176:191]
    ds_read_b128 v[232:235], v8 offset:10240
    v_add_f32 v151, v151, v64
    v_add_f32 v152, v152, v64
    v_add_f32 v153, v153, v64
    v_add_f32 v154, v154, v64
    v_add_f32 v155, v155, v64
    v_mfma_f32_32x32x16_bf16 v[176:191], v[244:247], a[180:183], v[176:191]
    ds_read_b128 v[236:239], v8 offset:11264
    v_add_f32 v156, v156, v64
    v_add_f32 v157, v157, v64
    v_add_f32 v158, v158, v64
    v_add_f32 v159, v159, v64
    v_mov_b32 v66, v64
    v_mfma_f32_32x32x16_bf16 v[176:191], v[248:251], a[184:187], v[176:191]
    ds_read_b128 v[240:243], v8 offset:12288
    v_mov_b32 v67, v64
    v_mov_b32 v68, v64
    v_mov_b32 v69, v64
    v_mov_b32 v70, v64
    v_mov_b32 v71, v64
    v_mfma_f32_32x32x16_bf16 v[176:191], v[252:255], a[188:191], v[176:191]
    ds_read_b128 v[244:247], v8 offset:13312
    v_mov_b32 v72, v64
    v_mov_b32 v73, v64
    v_mov_b32 v74, v64
    v_mov_b32 v75, v64
    v_mov_b32 v76, v64
    v_mov_b32 v77, v64
    v_mov_b32 v78, v64
    v_mov_b32 v79, v64
    ds_read_b128 v[248:251], v8 offset:14336
    ds_read_b128 v[252:255], v8 offset:15360
    s_lshl_b32 s58, s44, 8
    s_add_u32 s58, s58, 16384
    v_lshlrev_b32 v20, 2, v1
    v_add_u32 v20, s58, v20
    ds_write_b32 v20, v64
    v_xor_b32 v11, 0x100, v20
    v_exp_f32 v24, v128
    v_exp_f32 v25, v129
    v_exp_f32 v26, v130
    v_cvt_pk_bf16_f32 v96, v24, v25
    v_exp_f32 v27, v131
    v_exp_f32 v28, v132
    v_add_f32 v17, v25, v27
    v_exp_f32 v29, v133
    v_cvt_pk_bf16_f32 v97, v26, v27
    v_add_f32 v16, v24, v26
    v_exp_f32 v30, v134
    v_add_f32 v17, v17, v29
    v_exp_f32 v31, v135
    v_cvt_pk_bf16_f32 v98, v28, v29
    v_add_f32 v16, v16, v28
    v_exp_f32 v24, v136
    v_add_f32 v17, v17, v31
    v_exp_f32 v25, v137
    v_cvt_pk_bf16_f32 v99, v30, v31
    v_add_f32 v16, v16, v30
    v_exp_f32 v26, v138
    v_add_f32 v17, v17, v25
    v_exp_f32 v27, v139
    v_cvt_pk_bf16_f32 v100, v24, v25
    v_add_f32 v16, v16, v24
    v_exp_f32 v28, v140
    v_add_f32 v17, v17, v27
    v_exp_f32 v29, v141
    v_cvt_pk_bf16_f32 v101, v26, v27
    v_add_f32 v16, v16, v26
    v_exp_f32 v30, v142
    v_add_f32 v17, v17, v29
    v_exp_f32 v31, v143
    v_cvt_pk_bf16_f32 v102, v28, v29
    v_add_f32 v16, v16, v28
    v_exp_f32 v24, v144
    v_add_f32 v17, v17, v31
    v_exp_f32 v25, v145
    v_cvt_pk_bf16_f32 v103, v30, v31
    v_add_f32 v16, v16, v30
    v_exp_f32 v26, v146
    v_add_f32 v17, v17, v25
    v_exp_f32 v27, v147
    v_cvt_pk_bf16_f32 v104, v24, v25
    v_add_f32 v16, v16, v24
    v_exp_f32 v28, v148
    v_add_f32 v17, v17, v27
    v_exp_f32 v29, v149
    v_cvt_pk_bf16_f32 v105, v26, v27
    v_add_f32 v16, v16, v26
    v_exp_f32 v30, v150
    v_add_f32 v17, v17, v29
    v_exp_f32 v31, v151
    v_cvt_pk_bf16_f32 v106, v28, v29
    v_add_f32 v16, v16, v28
    v_exp_f32 v24, v152
    v_add_f32 v17, v17, v31
    v_exp_f32 v25, v153
    v_cvt_pk_bf16_f32 v107, v30, v31
    v_add_f32 v16, v16, v30
    v_exp_f32 v26, v154
    v_add_f32 v17, v17, v25
    v_exp_f32 v27, v155
    v_cvt_pk_bf16_f32 v108, v24, v25
    v_add_f32 v16, v16, v24
    v_exp_f32 v28, v156
    v_add_f32 v17, v17, v27
    v_exp_f32 v29, v157
    v_cvt_pk_bf16_f32 v109, v26, v27
    v_add_f32 v16, v16, v26
    v_exp_f32 v30, v158
    v_add_f32 v17, v17, v29
    v_exp_f32 v31, v159
    v_cvt_pk_bf16_f32 v110, v28, v29
    v_add_f32 v16, v16, v28
    v_cvt_pk_bf16_f32 v111, v30, v31
    v_add_f32 v16, v16, v30
    v_add_f32 v17, v17, v31
    v_add_f32 v16, v16, v17
    v_cmp_nge_f32 vcc, 0x47800000, v16
    s_cbranch_vccnz main_kernel_rdXp
main_kernel_rdXpr:
    v_add_f32 v12, v12, v16
    s_cmp_eq_u32 s3, 1
    s_cbranch_scc1 main_kernel_spin
main_kernel_spinr:
    s_waitcnt lgkmcnt(0)
    s_barrier
    ds_read_b32 v11, v11
    ds_read_b128 a[192:195], v9 offset:32768
    ds_read_b128 a[196:199], v9 offset:36864
    ds_read_b128 a[200:203], v9 offset:40960
    ds_read_b128 a[204:207], v9 offset:45056
    ds_read_b128 a[208:211], v9 offset:33792
    ds_read_b128 a[212:215], v9 offset:37888
    s_lshl_b32 s58, s64, 1
    s_sub_u32 s58, s58, s57
    s_cmp_lt_i32 s58, -1
    s_cbranch_scc1 main_kernel_m0r
    s_cmp_eq_i32 s58, -1
    s_cbranch_scc1 main_kernel_m0a
    v_mov_b32 v176, v15
    v_mov_b32 v177, v15
    v_pk_mov_b32 v[178:179], v[176:177], v[176:177]
    v_pk_mov_b32 v[180:181], v[176:177], v[176:177]
    v_pk_mov_b32 v[182:183], v[176:177], v[176:177]
    v_pk_mov_b32 v[184:185], v[176:177], v[176:177]
    v_pk_mov_b32 v[186:187], v[176:177], v[176:177]
    v_pk_mov_b32 v[188:189], v[176:177], v[176:177]
    v_pk_mov_b32 v[190:191], v[176:177], v[176:177]
    s_cmp_eq_i32 s58, 0
    s_cbranch_scc1 main_kernel_m0b
    v_pk_mov_b32 v[160:161], v[176:177], v[176:177]
    v_pk_mov_b32 v[162:163], v[176:177], v[176:177]
    v_pk_mov_b32 v[164:165], v[176:177], v[176:177]
    v_pk_mov_b32 v[166:167], v[176:177], v[176:177]
    v_pk_mov_b32 v[168:169], v[176:177], v[176:177]
    v_pk_mov_b32 v[170:171], v[176:177], v[176:177]
    v_pk_mov_b32 v[172:173], v[176:177], v[176:177]
    v_pk_mov_b32 v[174:175], v[176:177], v[176:177]
    s_branch main_kernel_m0r
main_kernel_m0a:
    v_cndmask_b32 v176, v15, v176, s[4:5]
    v_cndmask_b32 v177, v15, v177, s[6:7]
    v_cndmask_b32 v178, v15, v178, s[8:9]
    v_cndmask_b32 v179, v15, v179, s[10:11]
    v_cndmask_b32 v180, v15, v180, s[12:13]
    v_cndmask_b32 v181, v15, v181, s[14:15]
    v_cndmask_b32 v182, v15, v182, s[16:17]
    v_cndmask_b32 v183, v15, v183, s[18:19]
    v_cndmask_b32 v184, v15, v184, s[20:21]
    v_cndmask_b32 v185, v15, v185, s[22:23]
    v_cndmask_b32 v186, v15, v186, s[24:25]
    v_cndmask_b32 v187, v15, v187, s[26:27]
    v_cndmask_b32 v188, v15, v188, s[36:37]
    v_cndmask_b32 v189, v15, v189, s[38:39]
    v_cndmask_b32 v190, v15, v190, s[60:61]
    v_cndmask_b32 v191, v15, v191, s[62:63]
    s_branch main_kernel_m0r
main_kernel_m0b:
    v_cndmask_b32 v160, v15, v160, s[4:5]
    v_cndmask_b32 v161, v15, v161, s[6:7]
    v_cndmask_b32 v162, v15, v162, s[8:9]
    v_cndmask_b32 v163, v15, v163, s[10:11]
    v_cndmask_b32 v164, v15, v164, s[12:13]
    v_cndmask_b32 v165, v15, v165, s[14:15]
    v_cndmask_b32 v166, v15, v166, s[16:17]
    v_cndmask_b32 v167, v15, v167, s[18:19]
    v_cndmask_b32 v168, v15, v168, s[20:21]
    v_cndmask_b32 v169, v15, v169, s[22:23]
    v_cndmask_b32 v170, v15, v170, s[24:25]
    v_cndmask_b32 v171, v15, v171, s[26:27]
    v_cndmask_b32 v172, v15, v172, s[36:37]
    v_cndmask_b32 v173, v15, v173, s[38:39]
    v_cndmask_b32 v174, v15, v174, s[60:61]
    v_cndmask_b32 v175, v15, v175, s[62:63]
main_kernel_m0r:
    v_max3_f32 v18, v160, v161, v162
    v_max3_f32 v19, v163, v164, v165
    v_max3_f32 v18, v18, v166, v167
    v_max3_f32 v19, v19, v168, v169
    v_max3_f32 v18, v18, v170, v171
    v_max3_f32 v19, v19, v172, v173
    v_max3_f32 v18, v18, v174, v175
    v_max3_f32 v19, v19, v176, v177
    v_max3_f32 v18, v18, v178, v179
    v_max3_f32 v19, v19, v180, v181
    v_max3_f32 v18, v18, v182, v183
    v_max3_f32 v19, v19, v184, v185
    v_max3_f32 v18, v18, v186, v187
    v_max3_f32 v19, v19, v188, v189
    v_max3_f32 v18, v18, v190, v191
    v_max_f32 v18, v18, v19
    v_mov_b32 v19, v18
    s_nop 1
    v_permlane32_swap_b32 v19, v18
    s_nop 1
    v_max_f32 v18, v18, v19
    v_sub_f32 v80, 0, v18
    v_sub_f32 v81, 0, v18
    v_pk_add_f32 v[160:161], v[160:161], v[80:81]
    v_pk_add_f32 v[162:163], v[162:163], v[80:81]
    v_pk_add_f32 v[164:165], v[164:165], v[80:81]
    v_pk_add_f32 v[166:167], v[166:167], v[80:81]
    v_pk_add_f32 v[168:169], v[168:169], v[80:81]
    v_pk_add_f32 v[170:171], v[170:171], v[80:81]
    v_pk_add_f32 v[172:173], v[172:173], v[80:81]
    v_pk_add_f32 v[174:175], v[174:175], v[80:81]
    v_pk_add_f32 v[176:177], v[176:177], v[80:81]
    v_pk_add_f32 v[178:179], v[178:179], v[80:81]
    v_pk_add_f32 v[180:181], v[180:181], v[80:81]
    v_pk_add_f32 v[182:183], v[182:183], v[80:81]
    v_pk_add_f32 v[184:185], v[184:185], v[80:81]
    v_pk_add_f32 v[186:187], v[186:187], v[80:81]
    v_pk_add_f32 v[188:189], v[188:189], v[80:81]
    v_pk_add_f32 v[190:191], v[190:191], v[80:81]
    v_pk_mov_b32 v[82:83], v[80:81], v[80:81]
    v_pk_mov_b32 v[84:85], v[80:81], v[80:81]
    v_pk_mov_b32 v[86:87], v[80:81], v[80:81]
    v_pk_mov_b32 v[88:89], v[80:81], v[80:81]
    v_pk_mov_b32 v[90:91], v[80:81], v[80:81]
    v_pk_mov_b32 v[92:93], v[80:81], v[80:81]
    v_pk_mov_b32 v[94:95], v[80:81], v[80:81]
    s_cmp_lt_i32 s71, 1
    s_cbranch_scc1 main_kernel_loop16
main_kernel_loop8:
    s_waitcnt lgkmcnt(6)
    v_mfma_f32_32x32x16_bf16 v[128:143], v[192:195], a[128:131], v[64:79]
    ds_read_b128 a[216:219], v9 offset:41984
    v_exp_f32 v24, v160
    v_exp_f32 v25, v161
    v_mfma_f32_32x32x16_bf16 v[128:143], v[196:199], a[132:135], v[128:143]
    ds_read_b128 a[220:223], v9 offset:46080
    v_exp_f32 v26, v162
    v_cvt_pk_bf16_f32 v112, v24, v25
    v_mfma_f32_32x32x16_bf16 v[128:143], v[200:203], a[136:139], v[128:143]
    ds_read_b128 a[224:227], v9 offset:34816
    v_exp_f32 v27, v163
    v_exp_f32 v28, v164
    v_mfma_f32_32x32x16_bf16 v[128:143], v[204:207], a[140:143], v[128:143]
    ds_read_b128 a[228:231], v9 offset:38912
    v_add_f32 v17, v25, v27
    v_exp_f32 v29, v165
    v_mfma_f32_32x32x16_bf16 v[128:143], v[208:211], a[144:147], v[128:143]
    v_cvt_pk_bf16_f32 v113, v26, v27
    v_add_f32 v16, v24, v26
    v_exp_f32 v30, v166
    v_mfma_f32_32x32x16_bf16 v[128:143], v[212:215], a[148:151], v[128:143]
    ds_read_b128 a[232:235], v9 offset:43008
    v_add_f32 v17, v17, v29
    v_exp_f32 v31, v167
    v_cvt_pk_bf16_f32 v114, v28, v29
    v_mfma_f32_32x32x16_bf16 v[128:143], v[216:219], a[152:155], v[128:143]
    ds_read_b128 a[236:239], v9 offset:47104
    v_add_f32 v16, v16, v28
    v_exp_f32 v24, v168
    v_mfma_f32_32x32x16_bf16 v[128:143], v[220:223], a[156:159], v[128:143]
    ds_read_b128 a[240:243], v9 offset:35840
    v_add_f32 v17, v17, v31
    v_exp_f32 v25, v169
    v_cvt_pk_bf16_f32 v115, v30, v31
    v_mfma_f32_32x32x16_bf16 v[144:159], v[224:227], a[128:131], v[64:79]
    ds_read_b128 a[244:247], v9 offset:39936
    v_add_f32 v16, v16, v30
    v_exp_f32 v26, v170
    v_mfma_f32_32x32x16_bf16 v[144:159], v[228:231], a[132:135], v[144:159]
    v_add_f32 v17, v17, v25
    v_exp_f32 v27, v171
    v_cvt_pk_bf16_f32 v116, v24, v25
    v_mfma_f32_32x32x16_bf16 v[144:159], v[232:235], a[136:139], v[144:159]
    ds_read_b128 a[248:251], v9 offset:44032
    v_add_f32 v16, v16, v24
    v_exp_f32 v28, v172
    v_add_f32 v17, v17, v27
    v_mfma_f32_32x32x16_bf16 v[144:159], v[236:239], a[140:143], v[144:159]
    ds_read_b128 a[252:255], v9 offset:48128
    v_exp_f32 v29, v173
    v_cvt_pk_bf16_f32 v117, v26, v27
    v_mfma_f32_32x32x16_bf16 v[144:159], v[240:243], a[144:147], v[144:159]
    v_add_f32 v16, v16, v26
    v_exp_f32 v30, v174
    v_add_f32 v17, v17, v29
    v_mfma_f32_32x32x16_bf16 v[144:159], v[244:247], a[148:151], v[144:159]
    s_mov_b32 s54, s53
    s_mov_b32 s53, s52
    v_exp_f32 v31, v175
    v_cvt_pk_bf16_f32 v118, v28, v29
    v_mfma_f32_32x32x16_bf16 v[144:159], v[248:251], a[152:155], v[144:159]
    s_add_u32 s52, s52, 32768
    s_xor_b32 s55, s55, 0x10000
    v_add_f32 v16, v16, v28
    v_exp_f32 v24, v176
    v_mfma_f32_32x32x16_bf16 v[144:159], v[252:255], a[156:159], v[144:159]
    s_waitcnt vmcnt(0) lgkmcnt(0)
    s_barrier
    v_add_f32 v17, v17, v31
    v_exp_f32 v25, v177
    v_mfma_f32_32x32x16_bf16 a[0:15], a[192:195], v[96:99], a[0:15]
    s_add_u32 m0, s55, 0x8000
    v_cvt_pk_bf16_f32 v119, v30, v31
    v_add_f32 v16, v16, v30
    v_mfma_f32_32x32x16_bf16 a[0:15], a[196:199], v[100:103], a[0:15]
    buffer_load_dwordx4 v6, s[32:35], s54 offen sc1 lds
    v_exp_f32 v26, v178
    v_add_f32 v17, v17, v25
    v_mfma_f32_32x32x16_bf16 a[0:15], a[200:203], v[104:107], a[0:15]
    buffer_load_dwordx4 v6, s[32:35], s54 offen offset:1024 sc1 lds
    v_exp_f32 v27, v179
    v_cvt_pk_bf16_f32 v120, v24, v25
    v_add_f32 v16, v16, v24
    v_mfma_f32_32x32x16_bf16 a[0:15], a[204:207], v[108:111], a[0:15]
    v_exp_f32 v28, v180
    v_add_f32 v17, v17, v27
    v_exp_f32 v29, v181
    v_mfma_f32_32x32x16_bf16 a[16:31], a[208:211], v[96:99], a[16:31]
    buffer_load_dwordx4 v6, s[32:35], s54 offen offset:2048 sc1 lds
    v_cvt_pk_bf16_f32 v121, v26, v27
    v_add_f32 v16, v16, v26
    v_exp_f32 v30, v182
    v_mfma_f32_32x32x16_bf16 a[16:31], a[212:215], v[100:103], a[16:31]
    buffer_load_dwordx4 v6, s[32:35], s54 offen offset:3072 sc1 lds
    v_add_f32 v17, v17, v29
    v_exp_f32 v31, v183
    v_mfma_f32_32x32x16_bf16 a[16:31], a[216:219], v[104:107], a[16:31]
    v_cvt_pk_bf16_f32 v122, v28, v29
    v_add_f32 v16, v16, v28
    v_exp_f32 v24, v184
    v_mfma_f32_32x32x16_bf16 a[16:31], a[220:223], v[108:111], a[16:31]
    s_mov_b32 m0, s55
    v_add_f32 v17, v17, v31
    v_exp_f32 v25, v185
    v_cvt_pk_bf16_f32 v123, v30, v31
    v_mfma_f32_32x32x16_bf16 a[32:47], a[224:227], v[96:99], a[32:47]
    buffer_load_dwordx4 v4, s[28:31], s53 offen sc1 lds
    v_add_f32 v16, v16, v30
    v_exp_f32 v26, v186
    v_mfma_f32_32x32x16_bf16 a[32:47], a[228:231], v[100:103], a[32:47]
    buffer_load_dwordx4 v4, s[28:31], s53 offen offset:1024 sc1 lds
    v_add_f32 v17, v17, v25
    v_exp_f32 v27, v187
    v_mfma_f32_32x32x16_bf16 a[32:47], a[232:235], v[104:107], a[32:47]
    v_cvt_pk_bf16_f32 v124, v24, v25
    v_add_f32 v16, v16, v24
    v_exp_f32 v28, v188
    v_add_f32 v17, v17, v27
    v_mfma_f32_32x32x16_bf16 a[32:47], a[236:239], v[108:111], a[32:47]
    buffer_load_dwordx4 v4, s[28:31], s53 offen offset:2048 sc1 lds
    v_exp_f32 v29, v189
    v_cvt_pk_bf16_f32 v125, v26, v27
    v_mfma_f32_32x32x16_bf16 a[48:63], a[240:243], v[96:99], a[48:63]
    buffer_load_dwordx4 v4, s[28:31], s53 offen offset:3072 sc1 lds
    v_add_f32 v16, v16, v26
    v_exp_f32 v30, v190
    v_add_f32 v17, v17, v29
    v_mfma_f32_32x32x16_bf16 a[48:63], a[244:247], v[100:103], a[48:63]
    v_exp_f32 v31, v191
    v_cvt_pk_bf16_f32 v126, v28, v29
    v_add_f32 v16, v16, v28
    v_mfma_f32_32x32x16_bf16 a[48:63], a[248:251], v[104:107], a[48:63]
    v_xor_b32 v8, 0x10000, v8
    v_cvt_pk_bf16_f32 v127, v30, v31
    v_add_f32 v16, v16, v30
    v_add_f32 v17, v17, v31
    v_add_f32 v16, v16, v17
    v_mfma_f32_32x32x16_bf16 a[48:63], a[252:255], v[108:111], a[48:63]
    v_xor_b32 v9, 0x10000, v9
    v_cmp_nge_f32 vcc, 0x47800000, v16
    s_cbranch_vccnz main_kernel_rdYa
main_kernel_rdYar:
    v_add_f32 v13, v13, v16
    s_bitcmp1_b32 s70, s49
    s_cbranch_scc1 main_kernel_hB
main_kernel_hBr8:
    v_mfma_f32_32x32x16_bf16 v[160:175], v[192:195], a[160:163], v[80:95]
    v_exp_f32 v24, v128
    v_exp_f32 v25, v129
    v_mfma_f32_32x32x16_bf16 v[160:175], v[196:199], a[164:167], v[160:175]
    v_exp_f32 v26, v130
    v_cvt_pk_bf16_f32 v96, v24, v25
    v_exp_f32 v27, v131
    v_mfma_f32_32x32x16_bf16 v[160:175], v[200:203], a[168:171], v[160:175]
    ds_read_b128 v[192:195], v8 offset:0
    v_exp_f32 v28, v132
    v_add_f32 v17, v25, v27
    v_mfma_f32_32x32x16_bf16 v[160:175], v[204:207], a[172:175], v[160:175]
    ds_read_b128 v[196:199], v8 offset:1024
    v_exp_f32 v29, v133
    v_cvt_pk_bf16_f32 v97, v26, v27
    v_mfma_f32_32x32x16_bf16 v[160:175], v[208:211], a[176:179], v[160:175]
    ds_read_b128 v[200:203], v8 offset:2048
    v_add_f32 v16, v24, v26
    v_exp_f32 v30, v134
    v_mfma_f32_32x32x16_bf16 v[160:175], v[212:215], a[180:183], v[160:175]
    v_add_f32 v17, v17, v29
    v_exp_f32 v31, v135
    v_cvt_pk_bf16_f32 v98, v28, v29
    v_add_f32 v16, v16, v28
    v_mfma_f32_32x32x16_bf16 v[160:175], v[216:219], a[184:187], v[160:175]
    ds_read_b128 v[204:207], v8 offset:3072
    v_exp_f32 v24, v136
    v_add_f32 v17, v17, v31
    v_mfma_f32_32x32x16_bf16 v[160:175], v[220:223], a[188:191], v[160:175]
    ds_read_b128 v[208:211], v8 offset:4096
    v_exp_f32 v25, v137
    v_cvt_pk_bf16_f32 v99, v30, v31
    v_mfma_f32_32x32x16_bf16 v[176:191], v[224:227], a[160:163], v[80:95]
    ds_read_b128 v[212:215], v8 offset:5120
    v_add_f32 v16, v16, v30
    v_exp_f32 v26, v138
    v_mfma_f32_32x32x16_bf16 v[176:191], v[228:231], a[164:167], v[176:191]
    v_add_f32 v17, v17, v25
    v_exp_f32 v27, v139
    v_cvt_pk_bf16_f32 v100, v24, v25
    v_add_f32 v16, v16, v24
    v_mfma_f32_32x32x16_bf16 v[176:191], v[232:235], a[168:171], v[176:191]
    ds_read_b128 v[216:219], v8 offset:6144
    v_exp_f32 v28, v140
    v_add_f32 v17, v17, v27
    v_mfma_f32_32x32x16_bf16 v[176:191], v[236:239], a[172:175], v[176:191]
    ds_read_b128 v[220:223], v8 offset:7168
    v_exp_f32 v29, v141
    v_cvt_pk_bf16_f32 v101, v26, v27
    v_mfma_f32_32x32x16_bf16 v[176:191], v[240:243], a[176:179], v[176:191]
    ds_read_b128 v[224:227], v8 offset:8192
    v_add_f32 v16, v16, v26
    v_exp_f32 v30, v142
    v_mfma_f32_32x32x16_bf16 v[176:191], v[244:247], a[180:183], v[176:191]
    v_add_f32 v17, v17, v29
    v_exp_f32 v31, v143
    v_cvt_pk_bf16_f32 v102, v28, v29
    v_add_f32 v16, v16, v28
    v_mfma_f32_32x32x16_bf16 v[176:191], v[248:251], a[184:187], v[176:191]
    ds_read_b128 v[228:231], v8 offset:9216
    v_exp_f32 v24, v144
    v_add_f32 v17, v17, v31
    v_mfma_f32_32x32x16_bf16 v[176:191], v[252:255], a[188:191], v[176:191]
    ds_read_b128 v[232:235], v8 offset:10240
    v_exp_f32 v25, v145
    v_cvt_pk_bf16_f32 v103, v30, v31
    v_mfma_f32_32x32x16_bf16 a[64:79], a[192:195], v[112:115], a[64:79]
    ds_read_b128 v[236:239], v8 offset:11264
    v_add_f32 v16, v16, v30
    v_exp_f32 v26, v146
    v_mfma_f32_32x32x16_bf16 a[64:79], a[196:199], v[116:119], a[64:79]
    v_add_f32 v17, v17, v25
    v_exp_f32 v27, v147
    v_cvt_pk_bf16_f32 v104, v24, v25
    v_add_f32 v16, v16, v24
    v_mfma_f32_32x32x16_bf16 a[64:79], a[200:203], v[120:123], a[64:79]
    ds_read_b128 v[240:243], v8 offset:12288
    v_exp_f32 v28, v148
    v_add_f32 v17, v17, v27
    v_mfma_f32_32x32x16_bf16 a[64:79], a[204:207], v[124:127], a[64:79]
    ds_read_b128 v[244:247], v8 offset:13312
    v_exp_f32 v29, v149
    v_cvt_pk_bf16_f32 v105, v26, v27
    v_mfma_f32_32x32x16_bf16 a[80:95], a[208:211], v[112:115], a[80:95]
    ds_read_b128 v[248:251], v8 offset:14336
    v_add_f32 v16, v16, v26
    v_exp_f32 v30, v150
    v_mfma_f32_32x32x16_bf16 a[80:95], a[212:215], v[116:119], a[80:95]
    v_add_f32 v17, v17, v29
    v_exp_f32 v31, v151
    v_cvt_pk_bf16_f32 v106, v28, v29
    v_add_f32 v16, v16, v28
    v_mfma_f32_32x32x16_bf16 a[80:95], a[216:219], v[120:123], a[80:95]
    ds_read_b128 v[252:255], v8 offset:15360
    v_exp_f32 v24, v152
    v_add_f32 v17, v17, v31
    v_mfma_f32_32x32x16_bf16 a[80:95], a[220:223], v[124:127], a[80:95]
    v_exp_f32 v25, v153
    v_cvt_pk_bf16_f32 v107, v30, v31
    v_add_f32 v16, v16, v30
    v_mfma_f32_32x32x16_bf16 a[96:111], a[224:227], v[112:115], a[96:111]
    ds_read_b128 a[192:195], v9 offset:32768
    v_exp_f32 v26, v154
    v_add_f32 v17, v17, v25
    v_mfma_f32_32x32x16_bf16 a[96:111], a[228:231], v[116:119], a[96:111]
    ds_read_b128 a[196:199], v9 offset:36864
    v_exp_f32 v27, v155
    v_cvt_pk_bf16_f32 v108, v24, v25
    v_add_f32 v16, v16, v24
    v_mfma_f32_32x32x16_bf16 a[96:111], a[232:235], v[120:123], a[96:111]
    ds_read_b128 a[200:203], v9 offset:40960
    v_exp_f32 v28, v156
    v_add_f32 v17, v17, v27
    v_mfma_f32_32x32x16_bf16 a[96:111], a[236:239], v[124:127], a[96:111]
    ds_read_b128 a[204:207], v9 offset:45056
    v_exp_f32 v29, v157
    v_cvt_pk_bf16_f32 v109, v26, v27
    v_mfma_f32_32x32x16_bf16 a[112:127], a[240:243], v[112:115], a[112:127]
    v_add_f32 v16, v16, v26
    v_exp_f32 v30, v158
    v_add_f32 v17, v17, v29
    v_mfma_f32_32x32x16_bf16 a[112:127], a[244:247], v[116:119], a[112:127]
    ds_read_b128 a[208:211], v9 offset:33792
    v_exp_f32 v31, v159
    v_cvt_pk_bf16_f32 v110, v28, v29
    v_add_f32 v16, v16, v28
    v_mfma_f32_32x32x16_bf16 a[112:127], a[248:251], v[120:123], a[112:127]
    ds_read_b128 a[212:215], v9 offset:37888
    v_cvt_pk_bf16_f32 v111, v30, v31
    v_add_f32 v16, v16, v30
    v_add_f32 v17, v17, v31
    v_mfma_f32_32x32x16_bf16 a[112:127], a[252:255], v[124:127], a[112:127]
    v_add_f32 v16, v16, v17
    v_cmp_nge_f32 vcc, 0x47800000, v16
    s_cbranch_vccnz main_kernel_rdXa
main_kernel_rdXar:
    v_add_f32 v12, v12, v16
    s_add_u32 s49, s49, 1
    s_bitcmp1_b32 s69, s49
    s_cbranch_scc0 main_kernel_loop8
    s_branch main_kernel_hC
main_kernel_loop16:
    s_waitcnt lgkmcnt(6)
    v_mfma_f32_32x32x16_bf16 v[128:143], v[192:195], a[128:131], v[64:79]
    ds_read_b128 a[216:219], v9 offset:41984
    v_exp_f32 v24, v160
    v_exp_f32 v25, v161
    v_mfma_f32_32x32x16_bf16 v[128:143], v[196:199], a[132:135], v[128:143]
    ds_read_b128 a[220:223], v9 offset:46080
    v_exp_f32 v26, v162
    v_cvt_pk_bf16_f32 v112, v24, v25
    v_mfma_f32_32x32x16_bf16 v[128:143], v[200:203], a[136:139], v[128:143]
    ds_read_b128 a[224:227], v9 offset:34816
    v_exp_f32 v27, v163
    v_exp_f32 v28, v164
    v_mfma_f32_32x32x16_bf16 v[128:143], v[204:207], a[140:143], v[128:143]
    ds_read_b128 a[228:231], v9 offset:38912
    v_add_f32 v17, v25, v27
    v_exp_f32 v29, v165
    v_mfma_f32_32x32x16_bf16 v[128:143], v[208:211], a[144:147], v[128:143]
    v_cvt_pk_bf16_f32 v113, v26, v27
    v_add_f32 v16, v24, v26
    v_exp_f32 v30, v166
    v_add_f32 v17, v17, v29
    v_mfma_f32_32x32x16_bf16 v[128:143], v[212:215], a[148:151], v[128:143]
    ds_read_b128 a[232:235], v9 offset:43008
    v_exp_f32 v31, v167
    v_cvt_pk_bf16_f32 v114, v28, v29
    v_mfma_f32_32x32x16_bf16 v[128:143], v[216:219], a[152:155], v[128:143]
    ds_read_b128 a[236:239], v9 offset:47104
    v_add_f32 v16, v16, v28
    v_exp_f32 v24, v168
    v_add_f32 v17, v17, v31
    v_mfma_f32_32x32x16_bf16 v[128:143], v[220:223], a[156:159], v[128:143]
    ds_read_b128 a[240:243], v9 offset:35840
    v_exp_f32 v25, v169
    v_cvt_pk_bf16_f32 v115, v30, v31
    v_mfma_f32_32x32x16_bf16 v[144:159], v[224:227], a[128:131], v[64:79]
    ds_read_b128 a[244:247], v9 offset:39936
    v_add_f32 v16, v16, v30
    v_exp_f32 v26, v170
    v_add_f32 v17, v17, v25
    v_mfma_f32_32x32x16_bf16 v[144:159], v[228:231], a[132:135], v[144:159]
    v_exp_f32 v27, v171
    v_cvt_pk_bf16_f32 v116, v24, v25
    v_add_f32 v16, v16, v24
    v_mfma_f32_32x32x16_bf16 v[144:159], v[232:235], a[136:139], v[144:159]
    ds_read_b128 a[248:251], v9 offset:44032
    v_exp_f32 v28, v172
    v_add_f32 v17, v17, v27
    v_mfma_f32_32x32x16_bf16 v[144:159], v[236:239], a[140:143], v[144:159]
    ds_read_b128 a[252:255], v9 offset:48128
    v_exp_f32 v29, v173
    v_cvt_pk_bf16_f32 v117, v26, v27
    v_add_f32 v16, v16, v26
    v_mfma_f32_32x32x16_bf16 v[144:159], v[240:243], a[144:147], v[144:159]
    v_exp_f32 v30, v174
    v_add_f32 v17, v17, v29
    v_exp_f32 v31, v175
    v_mfma_f32_32x32x16_bf16 v[144:159], v[244:247], a[148:151], v[144:159]
    s_mov_b32 s54, s53
    s_mov_b32 s53, s52
    v_cvt_pk_bf16_f32 v118, v28, v29
    v_add_f32 v16, v16, v28
    v_mfma_f32_32x32x16_bf16 v[144:159], v[248:251], a[152:155], v[144:159]
    s_add_u32 s52, s52, 65536
    s_xor_b32 s55, s55, 0x10000
    v_exp_f32 v24, v176
    v_add_f32 v17, v17, v31
    v_mfma_f32_32x32x16_bf16 v[144:159], v[252:255], a[156:159], v[144:159]
    s_waitcnt vmcnt(0) lgkmcnt(0)
    s_barrier
    v_exp_f32 v25, v177
    v_mfma_f32_32x32x16_bf16 a[0:15], a[192:195], v[96:99], a[0:15]
    s_add_u32 m0, s55, 0x8000
    v_cvt_pk_bf16_f32 v119, v30, v31
    v_add_f32 v16, v16, v30
    v_exp_f32 v26, v178
    v_mfma_f32_32x32x16_bf16 a[0:15], a[196:199], v[100:103], a[0:15]
    buffer_load_dwordx4 v6, s[32:35], s54 offen sc1 lds
    v_add_f32 v17, v17, v25
    v_exp_f32 v27, v179
    v_mfma_f32_32x32x16_bf16 a[0:15], a[200:203], v[104:107], a[0:15]
    buffer_load_dwordx4 v6, s[32:35], s54 offen offset:1024 sc1 lds
    v_cvt_pk_bf16_f32 v120, v24, v25
    v_add_f32 v16, v16, v24
    v_exp_f32 v28, v180
    v_mfma_f32_32x32x16_bf16 a[0:15], a[204:207], v[108:111], a[0:15]
    buffer_load_dwordx4 v6, s[32:35], s54 offen offset:2048 sc1 lds
    v_add_f32 v17, v17, v27
    v_exp_f32 v29, v181
    v_mfma_f32_32x32x16_bf16 a[16:31], a[208:211], v[96:99], a[16:31]
    v_cvt_pk_bf16_f32 v121, v26, v27
    v_add_f32 v16, v16, v26
    v_exp_f32 v30, v182
    v_add_f32 v17, v17, v29
    v_mfma_f32_32x32x16_bf16 a[16:31], a[212:215], v[100:103], a[16:31]
    buffer_load_dwordx4 v6, s[32:35], s54 offen offset:3072 sc1 lds
    v_exp_f32 v31, v183
    v_cvt_pk_bf16_f32 v122, v28, v29
    v_mfma_f32_32x32x16_bf16 a[16:31], a[216:219], v[104:107], a[16:31]
    s_add_u32 m0, s55, 0xc000
    v_add_f32 v16, v16, v28
    v_exp_f32 v24, v184
    v_add_f32 v17, v17, v31
    v_mfma_f32_32x32x16_bf16 a[16:31], a[220:223], v[108:111], a[16:31]
    buffer_load_dwordx4 v7, s[32:35], s54 offen sc1 lds
    v_exp_f32 v25, v185
    v_cvt_pk_bf16_f32 v123, v30, v31
    v_mfma_f32_32x32x16_bf16 a[32:47], a[224:227], v[96:99], a[32:47]
    v_add_f32 v16, v16, v30
    v_exp_f32 v26, v186
    v_add_f32 v17, v17, v25
    v_mfma_f32_32x32x16_bf16 a[32:47], a[228:231], v[100:103], a[32:47]
    buffer_load_dwordx4 v7, s[32:35], s54 offen offset:1024 sc1 lds
    v_exp_f32 v27, v187
    v_cvt_pk_bf16_f32 v124, v24, v25
    v_add_f32 v16, v16, v24
    v_mfma_f32_32x32x16_bf16 a[32:47], a[232:235], v[104:107], a[32:47]
    buffer_load_dwordx4 v7, s[32:35], s54 offen offset:2048 sc1 lds
    v_exp_f32 v28, v188
    v_add_f32 v17, v17, v27
    v_mfma_f32_32x32x16_bf16 a[32:47], a[236:239], v[108:111], a[32:47]
    buffer_load_dwordx4 v7, s[32:35], s54 offen offset:3072 sc1 lds
    v_exp_f32 v29, v189
    v_cvt_pk_bf16_f32 v125, v26, v27
    v_add_f32 v16, v16, v26
    v_mfma_f32_32x32x16_bf16 a[48:63], a[240:243], v[96:99], a[48:63]
    v_exp_f32 v30, v190
    v_add_f32 v17, v17, v29
    v_exp_f32 v31, v191
    v_mfma_f32_32x32x16_bf16 a[48:63], a[244:247], v[100:103], a[48:63]
    s_cmp_eq_u32 s49, s64
    s_cselect_b32 s66, s77, 0x10000
    v_cvt_pk_bf16_f32 v126, v28, v29
    v_add_f32 v16, v16, v28
    v_mfma_f32_32x32x16_bf16 a[48:63], a[248:251], v[104:107], a[48:63]
    v_xor_b32 v8, s66, v8
    v_cvt_pk_bf16_f32 v127, v30, v31
    v_add_f32 v16, v16, v30
    v_add_f32 v17, v17, v31
    v_add_f32 v16, v16, v17
    v_mfma_f32_32x32x16_bf16 a[48:63], a[252:255], v[108:111], a[48:63]
    v_xor_b32 v9, 0x10000, v9
    v_cmp_nge_f32 vcc, 0x47800000, v16
    s_cbranch_vccnz main_kernel_rdYb
main_kernel_rdYbr:
    v_add_f32 v13, v13, v16
    s_bitcmp1_b32 s70, s49
    s_cbranch_scc1 main_kernel_hB
main_kernel_hBr:
    v_mfma_f32_32x32x16_bf16 v[160:175], v[192:195], a[160:163], v[80:95]
    s_mov_b32 m0, s55
    v_exp_f32 v24, v128
    v_exp_f32 v25, v129
    v_mfma_f32_32x32x16_bf16 v[160:175], v[196:199], a[164:167], v[160:175]
    buffer_load_dwordx4 v4, s[28:31], s53 offen sc1 lds
    v_exp_f32 v26, v130
    v_cvt_pk_bf16_f32 v96, v24, v25
    v_mfma_f32_32x32x16_bf16 v[160:175], v[200:203], a[168:171], v[160:175]
    ds_read_b128 v[192:195], v8 offset:0
    v_exp_f32 v27, v131
    v_exp_f32 v28, v132
    v_mfma_f32_32x32x16_bf16 v[160:175], v[204:207], a[172:175], v[160:175]
    buffer_load_dwordx4 v4, s[28:31], s53 offen offset:1024 sc1 lds
    ds_read_b128 v[196:199], v8 offset:1024
    v_add_f32 v17, v25, v27
    v_exp_f32 v29, v133
    v_mfma_f32_32x32x16_bf16 v[160:175], v[208:211], a[176:179], v[160:175]
    buffer_load_dwordx4 v4, s[28:31], s53 offen offset:2048 sc1 lds
    ds_read_b128 v[200:203], v8 offset:2048
    v_cvt_pk_bf16_f32 v97, v26, v27
    v_add_f32 v16, v24, v26
    v_mfma_f32_32x32x16_bf16 v[160:175], v[212:215], a[180:183], v[160:175]
    v_exp_f32 v30, v134
    v_add_f32 v17, v17, v29
    v_exp_f32 v31, v135
    v_mfma_f32_32x32x16_bf16 v[160:175], v[216:219], a[184:187], v[160:175]
    buffer_load_dwordx4 v4, s[28:31], s53 offen offset:3072 sc1 lds
    ds_read_b128 v[204:207], v8 offset:3072
    v_cvt_pk_bf16_f32 v98, v28, v29
    v_add_f32 v16, v16, v28
    v_mfma_f32_32x32x16_bf16 v[160:175], v[220:223], a[188:191], v[160:175]
    s_add_u32 m0, s55, 0x4000
    ds_read_b128 v[208:211], v8 offset:4096
    v_exp_f32 v24, v136
    v_add_f32 v17, v17, v31
    v_mfma_f32_32x32x16_bf16 v[176:191], v[224:227], a[160:163], v[80:95]
    ds_read_b128 v[212:215], v8 offset:5120
    v_exp_f32 v25, v137
    v_cvt_pk_bf16_f32 v99, v30, v31
    v_mfma_f32_32x32x16_bf16 v[176:191], v[228:231], a[164:167], v[176:191]
    buffer_load_dwordx4 v5, s[28:31], s53 offen sc1 lds
    v_add_f32 v16, v16, v30
    v_exp_f32 v26, v138
    v_add_f32 v17, v17, v25
    v_mfma_f32_32x32x16_bf16 v[176:191], v[232:235], a[168:171], v[176:191]
    buffer_load_dwordx4 v5, s[28:31], s53 offen offset:1024 sc1 lds
    ds_read_b128 v[216:219], v8 offset:6144
    v_exp_f32 v27, v139
    v_mfma_f32_32x32x16_bf16 v[176:191], v[236:239], a[172:175], v[176:191]
    ds_read_b128 v[220:223], v8 offset:7168
    v_cvt_pk_bf16_f32 v100, v24, v25
    v_add_f32 v16, v16, v24
    v_exp_f32 v28, v140
    v_mfma_f32_32x32x16_bf16 v[176:191], v[240:243], a[176:179], v[176:191]
    buffer_load_dwordx4 v5, s[28:31], s53 offen offset:2048 sc1 lds
    ds_read_b128 v[224:227], v8 offset:8192
    v_add_f32 v17, v17, v27
    v_exp_f32 v29, v141
    v_mfma_f32_32x32x16_bf16 v[176:191], v[244:247], a[180:183], v[176:191]
    buffer_load_dwordx4 v5, s[28:31], s53 offen offset:3072 sc1 lds
    v_cvt_pk_bf16_f32 v101, v26, v27
    v_add_f32 v16, v16, v26
    v_mfma_f32_32x32x16_bf16 v[176:191], v[248:251], a[184:187], v[176:191]
    ds_read_b128 v[228:231], v8 offset:9216
    v_exp_f32 v30, v142
    v_add_f32 v17, v17, v29
    v_exp_f32 v31, v143
    v_mfma_f32_32x32x16_bf16 v[176:191], v[252:255], a[188:191], v[176:191]
    ds_read_b128 v[232:235], v8 offset:10240
    v_cvt_pk_bf16_f32 v102, v28, v29
    v_add_f32 v16, v16, v28
    v_exp_f32 v24, v144
    v_mfma_f32_32x32x16_bf16 a[64:79], a[192:195], v[112:115], a[64:79]
    ds_read_b128 v[236:239], v8 offset:11264
    v_add_f32 v17, v17, v31
    v_exp_f32 v25, v145
    v_mfma_f32_32x32x16_bf16 a[64:79], a[196:199], v[116:119], a[64:79]
    v_cvt_pk_bf16_f32 v103, v30, v31
    v_add_f32 v16, v16, v30
    v_exp_f32 v26, v146
    v_mfma_f32_32x32x16_bf16 a[64:79], a[200:203], v[120:123], a[64:79]
    ds_read_b128 v[240:243], v8 offset:12288
    v_add_f32 v17, v17, v25
    v_exp_f32 v27, v147
    v_cvt_pk_bf16_f32 v104, v24, v25
    v_mfma_f32_32x32x16_bf16 a[64:79], a[204:207], v[124:127], a[64:79]
    ds_read_b128 v[244:247], v8 offset:13312
    v_add_f32 v16, v16, v24
    v_exp_f32 v28, v148
    v_mfma_f32_32x32x16_bf16 a[80:95], a[208:211], v[112:115], a[80:95]
    ds_read_b128 v[248:251], v8 offset:14336
    v_add_f32 v17, v17, v27
    v_exp_f32 v29, v149
    v_cvt_pk_bf16_f32 v105, v26, v27
    v_mfma_f32_32x32x16_bf16 a[80:95], a[212:215], v[116:119], a[80:95]
    v_add_f32 v16, v16, v26
    v_exp_f32 v30, v150
    v_add_f32 v17, v17, v29
    v_mfma_f32_32x32x16_bf16 a[80:95], a[216:219], v[120:123], a[80:95]
    ds_read_b128 v[252:255], v8 offset:15360
    v_exp_f32 v31, v151
    v_cvt_pk_bf16_f32 v106, v28, v29
    v_add_f32 v16, v16, v28
    v_mfma_f32_32x32x16_bf16 a[80:95], a[220:223], v[124:127], a[80:95]
    v_exp_f32 v24, v152
    v_add_f32 v17, v17, v31
    v_exp_f32 v25, v153
    v_mfma_f32_32x32x16_bf16 a[96:111], a[224:227], v[112:115], a[96:111]
    ds_read_b128 a[192:195], v9 offset:32768
    v_cvt_pk_bf16_f32 v107, v30, v31
    v_add_f32 v16, v16, v30
    v_exp_f32 v26, v154
    v_mfma_f32_32x32x16_bf16 a[96:111], a[228:231], v[116:119], a[96:111]
    ds_read_b128 a[196:199], v9 offset:36864
    v_add_f32 v17, v17, v25
    v_exp_f32 v27, v155
    v_mfma_f32_32x32x16_bf16 a[96:111], a[232:235], v[120:123], a[96:111]
    ds_read_b128 a[200:203], v9 offset:40960
    v_cvt_pk_bf16_f32 v108, v24, v25
    v_add_f32 v16, v16, v24
    v_exp_f32 v28, v156
    v_mfma_f32_32x32x16_bf16 a[96:111], a[236:239], v[124:127], a[96:111]
    ds_read_b128 a[204:207], v9 offset:45056
    v_add_f32 v17, v17, v27
    v_exp_f32 v29, v157
    v_mfma_f32_32x32x16_bf16 a[112:127], a[240:243], v[112:115], a[112:127]
    v_cvt_pk_bf16_f32 v109, v26, v27
    v_add_f32 v16, v16, v26
    v_exp_f32 v30, v158
    v_mfma_f32_32x32x16_bf16 a[112:127], a[244:247], v[116:119], a[112:127]
    ds_read_b128 a[208:211], v9 offset:33792
    v_add_f32 v17, v17, v29
    v_exp_f32 v31, v159
    v_cvt_pk_bf16_f32 v110, v28, v29
    v_mfma_f32_32x32x16_bf16 a[112:127], a[248:251], v[120:123], a[112:127]
    ds_read_b128 a[212:215], v9 offset:37888
    v_add_f32 v16, v16, v28
    v_cvt_pk_bf16_f32 v111, v30, v31
    v_add_f32 v16, v16, v30
    v_mfma_f32_32x32x16_bf16 a[112:127], a[252:255], v[124:127], a[112:127]
    v_add_f32 v17, v17, v31
    v_add_f32 v16, v16, v17
    v_cmp_nge_f32 vcc, 0x47800000, v16
    s_cbranch_vccnz main_kernel_rdXb
main_kernel_rdXbr:
    v_add_f32 v12, v12, v16
    s_add_u32 s49, s49, 1
    s_bitcmp1_b32 s69, s49
    s_cbranch_scc0 main_kernel_loop16
main_kernel_hC:
    s_cmp_eq_u32 s49, s48
    s_cbranch_scc1 main_kernel_sw2
main_kernel_hCa:
    s_and_b32 s58, s49, 15
    s_cmp_le_u32 s58, 1
    s_cbranch_scc1 main_kernel_mY
main_kernel_hCb:
    s_cmp_lt_i32 s49, s71
    s_cbranch_scc1 main_kernel_loop8
    s_add_u32 s58, s51, 0x10000
    s_cmp_eq_u32 s49, s71
    s_cselect_b32 s52, s58, s52
    s_branch main_kernel_loop16
main_kernel_mY:
    s_sub_u32 s58, 32, s48
    s_add_u32 s58, s58, s67
    s_sub_u32 s59, s48, 1
    s_cmp_eq_u32 s49, 1
    s_cselect_b32 s58, s59, s58
    s_lshl_b32 s58, s58, 1
    s_sub_u32 s58, s58, s57
    s_cmp_lt_i32 s58, -1
    s_cbranch_scc1 main_kernel_m1r
    s_cmp_eq_i32 s58, -1
    s_cbranch_scc1 main_kernel_m1a
    v_mov_b32 v176, v15
    v_mov_b32 v177, v15
    v_pk_mov_b32 v[178:179], v[176:177], v[176:177]
    v_pk_mov_b32 v[180:181], v[176:177], v[176:177]
    v_pk_mov_b32 v[182:183], v[176:177], v[176:177]
    v_pk_mov_b32 v[184:185], v[176:177], v[176:177]
    v_pk_mov_b32 v[186:187], v[176:177], v[176:177]
    v_pk_mov_b32 v[188:189], v[176:177], v[176:177]
    v_pk_mov_b32 v[190:191], v[176:177], v[176:177]
    s_cmp_eq_i32 s58, 0
    s_cbranch_scc1 main_kernel_m1b
    v_pk_mov_b32 v[160:161], v[176:177], v[176:177]
    v_pk_mov_b32 v[162:163], v[176:177], v[176:177]
    v_pk_mov_b32 v[164:165], v[176:177], v[176:177]
    v_pk_mov_b32 v[166:167], v[176:177], v[176:177]
    v_pk_mov_b32 v[168:169], v[176:177], v[176:177]
    v_pk_mov_b32 v[170:171], v[176:177], v[176:177]
    v_pk_mov_b32 v[172:173], v[176:177], v[176:177]
    v_pk_mov_b32 v[174:175], v[176:177], v[176:177]
    s_branch main_kernel_m1r
main_kernel_m1a:
    v_cndmask_b32 v176, v15, v176, s[4:5]
    v_cndmask_b32 v177, v15, v177, s[6:7]
    v_cndmask_b32 v178, v15, v178, s[8:9]
    v_cndmask_b32 v179, v15, v179, s[10:11]
    v_cndmask_b32 v180, v15, v180, s[12:13]
    v_cndmask_b32 v181, v15, v181, s[14:15]
    v_cndmask_b32 v182, v15, v182, s[16:17]
    v_cndmask_b32 v183, v15, v183, s[18:19]
    v_cndmask_b32 v184, v15, v184, s[20:21]
    v_cndmask_b32 v185, v15, v185, s[22:23]
    v_cndmask_b32 v186, v15, v186, s[24:25]
    v_cndmask_b32 v187, v15, v187, s[26:27]
    v_cndmask_b32 v188, v15, v188, s[36:37]
    v_cndmask_b32 v189, v15, v189, s[38:39]
    v_cndmask_b32 v190, v15, v190, s[60:61]
    v_cndmask_b32 v191, v15, v191, s[62:63]
    s_branch main_kernel_m1r
main_kernel_m1b:
    v_cndmask_b32 v160, v15, v160, s[4:5]
    v_cndmask_b32 v161, v15, v161, s[6:7]
    v_cndmask_b32 v162, v15, v162, s[8:9]
    v_cndmask_b32 v163, v15, v163, s[10:11]
    v_cndmask_b32 v164, v15, v164, s[12:13]
    v_cndmask_b32 v165, v15, v165, s[14:15]
    v_cndmask_b32 v166, v15, v166, s[16:17]
    v_cndmask_b32 v167, v15, v167, s[18:19]
    v_cndmask_b32 v168, v15, v168, s[20:21]
    v_cndmask_b32 v169, v15, v169, s[22:23]
    v_cndmask_b32 v170, v15, v170, s[24:25]
    v_cndmask_b32 v171, v15, v171, s[26:27]
    v_cndmask_b32 v172, v15, v172, s[36:37]
    v_cndmask_b32 v173, v15, v173, s[38:39]
    v_cndmask_b32 v174, v15, v174, s[60:61]
    v_cndmask_b32 v175, v15, v175, s[62:63]
main_kernel_m1r:
    s_cmp_eq_u32 s49, 1
    s_cbranch_scc1 main_kernel_hCb
    ds_read_b128 a[216:219], v9 offset:41984
    ds_read_b128 a[220:223], v9 offset:46080
    ds_read_b128 a[224:227], v9 offset:34816
    ds_read_b128 a[228:231], v9 offset:38912
    ds_read_b128 a[232:235], v9 offset:43008
    ds_read_b128 a[236:239], v9 offset:47104
    ds_read_b128 a[240:243], v9 offset:35840
    ds_read_b128 a[244:247], v9 offset:39936
    ds_read_b128 a[248:251], v9 offset:44032
    ds_read_b128 a[252:255], v9 offset:48128
    v_exp_f32 v24, v160
    v_exp_f32 v25, v161
    v_exp_f32 v26, v162
    v_cvt_pk_bf16_f32 v112, v24, v25
    v_exp_f32 v27, v163
    v_exp_f32 v28, v164
    v_add_f32 v17, v25, v27
    v_exp_f32 v29, v165
    v_cvt_pk_bf16_f32 v113, v26, v27
    v_add_f32 v16, v24, v26
    v_exp_f32 v30, v166
    v_add_f32 v17, v17, v29
    v_mov_b32 v3, 162816
    s_waitcnt vmcnt(0) lgkmcnt(0)
    s_barrier
    ds_read_b32 v3, v3
    v_mfma_f32_32x32x16_bf16 a[0:15], a[192:195], v[96:99], a[0:15]
    v_exp_f32 v31, v167
    v_cvt_pk_bf16_f32 v114, v28, v29
    v_add_f32 v16, v16, v28
    v_exp_f32 v24, v168
    v_mfma_f32_32x32x16_bf16 a[0:15], a[196:199], v[100:103], a[0:15]
    v_add_f32 v17, v17, v31
    v_exp_f32 v25, v169
    v_cvt_pk_bf16_f32 v115, v30, v31
    v_add_f32 v16, v16, v30
    v_mfma_f32_32x32x16_bf16 a[0:15], a[200:203], v[104:107], a[0:15]
    v_exp_f32 v26, v170
    v_add_f32 v17, v17, v25
    v_exp_f32 v27, v171
    v_cvt_pk_bf16_f32 v116, v24, v25
    v_mfma_f32_32x32x16_bf16 a[0:15], a[204:207], v[108:111], a[0:15]
    v_add_f32 v16, v16, v24
    v_exp_f32 v28, v172
    v_add_f32 v17, v17, v27
    v_exp_f32 v29, v173
    v_mfma_f32_32x32x16_bf16 a[16:31], a[208:211], v[96:99], a[16:31]
    v_cvt_pk_bf16_f32 v117, v26, v27
    v_add_f32 v16, v16, v26
    v_exp_f32 v30, v174
    v_add_f32 v17, v17, v29
    v_mfma_f32_32x32x16_bf16 a[16:31], a[212:215], v[100:103], a[16:31]
    v_exp_f32 v31, v175
    v_cvt_pk_bf16_f32 v118, v28, v29
    v_add_f32 v16, v16, v28
    v_exp_f32 v24, v176
    v_mfma_f32_32x32x16_bf16 a[16:31], a[216:219], v[104:107], a[16:31]
    v_add_f32 v17, v17, v31
    v_exp_f32 v25, v177
    v_cvt_pk_bf16_f32 v119, v30, v31
    v_add_f32 v16, v16, v30
    v_mfma_f32_32x32x16_bf16 a[16:31], a[220:223], v[108:111], a[16:31]
    v_exp_f32 v26, v178
    v_add_f32 v17, v17, v25
    v_exp_f32 v27, v179
    v_cvt_pk_bf16_f32 v120, v24, v25
    v_mfma_f32_32x32x16_bf16 a[32:47], a[224:227], v[96:99], a[32:47]
    v_add_f32 v16, v16, v24
    v_exp_f32 v28, v180
    v_add_f32 v17, v17, v27
    v_exp_f32 v29, v181
    v_mfma_f32_32x32x16_bf16 a[32:47], a[228:231], v[100:103], a[32:47]
    v_cvt_pk_bf16_f32 v121, v26, v27
    v_add_f32 v16, v16, v26
    v_exp_f32 v30, v182
    v_add_f32 v17, v17, v29
    v_mfma_f32_32x32x16_bf16 a[32:47], a[232:235], v[104:107], a[32:47]
    v_exp_f32 v31, v183
    v_cvt_pk_bf16_f32 v122, v28, v29
    v_add_f32 v16, v16, v28
    v_exp_f32 v24, v184
    v_mfma_f32_32x32x16_bf16 a[32:47], a[236:239], v[108:111], a[32:47]
    v_add_f32 v17, v17, v31
    v_exp_f32 v25, v185
    v_cvt_pk_bf16_f32 v123, v30, v31
    v_add_f32 v16, v16, v30
    v_mfma_f32_32x32x16_bf16 a[48:63], a[240:243], v[96:99], a[48:63]
    v_exp_f32 v26, v186
    v_add_f32 v17, v17, v25
    v_exp_f32 v27, v187
    v_cvt_pk_bf16_f32 v124, v24, v25
    v_mfma_f32_32x32x16_bf16 a[48:63], a[244:247], v[100:103], a[48:63]
    v_add_f32 v16, v16, v24
    v_exp_f32 v28, v188
    v_add_f32 v17, v17, v27
    v_exp_f32 v29, v189
    v_mfma_f32_32x32x16_bf16 a[48:63], a[248:251], v[104:107], a[48:63]
    v_cvt_pk_bf16_f32 v125, v26, v27
    v_add_f32 v16, v16, v26
    v_exp_f32 v30, v190
    v_add_f32 v17, v17, v29
    v_mfma_f32_32x32x16_bf16 a[48:63], a[252:255], v[108:111], a[48:63]
    v_exp_f32 v31, v191
    v_cvt_pk_bf16_f32 v126, v28, v29
    v_add_f32 v16, v16, v28
    v_cvt_pk_bf16_f32 v127, v30, v31
    v_add_f32 v16, v16, v30
    v_add_f32 v17, v17, v31
    v_add_f32 v16, v16, v17
    v_cmp_nge_f32 vcc, 0x47800000, v16
    s_cbranch_vccnz main_kernel_rdYe
main_kernel_rdYer:
    v_add_f32 v13, v13, v16
    s_waitcnt lgkmcnt(0)
    v_readfirstlane_b32 s51, v3
    s_and_b32 s52, s51, 0xffff
    s_lshr_b32 s58, s51, 16
    s_cmp_lt_u32 s58, 256
    s_cbranch_scc1 main_kernel_uspin
main_kernel_uok:
    s_cmp_lt_u32 s52, 160
    s_cbranch_scc1 main_kernel_cvld
main_kernel_cvldr:
    s_mul_i32 s58, s44, 17408
    s_add_u32 s58, s58, 90112
    v_add_u32 v20, s58, v4
    v_mov_b32 v81, v13
    ds_write_b64 v20, v[80:81] offset:16384
    v_mfma_f32_32x32x16_bf16 a[64:79], a[192:195], v[112:115], a[64:79]
    v_mfma_f32_32x32x16_bf16 a[64:79], a[196:199], v[116:119], a[64:79]
    v_accvgpr_read_b32 v192, a0
    v_accvgpr_read_b32 v193, a1
    v_accvgpr_read_b32 v194, a2
    v_accvgpr_read_b32 v195, a3
    v_accvgpr_read_b32 v196, a4
    v_mfma_f32_32x32x16_bf16 a[64:79], a[200:203], v[120:123], a[64:79]
    v_accvgpr_read_b32 v197, a5
    v_accvgpr_read_b32 v198, a6
    v_accvgpr_read_b32 v199, a7
    v_accvgpr_read_b32 v200, a8
    v_accvgpr_read_b32 v201, a9
    v_mfma_f32_32x32x16_bf16 a[64:79], a[204:207], v[124:127], a[64:79]
    v_accvgpr_read_b32 v202, a10
    v_accvgpr_read_b32 v203, a11
    v_accvgpr_read_b32 v204, a12
    v_accvgpr_read_b32 v205, a13
    v_accvgpr_read_b32 v206, a14
    v_mfma_f32_32x32x16_bf16 a[80:95], a[208:211], v[112:115], a[80:95]
    v_accvgpr_read_b32 v207, a15
    v_accvgpr_read_b32 v208, a16
    v_accvgpr_read_b32 v209, a17
    v_accvgpr_read_b32 v210, a18
    v_accvgpr_read_b32 v211, a19
    v_mfma_f32_32x32x16_bf16 a[80:95], a[212:215], v[116:119], a[80:95]
    v_accvgpr_read_b32 v212, a20
    v_accvgpr_read_b32 v213, a21
    v_accvgpr_read_b32 v214, a22
    v_accvgpr_read_b32 v215, a23
    v_accvgpr_read_b32 v216, a24
    v_mfma_f32_32x32x16_bf16 a[80:95], a[216:219], v[120:123], a[80:95]
    v_accvgpr_read_b32 v217, a25
    v_accvgpr_read_b32 v218, a26
    v_accvgpr_read_b32 v219, a27
    v_accvgpr_read_b32 v220, a28
    v_accvgpr_read_b32 v221, a29
    v_mfma_f32_32x32x16_bf16 a[80:95], a[220:223], v[124:127], a[80:95]
    v_accvgpr_read_b32 v222, a30
    v_accvgpr_read_b32 v223, a31
    v_accvgpr_read_b32 v224, a32
    v_accvgpr_read_b32 v225, a33
    v_accvgpr_read_b32 v226, a34
    ds_write_b128 v20, a[64:67] offset:0
    v_mfma_f32_32x32x16_bf16 a[96:111], a[224:227], v[112:115], a[96:111]
    v_accvgpr_read_b32 v227, a35
    v_accvgpr_read_b32 v228, a36
    v_accvgpr_read_b32 v229, a37
    v_accvgpr_read_b32 v230, a38
    v_accvgpr_read_b32 v231, a39
    ds_write_b128 v20, a[68:71] offset:1024
    v_mfma_f32_32x32x16_bf16 a[96:111], a[228:231], v[116:119], a[96:111]
    v_accvgpr_read_b32 v232, a40
    v_accvgpr_read_b32 v233, a41
    v_accvgpr_read_b32 v234, a42
    v_accvgpr_read_b32 v235, a43
    v_accvgpr_read_b32 v236, a44
    ds_write_b128 v20, a[72:75] offset:2048
    v_mfma_f32_32x32x16_bf16 a[96:111], a[232:235], v[120:123], a[96:111]
    v_accvgpr_read_b32 v237, a45
    v_accvgpr_read_b32 v238, a46
    v_accvgpr_read_b32 v239, a47
    ds_write_b128 v20, a[76:79] offset:3072
    v_mfma_f32_32x32x16_bf16 a[96:111], a[236:239], v[124:127], a[96:111]
    v_accvgpr_read_b32 v240, a48
    v_accvgpr_read_b32 v241, a49
    v_accvgpr_read_b32 v242, a50
    v_accvgpr_read_b32 v243, a51
    ds_write_b128 v20, a[80:83] offset:4096
    v_mfma_f32_32x32x16_bf16 a[112:127], a[240:243], v[112:115], a[112:127]
    v_accvgpr_read_b32 v244, a52
    v_accvgpr_read_b32 v245, a53
    v_accvgpr_read_b32 v246, a54
    v_accvgpr_read_b32 v247, a55
    ds_write_b128 v20, a[84:87] offset:5120
    v_mfma_f32_32x32x16_bf16 a[112:127], a[244:247], v[116:119], a[112:127]
    v_accvgpr_read_b32 v248, a56
    v_accvgpr_read_b32 v249, a57
    v_accvgpr_read_b32 v250, a58
    v_accvgpr_read_b32 v251, a59
    ds_write_b128 v20, a[88:91] offset:6144
    v_mfma_f32_32x32x16_bf16 a[112:127], a[248:251], v[120:123], a[112:127]
    v_accvgpr_read_b32 v252, a60
    v_accvgpr_read_b32 v253, a61
    v_accvgpr_read_b32 v254, a62
    v_accvgpr_read_b32 v255, a63
    ds_write_b128 v20, a[92:95] offset:7168
    v_mfma_f32_32x32x16_bf16 a[112:127], a[252:255], v[124:127], a[112:127]
    ds_write_b128 v20, a[96:99] offset:8192
    ds_write_b128 v20, a[100:103] offset:9216
    ds_write_b128 v20, a[104:107] offset:10240
    ds_write_b128 v20, a[108:111] offset:11264
    s_xor_b32 s3, s44, 1
    s_mul_i32 s58, s3, 17408
    s_add_u32 s58, s58, 90112
    v_add_u32 v21, s58, v4
    s_lshl_b32 s76, s56, 18
    s_nop 5
    ds_write_b128 v20, a[112:115] offset:12288
    ds_write_b128 v20, a[116:119] offset:13312
    ds_write_b128 v20, a[120:123] offset:14336
    ds_write_b128 v20, a[124:127] offset:15360
    s_waitcnt lgkmcnt(0)
    s_barrier
    ds_read_b64 v[80:81], v21 offset:16384
    ds_read_b128 v[128:131], v21 offset:0
    ds_read_b128 v[132:135], v21 offset:1024
    ds_read_b128 v[136:139], v21 offset:2048
    ds_read_b128 v[140:143], v21 offset:3072
    ds_read_b128 v[144:147], v21 offset:4096
    ds_read_b128 v[148:151], v21 offset:5120
    ds_read_b128 v[152:155], v21 offset:6144
    ds_read_b128 v[156:159], v21 offset:7168
    ds_read_b128 v[160:163], v21 offset:8192
    ds_read_b128 v[164:167], v21 offset:9216
    ds_read_b128 v[168:171], v21 offset:10240
    ds_read_b128 v[172:175], v21 offset:11264
    ds_read_b128 v[176:179], v21 offset:12288
    ds_read_b128 v[180:183], v21 offset:13312
    ds_read_b128 v[184:187], v21 offset:14336
    ds_read_b128 v[188:191], v21 offset:15360
    s_waitcnt lgkmcnt(15)
    v_min_f32 v24, v64, v80
    v_sub_f32 v26, v24, v64
    v_sub_f32 v28, v24, v80
    v_exp_f32 v26, v26
    v_exp_f32 v28, v28
    s_nop 0
    v_mul_f32 v12, v12, v26
    v_fma_f32 v12, v81, v28, v12
    v_mov_b32 v25, v12
    s_nop 1
    v_permlane32_swap_b32 v25, v12
    s_nop 1
    v_add_f32 v25, v25, v12
    v_rcp_f32 v25, v25
    s_nop 0
    v_mul_f32 v26, v26, v25
    v_mul_f32 v28, v28, v25
    v_mov_b32 v27, v26
    v_mov_b32 v29, v28
    v_pk_mul_f32 v[192:193], v[192:193], v[26:27]
    v_pk_mul_f32 v[194:195], v[194:195], v[26:27]
    v_pk_mul_f32 v[196:197], v[196:197], v[26:27]
    v_pk_mul_f32 v[198:199], v[198:199], v[26:27]
    v_pk_mul_f32 v[200:201], v[200:201], v[26:27]
    v_pk_mul_f32 v[202:203], v[202:203], v[26:27]
    v_pk_mul_f32 v[204:205], v[204:205], v[26:27]
    v_pk_mul_f32 v[206:207], v[206:207], v[26:27]
    v_pk_mul_f32 v[208:209], v[208:209], v[26:27]
    v_pk_mul_f32 v[210:211], v[210:211], v[26:27]
    v_pk_mul_f32 v[212:213], v[212:213], v[26:27]
    v_pk_mul_f32 v[214:215], v[214:215], v[26:27]
    v_pk_mul_f32 v[216:217], v[216:217], v[26:27]
    v_pk_mul_f32 v[218:219], v[218:219], v[26:27]
    v_pk_mul_f32 v[220:221], v[220:221], v[26:27]
    v_pk_mul_f32 v[222:223], v[222:223], v[26:27]
    v_pk_mul_f32 v[224:225], v[224:225], v[26:27]
    v_pk_mul_f32 v[226:227], v[226:227], v[26:27]
    v_pk_mul_f32 v[228:229], v[228:229], v[26:27]
    v_pk_mul_f32 v[230:231], v[230:231], v[26:27]
    v_pk_mul_f32 v[232:233], v[232:233], v[26:27]
    v_pk_mul_f32 v[234:235], v[234:235], v[26:27]
    v_pk_mul_f32 v[236:237], v[236:237], v[26:27]
    v_pk_mul_f32 v[238:239], v[238:239], v[26:27]
    v_pk_mul_f32 v[240:241], v[240:241], v[26:27]
    v_pk_mul_f32 v[242:243], v[242:243], v[26:27]
    v_pk_mul_f32 v[244:245], v[244:245], v[26:27]
    v_pk_mul_f32 v[246:247], v[246:247], v[26:27]
    v_pk_mul_f32 v[248:249], v[248:249], v[26:27]
    v_pk_mul_f32 v[250:251], v[250:251], v[26:27]
    v_pk_mul_f32 v[252:253], v[252:253], v[26:27]
    v_pk_mul_f32 v[254:255], v[254:255], v[26:27]
    s_waitcnt lgkmcnt(0)
    v_pk_fma_f32 v[192:193], v[128:129], v[28:29], v[192:193]
    v_pk_fma_f32 v[194:195], v[130:131], v[28:29], v[194:195]
    v_pk_fma_f32 v[196:197], v[132:133], v[28:29], v[196:197]
    v_pk_fma_f32 v[198:199], v[134:135], v[28:29], v[198:199]
    v_cvt_pk_bf16_f32 v32, v192, v193
    v_cvt_pk_bf16_f32 v33, v194, v195
    v_cvt_pk_bf16_f32 v34, v196, v197
    v_cvt_pk_bf16_f32 v35, v198, v199
    buffer_store_dwordx4 v[32:35], v10, s[40:43], s76 offen offset:0 sc1
    v_pk_fma_f32 v[200:201], v[136:137], v[28:29], v[200:201]
    v_pk_fma_f32 v[202:203], v[138:139], v[28:29], v[202:203]
    v_pk_fma_f32 v[204:205], v[140:141], v[28:29], v[204:205]
    v_pk_fma_f32 v[206:207], v[142:143], v[28:29], v[206:207]
    v_cvt_pk_bf16_f32 v36, v200, v201
    v_cvt_pk_bf16_f32 v37, v202, v203
    v_cvt_pk_bf16_f32 v38, v204, v205
    v_cvt_pk_bf16_f32 v39, v206, v207
    buffer_store_dwordx4 v[36:39], v10, s[40:43], s76 offen offset:512 sc1
    v_pk_fma_f32 v[208:209], v[144:145], v[28:29], v[208:209]
    v_pk_fma_f32 v[210:211], v[146:147], v[28:29], v[210:211]
    v_pk_fma_f32 v[212:213], v[148:149], v[28:29], v[212:213]
    v_pk_fma_f32 v[214:215], v[150:151], v[28:29], v[214:215]
    v_cvt_pk_bf16_f32 v40, v208, v209
    v_cvt_pk_bf16_f32 v41, v210, v211
    v_cvt_pk_bf16_f32 v42, v212, v213
    v_cvt_pk_bf16_f32 v43, v214, v215
    buffer_store_dwordx4 v[40:43], v10, s[40:43], s76 offen offset:1024 sc1
    v_pk_fma_f32 v[216:217], v[152:153], v[28:29], v[216:217]
    v_pk_fma_f32 v[218:219], v[154:155], v[28:29], v[218:219]
    v_pk_fma_f32 v[220:221], v[156:157], v[28:29], v[220:221]
    v_pk_fma_f32 v[222:223], v[158:159], v[28:29], v[222:223]
    v_cvt_pk_bf16_f32 v44, v216, v217
    v_cvt_pk_bf16_f32 v45, v218, v219
    v_cvt_pk_bf16_f32 v46, v220, v221
    v_cvt_pk_bf16_f32 v47, v222, v223
    buffer_store_dwordx4 v[44:47], v10, s[40:43], s76 offen offset:1536 sc1
    v_pk_fma_f32 v[224:225], v[160:161], v[28:29], v[224:225]
    v_pk_fma_f32 v[226:227], v[162:163], v[28:29], v[226:227]
    v_pk_fma_f32 v[228:229], v[164:165], v[28:29], v[228:229]
    v_pk_fma_f32 v[230:231], v[166:167], v[28:29], v[230:231]
    v_cvt_pk_bf16_f32 v48, v224, v225
    v_cvt_pk_bf16_f32 v49, v226, v227
    v_cvt_pk_bf16_f32 v50, v228, v229
    v_cvt_pk_bf16_f32 v51, v230, v231
    buffer_store_dwordx4 v[48:51], v10, s[40:43], s76 offen offset:2048 sc1
    v_pk_fma_f32 v[232:233], v[168:169], v[28:29], v[232:233]
    v_pk_fma_f32 v[234:235], v[170:171], v[28:29], v[234:235]
    v_pk_fma_f32 v[236:237], v[172:173], v[28:29], v[236:237]
    v_pk_fma_f32 v[238:239], v[174:175], v[28:29], v[238:239]
    v_cvt_pk_bf16_f32 v52, v232, v233
    v_cvt_pk_bf16_f32 v53, v234, v235
    v_cvt_pk_bf16_f32 v54, v236, v237
    v_cvt_pk_bf16_f32 v55, v238, v239
    buffer_store_dwordx4 v[52:55], v10, s[40:43], s76 offen offset:2560 sc1
    v_pk_fma_f32 v[240:241], v[176:177], v[28:29], v[240:241]
    v_pk_fma_f32 v[242:243], v[178:179], v[28:29], v[242:243]
    v_pk_fma_f32 v[244:245], v[180:181], v[28:29], v[244:245]
    v_pk_fma_f32 v[246:247], v[182:183], v[28:29], v[246:247]
    v_cvt_pk_bf16_f32 v56, v240, v241
    v_cvt_pk_bf16_f32 v57, v242, v243
    v_cvt_pk_bf16_f32 v58, v244, v245
    v_cvt_pk_bf16_f32 v59, v246, v247
    buffer_store_dwordx4 v[56:59], v10, s[40:43], s76 offen offset:3072 sc1
    v_pk_fma_f32 v[248:249], v[184:185], v[28:29], v[248:249]
    v_pk_fma_f32 v[250:251], v[186:187], v[28:29], v[250:251]
    v_pk_fma_f32 v[252:253], v[188:189], v[28:29], v[252:253]
    v_pk_fma_f32 v[254:255], v[190:191], v[28:29], v[254:255]
    v_cvt_pk_bf16_f32 v60, v248, v249
    v_cvt_pk_bf16_f32 v61, v250, v251
    v_cvt_pk_bf16_f32 v62, v252, v253
    v_cvt_pk_bf16_f32 v63, v254, v255
    buffer_store_dwordx4 v[60:63], v10, s[40:43], s76 offen offset:3584 sc1
    s_lshl_b32 s58, s47, 2
    s_bfe_u32 s59, s46, 0x20001
    s_add_u32 s58, s58, s59
    s_lshl_b32 s58, s58, 5
    s_lshr_b32 s59, s46, 3
    s_lshl_b32 s59, s59, 1
    s_add_u32 s58, s58, s59
    s_and_b32 s59, s46, 1
    s_add_u32 s58, s58, s59
    s_lshl_b32 s58, s58, 2
    s_add_u32 s58, s58, 0x4830000
    v_mov_b32 v2, s58
    v_mov_b32 v3, 1
    s_load_dwordx2 s[24:25], s[0:1], 0
    s_load_dwordx2 s[28:29], s[0:1], 104
    s_mov_b32 s16, s78
    s_mov_b32 s17, s79
    s_and_b32 s58, s2, 7
    s_lshr_b32 s47, s58, 1
    s_lshr_b32 s59, s2, 3
    s_and_b32 s45, s58, 1
    s_lshl_b32 s45, s45, 3
    s_and_b32 s58, s59, 7
    s_add_u32 s45, s45, s58
    s_lshr_b32 s46, s59, 3
    s_lshl_b32 s48, s45, 2
    s_add_u32 s48, s48, s46
    s_lshl_b32 s58, s45, 3
    s_lshl_b32 s59, s44, 1
    s_add_u32 s58, s58, s59
    s_lshl_b32 s58, s58, 17
    s_lshl_b32 s59, s47, 13
    s_add_u32 s58, s58, s59
    s_add_u32 s58, s58, 0x3000000
    v_add_u32 v25, s58, v4
    v_add_u32 v19, 0x20000, v25
    v_add_u32 v26, 0, v1
    v_mul_u32_u24 v27, 0xccd, v26
    v_lshrrev_b32 v27, 16, v27
    v_mul_u32_u24 v28, 20, v27
    v_sub_u32 v28, v26, v28
    v_bfe_u32 v29, v27, 2, 1
    v_lshlrev_b32 v29, 1, v29
    v_xor_b32 v28, v28, v29
    v_mul_u32_u24 v27, 0x500, v27
    v_lshl_add_u32 v20, v28, 4, v27
    v_add_u32 v26, 64, v1
    v_mul_u32_u24 v27, 0xccd, v26
    v_lshrrev_b32 v27, 16, v27
    v_mul_u32_u24 v28, 20, v27
    v_sub_u32 v28, v26, v28
    v_bfe_u32 v29, v27, 2, 1
    v_lshlrev_b32 v29, 1, v29
    v_xor_b32 v28, v28, v29
    v_mul_u32_u24 v27, 0x500, v27
    v_lshl_add_u32 v21, v28, 4, v27
    v_subrev_u32 v21, 1024, v21
    v_add_u32 v26, 128, v1
    v_mul_u32_u24 v27, 0xccd, v26
    v_lshrrev_b32 v27, 16, v27
    v_mul_u32_u24 v28, 20, v27
    v_sub_u32 v28, v26, v28
    v_bfe_u32 v29, v27, 2, 1
    v_lshlrev_b32 v29, 1, v29
    v_xor_b32 v28, v28, v29
    v_mul_u32_u24 v27, 0x500, v27
    v_lshl_add_u32 v22, v28, 4, v27
    v_subrev_u32 v22, 2048, v22
    v_add_u32 v26, 192, v1
    v_mul_u32_u24 v27, 0xccd, v26
    v_lshrrev_b32 v27, 16, v27
    v_mul_u32_u24 v28, 20, v27
    v_sub_u32 v28, v26, v28
    v_bfe_u32 v29, v27, 2, 1
    v_lshlrev_b32 v29, 1, v29
    v_xor_b32 v28, v28, v29
    v_mul_u32_u24 v27, 0x500, v27
    v_lshl_add_u32 v23, v28, 4, v27
    v_subrev_u32 v23, 3072, v23
    v_add_u32 v26, 256, v1
    v_mul_u32_u24 v27, 0xccd, v26
    v_lshrrev_b32 v27, 16, v27
    v_mul_u32_u24 v28, 20, v27
    v_sub_u32 v28, v26, v28
    v_bfe_u32 v29, v27, 2, 1
    v_lshlrev_b32 v29, 1, v29
    v_xor_b32 v28, v28, v29
    v_mul_u32_u24 v27, 0x500, v27
    v_lshl_add_u32 v24, v28, 4, v27
    s_lshl_b32 s20, s47, 8
    s_lshl_b32 s58, s44, 4
    s_add_u32 s20, s20, s58
    s_mul_i32 s20, s20, 1280
    s_mul_i32 s58, s46, 320
    s_add_u32 s20, s20, s58
    s_mul_i32 s21, s44, 5120
    s_add_u32 s21, s21, 0
    s_mov_b32 s18, 5242880
    s_mov_b32 s19, 0x00020000
    v_lshrrev_b32 v26, 5, v1
    v_lshlrev_b32 v26, 4, v26
    v_bfe_u32 v28, v1, 4, 1
    v_lshl_add_u32 v26, v28, 2, v26
    v_bfe_u32 v29, v1, 2, 2
    v_add_u32 v26, v26, v29
    v_mul_u32_u24 v26, 320, v26
    v_and_b32 v29, 3, v1
    v_lshl_add_u32 v26, v29, 3, v26
    v_add_u32 v26, 0, v26
    v_lshlrev_b32 v28, 5, v28
    v_sub_u32 v27, v26, v28
    v_add_u32 v27, 32, v27
    v_add_u32 v26, v26, v28
    v_add_u32 v28, 61440, v26
    v_add_u32 v29, 61440, v27
    v_add_u32 v30, 122880, v26
    v_add_u32 v31, 122880, v27
    s_sub_u32 s58, 15, s45
    s_min_u32 s58, s58, s45
    s_lshl_b32 s58, s58, 2
    s_add_u32 s58, s58, s47
    s_lshl_b32 s58, s58, 7
    s_add_u32 s58, s58, 0x4830000
    v_min_u32 v18, 7, v1
    v_lshlrev_b32 v18, 2, v18
    v_add_u32 v18, s58, v18
    v_cmp_eq_u32 vcc, v18, v2
    buffer_load_dword v8, v18, s[40:43], 0 offen sc1
    s_nop 0
    v_cndmask_b32 v7, 0, 1, vcc
    s_waitcnt vmcnt(0) lgkmcnt(0)
    s_barrier
    s_cmp_lg_u32 s44, 0
    s_cbranch_scc1 main_kernel_ncf
    s_mov_b64 exec, 1
    buffer_store_dword v3, v2, s[40:43], 0 offen sc1
    s_mov_b64 exec, -1
main_kernel_ncf:
    s_cmp_lt_u32 s52, 160
    s_cbranch_scc1 main_kernel_conv
    s_add_u32 m0, s21, 102400
    s_add_u32 s23, s20, 0
    buffer_load_dwordx4 v20, s[16:19], s23 offen lds
    buffer_load_dwordx4 v21, s[16:19], s23 offen offset:1024 lds
    buffer_load_dwordx4 v22, s[16:19], s23 offen offset:2048 lds
    buffer_load_dwordx4 v23, s[16:19], s23 offen offset:3072 lds
    s_add_u32 m0, s21, 106496
    s_nop 0
    buffer_load_dwordx4 v24, s[16:19], s23 offen lds
    s_add_u32 m0, s21, 122880
    s_add_u32 s23, s20, 81920
    buffer_load_dwordx4 v20, s[16:19], s23 offen lds
    buffer_load_dwordx4 v21, s[16:19], s23 offen offset:1024 lds
    buffer_load_dwordx4 v22, s[16:19], s23 offen offset:2048 lds
    buffer_load_dwordx4 v23, s[16:19], s23 offen offset:3072 lds
    s_add_u32 m0, s21, 126976
    s_nop 0
    buffer_load_dwordx4 v24, s[16:19], s23 offen lds
    s_add_u32 m0, s21, 143360
    s_add_u32 s23, s20, 163840
    buffer_load_dwordx4 v20, s[16:19], s23 offen lds
    buffer_load_dwordx4 v21, s[16:19], s23 offen offset:1024 lds
    buffer_load_dwordx4 v22, s[16:19], s23 offen offset:2048 lds
    buffer_load_dwordx4 v23, s[16:19], s23 offen offset:3072 lds
    s_add_u32 m0, s21, 147456
    s_nop 0
    buffer_load_dwordx4 v24, s[16:19], s23 offen lds
main_kernel_fin:
    v_or_b32 v8, v8, v7
    v_cmp_ne_u32 vcc, 1, v8
    s_mov_b32 s59, 0x100000
    s_cbranch_vccz main_kernel_cok
main_kernel_csp:
    buffer_load_dword v8, v18, s[40:43], 0 offen sc1
    s_waitcnt vmcnt(0)
    v_or_b32 v8, v8, v7
    v_cmp_ne_u32 vcc, 1, v8
    s_sub_u32 s59, s59, 1
    s_cmp_eq_u32 s59, 0
    s_cbranch_scc1 main_kernel_cok
    s_cbranch_vccz main_kernel_cok
    s_sleep 4
    s_branch main_kernel_csp
main_kernel_cok:
    s_mov_b32 s22, 0
    buffer_load_dwordx4 a[0:3], v25, s[40:43], s22 offen offset:0 sc1
    buffer_load_dwordx4 a[4:7], v19, s[40:43], s22 offen offset:0 sc1
    buffer_load_dwordx4 a[8:11], v25, s[40:43], s22 offen offset:1024 sc1
    buffer_load_dwordx4 a[12:15], v19, s[40:43], s22 offen offset:1024 sc1
    s_mov_b32 s22, 0
    buffer_load_dwordx4 a[16:19], v25, s[40:43], s22 offen offset:2048 sc1
    buffer_load_dwordx4 a[20:23], v19, s[40:43], s22 offen offset:2048 sc1
    buffer_load_dwordx4 a[24:27], v25, s[40:43], s22 offen offset:3072 sc1
    buffer_load_dwordx4 a[28:31], v19, s[40:43], s22 offen offset:3072 sc1
    s_mov_b32 s22, 4096
    buffer_load_dwordx4 a[32:35], v25, s[40:43], s22 offen offset:0 sc1
    buffer_load_dwordx4 a[36:39], v19, s[40:43], s22 offen offset:0 sc1
    buffer_load_dwordx4 a[40:43], v25, s[40:43], s22 offen offset:1024 sc1
    buffer_load_dwordx4 a[44:47], v19, s[40:43], s22 offen offset:1024 sc1
    s_waitcnt vmcnt(12) lgkmcnt(0)
    s_cmp_ge_u32 s52, 160
    s_cbranch_scc1 main_kernel_nyf
    s_mov_b64 exec, 1
    buffer_store_dword v3, v2, s[40:43], 0 offen sc1
    s_mov_b64 exec, -1
    main_kernel_nyf:
    s_barrier
    ds_read_b64_tr_b16 v[112:113], v28 offset:40960
    ds_read_b64_tr_b16 v[114:115], v28 offset:43520
    ds_read_b64_tr_b16 v[116:117], v29 offset:40960
    ds_read_b64_tr_b16 v[118:119], v29 offset:43520
    ds_read_b64_tr_b16 v[120:121], v28 offset:41024
    ds_read_b64_tr_b16 v[122:123], v28 offset:43584
    ds_read_b64_tr_b16 v[124:125], v29 offset:41024
    ds_read_b64_tr_b16 v[126:127], v29 offset:43584
    ds_read_b64_tr_b16 v[128:129], v28 offset:41088
    ds_read_b64_tr_b16 v[130:131], v28 offset:43648
    ds_read_b64_tr_b16 v[132:133], v29 offset:41088
    ds_read_b64_tr_b16 v[134:135], v29 offset:43648
    ds_read_b64_tr_b16 v[136:137], v28 offset:41152
    ds_read_b64_tr_b16 v[138:139], v28 offset:43712
    ds_read_b64_tr_b16 v[140:141], v29 offset:41152
    ds_read_b64_tr_b16 v[142:143], v29 offset:43712
    ds_read_b64_tr_b16 v[144:145], v28 offset:41216
    ds_read_b64_tr_b16 v[146:147], v28 offset:43776
    ds_read_b64_tr_b16 v[148:149], v29 offset:41216
    ds_read_b64_tr_b16 v[150:151], v29 offset:43776
    s_waitcnt vmcnt(8)
    s_waitcnt lgkmcnt(15)
    v_mfma_f32_16x16x32_bf16 v[32:35], v[112:115], a[0:3], 0
    ds_read_b64_tr_b16 v[152:153], v28 offset:51200
    v_mfma_f32_16x16x32_bf16 v[72:75], v[112:115], a[4:7], 0
    ds_read_b64_tr_b16 v[154:155], v28 offset:53760
    s_add_u32 m0, s21, 0
    s_add_u32 s23, s20, 245760
    buffer_load_dwordx4 v20, s[16:19], s23 offen lds
    v_mfma_f32_16x16x32_bf16 v[36:39], v[116:119], a[0:3], 0
    ds_read_b64_tr_b16 v[156:157], v29 offset:51200
    v_mfma_f32_16x16x32_bf16 v[76:79], v[116:119], a[4:7], 0
    ds_read_b64_tr_b16 v[158:159], v29 offset:53760
    buffer_load_dwordx4 v21, s[16:19], s23 offen offset:1024 lds
    s_waitcnt lgkmcnt(15)
    v_mfma_f32_16x16x32_bf16 v[40:43], v[120:123], a[0:3], 0
    ds_read_b64_tr_b16 v[160:161], v28 offset:51264
    v_mfma_f32_16x16x32_bf16 v[80:83], v[120:123], a[4:7], 0
    ds_read_b64_tr_b16 v[162:163], v28 offset:53824
    buffer_load_dwordx4 v22, s[16:19], s23 offen offset:2048 lds
    v_mfma_f32_16x16x32_bf16 v[44:47], v[124:127], a[0:3], 0
    ds_read_b64_tr_b16 v[164:165], v29 offset:51264
    v_mfma_f32_16x16x32_bf16 v[84:87], v[124:127], a[4:7], 0
    ds_read_b64_tr_b16 v[166:167], v29 offset:53824
    buffer_load_dwordx4 v23, s[16:19], s23 offen offset:3072 lds
    s_waitcnt lgkmcnt(15)
    v_mfma_f32_16x16x32_bf16 v[48:51], v[128:131], a[0:3], 0
    ds_read_b64_tr_b16 v[168:169], v28 offset:51328
    v_mfma_f32_16x16x32_bf16 v[88:91], v[128:131], a[4:7], 0
    ds_read_b64_tr_b16 v[170:171], v28 offset:53888
    s_add_u32 m0, s21, 4096
    s_nop 0
    buffer_load_dwordx4 v24, s[16:19], s23 offen lds
    v_mfma_f32_16x16x32_bf16 v[52:55], v[132:135], a[0:3], 0
    ds_read_b64_tr_b16 v[172:173], v29 offset:51328
    v_mfma_f32_16x16x32_bf16 v[92:95], v[132:135], a[4:7], 0
    ds_read_b64_tr_b16 v[174:175], v29 offset:53888
    s_mov_b32 s22, 4096
    buffer_load_dwordx4 a[48:51], v25, s[40:43], s22 offen offset:2048 sc1
    s_waitcnt lgkmcnt(15)
    v_mfma_f32_16x16x32_bf16 v[56:59], v[136:139], a[0:3], 0
    ds_read_b64_tr_b16 v[176:177], v28 offset:51392
    v_mfma_f32_16x16x32_bf16 v[96:99], v[136:139], a[4:7], 0
    ds_read_b64_tr_b16 v[178:179], v28 offset:53952
    buffer_load_dwordx4 a[52:55], v19, s[40:43], s22 offen offset:2048 sc1
    v_mfma_f32_16x16x32_bf16 v[60:63], v[140:143], a[0:3], 0
    ds_read_b64_tr_b16 v[180:181], v29 offset:51392
    v_mfma_f32_16x16x32_bf16 v[100:103], v[140:143], a[4:7], 0
    ds_read_b64_tr_b16 v[182:183], v29 offset:53952
    buffer_load_dwordx4 a[56:59], v25, s[40:43], s22 offen offset:3072 sc1
    s_waitcnt lgkmcnt(15)
    v_mfma_f32_16x16x32_bf16 v[64:67], v[144:147], a[0:3], 0
    ds_read_b64_tr_b16 v[184:185], v28 offset:51456
    v_mfma_f32_16x16x32_bf16 v[104:107], v[144:147], a[4:7], 0
    ds_read_b64_tr_b16 v[186:187], v28 offset:54016
    buffer_load_dwordx4 a[60:63], v19, s[40:43], s22 offen offset:3072 sc1
    v_mfma_f32_16x16x32_bf16 v[68:71], v[148:151], a[0:3], 0
    ds_read_b64_tr_b16 v[188:189], v29 offset:51456
    v_mfma_f32_16x16x32_bf16 v[108:111], v[148:151], a[4:7], 0
    ds_read_b64_tr_b16 v[190:191], v29 offset:54016
    s_waitcnt lgkmcnt(15)
    v_mfma_f32_16x16x32_bf16 v[32:35], v[152:155], a[8:11], v[32:35]
    ds_read_b64_tr_b16 v[112:113], v30 offset:0
    v_mfma_f32_16x16x32_bf16 v[72:75], v[152:155], a[12:15], v[72:75]
    ds_read_b64_tr_b16 v[114:115], v30 offset:2560
    s_add_u32 m0, s21, 20480
    s_add_u32 s23, s20, 1310720
    buffer_load_dwordx4 v20, s[16:19], s23 offen lds
    v_mfma_f32_16x16x32_bf16 v[36:39], v[156:159], a[8:11], v[36:39]
    ds_read_b64_tr_b16 v[116:117], v31 offset:0
    v_mfma_f32_16x16x32_bf16 v[76:79], v[156:159], a[12:15], v[76:79]
    ds_read_b64_tr_b16 v[118:119], v31 offset:2560
    s_waitcnt lgkmcnt(15)
    v_mfma_f32_16x16x32_bf16 v[40:43], v[160:163], a[8:11], v[40:43]
    ds_read_b64_tr_b16 v[120:121], v30 offset:64
    buffer_load_dwordx4 v21, s[16:19], s23 offen offset:1024 lds
    v_mfma_f32_16x16x32_bf16 v[80:83], v[160:163], a[12:15], v[80:83]
    ds_read_b64_tr_b16 v[122:123], v30 offset:2624
    v_mfma_f32_16x16x32_bf16 v[44:47], v[164:167], a[8:11], v[44:47]
    ds_read_b64_tr_b16 v[124:125], v31 offset:64
    v_mfma_f32_16x16x32_bf16 v[84:87], v[164:167], a[12:15], v[84:87]
    ds_read_b64_tr_b16 v[126:127], v31 offset:2624
    s_waitcnt lgkmcnt(15)
    v_mfma_f32_16x16x32_bf16 v[48:51], v[168:171], a[8:11], v[48:51]
    ds_read_b64_tr_b16 v[128:129], v30 offset:128
    buffer_load_dwordx4 v22, s[16:19], s23 offen offset:2048 lds
    v_mfma_f32_16x16x32_bf16 v[88:91], v[168:171], a[12:15], v[88:91]
    ds_read_b64_tr_b16 v[130:131], v30 offset:2688
    v_mfma_f32_16x16x32_bf16 v[52:55], v[172:175], a[8:11], v[52:55]
    ds_read_b64_tr_b16 v[132:133], v31 offset:128
    v_mfma_f32_16x16x32_bf16 v[92:95], v[172:175], a[12:15], v[92:95]
    ds_read_b64_tr_b16 v[134:135], v31 offset:2688
    s_waitcnt lgkmcnt(15)
    v_mfma_f32_16x16x32_bf16 v[56:59], v[176:179], a[8:11], v[56:59]
    ds_read_b64_tr_b16 v[136:137], v30 offset:192
    buffer_load_dwordx4 v23, s[16:19], s23 offen offset:3072 lds
    v_mfma_f32_16x16x32_bf16 v[96:99], v[176:179], a[12:15], v[96:99]
    ds_read_b64_tr_b16 v[138:139], v30 offset:2752
    v_mfma_f32_16x16x32_bf16 v[60:63], v[180:183], a[8:11], v[60:63]
    ds_read_b64_tr_b16 v[140:141], v31 offset:192
    v_mfma_f32_16x16x32_bf16 v[100:103], v[180:183], a[12:15], v[100:103]
    ds_read_b64_tr_b16 v[142:143], v31 offset:2752
    s_waitcnt lgkmcnt(15)
    v_mfma_f32_16x16x32_bf16 v[64:67], v[184:187], a[8:11], v[64:67]
    ds_read_b64_tr_b16 v[144:145], v30 offset:256
    s_add_u32 m0, s21, 24576
    s_nop 0
    buffer_load_dwordx4 v24, s[16:19], s23 offen lds
    v_mfma_f32_16x16x32_bf16 v[104:107], v[184:187], a[12:15], v[104:107]
    ds_read_b64_tr_b16 v[146:147], v30 offset:2816
    v_mfma_f32_16x16x32_bf16 v[68:71], v[188:191], a[8:11], v[68:71]
    ds_read_b64_tr_b16 v[148:149], v31 offset:256
    v_mfma_f32_16x16x32_bf16 v[108:111], v[188:191], a[12:15], v[108:111]
    ds_read_b64_tr_b16 v[150:151], v31 offset:2816
    s_waitcnt vmcnt(18)
    s_waitcnt lgkmcnt(15)
    v_mfma_f32_16x16x32_bf16 v[32:35], v[112:115], a[16:19], v[32:35]
    ds_read_b64_tr_b16 v[152:153], v30 offset:10240
    v_mfma_f32_16x16x32_bf16 v[72:75], v[112:115], a[20:23], v[72:75]
    ds_read_b64_tr_b16 v[154:155], v30 offset:12800
    s_mov_b32 s22, 32768
    buffer_load_dwordx4 a[64:67], v25, s[40:43], s22 offen offset:0 sc1
    v_mfma_f32_16x16x32_bf16 v[36:39], v[116:119], a[16:19], v[36:39]
    ds_read_b64_tr_b16 v[156:157], v31 offset:10240
    v_mfma_f32_16x16x32_bf16 v[76:79], v[116:119], a[20:23], v[76:79]
    ds_read_b64_tr_b16 v[158:159], v31 offset:12800
    s_waitcnt lgkmcnt(15)
    v_mfma_f32_16x16x32_bf16 v[40:43], v[120:123], a[16:19], v[40:43]
    ds_read_b64_tr_b16 v[160:161], v30 offset:10304
    v_mfma_f32_16x16x32_bf16 v[80:83], v[120:123], a[20:23], v[80:83]
    ds_read_b64_tr_b16 v[162:163], v30 offset:12864
    buffer_load_dwordx4 a[68:71], v19, s[40:43], s22 offen offset:0 sc1
    v_mfma_f32_16x16x32_bf16 v[44:47], v[124:127], a[16:19], v[44:47]
    ds_read_b64_tr_b16 v[164:165], v31 offset:10304
    v_mfma_f32_16x16x32_bf16 v[84:87], v[124:127], a[20:23], v[84:87]
    ds_read_b64_tr_b16 v[166:167], v31 offset:12864
    s_waitcnt lgkmcnt(15)
    v_mfma_f32_16x16x32_bf16 v[48:51], v[128:131], a[16:19], v[48:51]
    ds_read_b64_tr_b16 v[168:169], v30 offset:10368
    v_mfma_f32_16x16x32_bf16 v[88:91], v[128:131], a[20:23], v[88:91]
    ds_read_b64_tr_b16 v[170:171], v30 offset:12928
    v_mfma_f32_16x16x32_bf16 v[52:55], v[132:135], a[16:19], v[52:55]
    ds_read_b64_tr_b16 v[172:173], v31 offset:10368
    buffer_load_dwordx4 a[72:75], v25, s[40:43], s22 offen offset:1024 sc1
    v_mfma_f32_16x16x32_bf16 v[92:95], v[132:135], a[20:23], v[92:95]
    ds_read_b64_tr_b16 v[174:175], v31 offset:12928
    s_waitcnt lgkmcnt(15)
    v_mfma_f32_16x16x32_bf16 v[56:59], v[136:139], a[16:19], v[56:59]
    ds_read_b64_tr_b16 v[176:177], v30 offset:10432
    v_mfma_f32_16x16x32_bf16 v[96:99], v[136:139], a[20:23], v[96:99]
    ds_read_b64_tr_b16 v[178:179], v30 offset:12992
    v_mfma_f32_16x16x32_bf16 v[60:63], v[140:143], a[16:19], v[60:63]
    ds_read_b64_tr_b16 v[180:181], v31 offset:10432
    v_mfma_f32_16x16x32_bf16 v[100:103], v[140:143], a[20:23], v[100:103]
    ds_read_b64_tr_b16 v[182:183], v31 offset:12992
    buffer_load_dwordx4 a[76:79], v19, s[40:43], s22 offen offset:1024 sc1
    s_waitcnt lgkmcnt(15)
    v_mfma_f32_16x16x32_bf16 v[64:67], v[144:147], a[16:19], v[64:67]
    ds_read_b64_tr_b16 v[184:185], v30 offset:10496
    v_mfma_f32_16x16x32_bf16 v[104:107], v[144:147], a[20:23], v[104:107]
    ds_read_b64_tr_b16 v[186:187], v30 offset:13056
    v_mfma_f32_16x16x32_bf16 v[68:71], v[148:151], a[16:19], v[68:71]
    ds_read_b64_tr_b16 v[188:189], v31 offset:10496
    v_mfma_f32_16x16x32_bf16 v[108:111], v[148:151], a[20:23], v[108:111]
    ds_read_b64_tr_b16 v[190:191], v31 offset:13056
    s_waitcnt vmcnt(13)
    s_barrier
    s_waitcnt lgkmcnt(15)
    v_mfma_f32_16x16x32_bf16 v[32:35], v[152:155], a[24:27], v[32:35]
    ds_read_b64_tr_b16 v[112:113], v30 offset:20480
    v_mfma_f32_16x16x32_bf16 v[72:75], v[152:155], a[28:31], v[72:75]
    ds_read_b64_tr_b16 v[114:115], v30 offset:23040
    s_add_u32 m0, s21, 40960
    s_add_u32 s23, s20, 1392640
    buffer_load_dwordx4 v20, s[16:19], s23 offen lds
    v_mfma_f32_16x16x32_bf16 v[36:39], v[156:159], a[24:27], v[36:39]
    ds_read_b64_tr_b16 v[116:117], v31 offset:20480
    v_mfma_f32_16x16x32_bf16 v[76:79], v[156:159], a[28:31], v[76:79]
    ds_read_b64_tr_b16 v[118:119], v31 offset:23040
    s_waitcnt lgkmcnt(15)
    v_mfma_f32_16x16x32_bf16 v[40:43], v[160:163], a[24:27], v[40:43]
    ds_read_b64_tr_b16 v[120:121], v30 offset:20544
    buffer_load_dwordx4 v21, s[16:19], s23 offen offset:1024 lds
    v_mfma_f32_16x16x32_bf16 v[80:83], v[160:163], a[28:31], v[80:83]
    ds_read_b64_tr_b16 v[122:123], v30 offset:23104
    v_mfma_f32_16x16x32_bf16 v[44:47], v[164:167], a[24:27], v[44:47]
    ds_read_b64_tr_b16 v[124:125], v31 offset:20544
    v_mfma_f32_16x16x32_bf16 v[84:87], v[164:167], a[28:31], v[84:87]
    ds_read_b64_tr_b16 v[126:127], v31 offset:23104
    s_waitcnt lgkmcnt(15)
    v_mfma_f32_16x16x32_bf16 v[48:51], v[168:171], a[24:27], v[48:51]
    ds_read_b64_tr_b16 v[128:129], v30 offset:20608
    buffer_load_dwordx4 v22, s[16:19], s23 offen offset:2048 lds
    v_mfma_f32_16x16x32_bf16 v[88:91], v[168:171], a[28:31], v[88:91]
    ds_read_b64_tr_b16 v[130:131], v30 offset:23168
    v_mfma_f32_16x16x32_bf16 v[52:55], v[172:175], a[24:27], v[52:55]
    ds_read_b64_tr_b16 v[132:133], v31 offset:20608
    v_mfma_f32_16x16x32_bf16 v[92:95], v[172:175], a[28:31], v[92:95]
    ds_read_b64_tr_b16 v[134:135], v31 offset:23168
    s_waitcnt lgkmcnt(15)
    v_mfma_f32_16x16x32_bf16 v[56:59], v[176:179], a[24:27], v[56:59]
    ds_read_b64_tr_b16 v[136:137], v30 offset:20672
    buffer_load_dwordx4 v23, s[16:19], s23 offen offset:3072 lds
    v_mfma_f32_16x16x32_bf16 v[96:99], v[176:179], a[28:31], v[96:99]
    ds_read_b64_tr_b16 v[138:139], v30 offset:23232
    v_mfma_f32_16x16x32_bf16 v[60:63], v[180:183], a[24:27], v[60:63]
    ds_read_b64_tr_b16 v[140:141], v31 offset:20672
    v_mfma_f32_16x16x32_bf16 v[100:103], v[180:183], a[28:31], v[100:103]
    ds_read_b64_tr_b16 v[142:143], v31 offset:23232
    s_waitcnt lgkmcnt(15)
    v_mfma_f32_16x16x32_bf16 v[64:67], v[184:187], a[24:27], v[64:67]
    ds_read_b64_tr_b16 v[144:145], v30 offset:20736
    s_add_u32 m0, s21, 45056
    s_nop 0
    buffer_load_dwordx4 v24, s[16:19], s23 offen lds
    v_mfma_f32_16x16x32_bf16 v[104:107], v[184:187], a[28:31], v[104:107]
    ds_read_b64_tr_b16 v[146:147], v30 offset:23296
    v_mfma_f32_16x16x32_bf16 v[68:71], v[188:191], a[24:27], v[68:71]
    ds_read_b64_tr_b16 v[148:149], v31 offset:20736
    v_mfma_f32_16x16x32_bf16 v[108:111], v[188:191], a[28:31], v[108:111]
    ds_read_b64_tr_b16 v[150:151], v31 offset:23296
    s_waitcnt lgkmcnt(15)
    v_mfma_f32_16x16x32_bf16 v[32:35], v[112:115], a[32:35], v[32:35]
    ds_read_b64_tr_b16 v[152:153], v30 offset:30720
    v_mfma_f32_16x16x32_bf16 v[72:75], v[112:115], a[36:39], v[72:75]
    ds_read_b64_tr_b16 v[154:155], v30 offset:33280
    s_mov_b32 s22, 32768
    buffer_load_dwordx4 a[80:83], v25, s[40:43], s22 offen offset:2048 sc1
    v_mfma_f32_16x16x32_bf16 v[36:39], v[116:119], a[32:35], v[36:39]
    ds_read_b64_tr_b16 v[156:157], v31 offset:30720
    v_mfma_f32_16x16x32_bf16 v[76:79], v[116:119], a[36:39], v[76:79]
    ds_read_b64_tr_b16 v[158:159], v31 offset:33280
    s_waitcnt lgkmcnt(15)
    v_mfma_f32_16x16x32_bf16 v[40:43], v[120:123], a[32:35], v[40:43]
    ds_read_b64_tr_b16 v[160:161], v30 offset:30784
    v_mfma_f32_16x16x32_bf16 v[80:83], v[120:123], a[36:39], v[80:83]
    ds_read_b64_tr_b16 v[162:163], v30 offset:33344
    buffer_load_dwordx4 a[84:87], v19, s[40:43], s22 offen offset:2048 sc1
    v_mfma_f32_16x16x32_bf16 v[44:47], v[124:127], a[32:35], v[44:47]
    ds_read_b64_tr_b16 v[164:165], v31 offset:30784
    v_mfma_f32_16x16x32_bf16 v[84:87], v[124:127], a[36:39], v[84:87]
    ds_read_b64_tr_b16 v[166:167], v31 offset:33344
    s_waitcnt lgkmcnt(15)
    v_mfma_f32_16x16x32_bf16 v[48:51], v[128:131], a[32:35], v[48:51]
    ds_read_b64_tr_b16 v[168:169], v30 offset:30848
    v_mfma_f32_16x16x32_bf16 v[88:91], v[128:131], a[36:39], v[88:91]
    ds_read_b64_tr_b16 v[170:171], v30 offset:33408
    v_mfma_f32_16x16x32_bf16 v[52:55], v[132:135], a[32:35], v[52:55]
    ds_read_b64_tr_b16 v[172:173], v31 offset:30848
    buffer_load_dwordx4 a[88:91], v25, s[40:43], s22 offen offset:3072 sc1
    v_mfma_f32_16x16x32_bf16 v[92:95], v[132:135], a[36:39], v[92:95]
    ds_read_b64_tr_b16 v[174:175], v31 offset:33408
    s_waitcnt lgkmcnt(15)
    v_mfma_f32_16x16x32_bf16 v[56:59], v[136:139], a[32:35], v[56:59]
    ds_read_b64_tr_b16 v[176:177], v30 offset:30912
    v_mfma_f32_16x16x32_bf16 v[96:99], v[136:139], a[36:39], v[96:99]
    ds_read_b64_tr_b16 v[178:179], v30 offset:33472
    v_mfma_f32_16x16x32_bf16 v[60:63], v[140:143], a[32:35], v[60:63]
    ds_read_b64_tr_b16 v[180:181], v31 offset:30912
    v_mfma_f32_16x16x32_bf16 v[100:103], v[140:143], a[36:39], v[100:103]
    ds_read_b64_tr_b16 v[182:183], v31 offset:33472
    buffer_load_dwordx4 a[92:95], v19, s[40:43], s22 offen offset:3072 sc1
    s_waitcnt lgkmcnt(15)
    v_mfma_f32_16x16x32_bf16 v[64:67], v[144:147], a[32:35], v[64:67]
    ds_read_b64_tr_b16 v[184:185], v30 offset:30976
    v_mfma_f32_16x16x32_bf16 v[104:107], v[144:147], a[36:39], v[104:107]
    ds_read_b64_tr_b16 v[186:187], v30 offset:33536
    v_mfma_f32_16x16x32_bf16 v[68:71], v[148:151], a[32:35], v[68:71]
    ds_read_b64_tr_b16 v[188:189], v31 offset:30976
    v_mfma_f32_16x16x32_bf16 v[108:111], v[148:151], a[36:39], v[108:111]
    ds_read_b64_tr_b16 v[190:191], v31 offset:33536
    s_waitcnt lgkmcnt(15)
    v_mfma_f32_16x16x32_bf16 v[32:35], v[152:155], a[40:43], v[32:35]
    ds_read_b64_tr_b16 v[112:113], v26 offset:0
    v_mfma_f32_16x16x32_bf16 v[72:75], v[152:155], a[44:47], v[72:75]
    ds_read_b64_tr_b16 v[114:115], v26 offset:2560
    s_add_u32 m0, s21, 61440
    s_add_u32 s23, s20, 1474560
    buffer_load_dwordx4 v20, s[16:19], s23 offen lds
    v_mfma_f32_16x16x32_bf16 v[36:39], v[156:159], a[40:43], v[36:39]
    ds_read_b64_tr_b16 v[116:117], v27 offset:0
    v_mfma_f32_16x16x32_bf16 v[76:79], v[156:159], a[44:47], v[76:79]
    ds_read_b64_tr_b16 v[118:119], v27 offset:2560
    s_waitcnt lgkmcnt(15)
    v_mfma_f32_16x16x32_bf16 v[40:43], v[160:163], a[40:43], v[40:43]
    ds_read_b64_tr_b16 v[120:121], v26 offset:64
    buffer_load_dwordx4 v21, s[16:19], s23 offen offset:1024 lds
    v_mfma_f32_16x16x32_bf16 v[80:83], v[160:163], a[44:47], v[80:83]
    ds_read_b64_tr_b16 v[122:123], v26 offset:2624
    v_mfma_f32_16x16x32_bf16 v[44:47], v[164:167], a[40:43], v[44:47]
    ds_read_b64_tr_b16 v[124:125], v27 offset:64
    v_mfma_f32_16x16x32_bf16 v[84:87], v[164:167], a[44:47], v[84:87]
    ds_read_b64_tr_b16 v[126:127], v27 offset:2624
    s_waitcnt lgkmcnt(15)
    v_mfma_f32_16x16x32_bf16 v[48:51], v[168:171], a[40:43], v[48:51]
    ds_read_b64_tr_b16 v[128:129], v26 offset:128
    buffer_load_dwordx4 v22, s[16:19], s23 offen offset:2048 lds
    v_mfma_f32_16x16x32_bf16 v[88:91], v[168:171], a[44:47], v[88:91]
    ds_read_b64_tr_b16 v[130:131], v26 offset:2688
    v_mfma_f32_16x16x32_bf16 v[52:55], v[172:175], a[40:43], v[52:55]
    ds_read_b64_tr_b16 v[132:133], v27 offset:128
    v_mfma_f32_16x16x32_bf16 v[92:95], v[172:175], a[44:47], v[92:95]
    ds_read_b64_tr_b16 v[134:135], v27 offset:2688
    s_waitcnt lgkmcnt(15)
    v_mfma_f32_16x16x32_bf16 v[56:59], v[176:179], a[40:43], v[56:59]
    ds_read_b64_tr_b16 v[136:137], v26 offset:192
    buffer_load_dwordx4 v23, s[16:19], s23 offen offset:3072 lds
    v_mfma_f32_16x16x32_bf16 v[96:99], v[176:179], a[44:47], v[96:99]
    ds_read_b64_tr_b16 v[138:139], v26 offset:2752
    v_mfma_f32_16x16x32_bf16 v[60:63], v[180:183], a[40:43], v[60:63]
    ds_read_b64_tr_b16 v[140:141], v27 offset:192
    v_mfma_f32_16x16x32_bf16 v[100:103], v[180:183], a[44:47], v[100:103]
    ds_read_b64_tr_b16 v[142:143], v27 offset:2752
    s_waitcnt lgkmcnt(15)
    v_mfma_f32_16x16x32_bf16 v[64:67], v[184:187], a[40:43], v[64:67]
    ds_read_b64_tr_b16 v[144:145], v26 offset:256
    s_add_u32 m0, s21, 65536
    s_nop 0
    buffer_load_dwordx4 v24, s[16:19], s23 offen lds
    v_mfma_f32_16x16x32_bf16 v[104:107], v[184:187], a[44:47], v[104:107]
    ds_read_b64_tr_b16 v[146:147], v26 offset:2816
    v_mfma_f32_16x16x32_bf16 v[68:71], v[188:191], a[40:43], v[68:71]
    ds_read_b64_tr_b16 v[148:149], v27 offset:256
    v_mfma_f32_16x16x32_bf16 v[108:111], v[188:191], a[44:47], v[108:111]
    ds_read_b64_tr_b16 v[150:151], v27 offset:2816
    s_waitcnt vmcnt(23)
    s_waitcnt lgkmcnt(15)
    v_mfma_f32_16x16x32_bf16 v[32:35], v[112:115], a[48:51], v[32:35]
    ds_read_b64_tr_b16 v[152:153], v26 offset:10240
    v_mfma_f32_16x16x32_bf16 v[72:75], v[112:115], a[52:55], v[72:75]
    ds_read_b64_tr_b16 v[154:155], v26 offset:12800
    s_mov_b32 s22, 36864
    buffer_load_dwordx4 a[96:99], v25, s[40:43], s22 offen offset:0 sc1
    v_mfma_f32_16x16x32_bf16 v[36:39], v[116:119], a[48:51], v[36:39]
    ds_read_b64_tr_b16 v[156:157], v27 offset:10240
    v_mfma_f32_16x16x32_bf16 v[76:79], v[116:119], a[52:55], v[76:79]
    ds_read_b64_tr_b16 v[158:159], v27 offset:12800
    s_waitcnt lgkmcnt(15)
    v_mfma_f32_16x16x32_bf16 v[40:43], v[120:123], a[48:51], v[40:43]
    ds_read_b64_tr_b16 v[160:161], v26 offset:10304
    v_mfma_f32_16x16x32_bf16 v[80:83], v[120:123], a[52:55], v[80:83]
    ds_read_b64_tr_b16 v[162:163], v26 offset:12864
    buffer_load_dwordx4 a[100:103], v19, s[40:43], s22 offen offset:0 sc1
    v_mfma_f32_16x16x32_bf16 v[44:47], v[124:127], a[48:51], v[44:47]
    ds_read_b64_tr_b16 v[164:165], v27 offset:10304
    v_mfma_f32_16x16x32_bf16 v[84:87], v[124:127], a[52:55], v[84:87]
    ds_read_b64_tr_b16 v[166:167], v27 offset:12864
    s_waitcnt lgkmcnt(15)
    v_mfma_f32_16x16x32_bf16 v[48:51], v[128:131], a[48:51], v[48:51]
    ds_read_b64_tr_b16 v[168:169], v26 offset:10368
    v_mfma_f32_16x16x32_bf16 v[88:91], v[128:131], a[52:55], v[88:91]
    ds_read_b64_tr_b16 v[170:171], v26 offset:12928
    v_mfma_f32_16x16x32_bf16 v[52:55], v[132:135], a[48:51], v[52:55]
    ds_read_b64_tr_b16 v[172:173], v27 offset:10368
    buffer_load_dwordx4 a[104:107], v25, s[40:43], s22 offen offset:1024 sc1
    v_mfma_f32_16x16x32_bf16 v[92:95], v[132:135], a[52:55], v[92:95]
    ds_read_b64_tr_b16 v[174:175], v27 offset:12928
    s_waitcnt lgkmcnt(15)
    v_mfma_f32_16x16x32_bf16 v[56:59], v[136:139], a[48:51], v[56:59]
    ds_read_b64_tr_b16 v[176:177], v26 offset:10432
    v_mfma_f32_16x16x32_bf16 v[96:99], v[136:139], a[52:55], v[96:99]
    ds_read_b64_tr_b16 v[178:179], v26 offset:12992
    v_mfma_f32_16x16x32_bf16 v[60:63], v[140:143], a[48:51], v[60:63]
    ds_read_b64_tr_b16 v[180:181], v27 offset:10432
    v_mfma_f32_16x16x32_bf16 v[100:103], v[140:143], a[52:55], v[100:103]
    ds_read_b64_tr_b16 v[182:183], v27 offset:12992
    buffer_load_dwordx4 a[108:111], v19, s[40:43], s22 offen offset:1024 sc1
    s_waitcnt lgkmcnt(15)
    v_mfma_f32_16x16x32_bf16 v[64:67], v[144:147], a[48:51], v[64:67]
    ds_read_b64_tr_b16 v[184:185], v26 offset:10496
    v_mfma_f32_16x16x32_bf16 v[104:107], v[144:147], a[52:55], v[104:107]
    ds_read_b64_tr_b16 v[186:187], v26 offset:13056
    v_mfma_f32_16x16x32_bf16 v[68:71], v[148:151], a[48:51], v[68:71]
    ds_read_b64_tr_b16 v[188:189], v27 offset:10496
    v_mfma_f32_16x16x32_bf16 v[108:111], v[148:151], a[52:55], v[108:111]
    ds_read_b64_tr_b16 v[190:191], v27 offset:13056
    s_waitcnt vmcnt(13)
    s_barrier
    s_waitcnt lgkmcnt(15)
    v_mfma_f32_16x16x32_bf16 v[32:35], v[152:155], a[56:59], v[32:35]
    ds_read_b64_tr_b16 v[112:113], v26 offset:20480
    v_mfma_f32_16x16x32_bf16 v[72:75], v[152:155], a[60:63], v[72:75]
    ds_read_b64_tr_b16 v[114:115], v26 offset:23040
    s_add_u32 m0, s21, 81920
    s_add_u32 s23, s20, 1556480
    buffer_load_dwordx4 v20, s[16:19], s23 offen lds
    v_mfma_f32_16x16x32_bf16 v[36:39], v[156:159], a[56:59], v[36:39]
    ds_read_b64_tr_b16 v[116:117], v27 offset:20480
    v_mfma_f32_16x16x32_bf16 v[76:79], v[156:159], a[60:63], v[76:79]
    ds_read_b64_tr_b16 v[118:119], v27 offset:23040
    s_waitcnt lgkmcnt(15)
    v_mfma_f32_16x16x32_bf16 v[40:43], v[160:163], a[56:59], v[40:43]
    ds_read_b64_tr_b16 v[120:121], v26 offset:20544
    buffer_load_dwordx4 v21, s[16:19], s23 offen offset:1024 lds
    v_mfma_f32_16x16x32_bf16 v[80:83], v[160:163], a[60:63], v[80:83]
    ds_read_b64_tr_b16 v[122:123], v26 offset:23104
    v_mfma_f32_16x16x32_bf16 v[44:47], v[164:167], a[56:59], v[44:47]
    ds_read_b64_tr_b16 v[124:125], v27 offset:20544
    v_mfma_f32_16x16x32_bf16 v[84:87], v[164:167], a[60:63], v[84:87]
    ds_read_b64_tr_b16 v[126:127], v27 offset:23104
    s_waitcnt lgkmcnt(15)
    v_mfma_f32_16x16x32_bf16 v[48:51], v[168:171], a[56:59], v[48:51]
    ds_read_b64_tr_b16 v[128:129], v26 offset:20608
    buffer_load_dwordx4 v22, s[16:19], s23 offen offset:2048 lds
    v_mfma_f32_16x16x32_bf16 v[88:91], v[168:171], a[60:63], v[88:91]
    ds_read_b64_tr_b16 v[130:131], v26 offset:23168
    v_mfma_f32_16x16x32_bf16 v[52:55], v[172:175], a[56:59], v[52:55]
    ds_read_b64_tr_b16 v[132:133], v27 offset:20608
    v_mfma_f32_16x16x32_bf16 v[92:95], v[172:175], a[60:63], v[92:95]
    ds_read_b64_tr_b16 v[134:135], v27 offset:23168
    s_waitcnt lgkmcnt(15)
    v_mfma_f32_16x16x32_bf16 v[56:59], v[176:179], a[56:59], v[56:59]
    ds_read_b64_tr_b16 v[136:137], v26 offset:20672
    buffer_load_dwordx4 v23, s[16:19], s23 offen offset:3072 lds
    v_mfma_f32_16x16x32_bf16 v[96:99], v[176:179], a[60:63], v[96:99]
    ds_read_b64_tr_b16 v[138:139], v26 offset:23232
    v_mfma_f32_16x16x32_bf16 v[60:63], v[180:183], a[56:59], v[60:63]
    ds_read_b64_tr_b16 v[140:141], v27 offset:20672
    v_mfma_f32_16x16x32_bf16 v[100:103], v[180:183], a[60:63], v[100:103]
    ds_read_b64_tr_b16 v[142:143], v27 offset:23232
    s_waitcnt lgkmcnt(15)
    v_mfma_f32_16x16x32_bf16 v[64:67], v[184:187], a[56:59], v[64:67]
    ds_read_b64_tr_b16 v[144:145], v26 offset:20736
    s_add_u32 m0, s21, 86016
    s_nop 0
    buffer_load_dwordx4 v24, s[16:19], s23 offen lds
    v_mfma_f32_16x16x32_bf16 v[104:107], v[184:187], a[60:63], v[104:107]
    ds_read_b64_tr_b16 v[146:147], v26 offset:23296
    v_mfma_f32_16x16x32_bf16 v[68:71], v[188:191], a[56:59], v[68:71]
    ds_read_b64_tr_b16 v[148:149], v27 offset:20736
    v_mfma_f32_16x16x32_bf16 v[108:111], v[188:191], a[60:63], v[108:111]
    ds_read_b64_tr_b16 v[150:151], v27 offset:23296
    s_waitcnt lgkmcnt(15)
    v_mfma_f32_16x16x32_bf16 v[32:35], v[112:115], a[64:67], v[32:35]
    ds_read_b64_tr_b16 v[152:153], v26 offset:30720
    v_mfma_f32_16x16x32_bf16 v[72:75], v[112:115], a[68:71], v[72:75]
    ds_read_b64_tr_b16 v[154:155], v26 offset:33280
    s_mov_b32 s22, 36864
    buffer_load_dwordx4 a[112:115], v25, s[40:43], s22 offen offset:2048 sc1
    v_mfma_f32_16x16x32_bf16 v[36:39], v[116:119], a[64:67], v[36:39]
    ds_read_b64_tr_b16 v[156:157], v27 offset:30720
    v_mfma_f32_16x16x32_bf16 v[76:79], v[116:119], a[68:71], v[76:79]
    ds_read_b64_tr_b16 v[158:159], v27 offset:33280
    s_waitcnt lgkmcnt(15)
    v_mfma_f32_16x16x32_bf16 v[40:43], v[120:123], a[64:67], v[40:43]
    ds_read_b64_tr_b16 v[160:161], v26 offset:30784
    v_mfma_f32_16x16x32_bf16 v[80:83], v[120:123], a[68:71], v[80:83]
    ds_read_b64_tr_b16 v[162:163], v26 offset:33344
    buffer_load_dwordx4 a[116:119], v19, s[40:43], s22 offen offset:2048 sc1
    v_mfma_f32_16x16x32_bf16 v[44:47], v[124:127], a[64:67], v[44:47]
    ds_read_b64_tr_b16 v[164:165], v27 offset:30784
    v_mfma_f32_16x16x32_bf16 v[84:87], v[124:127], a[68:71], v[84:87]
    ds_read_b64_tr_b16 v[166:167], v27 offset:33344
    s_waitcnt lgkmcnt(15)
    v_mfma_f32_16x16x32_bf16 v[48:51], v[128:131], a[64:67], v[48:51]
    ds_read_b64_tr_b16 v[168:169], v26 offset:30848
    v_mfma_f32_16x16x32_bf16 v[88:91], v[128:131], a[68:71], v[88:91]
    ds_read_b64_tr_b16 v[170:171], v26 offset:33408
    v_mfma_f32_16x16x32_bf16 v[52:55], v[132:135], a[64:67], v[52:55]
    ds_read_b64_tr_b16 v[172:173], v27 offset:30848
    buffer_load_dwordx4 a[120:123], v25, s[40:43], s22 offen offset:3072 sc1
    v_mfma_f32_16x16x32_bf16 v[92:95], v[132:135], a[68:71], v[92:95]
    ds_read_b64_tr_b16 v[174:175], v27 offset:33408
    s_waitcnt lgkmcnt(15)
    v_mfma_f32_16x16x32_bf16 v[56:59], v[136:139], a[64:67], v[56:59]
    ds_read_b64_tr_b16 v[176:177], v26 offset:30912
    v_mfma_f32_16x16x32_bf16 v[96:99], v[136:139], a[68:71], v[96:99]
    ds_read_b64_tr_b16 v[178:179], v26 offset:33472
    v_mfma_f32_16x16x32_bf16 v[60:63], v[140:143], a[64:67], v[60:63]
    ds_read_b64_tr_b16 v[180:181], v27 offset:30912
    v_mfma_f32_16x16x32_bf16 v[100:103], v[140:143], a[68:71], v[100:103]
    ds_read_b64_tr_b16 v[182:183], v27 offset:33472
    buffer_load_dwordx4 a[124:127], v19, s[40:43], s22 offen offset:3072 sc1
    s_waitcnt lgkmcnt(15)
    v_mfma_f32_16x16x32_bf16 v[64:67], v[144:147], a[64:67], v[64:67]
    ds_read_b64_tr_b16 v[184:185], v26 offset:30976
    v_mfma_f32_16x16x32_bf16 v[104:107], v[144:147], a[68:71], v[104:107]
    ds_read_b64_tr_b16 v[186:187], v26 offset:33536
    v_mfma_f32_16x16x32_bf16 v[68:71], v[148:151], a[64:67], v[68:71]
    ds_read_b64_tr_b16 v[188:189], v27 offset:30976
    v_mfma_f32_16x16x32_bf16 v[108:111], v[148:151], a[68:71], v[108:111]
    ds_read_b64_tr_b16 v[190:191], v27 offset:33536
    s_waitcnt lgkmcnt(15)
    v_mfma_f32_16x16x32_bf16 v[32:35], v[152:155], a[72:75], v[32:35]
    ds_read_b64_tr_b16 v[112:113], v26 offset:40960
    v_mfma_f32_16x16x32_bf16 v[72:75], v[152:155], a[76:79], v[72:75]
    ds_read_b64_tr_b16 v[114:115], v26 offset:43520
    s_add_u32 m0, s21, 102400
    s_add_u32 s23, s20, 2621440
    buffer_load_dwordx4 v20, s[16:19], s23 offen lds
    v_mfma_f32_16x16x32_bf16 v[36:39], v[156:159], a[72:75], v[36:39]
    ds_read_b64_tr_b16 v[116:117], v27 offset:40960
    v_mfma_f32_16x16x32_bf16 v[76:79], v[156:159], a[76:79], v[76:79]
    ds_read_b64_tr_b16 v[118:119], v27 offset:43520
    s_waitcnt lgkmcnt(15)
    v_mfma_f32_16x16x32_bf16 v[40:43], v[160:163], a[72:75], v[40:43]
    ds_read_b64_tr_b16 v[120:121], v26 offset:41024
    buffer_load_dwordx4 v21, s[16:19], s23 offen offset:1024 lds
    v_mfma_f32_16x16x32_bf16 v[80:83], v[160:163], a[76:79], v[80:83]
    ds_read_b64_tr_b16 v[122:123], v26 offset:43584
    v_mfma_f32_16x16x32_bf16 v[44:47], v[164:167], a[72:75], v[44:47]
    ds_read_b64_tr_b16 v[124:125], v27 offset:41024
    v_mfma_f32_16x16x32_bf16 v[84:87], v[164:167], a[76:79], v[84:87]
    ds_read_b64_tr_b16 v[126:127], v27 offset:43584
    s_waitcnt lgkmcnt(15)
    v_mfma_f32_16x16x32_bf16 v[48:51], v[168:171], a[72:75], v[48:51]
    ds_read_b64_tr_b16 v[128:129], v26 offset:41088
    buffer_load_dwordx4 v22, s[16:19], s23 offen offset:2048 lds
    v_mfma_f32_16x16x32_bf16 v[88:91], v[168:171], a[76:79], v[88:91]
    ds_read_b64_tr_b16 v[130:131], v26 offset:43648
    v_mfma_f32_16x16x32_bf16 v[52:55], v[172:175], a[72:75], v[52:55]
    ds_read_b64_tr_b16 v[132:133], v27 offset:41088
    v_mfma_f32_16x16x32_bf16 v[92:95], v[172:175], a[76:79], v[92:95]
    ds_read_b64_tr_b16 v[134:135], v27 offset:43648
    s_waitcnt lgkmcnt(15)
    v_mfma_f32_16x16x32_bf16 v[56:59], v[176:179], a[72:75], v[56:59]
    ds_read_b64_tr_b16 v[136:137], v26 offset:41152
    buffer_load_dwordx4 v23, s[16:19], s23 offen offset:3072 lds
    v_mfma_f32_16x16x32_bf16 v[96:99], v[176:179], a[76:79], v[96:99]
    ds_read_b64_tr_b16 v[138:139], v26 offset:43712
    v_mfma_f32_16x16x32_bf16 v[60:63], v[180:183], a[72:75], v[60:63]
    ds_read_b64_tr_b16 v[140:141], v27 offset:41152
    v_mfma_f32_16x16x32_bf16 v[100:103], v[180:183], a[76:79], v[100:103]
    ds_read_b64_tr_b16 v[142:143], v27 offset:43712
    s_waitcnt lgkmcnt(15)
    v_mfma_f32_16x16x32_bf16 v[64:67], v[184:187], a[72:75], v[64:67]
    ds_read_b64_tr_b16 v[144:145], v26 offset:41216
    s_add_u32 m0, s21, 106496
    s_nop 0
    buffer_load_dwordx4 v24, s[16:19], s23 offen lds
    v_mfma_f32_16x16x32_bf16 v[104:107], v[184:187], a[76:79], v[104:107]
    ds_read_b64_tr_b16 v[146:147], v26 offset:43776
    v_mfma_f32_16x16x32_bf16 v[68:71], v[188:191], a[72:75], v[68:71]
    ds_read_b64_tr_b16 v[148:149], v27 offset:41216
    v_mfma_f32_16x16x32_bf16 v[108:111], v[188:191], a[76:79], v[108:111]
    ds_read_b64_tr_b16 v[150:151], v27 offset:43776
    s_waitcnt vmcnt(23)
    s_waitcnt lgkmcnt(15)
    v_mfma_f32_16x16x32_bf16 v[32:35], v[112:115], a[80:83], v[32:35]
    ds_read_b64_tr_b16 v[152:153], v26 offset:51200
    v_mfma_f32_16x16x32_bf16 v[72:75], v[112:115], a[84:87], v[72:75]
    ds_read_b64_tr_b16 v[154:155], v26 offset:53760
    s_mov_b32 s22, 65536
    buffer_load_dwordx4 a[0:3], v25, s[40:43], s22 offen offset:0 sc1
    v_mfma_f32_16x16x32_bf16 v[36:39], v[116:119], a[80:83], v[36:39]
    ds_read_b64_tr_b16 v[156:157], v27 offset:51200
    v_mfma_f32_16x16x32_bf16 v[76:79], v[116:119], a[84:87], v[76:79]
    ds_read_b64_tr_b16 v[158:159], v27 offset:53760
    s_waitcnt lgkmcnt(15)
    v_mfma_f32_16x16x32_bf16 v[40:43], v[120:123], a[80:83], v[40:43]
    ds_read_b64_tr_b16 v[160:161], v26 offset:51264
    v_mfma_f32_16x16x32_bf16 v[80:83], v[120:123], a[84:87], v[80:83]
    ds_read_b64_tr_b16 v[162:163], v26 offset:53824
    buffer_load_dwordx4 a[4:7], v19, s[40:43], s22 offen offset:0 sc1
    v_mfma_f32_16x16x32_bf16 v[44:47], v[124:127], a[80:83], v[44:47]
    ds_read_b64_tr_b16 v[164:165], v27 offset:51264
    v_mfma_f32_16x16x32_bf16 v[84:87], v[124:127], a[84:87], v[84:87]
    ds_read_b64_tr_b16 v[166:167], v27 offset:53824
    s_waitcnt lgkmcnt(15)
    v_mfma_f32_16x16x32_bf16 v[48:51], v[128:131], a[80:83], v[48:51]
    ds_read_b64_tr_b16 v[168:169], v26 offset:51328
    v_mfma_f32_16x16x32_bf16 v[88:91], v[128:131], a[84:87], v[88:91]
    ds_read_b64_tr_b16 v[170:171], v26 offset:53888
    v_mfma_f32_16x16x32_bf16 v[52:55], v[132:135], a[80:83], v[52:55]
    ds_read_b64_tr_b16 v[172:173], v27 offset:51328
    buffer_load_dwordx4 a[8:11], v25, s[40:43], s22 offen offset:1024 sc1
    v_mfma_f32_16x16x32_bf16 v[92:95], v[132:135], a[84:87], v[92:95]
    ds_read_b64_tr_b16 v[174:175], v27 offset:53888
    s_waitcnt lgkmcnt(15)
    v_mfma_f32_16x16x32_bf16 v[56:59], v[136:139], a[80:83], v[56:59]
    ds_read_b64_tr_b16 v[176:177], v26 offset:51392
    v_mfma_f32_16x16x32_bf16 v[96:99], v[136:139], a[84:87], v[96:99]
    ds_read_b64_tr_b16 v[178:179], v26 offset:53952
    v_mfma_f32_16x16x32_bf16 v[60:63], v[140:143], a[80:83], v[60:63]
    ds_read_b64_tr_b16 v[180:181], v27 offset:51392
    v_mfma_f32_16x16x32_bf16 v[100:103], v[140:143], a[84:87], v[100:103]
    ds_read_b64_tr_b16 v[182:183], v27 offset:53952
    buffer_load_dwordx4 a[12:15], v19, s[40:43], s22 offen offset:1024 sc1
    s_waitcnt lgkmcnt(15)
    v_mfma_f32_16x16x32_bf16 v[64:67], v[144:147], a[80:83], v[64:67]
    ds_read_b64_tr_b16 v[184:185], v26 offset:51456
    v_mfma_f32_16x16x32_bf16 v[104:107], v[144:147], a[84:87], v[104:107]
    ds_read_b64_tr_b16 v[186:187], v26 offset:54016
    v_mfma_f32_16x16x32_bf16 v[68:71], v[148:151], a[80:83], v[68:71]
    ds_read_b64_tr_b16 v[188:189], v27 offset:51456
    v_mfma_f32_16x16x32_bf16 v[108:111], v[148:151], a[84:87], v[108:111]
    ds_read_b64_tr_b16 v[190:191], v27 offset:54016
    s_waitcnt vmcnt(13)
    s_barrier
    s_waitcnt lgkmcnt(15)
    v_mfma_f32_16x16x32_bf16 v[32:35], v[152:155], a[88:91], v[32:35]
    ds_read_b64_tr_b16 v[112:113], v28 offset:0
    v_mfma_f32_16x16x32_bf16 v[72:75], v[152:155], a[92:95], v[72:75]
    ds_read_b64_tr_b16 v[114:115], v28 offset:2560
    s_add_u32 m0, s21, 122880
    s_add_u32 s23, s20, 2703360
    buffer_load_dwordx4 v20, s[16:19], s23 offen lds
    v_mfma_f32_16x16x32_bf16 v[36:39], v[156:159], a[88:91], v[36:39]
    ds_read_b64_tr_b16 v[116:117], v29 offset:0
    v_mfma_f32_16x16x32_bf16 v[76:79], v[156:159], a[92:95], v[76:79]
    ds_read_b64_tr_b16 v[118:119], v29 offset:2560
    s_waitcnt lgkmcnt(15)
    v_mfma_f32_16x16x32_bf16 v[40:43], v[160:163], a[88:91], v[40:43]
    ds_read_b64_tr_b16 v[120:121], v28 offset:64
    buffer_load_dwordx4 v21, s[16:19], s23 offen offset:1024 lds
    v_mfma_f32_16x16x32_bf16 v[80:83], v[160:163], a[92:95], v[80:83]
    ds_read_b64_tr_b16 v[122:123], v28 offset:2624
    v_mfma_f32_16x16x32_bf16 v[44:47], v[164:167], a[88:91], v[44:47]
    ds_read_b64_tr_b16 v[124:125], v29 offset:64
    v_mfma_f32_16x16x32_bf16 v[84:87], v[164:167], a[92:95], v[84:87]
    ds_read_b64_tr_b16 v[126:127], v29 offset:2624
    s_waitcnt lgkmcnt(15)
    v_mfma_f32_16x16x32_bf16 v[48:51], v[168:171], a[88:91], v[48:51]
    ds_read_b64_tr_b16 v[128:129], v28 offset:128
    buffer_load_dwordx4 v22, s[16:19], s23 offen offset:2048 lds
    v_mfma_f32_16x16x32_bf16 v[88:91], v[168:171], a[92:95], v[88:91]
    ds_read_b64_tr_b16 v[130:131], v28 offset:2688
    v_mfma_f32_16x16x32_bf16 v[52:55], v[172:175], a[88:91], v[52:55]
    ds_read_b64_tr_b16 v[132:133], v29 offset:128
    v_mfma_f32_16x16x32_bf16 v[92:95], v[172:175], a[92:95], v[92:95]
    ds_read_b64_tr_b16 v[134:135], v29 offset:2688
    s_waitcnt lgkmcnt(15)
    v_mfma_f32_16x16x32_bf16 v[56:59], v[176:179], a[88:91], v[56:59]
    ds_read_b64_tr_b16 v[136:137], v28 offset:192
    buffer_load_dwordx4 v23, s[16:19], s23 offen offset:3072 lds
    v_mfma_f32_16x16x32_bf16 v[96:99], v[176:179], a[92:95], v[96:99]
    ds_read_b64_tr_b16 v[138:139], v28 offset:2752
    v_mfma_f32_16x16x32_bf16 v[60:63], v[180:183], a[88:91], v[60:63]
    ds_read_b64_tr_b16 v[140:141], v29 offset:192
    v_mfma_f32_16x16x32_bf16 v[100:103], v[180:183], a[92:95], v[100:103]
    ds_read_b64_tr_b16 v[142:143], v29 offset:2752
    s_waitcnt lgkmcnt(15)
    v_mfma_f32_16x16x32_bf16 v[64:67], v[184:187], a[88:91], v[64:67]
    ds_read_b64_tr_b16 v[144:145], v28 offset:256
    s_add_u32 m0, s21, 126976
    s_nop 0
    buffer_load_dwordx4 v24, s[16:19], s23 offen lds
    v_mfma_f32_16x16x32_bf16 v[104:107], v[184:187], a[92:95], v[104:107]
    ds_read_b64_tr_b16 v[146:147], v28 offset:2816
    v_mfma_f32_16x16x32_bf16 v[68:71], v[188:191], a[88:91], v[68:71]
    ds_read_b64_tr_b16 v[148:149], v29 offset:256
    v_mfma_f32_16x16x32_bf16 v[108:111], v[188:191], a[92:95], v[108:111]
    ds_read_b64_tr_b16 v[150:151], v29 offset:2816
    s_waitcnt lgkmcnt(15)
    v_mfma_f32_16x16x32_bf16 v[32:35], v[112:115], a[96:99], v[32:35]
    ds_read_b64_tr_b16 v[152:153], v28 offset:10240
    v_mfma_f32_16x16x32_bf16 v[72:75], v[112:115], a[100:103], v[72:75]
    ds_read_b64_tr_b16 v[154:155], v28 offset:12800
    s_mov_b32 s22, 65536
    buffer_load_dwordx4 a[16:19], v25, s[40:43], s22 offen offset:2048 sc1
    v_mfma_f32_16x16x32_bf16 v[36:39], v[116:119], a[96:99], v[36:39]
    ds_read_b64_tr_b16 v[156:157], v29 offset:10240
    v_mfma_f32_16x16x32_bf16 v[76:79], v[116:119], a[100:103], v[76:79]
    ds_read_b64_tr_b16 v[158:159], v29 offset:12800
    s_waitcnt lgkmcnt(15)
    v_mfma_f32_16x16x32_bf16 v[40:43], v[120:123], a[96:99], v[40:43]
    ds_read_b64_tr_b16 v[160:161], v28 offset:10304
    v_mfma_f32_16x16x32_bf16 v[80:83], v[120:123], a[100:103], v[80:83]
    ds_read_b64_tr_b16 v[162:163], v28 offset:12864
    buffer_load_dwordx4 a[20:23], v19, s[40:43], s22 offen offset:2048 sc1
    v_mfma_f32_16x16x32_bf16 v[44:47], v[124:127], a[96:99], v[44:47]
    ds_read_b64_tr_b16 v[164:165], v29 offset:10304
    v_mfma_f32_16x16x32_bf16 v[84:87], v[124:127], a[100:103], v[84:87]
    ds_read_b64_tr_b16 v[166:167], v29 offset:12864
    s_waitcnt lgkmcnt(15)
    v_mfma_f32_16x16x32_bf16 v[48:51], v[128:131], a[96:99], v[48:51]
    ds_read_b64_tr_b16 v[168:169], v28 offset:10368
    v_mfma_f32_16x16x32_bf16 v[88:91], v[128:131], a[100:103], v[88:91]
    ds_read_b64_tr_b16 v[170:171], v28 offset:12928
    v_mfma_f32_16x16x32_bf16 v[52:55], v[132:135], a[96:99], v[52:55]
    ds_read_b64_tr_b16 v[172:173], v29 offset:10368
    buffer_load_dwordx4 a[24:27], v25, s[40:43], s22 offen offset:3072 sc1
    v_mfma_f32_16x16x32_bf16 v[92:95], v[132:135], a[100:103], v[92:95]
    ds_read_b64_tr_b16 v[174:175], v29 offset:12928
    s_waitcnt lgkmcnt(15)
    v_mfma_f32_16x16x32_bf16 v[56:59], v[136:139], a[96:99], v[56:59]
    ds_read_b64_tr_b16 v[176:177], v28 offset:10432
    v_mfma_f32_16x16x32_bf16 v[96:99], v[136:139], a[100:103], v[96:99]
    ds_read_b64_tr_b16 v[178:179], v28 offset:12992
    v_mfma_f32_16x16x32_bf16 v[60:63], v[140:143], a[96:99], v[60:63]
    ds_read_b64_tr_b16 v[180:181], v29 offset:10432
    v_mfma_f32_16x16x32_bf16 v[100:103], v[140:143], a[100:103], v[100:103]
    ds_read_b64_tr_b16 v[182:183], v29 offset:12992
    buffer_load_dwordx4 a[28:31], v19, s[40:43], s22 offen offset:3072 sc1
    s_waitcnt lgkmcnt(15)
    v_mfma_f32_16x16x32_bf16 v[64:67], v[144:147], a[96:99], v[64:67]
    ds_read_b64_tr_b16 v[184:185], v28 offset:10496
    v_mfma_f32_16x16x32_bf16 v[104:107], v[144:147], a[100:103], v[104:107]
    ds_read_b64_tr_b16 v[186:187], v28 offset:13056
    v_mfma_f32_16x16x32_bf16 v[68:71], v[148:151], a[96:99], v[68:71]
    ds_read_b64_tr_b16 v[188:189], v29 offset:10496
    v_mfma_f32_16x16x32_bf16 v[108:111], v[148:151], a[100:103], v[108:111]
    ds_read_b64_tr_b16 v[190:191], v29 offset:13056
    s_waitcnt lgkmcnt(15)
    v_mfma_f32_16x16x32_bf16 v[32:35], v[152:155], a[104:107], v[32:35]
    ds_read_b64_tr_b16 v[112:113], v28 offset:20480
    v_mfma_f32_16x16x32_bf16 v[72:75], v[152:155], a[108:111], v[72:75]
    ds_read_b64_tr_b16 v[114:115], v28 offset:23040
    s_add_u32 m0, s21, 143360
    s_add_u32 s23, s20, 2785280
    buffer_load_dwordx4 v20, s[16:19], s23 offen lds
    v_mfma_f32_16x16x32_bf16 v[36:39], v[156:159], a[104:107], v[36:39]
    ds_read_b64_tr_b16 v[116:117], v29 offset:20480
    v_mfma_f32_16x16x32_bf16 v[76:79], v[156:159], a[108:111], v[76:79]
    ds_read_b64_tr_b16 v[118:119], v29 offset:23040
    s_waitcnt lgkmcnt(15)
    v_mfma_f32_16x16x32_bf16 v[40:43], v[160:163], a[104:107], v[40:43]
    ds_read_b64_tr_b16 v[120:121], v28 offset:20544
    buffer_load_dwordx4 v21, s[16:19], s23 offen offset:1024 lds
    v_mfma_f32_16x16x32_bf16 v[80:83], v[160:163], a[108:111], v[80:83]
    ds_read_b64_tr_b16 v[122:123], v28 offset:23104
    v_mfma_f32_16x16x32_bf16 v[44:47], v[164:167], a[104:107], v[44:47]
    ds_read_b64_tr_b16 v[124:125], v29 offset:20544
    v_mfma_f32_16x16x32_bf16 v[84:87], v[164:167], a[108:111], v[84:87]
    ds_read_b64_tr_b16 v[126:127], v29 offset:23104
    s_waitcnt lgkmcnt(15)
    v_mfma_f32_16x16x32_bf16 v[48:51], v[168:171], a[104:107], v[48:51]
    ds_read_b64_tr_b16 v[128:129], v28 offset:20608
    buffer_load_dwordx4 v22, s[16:19], s23 offen offset:2048 lds
    v_mfma_f32_16x16x32_bf16 v[88:91], v[168:171], a[108:111], v[88:91]
    ds_read_b64_tr_b16 v[130:131], v28 offset:23168
    v_mfma_f32_16x16x32_bf16 v[52:55], v[172:175], a[104:107], v[52:55]
    ds_read_b64_tr_b16 v[132:133], v29 offset:20608
    v_mfma_f32_16x16x32_bf16 v[92:95], v[172:175], a[108:111], v[92:95]
    ds_read_b64_tr_b16 v[134:135], v29 offset:23168
    s_waitcnt lgkmcnt(15)
    v_mfma_f32_16x16x32_bf16 v[56:59], v[176:179], a[104:107], v[56:59]
    ds_read_b64_tr_b16 v[136:137], v28 offset:20672
    buffer_load_dwordx4 v23, s[16:19], s23 offen offset:3072 lds
    v_mfma_f32_16x16x32_bf16 v[96:99], v[176:179], a[108:111], v[96:99]
    ds_read_b64_tr_b16 v[138:139], v28 offset:23232
    v_mfma_f32_16x16x32_bf16 v[60:63], v[180:183], a[104:107], v[60:63]
    ds_read_b64_tr_b16 v[140:141], v29 offset:20672
    v_mfma_f32_16x16x32_bf16 v[100:103], v[180:183], a[108:111], v[100:103]
    ds_read_b64_tr_b16 v[142:143], v29 offset:23232
    s_waitcnt lgkmcnt(15)
    v_mfma_f32_16x16x32_bf16 v[64:67], v[184:187], a[104:107], v[64:67]
    ds_read_b64_tr_b16 v[144:145], v28 offset:20736
    s_add_u32 m0, s21, 147456
    s_nop 0
    buffer_load_dwordx4 v24, s[16:19], s23 offen lds
    v_mfma_f32_16x16x32_bf16 v[104:107], v[184:187], a[108:111], v[104:107]
    ds_read_b64_tr_b16 v[146:147], v28 offset:23296
    v_mfma_f32_16x16x32_bf16 v[68:71], v[188:191], a[104:107], v[68:71]
    ds_read_b64_tr_b16 v[148:149], v29 offset:20736
    v_mfma_f32_16x16x32_bf16 v[108:111], v[188:191], a[108:111], v[108:111]
    ds_read_b64_tr_b16 v[150:151], v29 offset:23296
    s_waitcnt vmcnt(23)
    s_waitcnt lgkmcnt(15)
    v_mfma_f32_16x16x32_bf16 v[32:35], v[112:115], a[112:115], v[32:35]
    ds_read_b64_tr_b16 v[152:153], v28 offset:30720
    v_mfma_f32_16x16x32_bf16 v[72:75], v[112:115], a[116:119], v[72:75]
    ds_read_b64_tr_b16 v[154:155], v28 offset:33280
    s_mov_b32 s22, 69632
    buffer_load_dwordx4 a[32:35], v25, s[40:43], s22 offen offset:0 sc1
    v_mfma_f32_16x16x32_bf16 v[36:39], v[116:119], a[112:115], v[36:39]
    ds_read_b64_tr_b16 v[156:157], v29 offset:30720
    v_mfma_f32_16x16x32_bf16 v[76:79], v[116:119], a[116:119], v[76:79]
    ds_read_b64_tr_b16 v[158:159], v29 offset:33280
    s_waitcnt lgkmcnt(15)
    v_mfma_f32_16x16x32_bf16 v[40:43], v[120:123], a[112:115], v[40:43]
    ds_read_b64_tr_b16 v[160:161], v28 offset:30784
    v_mfma_f32_16x16x32_bf16 v[80:83], v[120:123], a[116:119], v[80:83]
    ds_read_b64_tr_b16 v[162:163], v28 offset:33344
    buffer_load_dwordx4 a[36:39], v19, s[40:43], s22 offen offset:0 sc1
    v_mfma_f32_16x16x32_bf16 v[44:47], v[124:127], a[112:115], v[44:47]
    ds_read_b64_tr_b16 v[164:165], v29 offset:30784
    v_mfma_f32_16x16x32_bf16 v[84:87], v[124:127], a[116:119], v[84:87]
    ds_read_b64_tr_b16 v[166:167], v29 offset:33344
    s_waitcnt lgkmcnt(15)
    v_mfma_f32_16x16x32_bf16 v[48:51], v[128:131], a[112:115], v[48:51]
    ds_read_b64_tr_b16 v[168:169], v28 offset:30848
    v_mfma_f32_16x16x32_bf16 v[88:91], v[128:131], a[116:119], v[88:91]
    ds_read_b64_tr_b16 v[170:171], v28 offset:33408
    v_mfma_f32_16x16x32_bf16 v[52:55], v[132:135], a[112:115], v[52:55]
    ds_read_b64_tr_b16 v[172:173], v29 offset:30848
    buffer_load_dwordx4 a[40:43], v25, s[40:43], s22 offen offset:1024 sc1
    v_mfma_f32_16x16x32_bf16 v[92:95], v[132:135], a[116:119], v[92:95]
    ds_read_b64_tr_b16 v[174:175], v29 offset:33408
    s_waitcnt lgkmcnt(15)
    v_mfma_f32_16x16x32_bf16 v[56:59], v[136:139], a[112:115], v[56:59]
    ds_read_b64_tr_b16 v[176:177], v28 offset:30912
    v_mfma_f32_16x16x32_bf16 v[96:99], v[136:139], a[116:119], v[96:99]
    ds_read_b64_tr_b16 v[178:179], v28 offset:33472
    v_mfma_f32_16x16x32_bf16 v[60:63], v[140:143], a[112:115], v[60:63]
    ds_read_b64_tr_b16 v[180:181], v29 offset:30912
    v_mfma_f32_16x16x32_bf16 v[100:103], v[140:143], a[116:119], v[100:103]
    ds_read_b64_tr_b16 v[182:183], v29 offset:33472
    buffer_load_dwordx4 a[44:47], v19, s[40:43], s22 offen offset:1024 sc1
    s_waitcnt lgkmcnt(15)
    v_mfma_f32_16x16x32_bf16 v[64:67], v[144:147], a[112:115], v[64:67]
    ds_read_b64_tr_b16 v[184:185], v28 offset:30976
    v_mfma_f32_16x16x32_bf16 v[104:107], v[144:147], a[116:119], v[104:107]
    ds_read_b64_tr_b16 v[186:187], v28 offset:33536
    v_mfma_f32_16x16x32_bf16 v[68:71], v[148:151], a[112:115], v[68:71]
    ds_read_b64_tr_b16 v[188:189], v29 offset:30976
    v_mfma_f32_16x16x32_bf16 v[108:111], v[148:151], a[116:119], v[108:111]
    ds_read_b64_tr_b16 v[190:191], v29 offset:33536
    s_waitcnt vmcnt(13)
    s_barrier
    s_waitcnt lgkmcnt(15)
    v_mfma_f32_16x16x32_bf16 v[32:35], v[152:155], a[120:123], v[32:35]
    ds_read_b64_tr_b16 v[112:113], v28 offset:40960
    v_mfma_f32_16x16x32_bf16 v[72:75], v[152:155], a[124:127], v[72:75]
    ds_read_b64_tr_b16 v[114:115], v28 offset:43520
    s_add_u32 m0, s21, 0
    s_add_u32 s23, s20, 2867200
    buffer_load_dwordx4 v20, s[16:19], s23 offen lds
    v_mfma_f32_16x16x32_bf16 v[36:39], v[156:159], a[120:123], v[36:39]
    ds_read_b64_tr_b16 v[116:117], v29 offset:40960
    v_mfma_f32_16x16x32_bf16 v[76:79], v[156:159], a[124:127], v[76:79]
    ds_read_b64_tr_b16 v[118:119], v29 offset:43520
    s_waitcnt lgkmcnt(15)
    v_mfma_f32_16x16x32_bf16 v[40:43], v[160:163], a[120:123], v[40:43]
    ds_read_b64_tr_b16 v[120:121], v28 offset:41024
    buffer_load_dwordx4 v21, s[16:19], s23 offen offset:1024 lds
    v_mfma_f32_16x16x32_bf16 v[80:83], v[160:163], a[124:127], v[80:83]
    ds_read_b64_tr_b16 v[122:123], v28 offset:43584
    v_mfma_f32_16x16x32_bf16 v[44:47], v[164:167], a[120:123], v[44:47]
    ds_read_b64_tr_b16 v[124:125], v29 offset:41024
    v_mfma_f32_16x16x32_bf16 v[84:87], v[164:167], a[124:127], v[84:87]
    ds_read_b64_tr_b16 v[126:127], v29 offset:43584
    s_waitcnt lgkmcnt(15)
    v_mfma_f32_16x16x32_bf16 v[48:51], v[168:171], a[120:123], v[48:51]
    ds_read_b64_tr_b16 v[128:129], v28 offset:41088
    buffer_load_dwordx4 v22, s[16:19], s23 offen offset:2048 lds
    v_mfma_f32_16x16x32_bf16 v[88:91], v[168:171], a[124:127], v[88:91]
    ds_read_b64_tr_b16 v[130:131], v28 offset:43648
    v_mfma_f32_16x16x32_bf16 v[52:55], v[172:175], a[120:123], v[52:55]
    ds_read_b64_tr_b16 v[132:133], v29 offset:41088
    v_mfma_f32_16x16x32_bf16 v[92:95], v[172:175], a[124:127], v[92:95]
    ds_read_b64_tr_b16 v[134:135], v29 offset:43648
    s_waitcnt lgkmcnt(15)
    v_mfma_f32_16x16x32_bf16 v[56:59], v[176:179], a[120:123], v[56:59]
    ds_read_b64_tr_b16 v[136:137], v28 offset:41152
    buffer_load_dwordx4 v23, s[16:19], s23 offen offset:3072 lds
    v_mfma_f32_16x16x32_bf16 v[96:99], v[176:179], a[124:127], v[96:99]
    ds_read_b64_tr_b16 v[138:139], v28 offset:43712
    v_mfma_f32_16x16x32_bf16 v[60:63], v[180:183], a[120:123], v[60:63]
    ds_read_b64_tr_b16 v[140:141], v29 offset:41152
    v_mfma_f32_16x16x32_bf16 v[100:103], v[180:183], a[124:127], v[100:103]
    ds_read_b64_tr_b16 v[142:143], v29 offset:43712
    s_waitcnt lgkmcnt(15)
    v_mfma_f32_16x16x32_bf16 v[64:67], v[184:187], a[120:123], v[64:67]
    ds_read_b64_tr_b16 v[144:145], v28 offset:41216
    s_add_u32 m0, s21, 4096
    s_nop 0
    buffer_load_dwordx4 v24, s[16:19], s23 offen lds
    v_mfma_f32_16x16x32_bf16 v[104:107], v[184:187], a[124:127], v[104:107]
    ds_read_b64_tr_b16 v[146:147], v28 offset:43776
    v_mfma_f32_16x16x32_bf16 v[68:71], v[188:191], a[120:123], v[68:71]
    ds_read_b64_tr_b16 v[148:149], v29 offset:41216
    v_mfma_f32_16x16x32_bf16 v[108:111], v[188:191], a[124:127], v[108:111]
    ds_read_b64_tr_b16 v[150:151], v29 offset:43776
    s_waitcnt lgkmcnt(15)
    v_mfma_f32_16x16x32_bf16 v[32:35], v[112:115], a[0:3], v[32:35]
    ds_read_b64_tr_b16 v[152:153], v28 offset:51200
    v_mfma_f32_16x16x32_bf16 v[72:75], v[112:115], a[4:7], v[72:75]
    ds_read_b64_tr_b16 v[154:155], v28 offset:53760
    s_mov_b32 s22, 69632
    buffer_load_dwordx4 a[48:51], v25, s[40:43], s22 offen offset:2048 sc1
    v_mfma_f32_16x16x32_bf16 v[36:39], v[116:119], a[0:3], v[36:39]
    ds_read_b64_tr_b16 v[156:157], v29 offset:51200
    v_mfma_f32_16x16x32_bf16 v[76:79], v[116:119], a[4:7], v[76:79]
    ds_read_b64_tr_b16 v[158:159], v29 offset:53760
    s_waitcnt lgkmcnt(15)
    v_mfma_f32_16x16x32_bf16 v[40:43], v[120:123], a[0:3], v[40:43]
    ds_read_b64_tr_b16 v[160:161], v28 offset:51264
    v_mfma_f32_16x16x32_bf16 v[80:83], v[120:123], a[4:7], v[80:83]
    ds_read_b64_tr_b16 v[162:163], v28 offset:53824
    buffer_load_dwordx4 a[52:55], v19, s[40:43], s22 offen offset:2048 sc1
    v_mfma_f32_16x16x32_bf16 v[44:47], v[124:127], a[0:3], v[44:47]
    ds_read_b64_tr_b16 v[164:165], v29 offset:51264
    v_mfma_f32_16x16x32_bf16 v[84:87], v[124:127], a[4:7], v[84:87]
    ds_read_b64_tr_b16 v[166:167], v29 offset:53824
    s_waitcnt lgkmcnt(15)
    v_mfma_f32_16x16x32_bf16 v[48:51], v[128:131], a[0:3], v[48:51]
    ds_read_b64_tr_b16 v[168:169], v28 offset:51328
    v_mfma_f32_16x16x32_bf16 v[88:91], v[128:131], a[4:7], v[88:91]
    ds_read_b64_tr_b16 v[170:171], v28 offset:53888
    v_mfma_f32_16x16x32_bf16 v[52:55], v[132:135], a[0:3], v[52:55]
    ds_read_b64_tr_b16 v[172:173], v29 offset:51328
    buffer_load_dwordx4 a[56:59], v25, s[40:43], s22 offen offset:3072 sc1
    v_mfma_f32_16x16x32_bf16 v[92:95], v[132:135], a[4:7], v[92:95]
    ds_read_b64_tr_b16 v[174:175], v29 offset:53888
    s_waitcnt lgkmcnt(15)
    v_mfma_f32_16x16x32_bf16 v[56:59], v[136:139], a[0:3], v[56:59]
    ds_read_b64_tr_b16 v[176:177], v28 offset:51392
    v_mfma_f32_16x16x32_bf16 v[96:99], v[136:139], a[4:7], v[96:99]
    ds_read_b64_tr_b16 v[178:179], v28 offset:53952
    v_mfma_f32_16x16x32_bf16 v[60:63], v[140:143], a[0:3], v[60:63]
    ds_read_b64_tr_b16 v[180:181], v29 offset:51392
    v_mfma_f32_16x16x32_bf16 v[100:103], v[140:143], a[4:7], v[100:103]
    ds_read_b64_tr_b16 v[182:183], v29 offset:53952
    buffer_load_dwordx4 a[60:63], v19, s[40:43], s22 offen offset:3072 sc1
    s_waitcnt lgkmcnt(15)
    v_mfma_f32_16x16x32_bf16 v[64:67], v[144:147], a[0:3], v[64:67]
    ds_read_b64_tr_b16 v[184:185], v28 offset:51456
    v_mfma_f32_16x16x32_bf16 v[104:107], v[144:147], a[4:7], v[104:107]
    ds_read_b64_tr_b16 v[186:187], v28 offset:54016
    v_mfma_f32_16x16x32_bf16 v[68:71], v[148:151], a[0:3], v[68:71]
    ds_read_b64_tr_b16 v[188:189], v29 offset:51456
    v_mfma_f32_16x16x32_bf16 v[108:111], v[148:151], a[4:7], v[108:111]
    ds_read_b64_tr_b16 v[190:191], v29 offset:54016
    s_waitcnt lgkmcnt(15)
    v_mfma_f32_16x16x32_bf16 v[32:35], v[152:155], a[8:11], v[32:35]
    ds_read_b64_tr_b16 v[112:113], v30 offset:0
    v_mfma_f32_16x16x32_bf16 v[72:75], v[152:155], a[12:15], v[72:75]
    ds_read_b64_tr_b16 v[114:115], v30 offset:2560
    s_add_u32 m0, s21, 20480
    s_add_u32 s23, s20, 3932160
    buffer_load_dwordx4 v20, s[16:19], s23 offen lds
    v_mfma_f32_16x16x32_bf16 v[36:39], v[156:159], a[8:11], v[36:39]
    ds_read_b64_tr_b16 v[116:117], v31 offset:0
    v_mfma_f32_16x16x32_bf16 v[76:79], v[156:159], a[12:15], v[76:79]
    ds_read_b64_tr_b16 v[118:119], v31 offset:2560
    s_waitcnt lgkmcnt(15)
    v_mfma_f32_16x16x32_bf16 v[40:43], v[160:163], a[8:11], v[40:43]
    ds_read_b64_tr_b16 v[120:121], v30 offset:64
    buffer_load_dwordx4 v21, s[16:19], s23 offen offset:1024 lds
    v_mfma_f32_16x16x32_bf16 v[80:83], v[160:163], a[12:15], v[80:83]
    ds_read_b64_tr_b16 v[122:123], v30 offset:2624
    v_mfma_f32_16x16x32_bf16 v[44:47], v[164:167], a[8:11], v[44:47]
    ds_read_b64_tr_b16 v[124:125], v31 offset:64
    v_mfma_f32_16x16x32_bf16 v[84:87], v[164:167], a[12:15], v[84:87]
    ds_read_b64_tr_b16 v[126:127], v31 offset:2624
    s_waitcnt lgkmcnt(15)
    v_mfma_f32_16x16x32_bf16 v[48:51], v[168:171], a[8:11], v[48:51]
    ds_read_b64_tr_b16 v[128:129], v30 offset:128
    buffer_load_dwordx4 v22, s[16:19], s23 offen offset:2048 lds
    v_mfma_f32_16x16x32_bf16 v[88:91], v[168:171], a[12:15], v[88:91]
    ds_read_b64_tr_b16 v[130:131], v30 offset:2688
    v_mfma_f32_16x16x32_bf16 v[52:55], v[172:175], a[8:11], v[52:55]
    ds_read_b64_tr_b16 v[132:133], v31 offset:128
    v_mfma_f32_16x16x32_bf16 v[92:95], v[172:175], a[12:15], v[92:95]
    ds_read_b64_tr_b16 v[134:135], v31 offset:2688
    s_waitcnt lgkmcnt(15)
    v_mfma_f32_16x16x32_bf16 v[56:59], v[176:179], a[8:11], v[56:59]
    ds_read_b64_tr_b16 v[136:137], v30 offset:192
    buffer_load_dwordx4 v23, s[16:19], s23 offen offset:3072 lds
    v_mfma_f32_16x16x32_bf16 v[96:99], v[176:179], a[12:15], v[96:99]
    ds_read_b64_tr_b16 v[138:139], v30 offset:2752
    v_mfma_f32_16x16x32_bf16 v[60:63], v[180:183], a[8:11], v[60:63]
    ds_read_b64_tr_b16 v[140:141], v31 offset:192
    v_mfma_f32_16x16x32_bf16 v[100:103], v[180:183], a[12:15], v[100:103]
    ds_read_b64_tr_b16 v[142:143], v31 offset:2752
    s_waitcnt lgkmcnt(15)
    v_mfma_f32_16x16x32_bf16 v[64:67], v[184:187], a[8:11], v[64:67]
    ds_read_b64_tr_b16 v[144:145], v30 offset:256
    s_add_u32 m0, s21, 24576
    s_nop 0
    buffer_load_dwordx4 v24, s[16:19], s23 offen lds
    v_mfma_f32_16x16x32_bf16 v[104:107], v[184:187], a[12:15], v[104:107]
    ds_read_b64_tr_b16 v[146:147], v30 offset:2816
    v_mfma_f32_16x16x32_bf16 v[68:71], v[188:191], a[8:11], v[68:71]
    ds_read_b64_tr_b16 v[148:149], v31 offset:256
    v_mfma_f32_16x16x32_bf16 v[108:111], v[188:191], a[12:15], v[108:111]
    ds_read_b64_tr_b16 v[150:151], v31 offset:2816
    s_waitcnt vmcnt(23)
    s_waitcnt lgkmcnt(15)
    v_mfma_f32_16x16x32_bf16 v[32:35], v[112:115], a[16:19], v[32:35]
    ds_read_b64_tr_b16 v[152:153], v30 offset:10240
    v_mfma_f32_16x16x32_bf16 v[72:75], v[112:115], a[20:23], v[72:75]
    ds_read_b64_tr_b16 v[154:155], v30 offset:12800
    s_mov_b32 s22, 98304
    buffer_load_dwordx4 a[64:67], v25, s[40:43], s22 offen offset:0 sc1
    v_mfma_f32_16x16x32_bf16 v[36:39], v[116:119], a[16:19], v[36:39]
    ds_read_b64_tr_b16 v[156:157], v31 offset:10240
    v_mfma_f32_16x16x32_bf16 v[76:79], v[116:119], a[20:23], v[76:79]
    ds_read_b64_tr_b16 v[158:159], v31 offset:12800
    s_waitcnt lgkmcnt(15)
    v_mfma_f32_16x16x32_bf16 v[40:43], v[120:123], a[16:19], v[40:43]
    ds_read_b64_tr_b16 v[160:161], v30 offset:10304
    v_mfma_f32_16x16x32_bf16 v[80:83], v[120:123], a[20:23], v[80:83]
    ds_read_b64_tr_b16 v[162:163], v30 offset:12864
    buffer_load_dwordx4 a[68:71], v19, s[40:43], s22 offen offset:0 sc1
    v_mfma_f32_16x16x32_bf16 v[44:47], v[124:127], a[16:19], v[44:47]
    ds_read_b64_tr_b16 v[164:165], v31 offset:10304
    v_mfma_f32_16x16x32_bf16 v[84:87], v[124:127], a[20:23], v[84:87]
    ds_read_b64_tr_b16 v[166:167], v31 offset:12864
    s_waitcnt lgkmcnt(15)
    v_mfma_f32_16x16x32_bf16 v[48:51], v[128:131], a[16:19], v[48:51]
    ds_read_b64_tr_b16 v[168:169], v30 offset:10368
    v_mfma_f32_16x16x32_bf16 v[88:91], v[128:131], a[20:23], v[88:91]
    ds_read_b64_tr_b16 v[170:171], v30 offset:12928
    v_mfma_f32_16x16x32_bf16 v[52:55], v[132:135], a[16:19], v[52:55]
    ds_read_b64_tr_b16 v[172:173], v31 offset:10368
    buffer_load_dwordx4 a[72:75], v25, s[40:43], s22 offen offset:1024 sc1
    v_mfma_f32_16x16x32_bf16 v[92:95], v[132:135], a[20:23], v[92:95]
    ds_read_b64_tr_b16 v[174:175], v31 offset:12928
    s_waitcnt lgkmcnt(15)
    v_mfma_f32_16x16x32_bf16 v[56:59], v[136:139], a[16:19], v[56:59]
    ds_read_b64_tr_b16 v[176:177], v30 offset:10432
    v_mfma_f32_16x16x32_bf16 v[96:99], v[136:139], a[20:23], v[96:99]
    ds_read_b64_tr_b16 v[178:179], v30 offset:12992
    v_mfma_f32_16x16x32_bf16 v[60:63], v[140:143], a[16:19], v[60:63]
    ds_read_b64_tr_b16 v[180:181], v31 offset:10432
    v_mfma_f32_16x16x32_bf16 v[100:103], v[140:143], a[20:23], v[100:103]
    ds_read_b64_tr_b16 v[182:183], v31 offset:12992
    buffer_load_dwordx4 a[76:79], v19, s[40:43], s22 offen offset:1024 sc1
    s_waitcnt lgkmcnt(15)
    v_mfma_f32_16x16x32_bf16 v[64:67], v[144:147], a[16:19], v[64:67]
    ds_read_b64_tr_b16 v[184:185], v30 offset:10496
    v_mfma_f32_16x16x32_bf16 v[104:107], v[144:147], a[20:23], v[104:107]
    ds_read_b64_tr_b16 v[186:187], v30 offset:13056
    v_mfma_f32_16x16x32_bf16 v[68:71], v[148:151], a[16:19], v[68:71]
    ds_read_b64_tr_b16 v[188:189], v31 offset:10496
    v_mfma_f32_16x16x32_bf16 v[108:111], v[148:151], a[20:23], v[108:111]
    ds_read_b64_tr_b16 v[190:191], v31 offset:13056
    s_waitcnt vmcnt(13)
    s_barrier
    s_waitcnt lgkmcnt(15)
    v_mfma_f32_16x16x32_bf16 v[32:35], v[152:155], a[24:27], v[32:35]
    ds_read_b64_tr_b16 v[112:113], v30 offset:20480
    v_mfma_f32_16x16x32_bf16 v[72:75], v[152:155], a[28:31], v[72:75]
    ds_read_b64_tr_b16 v[114:115], v30 offset:23040
    s_add_u32 m0, s21, 40960
    s_add_u32 s23, s20, 4014080
    buffer_load_dwordx4 v20, s[16:19], s23 offen lds
    v_mfma_f32_16x16x32_bf16 v[36:39], v[156:159], a[24:27], v[36:39]
    ds_read_b64_tr_b16 v[116:117], v31 offset:20480
    v_mfma_f32_16x16x32_bf16 v[76:79], v[156:159], a[28:31], v[76:79]
    ds_read_b64_tr_b16 v[118:119], v31 offset:23040
    s_waitcnt lgkmcnt(15)
    v_mfma_f32_16x16x32_bf16 v[40:43], v[160:163], a[24:27], v[40:43]
    ds_read_b64_tr_b16 v[120:121], v30 offset:20544
    buffer_load_dwordx4 v21, s[16:19], s23 offen offset:1024 lds
    v_mfma_f32_16x16x32_bf16 v[80:83], v[160:163], a[28:31], v[80:83]
    ds_read_b64_tr_b16 v[122:123], v30 offset:23104
    v_mfma_f32_16x16x32_bf16 v[44:47], v[164:167], a[24:27], v[44:47]
    ds_read_b64_tr_b16 v[124:125], v31 offset:20544
    v_mfma_f32_16x16x32_bf16 v[84:87], v[164:167], a[28:31], v[84:87]
    ds_read_b64_tr_b16 v[126:127], v31 offset:23104
    s_waitcnt lgkmcnt(15)
    v_mfma_f32_16x16x32_bf16 v[48:51], v[168:171], a[24:27], v[48:51]
    ds_read_b64_tr_b16 v[128:129], v30 offset:20608
    buffer_load_dwordx4 v22, s[16:19], s23 offen offset:2048 lds
    v_mfma_f32_16x16x32_bf16 v[88:91], v[168:171], a[28:31], v[88:91]
    ds_read_b64_tr_b16 v[130:131], v30 offset:23168
    v_mfma_f32_16x16x32_bf16 v[52:55], v[172:175], a[24:27], v[52:55]
    ds_read_b64_tr_b16 v[132:133], v31 offset:20608
    v_mfma_f32_16x16x32_bf16 v[92:95], v[172:175], a[28:31], v[92:95]
    ds_read_b64_tr_b16 v[134:135], v31 offset:23168
    s_waitcnt lgkmcnt(15)
    v_mfma_f32_16x16x32_bf16 v[56:59], v[176:179], a[24:27], v[56:59]
    ds_read_b64_tr_b16 v[136:137], v30 offset:20672
    buffer_load_dwordx4 v23, s[16:19], s23 offen offset:3072 lds
    v_mfma_f32_16x16x32_bf16 v[96:99], v[176:179], a[28:31], v[96:99]
    ds_read_b64_tr_b16 v[138:139], v30 offset:23232
    v_mfma_f32_16x16x32_bf16 v[60:63], v[180:183], a[24:27], v[60:63]
    ds_read_b64_tr_b16 v[140:141], v31 offset:20672
    v_mfma_f32_16x16x32_bf16 v[100:103], v[180:183], a[28:31], v[100:103]
    ds_read_b64_tr_b16 v[142:143], v31 offset:23232
    s_waitcnt lgkmcnt(15)
    v_mfma_f32_16x16x32_bf16 v[64:67], v[184:187], a[24:27], v[64:67]
    ds_read_b64_tr_b16 v[144:145], v30 offset:20736
    s_add_u32 m0, s21, 45056
    s_nop 0
    buffer_load_dwordx4 v24, s[16:19], s23 offen lds
    v_mfma_f32_16x16x32_bf16 v[104:107], v[184:187], a[28:31], v[104:107]
    ds_read_b64_tr_b16 v[146:147], v30 offset:23296
    v_mfma_f32_16x16x32_bf16 v[68:71], v[188:191], a[24:27], v[68:71]
    ds_read_b64_tr_b16 v[148:149], v31 offset:20736
    v_mfma_f32_16x16x32_bf16 v[108:111], v[188:191], a[28:31], v[108:111]
    ds_read_b64_tr_b16 v[150:151], v31 offset:23296
    s_waitcnt lgkmcnt(15)
    v_mfma_f32_16x16x32_bf16 v[32:35], v[112:115], a[32:35], v[32:35]
    ds_read_b64_tr_b16 v[152:153], v30 offset:30720
    v_mfma_f32_16x16x32_bf16 v[72:75], v[112:115], a[36:39], v[72:75]
    ds_read_b64_tr_b16 v[154:155], v30 offset:33280
    s_mov_b32 s22, 98304
    buffer_load_dwordx4 a[80:83], v25, s[40:43], s22 offen offset:2048 sc1
    v_mfma_f32_16x16x32_bf16 v[36:39], v[116:119], a[32:35], v[36:39]
    ds_read_b64_tr_b16 v[156:157], v31 offset:30720
    v_mfma_f32_16x16x32_bf16 v[76:79], v[116:119], a[36:39], v[76:79]
    ds_read_b64_tr_b16 v[158:159], v31 offset:33280
    s_waitcnt lgkmcnt(15)
    v_mfma_f32_16x16x32_bf16 v[40:43], v[120:123], a[32:35], v[40:43]
    ds_read_b64_tr_b16 v[160:161], v30 offset:30784
    v_mfma_f32_16x16x32_bf16 v[80:83], v[120:123], a[36:39], v[80:83]
    ds_read_b64_tr_b16 v[162:163], v30 offset:33344
    buffer_load_dwordx4 a[84:87], v19, s[40:43], s22 offen offset:2048 sc1
    v_mfma_f32_16x16x32_bf16 v[44:47], v[124:127], a[32:35], v[44:47]
    ds_read_b64_tr_b16 v[164:165], v31 offset:30784
    v_mfma_f32_16x16x32_bf16 v[84:87], v[124:127], a[36:39], v[84:87]
    ds_read_b64_tr_b16 v[166:167], v31 offset:33344
    s_waitcnt lgkmcnt(15)
    v_mfma_f32_16x16x32_bf16 v[48:51], v[128:131], a[32:35], v[48:51]
    ds_read_b64_tr_b16 v[168:169], v30 offset:30848
    v_mfma_f32_16x16x32_bf16 v[88:91], v[128:131], a[36:39], v[88:91]
    ds_read_b64_tr_b16 v[170:171], v30 offset:33408
    v_mfma_f32_16x16x32_bf16 v[52:55], v[132:135], a[32:35], v[52:55]
    ds_read_b64_tr_b16 v[172:173], v31 offset:30848
    buffer_load_dwordx4 a[88:91], v25, s[40:43], s22 offen offset:3072 sc1
    v_mfma_f32_16x16x32_bf16 v[92:95], v[132:135], a[36:39], v[92:95]
    ds_read_b64_tr_b16 v[174:175], v31 offset:33408
    s_waitcnt lgkmcnt(15)
    v_mfma_f32_16x16x32_bf16 v[56:59], v[136:139], a[32:35], v[56:59]
    ds_read_b64_tr_b16 v[176:177], v30 offset:30912
    v_mfma_f32_16x16x32_bf16 v[96:99], v[136:139], a[36:39], v[96:99]
    ds_read_b64_tr_b16 v[178:179], v30 offset:33472
    v_mfma_f32_16x16x32_bf16 v[60:63], v[140:143], a[32:35], v[60:63]
    ds_read_b64_tr_b16 v[180:181], v31 offset:30912
    v_mfma_f32_16x16x32_bf16 v[100:103], v[140:143], a[36:39], v[100:103]
    ds_read_b64_tr_b16 v[182:183], v31 offset:33472
    buffer_load_dwordx4 a[92:95], v19, s[40:43], s22 offen offset:3072 sc1
    s_waitcnt lgkmcnt(15)
    v_mfma_f32_16x16x32_bf16 v[64:67], v[144:147], a[32:35], v[64:67]
    ds_read_b64_tr_b16 v[184:185], v30 offset:30976
    v_mfma_f32_16x16x32_bf16 v[104:107], v[144:147], a[36:39], v[104:107]
    ds_read_b64_tr_b16 v[186:187], v30 offset:33536
    v_mfma_f32_16x16x32_bf16 v[68:71], v[148:151], a[32:35], v[68:71]
    ds_read_b64_tr_b16 v[188:189], v31 offset:30976
    v_mfma_f32_16x16x32_bf16 v[108:111], v[148:151], a[36:39], v[108:111]
    ds_read_b64_tr_b16 v[190:191], v31 offset:33536
    s_waitcnt lgkmcnt(15)
    v_mfma_f32_16x16x32_bf16 v[32:35], v[152:155], a[40:43], v[32:35]
    ds_read_b64_tr_b16 v[112:113], v26 offset:0
    v_mfma_f32_16x16x32_bf16 v[72:75], v[152:155], a[44:47], v[72:75]
    ds_read_b64_tr_b16 v[114:115], v26 offset:2560
    s_add_u32 m0, s21, 61440
    s_add_u32 s23, s20, 4096000
    buffer_load_dwordx4 v20, s[16:19], s23 offen lds
    v_mfma_f32_16x16x32_bf16 v[36:39], v[156:159], a[40:43], v[36:39]
    ds_read_b64_tr_b16 v[116:117], v27 offset:0
    v_mfma_f32_16x16x32_bf16 v[76:79], v[156:159], a[44:47], v[76:79]
    ds_read_b64_tr_b16 v[118:119], v27 offset:2560
    s_waitcnt lgkmcnt(15)
    v_mfma_f32_16x16x32_bf16 v[40:43], v[160:163], a[40:43], v[40:43]
    ds_read_b64_tr_b16 v[120:121], v26 offset:64
    buffer_load_dwordx4 v21, s[16:19], s23 offen offset:1024 lds
    v_mfma_f32_16x16x32_bf16 v[80:83], v[160:163], a[44:47], v[80:83]
    ds_read_b64_tr_b16 v[122:123], v26 offset:2624
    v_mfma_f32_16x16x32_bf16 v[44:47], v[164:167], a[40:43], v[44:47]
    ds_read_b64_tr_b16 v[124:125], v27 offset:64
    v_mfma_f32_16x16x32_bf16 v[84:87], v[164:167], a[44:47], v[84:87]
    ds_read_b64_tr_b16 v[126:127], v27 offset:2624
    s_waitcnt lgkmcnt(15)
    v_mfma_f32_16x16x32_bf16 v[48:51], v[168:171], a[40:43], v[48:51]
    ds_read_b64_tr_b16 v[128:129], v26 offset:128
    buffer_load_dwordx4 v22, s[16:19], s23 offen offset:2048 lds
    v_mfma_f32_16x16x32_bf16 v[88:91], v[168:171], a[44:47], v[88:91]
    ds_read_b64_tr_b16 v[130:131], v26 offset:2688
    v_mfma_f32_16x16x32_bf16 v[52:55], v[172:175], a[40:43], v[52:55]
    ds_read_b64_tr_b16 v[132:133], v27 offset:128
    v_mfma_f32_16x16x32_bf16 v[92:95], v[172:175], a[44:47], v[92:95]
    ds_read_b64_tr_b16 v[134:135], v27 offset:2688
    s_waitcnt lgkmcnt(15)
    v_mfma_f32_16x16x32_bf16 v[56:59], v[176:179], a[40:43], v[56:59]
    ds_read_b64_tr_b16 v[136:137], v26 offset:192
    buffer_load_dwordx4 v23, s[16:19], s23 offen offset:3072 lds
    v_mfma_f32_16x16x32_bf16 v[96:99], v[176:179], a[44:47], v[96:99]
    ds_read_b64_tr_b16 v[138:139], v26 offset:2752
    v_mfma_f32_16x16x32_bf16 v[60:63], v[180:183], a[40:43], v[60:63]
    ds_read_b64_tr_b16 v[140:141], v27 offset:192
    v_mfma_f32_16x16x32_bf16 v[100:103], v[180:183], a[44:47], v[100:103]
    ds_read_b64_tr_b16 v[142:143], v27 offset:2752
    s_waitcnt lgkmcnt(15)
    v_mfma_f32_16x16x32_bf16 v[64:67], v[184:187], a[40:43], v[64:67]
    ds_read_b64_tr_b16 v[144:145], v26 offset:256
    s_add_u32 m0, s21, 65536
    s_nop 0
    buffer_load_dwordx4 v24, s[16:19], s23 offen lds
    v_mfma_f32_16x16x32_bf16 v[104:107], v[184:187], a[44:47], v[104:107]
    ds_read_b64_tr_b16 v[146:147], v26 offset:2816
    v_mfma_f32_16x16x32_bf16 v[68:71], v[188:191], a[40:43], v[68:71]
    ds_read_b64_tr_b16 v[148:149], v27 offset:256
    v_mfma_f32_16x16x32_bf16 v[108:111], v[188:191], a[44:47], v[108:111]
    ds_read_b64_tr_b16 v[150:151], v27 offset:2816
    s_waitcnt vmcnt(23)
    s_waitcnt lgkmcnt(15)
    v_mfma_f32_16x16x32_bf16 v[32:35], v[112:115], a[48:51], v[32:35]
    ds_read_b64_tr_b16 v[152:153], v26 offset:10240
    v_mfma_f32_16x16x32_bf16 v[72:75], v[112:115], a[52:55], v[72:75]
    ds_read_b64_tr_b16 v[154:155], v26 offset:12800
    s_mov_b32 s22, 102400
    buffer_load_dwordx4 a[96:99], v25, s[40:43], s22 offen offset:0 sc1
    v_mfma_f32_16x16x32_bf16 v[36:39], v[116:119], a[48:51], v[36:39]
    ds_read_b64_tr_b16 v[156:157], v27 offset:10240
    v_mfma_f32_16x16x32_bf16 v[76:79], v[116:119], a[52:55], v[76:79]
    ds_read_b64_tr_b16 v[158:159], v27 offset:12800
    buffer_load_dwordx4 a[100:103], v19, s[40:43], s22 offen offset:0 sc1
    s_waitcnt lgkmcnt(15)
    v_mfma_f32_16x16x32_bf16 v[40:43], v[120:123], a[48:51], v[40:43]
    ds_read_b64_tr_b16 v[160:161], v26 offset:10304
    v_mfma_f32_16x16x32_bf16 v[80:83], v[120:123], a[52:55], v[80:83]
    ds_read_b64_tr_b16 v[162:163], v26 offset:12864
    buffer_load_dwordx4 a[104:107], v25, s[40:43], s22 offen offset:1024 sc1
    v_mfma_f32_16x16x32_bf16 v[44:47], v[124:127], a[48:51], v[44:47]
    ds_read_b64_tr_b16 v[164:165], v27 offset:10304
    v_mfma_f32_16x16x32_bf16 v[84:87], v[124:127], a[52:55], v[84:87]
    ds_read_b64_tr_b16 v[166:167], v27 offset:12864
    buffer_load_dwordx4 a[108:111], v19, s[40:43], s22 offen offset:1024 sc1
    s_waitcnt lgkmcnt(15)
    v_mfma_f32_16x16x32_bf16 v[48:51], v[128:131], a[48:51], v[48:51]
    ds_read_b64_tr_b16 v[168:169], v26 offset:10368
    v_mfma_f32_16x16x32_bf16 v[88:91], v[128:131], a[52:55], v[88:91]
    ds_read_b64_tr_b16 v[170:171], v26 offset:12928
    v_min_u32 v7, 39, v1
    v_mfma_f32_16x16x32_bf16 v[52:55], v[132:135], a[48:51], v[52:55]
    ds_read_b64_tr_b16 v[172:173], v27 offset:10368
    v_mfma_f32_16x16x32_bf16 v[92:95], v[132:135], a[52:55], v[92:95]
    ds_read_b64_tr_b16 v[174:175], v27 offset:12928
    v_lshlrev_b32 v7, 4, v7
    s_waitcnt lgkmcnt(15)
    v_mfma_f32_16x16x32_bf16 v[56:59], v[136:139], a[48:51], v[56:59]
    ds_read_b64_tr_b16 v[176:177], v26 offset:10432
    v_mfma_f32_16x16x32_bf16 v[96:99], v[136:139], a[52:55], v[96:99]
    ds_read_b64_tr_b16 v[178:179], v26 offset:12992
    s_mul_i32 s58, s46, 640
    v_mfma_f32_16x16x32_bf16 v[60:63], v[140:143], a[48:51], v[60:63]
    ds_read_b64_tr_b16 v[180:181], v27 offset:10432
    v_mfma_f32_16x16x32_bf16 v[100:103], v[140:143], a[52:55], v[100:103]
    ds_read_b64_tr_b16 v[182:183], v27 offset:12992
    s_add_u32 s58, s58, 0x4810000
    s_waitcnt lgkmcnt(15)
    v_mfma_f32_16x16x32_bf16 v[64:67], v[144:147], a[48:51], v[64:67]
    ds_read_b64_tr_b16 v[184:185], v26 offset:10496
    v_mfma_f32_16x16x32_bf16 v[104:107], v[144:147], a[52:55], v[104:107]
    ds_read_b64_tr_b16 v[186:187], v26 offset:13056
    v_add_u32 v7, s58, v7
    v_mfma_f32_16x16x32_bf16 v[68:71], v[148:151], a[48:51], v[68:71]
    ds_read_b64_tr_b16 v[188:189], v27 offset:10496
    v_mfma_f32_16x16x32_bf16 v[108:111], v[148:151], a[52:55], v[108:111]
    ds_read_b64_tr_b16 v[190:191], v27 offset:13056
    s_waitcnt vmcnt(13)
    s_barrier
    s_waitcnt lgkmcnt(15)
    v_mfma_f32_16x16x32_bf16 v[32:35], v[152:155], a[56:59], v[32:35]
    ds_read_b64_tr_b16 v[112:113], v26 offset:20480
    v_mfma_f32_16x16x32_bf16 v[72:75], v[152:155], a[60:63], v[72:75]
    ds_read_b64_tr_b16 v[114:115], v26 offset:23040
    s_add_u32 m0, s21, 81920
    s_add_u32 s23, s20, 4177920
    buffer_load_dwordx4 v20, s[16:19], s23 offen lds
    v_mfma_f32_16x16x32_bf16 v[36:39], v[156:159], a[56:59], v[36:39]
    ds_read_b64_tr_b16 v[116:117], v27 offset:20480
    v_mfma_f32_16x16x32_bf16 v[76:79], v[156:159], a[60:63], v[76:79]
    ds_read_b64_tr_b16 v[118:119], v27 offset:23040
    s_waitcnt lgkmcnt(15)
    v_mfma_f32_16x16x32_bf16 v[40:43], v[160:163], a[56:59], v[40:43]
    ds_read_b64_tr_b16 v[120:121], v26 offset:20544
    buffer_load_dwordx4 v21, s[16:19], s23 offen offset:1024 lds
    v_mfma_f32_16x16x32_bf16 v[80:83], v[160:163], a[60:63], v[80:83]
    ds_read_b64_tr_b16 v[122:123], v26 offset:23104
    v_mfma_f32_16x16x32_bf16 v[44:47], v[164:167], a[56:59], v[44:47]
    ds_read_b64_tr_b16 v[124:125], v27 offset:20544
    v_mfma_f32_16x16x32_bf16 v[84:87], v[164:167], a[60:63], v[84:87]
    ds_read_b64_tr_b16 v[126:127], v27 offset:23104
    s_waitcnt lgkmcnt(15)
    v_mfma_f32_16x16x32_bf16 v[48:51], v[168:171], a[56:59], v[48:51]
    ds_read_b64_tr_b16 v[128:129], v26 offset:20608
    buffer_load_dwordx4 v22, s[16:19], s23 offen offset:2048 lds
    v_mfma_f32_16x16x32_bf16 v[88:91], v[168:171], a[60:63], v[88:91]
    ds_read_b64_tr_b16 v[130:131], v26 offset:23168
    v_mfma_f32_16x16x32_bf16 v[52:55], v[172:175], a[56:59], v[52:55]
    ds_read_b64_tr_b16 v[132:133], v27 offset:20608
    v_mfma_f32_16x16x32_bf16 v[92:95], v[172:175], a[60:63], v[92:95]
    ds_read_b64_tr_b16 v[134:135], v27 offset:23168
    s_waitcnt lgkmcnt(15)
    v_mfma_f32_16x16x32_bf16 v[56:59], v[176:179], a[56:59], v[56:59]
    ds_read_b64_tr_b16 v[136:137], v26 offset:20672
    buffer_load_dwordx4 v23, s[16:19], s23 offen offset:3072 lds
    v_mfma_f32_16x16x32_bf16 v[96:99], v[176:179], a[60:63], v[96:99]
    ds_read_b64_tr_b16 v[138:139], v26 offset:23232
    v_mfma_f32_16x16x32_bf16 v[60:63], v[180:183], a[56:59], v[60:63]
    ds_read_b64_tr_b16 v[140:141], v27 offset:20672
    v_mfma_f32_16x16x32_bf16 v[100:103], v[180:183], a[60:63], v[100:103]
    ds_read_b64_tr_b16 v[142:143], v27 offset:23232
    s_waitcnt lgkmcnt(15)
    v_mfma_f32_16x16x32_bf16 v[64:67], v[184:187], a[56:59], v[64:67]
    ds_read_b64_tr_b16 v[144:145], v26 offset:20736
    s_add_u32 m0, s21, 86016
    s_nop 0
    buffer_load_dwordx4 v24, s[16:19], s23 offen lds
    v_mfma_f32_16x16x32_bf16 v[104:107], v[184:187], a[60:63], v[104:107]
    ds_read_b64_tr_b16 v[146:147], v26 offset:23296
    v_mfma_f32_16x16x32_bf16 v[68:71], v[188:191], a[56:59], v[68:71]
    ds_read_b64_tr_b16 v[148:149], v27 offset:20736
    v_mfma_f32_16x16x32_bf16 v[108:111], v[188:191], a[60:63], v[108:111]
    ds_read_b64_tr_b16 v[150:151], v27 offset:23296
    s_waitcnt lgkmcnt(15)
    v_mfma_f32_16x16x32_bf16 v[32:35], v[112:115], a[64:67], v[32:35]
    ds_read_b64_tr_b16 v[152:153], v26 offset:30720
    v_mfma_f32_16x16x32_bf16 v[72:75], v[112:115], a[68:71], v[72:75]
    ds_read_b64_tr_b16 v[154:155], v26 offset:33280
    s_mov_b32 s22, 102400
    buffer_load_dwordx4 a[112:115], v25, s[40:43], s22 offen offset:2048 sc1
    v_mfma_f32_16x16x32_bf16 v[36:39], v[116:119], a[64:67], v[36:39]
    ds_read_b64_tr_b16 v[156:157], v27 offset:30720
    v_mfma_f32_16x16x32_bf16 v[76:79], v[116:119], a[68:71], v[76:79]
    ds_read_b64_tr_b16 v[158:159], v27 offset:33280
    s_waitcnt lgkmcnt(15)
    v_mfma_f32_16x16x32_bf16 v[40:43], v[120:123], a[64:67], v[40:43]
    ds_read_b64_tr_b16 v[160:161], v26 offset:30784
    buffer_load_dwordx4 a[116:119], v19, s[40:43], s22 offen offset:2048 sc1
    v_mfma_f32_16x16x32_bf16 v[80:83], v[120:123], a[68:71], v[80:83]
    ds_read_b64_tr_b16 v[162:163], v26 offset:33344
    v_mfma_f32_16x16x32_bf16 v[44:47], v[124:127], a[64:67], v[44:47]
    ds_read_b64_tr_b16 v[164:165], v27 offset:30784
    v_mfma_f32_16x16x32_bf16 v[84:87], v[124:127], a[68:71], v[84:87]
    ds_read_b64_tr_b16 v[166:167], v27 offset:33344
    s_waitcnt lgkmcnt(15)
    v_mfma_f32_16x16x32_bf16 v[48:51], v[128:131], a[64:67], v[48:51]
    ds_read_b64_tr_b16 v[168:169], v26 offset:30848
    buffer_load_dwordx4 a[120:123], v25, s[40:43], s22 offen offset:3072 sc1
    v_mfma_f32_16x16x32_bf16 v[88:91], v[128:131], a[68:71], v[88:91]
    ds_read_b64_tr_b16 v[170:171], v26 offset:33408
    v_mfma_f32_16x16x32_bf16 v[52:55], v[132:135], a[64:67], v[52:55]
    ds_read_b64_tr_b16 v[172:173], v27 offset:30848
    v_mfma_f32_16x16x32_bf16 v[92:95], v[132:135], a[68:71], v[92:95]
    ds_read_b64_tr_b16 v[174:175], v27 offset:33408
    s_waitcnt lgkmcnt(15)
    v_mfma_f32_16x16x32_bf16 v[56:59], v[136:139], a[64:67], v[56:59]
    ds_read_b64_tr_b16 v[176:177], v26 offset:30912
    buffer_load_dwordx4 a[124:127], v19, s[40:43], s22 offen offset:3072 sc1
    v_mfma_f32_16x16x32_bf16 v[96:99], v[136:139], a[68:71], v[96:99]
    ds_read_b64_tr_b16 v[178:179], v26 offset:33472
    v_mfma_f32_16x16x32_bf16 v[60:63], v[140:143], a[64:67], v[60:63]
    ds_read_b64_tr_b16 v[180:181], v27 offset:30912
    v_mfma_f32_16x16x32_bf16 v[100:103], v[140:143], a[68:71], v[100:103]
    ds_read_b64_tr_b16 v[182:183], v27 offset:33472
    s_waitcnt lgkmcnt(15)
    v_mfma_f32_16x16x32_bf16 v[64:67], v[144:147], a[64:67], v[64:67]
    ds_read_b64_tr_b16 v[184:185], v26 offset:30976
    buffer_load_dwordx4 v[192:195], v7, s[40:43], 0 offen sc1
    v_mfma_f32_16x16x32_bf16 v[104:107], v[144:147], a[68:71], v[104:107]
    ds_read_b64_tr_b16 v[186:187], v26 offset:33536
    v_mfma_f32_16x16x32_bf16 v[68:71], v[148:151], a[64:67], v[68:71]
    ds_read_b64_tr_b16 v[188:189], v27 offset:30976
    v_mfma_f32_16x16x32_bf16 v[108:111], v[148:151], a[68:71], v[108:111]
    ds_read_b64_tr_b16 v[190:191], v27 offset:33536
    s_waitcnt lgkmcnt(15)
    v_mfma_f32_16x16x32_bf16 v[32:35], v[152:155], a[72:75], v[32:35]
    ds_read_b64_tr_b16 v[112:113], v26 offset:40960
    v_mfma_f32_16x16x32_bf16 v[72:75], v[152:155], a[76:79], v[72:75]
    ds_read_b64_tr_b16 v[114:115], v26 offset:43520
    s_lshl_b32 s49, s45, 7
    v_mfma_f32_16x16x32_bf16 v[36:39], v[156:159], a[72:75], v[36:39]
    ds_read_b64_tr_b16 v[116:117], v27 offset:40960
    s_lshl_b32 s58, s47, 5
    v_mfma_f32_16x16x32_bf16 v[76:79], v[156:159], a[76:79], v[76:79]
    ds_read_b64_tr_b16 v[118:119], v27 offset:43520
    s_add_u32 s49, s49, s58
    s_waitcnt lgkmcnt(15)
    v_mfma_f32_16x16x32_bf16 v[40:43], v[160:163], a[72:75], v[40:43]
    ds_read_b64_tr_b16 v[120:121], v26 offset:41024
    s_lshr_b32 s58, s44, 1
    v_mfma_f32_16x16x32_bf16 v[80:83], v[160:163], a[76:79], v[80:83]
    ds_read_b64_tr_b16 v[122:123], v26 offset:43584
    s_lshl_b32 s58, s58, 4
    v_mfma_f32_16x16x32_bf16 v[44:47], v[164:167], a[72:75], v[44:47]
    ds_read_b64_tr_b16 v[124:125], v27 offset:41024
    s_add_u32 s58, s58, s49
    v_mfma_f32_16x16x32_bf16 v[84:87], v[164:167], a[76:79], v[84:87]
    ds_read_b64_tr_b16 v[126:127], v27 offset:43584
    v_and_b32 v20, 15, v1
    s_waitcnt lgkmcnt(15)
    v_mfma_f32_16x16x32_bf16 v[48:51], v[168:171], a[72:75], v[48:51]
    ds_read_b64_tr_b16 v[128:129], v26 offset:41088
    v_add_u32 v20, s58, v20
    v_mfma_f32_16x16x32_bf16 v[88:91], v[168:171], a[76:79], v[88:91]
    ds_read_b64_tr_b16 v[130:131], v26 offset:43648
    v_lshlrev_b32 v21, 2, v20
    v_mfma_f32_16x16x32_bf16 v[52:55], v[172:175], a[72:75], v[52:55]
    ds_read_b64_tr_b16 v[132:133], v27 offset:41088
    v_mul_u32_u24 v20, 0x500, v20
    v_mfma_f32_16x16x32_bf16 v[92:95], v[172:175], a[76:79], v[92:95]
    ds_read_b64_tr_b16 v[134:135], v27 offset:43648
    v_lshrrev_b32 v22, 4, v1
    s_waitcnt lgkmcnt(15)
    v_mfma_f32_16x16x32_bf16 v[56:59], v[176:179], a[72:75], v[56:59]
    ds_read_b64_tr_b16 v[136:137], v26 offset:41152
    v_lshlrev_b32 v22, 3, v22
    v_mfma_f32_16x16x32_bf16 v[96:99], v[176:179], a[76:79], v[96:99]
    ds_read_b64_tr_b16 v[138:139], v26 offset:43712
    s_and_b32 s58, s44, 1
    v_mfma_f32_16x16x32_bf16 v[60:63], v[180:183], a[72:75], v[60:63]
    ds_read_b64_tr_b16 v[140:141], v27 offset:41152
    s_lshl_b32 s59, s46, 1
    v_mfma_f32_16x16x32_bf16 v[100:103], v[180:183], a[76:79], v[100:103]
    ds_read_b64_tr_b16 v[142:143], v27 offset:43712
    s_add_u32 s58, s58, s59
    s_waitcnt lgkmcnt(15)
    v_mfma_f32_16x16x32_bf16 v[64:67], v[184:187], a[72:75], v[64:67]
    ds_read_b64_tr_b16 v[144:145], v26 offset:41216
    s_mul_i32 s58, s58, 160
    v_mfma_f32_16x16x32_bf16 v[104:107], v[184:187], a[76:79], v[104:107]
    ds_read_b64_tr_b16 v[146:147], v26 offset:43776
    v_add3_u32 v20, v20, v22, s58
    v_mfma_f32_16x16x32_bf16 v[68:71], v[188:191], a[72:75], v[68:71]
    ds_read_b64_tr_b16 v[148:149], v27 offset:41216
    s_mov_b32 s57, 0x4800000
    v_mfma_f32_16x16x32_bf16 v[108:111], v[188:191], a[76:79], v[108:111]
    ds_read_b64_tr_b16 v[150:151], v27 offset:43776
    s_waitcnt vmcnt(19)
    s_waitcnt lgkmcnt(15)
    v_mfma_f32_16x16x32_bf16 v[32:35], v[112:115], a[80:83], v[32:35]
    ds_read_b64_tr_b16 v[152:153], v26 offset:51200
    v_mfma_f32_16x16x32_bf16 v[72:75], v[112:115], a[84:87], v[72:75]
    ds_read_b64_tr_b16 v[154:155], v26 offset:53760
    s_mov_b32 s26, 2621440
    s_mov_b32 s27, 0x00020000
    v_mfma_f32_16x16x32_bf16 v[36:39], v[116:119], a[80:83], v[36:39]
    ds_read_b64_tr_b16 v[156:157], v27 offset:51200
    v_mfma_f32_16x16x32_bf16 v[76:79], v[116:119], a[84:87], v[76:79]
    ds_read_b64_tr_b16 v[158:159], v27 offset:53760
    s_mov_b32 s30, 2621440
    s_mov_b32 s31, 0x00020000
    s_waitcnt lgkmcnt(15)
    v_mfma_f32_16x16x32_bf16 v[40:43], v[120:123], a[80:83], v[40:43]
    ds_read_b64_tr_b16 v[160:161], v26 offset:51264
    v_mfma_f32_16x16x32_bf16 v[80:83], v[120:123], a[84:87], v[80:83]
    ds_read_b64_tr_b16 v[162:163], v26 offset:53824
    buffer_load_dwordx2 v[8:9], v20, s[24:27], 0 offen offset:0
    v_mfma_f32_16x16x32_bf16 v[44:47], v[124:127], a[80:83], v[44:47]
    ds_read_b64_tr_b16 v[164:165], v27 offset:51264
    v_mfma_f32_16x16x32_bf16 v[84:87], v[124:127], a[84:87], v[84:87]
    ds_read_b64_tr_b16 v[166:167], v27 offset:53824
    s_waitcnt lgkmcnt(15)
    v_mfma_f32_16x16x32_bf16 v[48:51], v[128:131], a[80:83], v[48:51]
    ds_read_b64_tr_b16 v[168:169], v26 offset:51328
    buffer_load_dwordx2 v[10:11], v20, s[24:27], 0 offen offset:32
    v_mfma_f32_16x16x32_bf16 v[88:91], v[128:131], a[84:87], v[88:91]
    ds_read_b64_tr_b16 v[170:171], v26 offset:53888
    v_mfma_f32_16x16x32_bf16 v[52:55], v[132:135], a[80:83], v[52:55]
    ds_read_b64_tr_b16 v[172:173], v27 offset:51328
    buffer_load_dwordx2 v[12:13], v20, s[24:27], 0 offen offset:64
    v_mfma_f32_16x16x32_bf16 v[92:95], v[132:135], a[84:87], v[92:95]
    ds_read_b64_tr_b16 v[174:175], v27 offset:53888
    s_waitcnt lgkmcnt(15)
    v_mfma_f32_16x16x32_bf16 v[56:59], v[136:139], a[80:83], v[56:59]
    ds_read_b64_tr_b16 v[176:177], v26 offset:51392
    buffer_load_dwordx2 v[14:15], v20, s[24:27], 0 offen offset:96
    v_mfma_f32_16x16x32_bf16 v[96:99], v[136:139], a[84:87], v[96:99]
    ds_read_b64_tr_b16 v[178:179], v26 offset:53952
    v_mfma_f32_16x16x32_bf16 v[60:63], v[140:143], a[80:83], v[60:63]
    ds_read_b64_tr_b16 v[180:181], v27 offset:51392
    v_mfma_f32_16x16x32_bf16 v[100:103], v[140:143], a[84:87], v[100:103]
    ds_read_b64_tr_b16 v[182:183], v27 offset:53952
    buffer_load_dwordx2 v[16:17], v20, s[24:27], 0 offen offset:128
    s_waitcnt lgkmcnt(15)
    v_mfma_f32_16x16x32_bf16 v[64:67], v[144:147], a[80:83], v[64:67]
    ds_read_b64_tr_b16 v[184:185], v26 offset:51456
    v_mfma_f32_16x16x32_bf16 v[104:107], v[144:147], a[84:87], v[104:107]
    ds_read_b64_tr_b16 v[186:187], v26 offset:54016
    buffer_load_dword v2, v21, s[40:43], s57 offen sc1
    v_mfma_f32_16x16x32_bf16 v[68:71], v[148:151], a[80:83], v[68:71]
    ds_read_b64_tr_b16 v[188:189], v27 offset:51456
    v_mfma_f32_16x16x32_bf16 v[108:111], v[148:151], a[84:87], v[108:111]
    ds_read_b64_tr_b16 v[190:191], v27 offset:54016
    s_waitcnt vmcnt(6)
    v_and_b32 v192, v192, v193
    v_and_b32 v194, v194, v195
    v_and_b32 v192, v192, v194
    v_cmp_ne_u32 vcc, 1, v192
    s_cbranch_vccnz main_kernel_yspin
main_kernel_yok:
    s_barrier
    s_waitcnt lgkmcnt(15)
    v_mfma_f32_16x16x32_bf16 v[32:35], v[152:155], a[88:91], v[32:35]
    ds_read_b64_tr_b16 v[112:113], v28 offset:0
    v_mfma_f32_16x16x32_bf16 v[72:75], v[152:155], a[92:95], v[72:75]
    ds_read_b64_tr_b16 v[114:115], v28 offset:2560
    v_lshrrev_b32 v5, 2, v1
    v_mul_u32_u24 v5, 80, v5
    v_mfma_f32_16x16x32_bf16 v[36:39], v[156:159], a[88:91], v[36:39]
    ds_read_b64_tr_b16 v[116:117], v29 offset:0
    v_and_b32 v6, 3, v1
    v_mfma_f32_16x16x32_bf16 v[76:79], v[156:159], a[92:95], v[76:79]
    ds_read_b64_tr_b16 v[118:119], v29 offset:2560
    v_lshlrev_b32 v6, 3, v6
    s_waitcnt lgkmcnt(15)
    v_mfma_f32_16x16x32_bf16 v[40:43], v[160:163], a[88:91], v[40:43]
    ds_read_b64_tr_b16 v[120:121], v28 offset:64
    s_lshr_b32 s58, s44, 1
    v_mfma_f32_16x16x32_bf16 v[80:83], v[160:163], a[92:95], v[80:83]
    ds_read_b64_tr_b16 v[122:123], v28 offset:2624
    s_lshl_b32 s58, s58, 5
    s_and_b32 s59, s44, 1
    v_mfma_f32_16x16x32_bf16 v[44:47], v[164:167], a[88:91], v[44:47]
    ds_read_b64_tr_b16 v[124:125], v29 offset:64
    s_mul_i32 s59, s59, 6400
    v_mfma_f32_16x16x32_bf16 v[84:87], v[164:167], a[92:95], v[84:87]
    ds_read_b64_tr_b16 v[126:127], v29 offset:2624
    s_add_u32 s58, s58, s59
    s_waitcnt lgkmcnt(15)
    v_mfma_f32_16x16x32_bf16 v[48:51], v[168:171], a[88:91], v[48:51]
    ds_read_b64_tr_b16 v[128:129], v28 offset:128
    s_add_u32 s58, s58, 20480
    v_mfma_f32_16x16x32_bf16 v[88:91], v[168:171], a[92:95], v[88:91]
    ds_read_b64_tr_b16 v[130:131], v28 offset:2688
    v_add3_u32 v5, v5, v6, s58
    v_mfma_f32_16x16x32_bf16 v[52:55], v[172:175], a[88:91], v[52:55]
    ds_read_b64_tr_b16 v[132:133], v29 offset:128
    v_lshrrev_b32 v23, 2, v0
    v_and_b32 v6, 3, v0
    v_mfma_f32_16x16x32_bf16 v[92:95], v[172:175], a[92:95], v[92:95]
    ds_read_b64_tr_b16 v[134:135], v29 offset:2688
    s_mul_i32 s58, s46, 160
    s_waitcnt lgkmcnt(15)
    v_mfma_f32_16x16x32_bf16 v[56:59], v[176:179], a[88:91], v[56:59]
    ds_read_b64_tr_b16 v[136:137], v28 offset:192
    v_add_u32 v22, s58, v23
    v_mfma_f32_16x16x32_bf16 v[96:99], v[176:179], a[92:95], v[96:99]
    ds_read_b64_tr_b16 v[138:139], v28 offset:2752
    v_lshlrev_b32 v22, 12, v22
    v_mfma_f32_16x16x32_bf16 v[60:63], v[180:183], a[88:91], v[60:63]
    ds_read_b64_tr_b16 v[140:141], v29 offset:192
    v_lshlrev_b32 v6, 4, v6
    v_mfma_f32_16x16x32_bf16 v[100:103], v[180:183], a[92:95], v[100:103]
    ds_read_b64_tr_b16 v[142:143], v29 offset:2752
    s_lshl_b32 s58, s49, 1
    s_add_u32 s58, s58, 0x4400000
    s_waitcnt lgkmcnt(15)
    v_mfma_f32_16x16x32_bf16 v[64:67], v[184:187], a[88:91], v[64:67]
    ds_read_b64_tr_b16 v[144:145], v28 offset:256
    v_add3_u32 v22, v22, v6, s58
    v_mfma_f32_16x16x32_bf16 v[104:107], v[184:187], a[92:95], v[104:107]
    ds_read_b64_tr_b16 v[146:147], v28 offset:2816
    v_mul_u32_u24 v23, 80, v23
    v_mfma_f32_16x16x32_bf16 v[68:71], v[188:191], a[88:91], v[68:71]
    ds_read_b64_tr_b16 v[148:149], v29 offset:256
    v_add_u32 v23, v23, v6
    v_mfma_f32_16x16x32_bf16 v[108:111], v[188:191], a[92:95], v[108:111]
    ds_read_b64_tr_b16 v[150:151], v29 offset:2816
    v_add_u32 v23, 20480, v23
    s_waitcnt lgkmcnt(15)
    v_mfma_f32_16x16x32_bf16 v[32:35], v[112:115], a[96:99], v[32:35]
    ds_read_b64_tr_b16 v[152:153], v28 offset:10240
    v_mfma_f32_16x16x32_bf16 v[72:75], v[112:115], a[100:103], v[72:75]
    ds_read_b64_tr_b16 v[154:155], v28 offset:12800
    s_mov_b32 s60, 0x40000
    s_mov_b32 s61, 0x80000
    v_mfma_f32_16x16x32_bf16 v[36:39], v[116:119], a[96:99], v[36:39]
    ds_read_b64_tr_b16 v[156:157], v29 offset:10240
    s_lshl_b32 s59, s48, 7
    v_mfma_f32_16x16x32_bf16 v[76:79], v[116:119], a[100:103], v[76:79]
    ds_read_b64_tr_b16 v[158:159], v29 offset:12800
    s_add_u32 s59, s59, 0x4811000
    s_waitcnt lgkmcnt(15)
    v_mfma_f32_16x16x32_bf16 v[40:43], v[120:123], a[96:99], v[40:43]
    ds_read_b64_tr_b16 v[160:161], v28 offset:10304
    s_lshl_b32 s58, s47, 2
    v_mfma_f32_16x16x32_bf16 v[80:83], v[120:123], a[100:103], v[80:83]
    ds_read_b64_tr_b16 v[162:163], v28 offset:12864
    s_add_u32 s58, s58, s59
    v_mfma_f32_16x16x32_bf16 v[44:47], v[124:127], a[96:99], v[44:47]
    ds_read_b64_tr_b16 v[164:165], v29 offset:10304
    v_mov_b32 v24, s58
    v_mfma_f32_16x16x32_bf16 v[84:87], v[124:127], a[100:103], v[84:87]
    ds_read_b64_tr_b16 v[166:167], v29 offset:12864
    v_mov_b32 v25, 1
    s_waitcnt lgkmcnt(15)
    v_mfma_f32_16x16x32_bf16 v[48:51], v[128:131], a[96:99], v[48:51]
    ds_read_b64_tr_b16 v[168:169], v28 offset:10368
    v_min_u32 v19, 2, v1
    v_mfma_f32_16x16x32_bf16 v[88:91], v[128:131], a[100:103], v[88:91]
    ds_read_b64_tr_b16 v[170:171], v28 offset:12928
    v_add_u32 v19, s47, v19
    v_mfma_f32_16x16x32_bf16 v[52:55], v[132:135], a[96:99], v[52:55]
    ds_read_b64_tr_b16 v[172:173], v29 offset:10368
    v_add_u32 v19, 1, v19
    v_mfma_f32_16x16x32_bf16 v[92:95], v[132:135], a[100:103], v[92:95]
    ds_read_b64_tr_b16 v[174:175], v29 offset:12928
    v_and_b32 v19, 3, v19
    s_waitcnt lgkmcnt(15)
    v_mfma_f32_16x16x32_bf16 v[56:59], v[136:139], a[96:99], v[56:59]
    ds_read_b64_tr_b16 v[176:177], v28 offset:10432
    v_lshlrev_b32 v19, 2, v19
    v_mfma_f32_16x16x32_bf16 v[96:99], v[136:139], a[100:103], v[96:99]
    ds_read_b64_tr_b16 v[178:179], v28 offset:12992
    v_add_u32 v19, s59, v19
    v_mfma_f32_16x16x32_bf16 v[60:63], v[140:143], a[96:99], v[60:63]
    ds_read_b64_tr_b16 v[180:181], v29 offset:10432
    v_lshlrev_b32 v18, 3, v1
    v_mfma_f32_16x16x32_bf16 v[100:103], v[140:143], a[100:103], v[100:103]
    ds_read_b64_tr_b16 v[182:183], v29 offset:12992
    s_mul_i32 s58, s44, 5120
    s_waitcnt lgkmcnt(15)
    v_mfma_f32_16x16x32_bf16 v[64:67], v[144:147], a[96:99], v[64:67]
    ds_read_b64_tr_b16 v[184:185], v28 offset:10496
    v_add_u32 v21, s58, v4
    v_mfma_f32_16x16x32_bf16 v[104:107], v[144:147], a[100:103], v[104:107]
    ds_read_b64_tr_b16 v[186:187], v28 offset:13056
    buffer_load_dwordx4 v[192:195], v22, s[40:43], 0 offen sc1
    v_mfma_f32_16x16x32_bf16 v[68:71], v[148:151], a[96:99], v[68:71]
    ds_read_b64_tr_b16 v[188:189], v29 offset:10496
    buffer_load_dwordx4 v[196:199], v22, s[40:43], s60 offen sc1
    v_mfma_f32_16x16x32_bf16 v[108:111], v[148:151], a[100:103], v[108:111]
    ds_read_b64_tr_b16 v[190:191], v29 offset:13056
    buffer_load_dwordx4 v[200:203], v22, s[40:43], s61 offen sc1
    s_waitcnt lgkmcnt(15)
    v_mfma_f32_16x16x32_bf16 v[32:35], v[152:155], a[104:107], v[32:35]
    ds_read_b64_tr_b16 v[112:113], v28 offset:20480
    v_mfma_f32_16x16x32_bf16 v[72:75], v[152:155], a[108:111], v[72:75]
    ds_read_b64_tr_b16 v[114:115], v28 offset:23040
    s_lshl_b32 s58, s48, 2
    v_mfma_f32_16x16x32_bf16 v[36:39], v[156:159], a[104:107], v[36:39]
    ds_read_b64_tr_b16 v[116:117], v29 offset:20480
    s_add_u32 s55, s58, s44
    v_mfma_f32_16x16x32_bf16 v[76:79], v[156:159], a[108:111], v[76:79]
    ds_read_b64_tr_b16 v[118:119], v29 offset:23040
    s_lshl_b32 s55, s55, 2
    s_waitcnt lgkmcnt(15)
    v_mfma_f32_16x16x32_bf16 v[40:43], v[160:163], a[104:107], v[40:43]
    ds_read_b64_tr_b16 v[120:121], v28 offset:20544
    s_add_u32 s55, s55, s47
    v_mfma_f32_16x16x32_bf16 v[80:83], v[160:163], a[108:111], v[80:83]
    ds_read_b64_tr_b16 v[122:123], v28 offset:23104
    s_mul_i32 s55, s55, 10240
    v_mfma_f32_16x16x32_bf16 v[44:47], v[164:167], a[104:107], v[44:47]
    ds_read_b64_tr_b16 v[124:125], v29 offset:20544
    s_add_u32 s55, s55, 0x0
    v_mfma_f32_16x16x32_bf16 v[84:87], v[164:167], a[108:111], v[84:87]
    ds_read_b64_tr_b16 v[126:127], v29 offset:23104
    s_add_u32 s54, s58, s47
    s_waitcnt lgkmcnt(15)
    v_mfma_f32_16x16x32_bf16 v[48:51], v[168:171], a[104:107], v[48:51]
    ds_read_b64_tr_b16 v[128:129], v28 offset:20608
    s_mul_i32 s54, s54, 40960
    v_mfma_f32_16x16x32_bf16 v[88:91], v[168:171], a[108:111], v[88:91]
    ds_read_b64_tr_b16 v[130:131], v28 offset:23168
    s_mul_i32 s59, s44, 2560
    v_mfma_f32_16x16x32_bf16 v[52:55], v[172:175], a[104:107], v[52:55]
    ds_read_b64_tr_b16 v[132:133], v29 offset:20608
    v_mfma_f32_16x16x32_bf16 v[92:95], v[172:175], a[108:111], v[92:95]
    ds_read_b64_tr_b16 v[134:135], v29 offset:23168
    s_add_u32 s54, s54, s59
    s_waitcnt lgkmcnt(15)
    v_mfma_f32_16x16x32_bf16 v[56:59], v[176:179], a[104:107], v[56:59]
    ds_read_b64_tr_b16 v[136:137], v28 offset:20672
    s_add_u32 s54, s54, 0x0
    v_mfma_f32_16x16x32_bf16 v[96:99], v[176:179], a[108:111], v[96:99]
    ds_read_b64_tr_b16 v[138:139], v28 offset:23232
    s_add_u32 s51, s47, 1
    s_and_b32 s51, s51, 3
    v_mfma_f32_16x16x32_bf16 v[60:63], v[180:183], a[104:107], v[60:63]
    ds_read_b64_tr_b16 v[140:141], v29 offset:20672
    s_mul_i32 s51, s51, 10240
    s_add_u32 s51, s51, s54
    v_mfma_f32_16x16x32_bf16 v[100:103], v[180:183], a[108:111], v[100:103]
    ds_read_b64_tr_b16 v[142:143], v29 offset:23232
    s_add_u32 s52, s47, 2
    s_and_b32 s52, s52, 3
    s_waitcnt lgkmcnt(15)
    v_mfma_f32_16x16x32_bf16 v[64:67], v[184:187], a[104:107], v[64:67]
    ds_read_b64_tr_b16 v[144:145], v28 offset:20736
    s_mul_i32 s52, s52, 10240
    s_add_u32 s52, s52, s54
    v_mfma_f32_16x16x32_bf16 v[104:107], v[184:187], a[108:111], v[104:107]
    ds_read_b64_tr_b16 v[146:147], v28 offset:23296
    s_add_u32 s53, s47, 3
    s_and_b32 s53, s53, 3
    v_mfma_f32_16x16x32_bf16 v[68:71], v[188:191], a[104:107], v[68:71]
    ds_read_b64_tr_b16 v[148:149], v29 offset:20736
    s_mul_i32 s53, s53, 10240
    s_add_u32 s53, s53, s54
    v_mfma_f32_16x16x32_bf16 v[108:111], v[188:191], a[108:111], v[108:111]
    ds_read_b64_tr_b16 v[150:151], v29 offset:23296
    s_waitcnt vmcnt(3)
    s_waitcnt lgkmcnt(15)
    v_mfma_f32_16x16x32_bf16 v[32:35], v[112:115], a[112:115], v[32:35]
    ds_read_b64_tr_b16 v[152:153], v28 offset:30720
    v_mfma_f32_16x16x32_bf16 v[72:75], v[112:115], a[116:119], v[72:75]
    ds_read_b64_tr_b16 v[154:155], v28 offset:33280
    v_mfma_f32_16x16x32_bf16 v[36:39], v[116:119], a[112:115], v[36:39]
    ds_read_b64_tr_b16 v[156:157], v29 offset:30720
    v_mfma_f32_16x16x32_bf16 v[76:79], v[116:119], a[116:119], v[76:79]
    ds_read_b64_tr_b16 v[158:159], v29 offset:33280
    s_waitcnt lgkmcnt(15)
    v_mfma_f32_16x16x32_bf16 v[40:43], v[120:123], a[112:115], v[40:43]
    ds_read_b64_tr_b16 v[160:161], v28 offset:30784
    v_mfma_f32_16x16x32_bf16 v[80:83], v[120:123], a[116:119], v[80:83]
    ds_read_b64_tr_b16 v[162:163], v28 offset:33344
    v_mfma_f32_16x16x32_bf16 v[44:47], v[124:127], a[112:115], v[44:47]
    ds_read_b64_tr_b16 v[164:165], v29 offset:30784
    v_mfma_f32_16x16x32_bf16 v[84:87], v[124:127], a[116:119], v[84:87]
    ds_read_b64_tr_b16 v[166:167], v29 offset:33344
    s_waitcnt lgkmcnt(15)
    v_mfma_f32_16x16x32_bf16 v[48:51], v[128:131], a[112:115], v[48:51]
    ds_read_b64_tr_b16 v[168:169], v28 offset:30848
    v_mfma_f32_16x16x32_bf16 v[88:91], v[128:131], a[116:119], v[88:91]
    ds_read_b64_tr_b16 v[170:171], v28 offset:33408
    v_mfma_f32_16x16x32_bf16 v[52:55], v[132:135], a[112:115], v[52:55]
    ds_read_b64_tr_b16 v[172:173], v29 offset:30848
    v_mfma_f32_16x16x32_bf16 v[92:95], v[132:135], a[116:119], v[92:95]
    ds_read_b64_tr_b16 v[174:175], v29 offset:33408
    s_waitcnt lgkmcnt(15)
    v_mfma_f32_16x16x32_bf16 v[56:59], v[136:139], a[112:115], v[56:59]
    ds_read_b64_tr_b16 v[176:177], v28 offset:30912
    v_mfma_f32_16x16x32_bf16 v[96:99], v[136:139], a[116:119], v[96:99]
    ds_read_b64_tr_b16 v[178:179], v28 offset:33472
    v_mfma_f32_16x16x32_bf16 v[60:63], v[140:143], a[112:115], v[60:63]
    ds_read_b64_tr_b16 v[180:181], v29 offset:30912
    v_mfma_f32_16x16x32_bf16 v[100:103], v[140:143], a[116:119], v[100:103]
    ds_read_b64_tr_b16 v[182:183], v29 offset:33472
    s_waitcnt lgkmcnt(15)
    v_mfma_f32_16x16x32_bf16 v[64:67], v[144:147], a[112:115], v[64:67]
    ds_read_b64_tr_b16 v[184:185], v28 offset:30976
    v_mfma_f32_16x16x32_bf16 v[104:107], v[144:147], a[116:119], v[104:107]
    ds_read_b64_tr_b16 v[186:187], v28 offset:33536
    v_mfma_f32_16x16x32_bf16 v[68:71], v[148:151], a[112:115], v[68:71]
    ds_read_b64_tr_b16 v[188:189], v29 offset:30976
    v_mfma_f32_16x16x32_bf16 v[108:111], v[148:151], a[116:119], v[108:111]
    ds_read_b64_tr_b16 v[190:191], v29 offset:33536
    s_waitcnt lgkmcnt(15)
    v_mfma_f32_16x16x32_bf16 v[32:35], v[152:155], a[120:123], v[32:35]
    v_mfma_f32_16x16x32_bf16 v[72:75], v[152:155], a[124:127], v[72:75]
    v_mfma_f32_16x16x32_bf16 v[36:39], v[156:159], a[120:123], v[36:39]
    v_mfma_f32_16x16x32_bf16 v[76:79], v[156:159], a[124:127], v[76:79]
    s_waitcnt lgkmcnt(12)
    v_mfma_f32_16x16x32_bf16 v[40:43], v[160:163], a[120:123], v[40:43]
    v_mfma_f32_16x16x32_bf16 v[80:83], v[160:163], a[124:127], v[80:83]
    v_mfma_f32_16x16x32_bf16 v[44:47], v[164:167], a[120:123], v[44:47]
    v_mfma_f32_16x16x32_bf16 v[84:87], v[164:167], a[124:127], v[84:87]
    s_waitcnt lgkmcnt(8)
    v_mfma_f32_16x16x32_bf16 v[48:51], v[168:171], a[120:123], v[48:51]
    v_mfma_f32_16x16x32_bf16 v[88:91], v[168:171], a[124:127], v[88:91]
    v_mfma_f32_16x16x32_bf16 v[52:55], v[172:175], a[120:123], v[52:55]
    v_mfma_f32_16x16x32_bf16 v[92:95], v[172:175], a[124:127], v[92:95]
    s_waitcnt lgkmcnt(4)
    v_mfma_f32_16x16x32_bf16 v[56:59], v[176:179], a[120:123], v[56:59]
    v_mfma_f32_16x16x32_bf16 v[96:99], v[176:179], a[124:127], v[96:99]
    v_mfma_f32_16x16x32_bf16 v[60:63], v[180:183], a[120:123], v[60:63]
    v_mfma_f32_16x16x32_bf16 v[100:103], v[180:183], a[124:127], v[100:103]
    s_waitcnt lgkmcnt(0)
    v_mfma_f32_16x16x32_bf16 v[64:67], v[184:187], a[120:123], v[64:67]
    v_mfma_f32_16x16x32_bf16 v[104:107], v[184:187], a[124:127], v[104:107]
    v_mfma_f32_16x16x32_bf16 v[68:71], v[188:191], a[120:123], v[68:71]
    v_mfma_f32_16x16x32_bf16 v[108:111], v[188:191], a[124:127], v[108:111]
    s_cmp_eq_u32 s44, s47
    s_cbranch_scc1 main_kernel_own
    v_cvt_pk_bf16_f32 v112, v32, v33
    v_cvt_pk_bf16_f32 v113, v34, v35
    v_cvt_pk_bf16_f32 v114, v36, v37
    v_cvt_pk_bf16_f32 v115, v38, v39
    v_cvt_pk_bf16_f32 v116, v40, v41
    v_cvt_pk_bf16_f32 v117, v42, v43
    v_cvt_pk_bf16_f32 v118, v44, v45
    v_cvt_pk_bf16_f32 v119, v46, v47
    v_cvt_pk_bf16_f32 v120, v48, v49
    v_cvt_pk_bf16_f32 v121, v50, v51
    buffer_store_dwordx4 v[112:115], v4, s[40:43], s55 offen sc1
    buffer_store_dwordx4 v[116:119], v4, s[40:43], s55 offen offset:1024 sc1
    buffer_store_dwordx2 v[120:121], v18, s[40:43], s55 offen offset:2048 sc1
    s_add_u32 s55, s55, 2560
    v_cvt_pk_bf16_f32 v122, v52, v53
    v_cvt_pk_bf16_f32 v123, v54, v55
    v_cvt_pk_bf16_f32 v124, v56, v57
    v_cvt_pk_bf16_f32 v125, v58, v59
    v_cvt_pk_bf16_f32 v126, v60, v61
    v_cvt_pk_bf16_f32 v127, v62, v63
    v_cvt_pk_bf16_f32 v128, v64, v65
    v_cvt_pk_bf16_f32 v129, v66, v67
    v_cvt_pk_bf16_f32 v130, v68, v69
    v_cvt_pk_bf16_f32 v131, v70, v71
    buffer_store_dwordx4 v[122:125], v4, s[40:43], s55 offen sc1
    buffer_store_dwordx4 v[126:129], v4, s[40:43], s55 offen offset:1024 sc1
    buffer_store_dwordx2 v[130:131], v18, s[40:43], s55 offen offset:2048 sc1
    s_add_u32 s55, s55, 2560
    v_cvt_pk_bf16_f32 v132, v72, v73
    v_cvt_pk_bf16_f32 v133, v74, v75
    v_cvt_pk_bf16_f32 v134, v76, v77
    v_cvt_pk_bf16_f32 v135, v78, v79
    v_cvt_pk_bf16_f32 v136, v80, v81
    v_cvt_pk_bf16_f32 v137, v82, v83
    v_cvt_pk_bf16_f32 v138, v84, v85
    v_cvt_pk_bf16_f32 v139, v86, v87
    v_cvt_pk_bf16_f32 v140, v88, v89
    v_cvt_pk_bf16_f32 v141, v90, v91
    buffer_store_dwordx4 v[132:135], v4, s[40:43], s55 offen sc1
    buffer_store_dwordx4 v[136:139], v4, s[40:43], s55 offen offset:1024 sc1
    buffer_store_dwordx2 v[140:141], v18, s[40:43], s55 offen offset:2048 sc1
    s_add_u32 s55, s55, 2560
    v_cvt_pk_bf16_f32 v142, v92, v93
    v_cvt_pk_bf16_f32 v143, v94, v95
    v_cvt_pk_bf16_f32 v144, v96, v97
    v_cvt_pk_bf16_f32 v145, v98, v99
    v_cvt_pk_bf16_f32 v146, v100, v101
    v_cvt_pk_bf16_f32 v147, v102, v103
    v_cvt_pk_bf16_f32 v148, v104, v105
    v_cvt_pk_bf16_f32 v149, v106, v107
    v_cvt_pk_bf16_f32 v150, v108, v109
    v_cvt_pk_bf16_f32 v151, v110, v111
    buffer_store_dwordx4 v[142:145], v4, s[40:43], s55 offen sc1
    buffer_store_dwordx4 v[146:149], v4, s[40:43], s55 offen offset:1024 sc1
    buffer_store_dwordx2 v[150:151], v18, s[40:43], s55 offen offset:2048 sc1
    s_add_u32 s55, s55, 2560
    s_branch main_kernel_sent
main_kernel_own:
    ds_write_b128 v4, v[32:35] offset:0
    ds_write_b128 v4, v[36:39] offset:1024
    ds_write_b128 v4, v[40:43] offset:2048
    ds_write_b128 v4, v[44:47] offset:3072
    ds_write_b128 v4, v[48:51] offset:4096
    ds_write_b128 v4, v[52:55] offset:5120
    ds_write_b128 v4, v[56:59] offset:6144
    ds_write_b128 v4, v[60:63] offset:7168
    ds_write_b128 v4, v[64:67] offset:8192
    ds_write_b128 v4, v[68:71] offset:9216
    ds_write_b128 v4, v[72:75] offset:10240
    ds_write_b128 v4, v[76:79] offset:11264
    ds_write_b128 v4, v[80:83] offset:12288
    ds_write_b128 v4, v[84:87] offset:13312
    ds_write_b128 v4, v[88:91] offset:14336
    ds_write_b128 v4, v[92:95] offset:15360
    ds_write_b128 v4, v[96:99] offset:16384
    ds_write_b128 v4, v[100:103] offset:17408
    ds_write_b128 v4, v[104:107] offset:18432
    ds_write_b128 v4, v[108:111] offset:19456
main_kernel_sent:
    v_sub_f32 v3, 1.0, v2
    v_cvt_pk_bf16_f32 v3, v3, v3
    v_lshlrev_b32 v3, 16, v3
    v_lshlrev_b32 v152, 16, v8
    v_and_b32 v153, s50, v8
    v_lshlrev_b32 v154, 16, v9
    v_and_b32 v155, s50, v9
    v_mul_f32 v152, v3, v152
    v_mul_f32 v153, v3, v153
    v_mul_f32 v154, v3, v154
    v_mul_f32 v155, v3, v155
    v_lshlrev_b32 v156, 16, v10
    v_and_b32 v157, s50, v10
    v_lshlrev_b32 v158, 16, v11
    v_and_b32 v159, s50, v11
    v_mul_f32 v156, v3, v156
    v_mul_f32 v157, v3, v157
    v_mul_f32 v158, v3, v158
    v_mul_f32 v159, v3, v159
    v_lshlrev_b32 v160, 16, v12
    v_and_b32 v161, s50, v12
    v_lshlrev_b32 v162, 16, v13
    v_and_b32 v163, s50, v13
    v_mul_f32 v160, v3, v160
    v_mul_f32 v161, v3, v161
    v_mul_f32 v162, v3, v162
    v_mul_f32 v163, v3, v163
    v_lshlrev_b32 v164, 16, v14
    v_and_b32 v165, s50, v14
    v_lshlrev_b32 v166, 16, v15
    v_and_b32 v167, s50, v15
    v_mul_f32 v164, v3, v164
    v_mul_f32 v165, v3, v165
    v_mul_f32 v166, v3, v166
    v_mul_f32 v167, v3, v167
    v_lshlrev_b32 v168, 16, v16
    v_and_b32 v169, s50, v16
    v_lshlrev_b32 v170, 16, v17
    v_and_b32 v171, s50, v17
    v_mul_f32 v168, v3, v168
    v_mul_f32 v169, v3, v169
    v_mul_f32 v170, v3, v170
    v_mul_f32 v171, v3, v171
    buffer_load_dword v10, v19, s[40:43], 0 offen sc1
    s_waitcnt vmcnt(0)
    v_cmp_ne_u32 vcc, 1, v10
    s_mov_b32 s56, 0
    s_cbranch_vccnz main_kernel_xne
    s_mov_b32 s56, 1
    buffer_load_dwordx4 v[204:207], v4, s[40:43], s51 offen sc1
    buffer_load_dwordx4 v[208:211], v4, s[40:43], s51 offen offset:1024 sc1
    buffer_load_dwordx2 v[212:213], v18, s[40:43], s51 offen offset:2048 sc1
    buffer_load_dwordx4 v[216:219], v4, s[40:43], s52 offen sc1
    buffer_load_dwordx4 v[220:223], v4, s[40:43], s52 offen offset:1024 sc1
    buffer_load_dwordx2 v[224:225], v18, s[40:43], s52 offen offset:2048 sc1
    buffer_load_dwordx4 v[228:231], v4, s[40:43], s53 offen sc1
    buffer_load_dwordx4 v[232:235], v4, s[40:43], s53 offen offset:1024 sc1
    buffer_load_dwordx2 v[236:237], v18, s[40:43], s53 offen offset:2048 sc1
main_kernel_xne:
    ds_write_b128 v23, v[192:195] offset:0
    ds_write_b128 v23, v[196:199] offset:5120
    ds_write_b128 v23, v[200:203] offset:10240
    s_waitcnt lgkmcnt(0)
    s_barrier
    s_cmp_lg_u32 s44, 0
    s_cbranch_scc1 main_kernel_nxf
    s_mov_b64 exec, 1
    buffer_store_dword v25, v24, s[40:43], 0 offen sc1
    s_mov_b64 exec, -1
main_kernel_nxf:
    ds_read_b64_tr_b16 v[84:85], v5 offset:0
    ds_read_b64_tr_b16 v[86:87], v5 offset:1280
    ds_read_b64_tr_b16 v[88:89], v5 offset:2560
    ds_read_b64_tr_b16 v[90:91], v5 offset:3840
    ds_read_b64_tr_b16 v[92:93], v5 offset:5120
    ds_read_b128 v[112:115], v21 offset:0
    ds_read_b128 v[116:119], v21 offset:1024
    ds_read_b128 v[120:123], v21 offset:2048
    ds_read_b128 v[124:127], v21 offset:3072
    ds_read_b128 v[128:131], v21 offset:4096
    s_waitcnt lgkmcnt(5)
    v_lshlrev_b32 v132, 16, v84
    v_and_b32 v133, s50, v84
    v_lshlrev_b32 v134, 16, v85
    v_and_b32 v135, s50, v85
    v_pk_mul_f32 v[152:153], v[152:153], v[132:133]
    v_pk_mul_f32 v[154:155], v[154:155], v[134:135]
    v_lshlrev_b32 v136, 16, v86
    v_and_b32 v137, s50, v86
    v_lshlrev_b32 v138, 16, v87
    v_and_b32 v139, s50, v87
    v_pk_mul_f32 v[156:157], v[156:157], v[136:137]
    v_pk_mul_f32 v[158:159], v[158:159], v[138:139]
    v_lshlrev_b32 v140, 16, v88
    v_and_b32 v141, s50, v88
    v_lshlrev_b32 v142, 16, v89
    v_and_b32 v143, s50, v89
    v_pk_mul_f32 v[160:161], v[160:161], v[140:141]
    v_pk_mul_f32 v[162:163], v[162:163], v[142:143]
    v_lshlrev_b32 v144, 16, v90
    v_and_b32 v145, s50, v90
    v_lshlrev_b32 v146, 16, v91
    v_and_b32 v147, s50, v91
    v_pk_mul_f32 v[164:165], v[164:165], v[144:145]
    v_pk_mul_f32 v[166:167], v[166:167], v[146:147]
    v_lshlrev_b32 v148, 16, v92
    v_and_b32 v149, s50, v92
    v_lshlrev_b32 v150, 16, v93
    v_and_b32 v151, s50, v93
    v_pk_mul_f32 v[168:169], v[168:169], v[148:149]
    v_pk_mul_f32 v[170:171], v[170:171], v[150:151]
    s_cmp_eq_u32 s56, 1
    s_cbranch_scc1 main_kernel_xgo
    s_mov_b32 s59, 0x100000
main_kernel_xsp:
    buffer_load_dword v10, v19, s[40:43], 0 offen sc1
    s_waitcnt vmcnt(0)
    v_cmp_ne_u32 vcc, 1, v10
    s_sub_u32 s59, s59, 1
    s_cmp_eq_u32 s59, 0
    s_cbranch_scc1 main_kernel_xok
    s_cbranch_vccz main_kernel_xok
    s_sleep 2
    s_branch main_kernel_xsp
main_kernel_xok:
    buffer_load_dwordx4 v[204:207], v4, s[40:43], s51 offen sc1
    buffer_load_dwordx4 v[208:211], v4, s[40:43], s51 offen offset:1024 sc1
    buffer_load_dwordx2 v[212:213], v18, s[40:43], s51 offen offset:2048 sc1
    buffer_load_dwordx4 v[216:219], v4, s[40:43], s52 offen sc1
    buffer_load_dwordx4 v[220:223], v4, s[40:43], s52 offen offset:1024 sc1
    buffer_load_dwordx2 v[224:225], v18, s[40:43], s52 offen offset:2048 sc1
    buffer_load_dwordx4 v[228:231], v4, s[40:43], s53 offen sc1
    buffer_load_dwordx4 v[232:235], v4, s[40:43], s53 offen offset:1024 sc1
    buffer_load_dwordx2 v[236:237], v18, s[40:43], s53 offen offset:2048 sc1
main_kernel_xgo:
    s_waitcnt lgkmcnt(0)
    s_waitcnt vmcnt(6)
    v_lshlrev_b32 v132, 16, v204
    v_and_b32 v133, s50, v204
    v_lshlrev_b32 v134, 16, v205
    v_and_b32 v135, s50, v205
    v_pk_add_f32 v[112:113], v[112:113], v[132:133]
    v_pk_add_f32 v[114:115], v[114:115], v[134:135]
    v_lshlrev_b32 v136, 16, v206
    v_and_b32 v137, s50, v206
    v_lshlrev_b32 v138, 16, v207
    v_and_b32 v139, s50, v207
    v_pk_add_f32 v[116:117], v[116:117], v[136:137]
    v_pk_add_f32 v[118:119], v[118:119], v[138:139]
    v_lshlrev_b32 v140, 16, v208
    v_and_b32 v141, s50, v208
    v_lshlrev_b32 v142, 16, v209
    v_and_b32 v143, s50, v209
    v_pk_add_f32 v[120:121], v[120:121], v[140:141]
    v_pk_add_f32 v[122:123], v[122:123], v[142:143]
    v_lshlrev_b32 v144, 16, v210
    v_and_b32 v145, s50, v210
    v_lshlrev_b32 v146, 16, v211
    v_and_b32 v147, s50, v211
    v_pk_add_f32 v[124:125], v[124:125], v[144:145]
    v_pk_add_f32 v[126:127], v[126:127], v[146:147]
    v_lshlrev_b32 v148, 16, v212
    v_and_b32 v149, s50, v212
    v_lshlrev_b32 v150, 16, v213
    v_and_b32 v151, s50, v213
    v_pk_add_f32 v[128:129], v[128:129], v[148:149]
    v_pk_add_f32 v[130:131], v[130:131], v[150:151]
    s_waitcnt vmcnt(3)
    v_lshlrev_b32 v132, 16, v216
    v_and_b32 v133, s50, v216
    v_lshlrev_b32 v134, 16, v217
    v_and_b32 v135, s50, v217
    v_pk_add_f32 v[112:113], v[112:113], v[132:133]
    v_pk_add_f32 v[114:115], v[114:115], v[134:135]
    v_lshlrev_b32 v136, 16, v218
    v_and_b32 v137, s50, v218
    v_lshlrev_b32 v138, 16, v219
    v_and_b32 v139, s50, v219
    v_pk_add_f32 v[116:117], v[116:117], v[136:137]
    v_pk_add_f32 v[118:119], v[118:119], v[138:139]
    v_lshlrev_b32 v140, 16, v220
    v_and_b32 v141, s50, v220
    v_lshlrev_b32 v142, 16, v221
    v_and_b32 v143, s50, v221
    v_pk_add_f32 v[120:121], v[120:121], v[140:141]
    v_pk_add_f32 v[122:123], v[122:123], v[142:143]
    v_lshlrev_b32 v144, 16, v222
    v_and_b32 v145, s50, v222
    v_lshlrev_b32 v146, 16, v223
    v_and_b32 v147, s50, v223
    v_pk_add_f32 v[124:125], v[124:125], v[144:145]
    v_pk_add_f32 v[126:127], v[126:127], v[146:147]
    v_lshlrev_b32 v148, 16, v224
    v_and_b32 v149, s50, v224
    v_lshlrev_b32 v150, 16, v225
    v_and_b32 v151, s50, v225
    v_pk_add_f32 v[128:129], v[128:129], v[148:149]
    v_pk_add_f32 v[130:131], v[130:131], v[150:151]
    s_waitcnt vmcnt(0)
    v_lshlrev_b32 v132, 16, v228
    v_and_b32 v133, s50, v228
    v_lshlrev_b32 v134, 16, v229
    v_and_b32 v135, s50, v229
    v_pk_add_f32 v[112:113], v[112:113], v[132:133]
    v_pk_add_f32 v[114:115], v[114:115], v[134:135]
    v_fmac_f32 v152, v2, v112
    v_fmac_f32 v153, v2, v113
    v_fmac_f32 v154, v2, v114
    v_fmac_f32 v155, v2, v115
    v_cvt_pk_bf16_f32 v132, v152, v153
    v_cvt_pk_bf16_f32 v133, v154, v155
    buffer_store_dwordx2 v[132:133], v20, s[28:31], 0 offen offset:0
    v_lshlrev_b32 v136, 16, v230
    v_and_b32 v137, s50, v230
    v_lshlrev_b32 v138, 16, v231
    v_and_b32 v139, s50, v231
    v_pk_add_f32 v[116:117], v[116:117], v[136:137]
    v_pk_add_f32 v[118:119], v[118:119], v[138:139]
    v_fmac_f32 v156, v2, v116
    v_fmac_f32 v157, v2, v117
    v_fmac_f32 v158, v2, v118
    v_fmac_f32 v159, v2, v119
    v_cvt_pk_bf16_f32 v136, v156, v157
    v_cvt_pk_bf16_f32 v137, v158, v159
    buffer_store_dwordx2 v[136:137], v20, s[28:31], 0 offen offset:32
    v_lshlrev_b32 v140, 16, v232
    v_and_b32 v141, s50, v232
    v_lshlrev_b32 v142, 16, v233
    v_and_b32 v143, s50, v233
    v_pk_add_f32 v[120:121], v[120:121], v[140:141]
    v_pk_add_f32 v[122:123], v[122:123], v[142:143]
    v_fmac_f32 v160, v2, v120
    v_fmac_f32 v161, v2, v121
    v_fmac_f32 v162, v2, v122
    v_fmac_f32 v163, v2, v123
    v_cvt_pk_bf16_f32 v140, v160, v161
    v_cvt_pk_bf16_f32 v141, v162, v163
    buffer_store_dwordx2 v[140:141], v20, s[28:31], 0 offen offset:64
    v_lshlrev_b32 v144, 16, v234
    v_and_b32 v145, s50, v234
    v_lshlrev_b32 v146, 16, v235
    v_and_b32 v147, s50, v235
    v_pk_add_f32 v[124:125], v[124:125], v[144:145]
    v_pk_add_f32 v[126:127], v[126:127], v[146:147]
    v_fmac_f32 v164, v2, v124
    v_fmac_f32 v165, v2, v125
    v_fmac_f32 v166, v2, v126
    v_fmac_f32 v167, v2, v127
    v_cvt_pk_bf16_f32 v144, v164, v165
    v_cvt_pk_bf16_f32 v145, v166, v167
    buffer_store_dwordx2 v[144:145], v20, s[28:31], 0 offen offset:96
    v_lshlrev_b32 v148, 16, v236
    v_and_b32 v149, s50, v236
    v_lshlrev_b32 v150, 16, v237
    v_and_b32 v151, s50, v237
    v_pk_add_f32 v[128:129], v[128:129], v[148:149]
    v_pk_add_f32 v[130:131], v[130:131], v[150:151]
    v_fmac_f32 v168, v2, v128
    v_fmac_f32 v169, v2, v129
    v_fmac_f32 v170, v2, v130
    v_fmac_f32 v171, v2, v131
    v_cvt_pk_bf16_f32 v148, v168, v169
    v_cvt_pk_bf16_f32 v149, v170, v171
    buffer_store_dwordx2 v[148:149], v20, s[28:31], 0 offen offset:128
main_kernel_end:
    s_endpgm
main_kernel_sw2:
    v_mov_b32 v18, v14
    v_mov_b32 v20, 0
    v_mov_b32 v21, 0
    v_permlane32_swap_b32 v18, v14
    v_mov_b32 v22, 0
    v_mov_b32 v23, 0
    v_add_f32 v18, v18, v14
    v_rcp_f32 v18, v18
    s_nop 1
    v_mov_b32 v19, v18
    v_accvgpr_read_b32 v32, a64
    v_accvgpr_read_b32 v33, a65
    v_accvgpr_read_b32 v34, a66
    v_accvgpr_read_b32 v35, a67
    v_accvgpr_read_b32 v36, a68
    v_accvgpr_read_b32 v37, a69
    v_accvgpr_read_b32 v38, a70
    v_accvgpr_read_b32 v39, a71
    v_accvgpr_read_b32 v40, a72
    v_accvgpr_read_b32 v41, a73
    v_accvgpr_read_b32 v42, a74
    v_accvgpr_read_b32 v43, a75
    v_accvgpr_read_b32 v44, a76
    v_accvgpr_read_b32 v45, a77
    v_accvgpr_read_b32 v46, a78
    v_accvgpr_read_b32 v47, a79
    v_mfma_f32_32x32x16_bf16 a[64:79], v[20:23], v[20:23], 0
    v_pk_mul_f32 v[32:33], v[32:33], v[18:19]
    v_pk_mul_f32 v[34:35], v[34:35], v[18:19]
    v_pk_mul_f32 v[36:37], v[36:37], v[18:19]
    v_pk_mul_f32 v[38:39], v[38:39], v[18:19]
    v_pk_mul_f32 v[40:41], v[40:41], v[18:19]
    v_pk_mul_f32 v[42:43], v[42:43], v[18:19]
    v_pk_mul_f32 v[44:45], v[44:45], v[18:19]
    v_pk_mul_f32 v[46:47], v[46:47], v[18:19]
    v_cvt_pk_bf16_f32 v112, v32, v33
    v_cvt_pk_bf16_f32 v113, v34, v35
    v_cvt_pk_bf16_f32 v114, v36, v37
    v_cvt_pk_bf16_f32 v115, v38, v39
    buffer_store_dwordx4 v[112:115], v10, s[40:43], s76 offen offset:0 sc1
    v_cvt_pk_bf16_f32 v116, v40, v41
    v_cvt_pk_bf16_f32 v117, v42, v43
    v_cvt_pk_bf16_f32 v118, v44, v45
    v_cvt_pk_bf16_f32 v119, v46, v47
    buffer_store_dwordx4 v[116:119], v10, s[40:43], s76 offen offset:512 sc1
    v_accvgpr_read_b32 v48, a80
    v_accvgpr_read_b32 v49, a81
    v_accvgpr_read_b32 v50, a82
    v_accvgpr_read_b32 v51, a83
    v_accvgpr_read_b32 v52, a84
    v_accvgpr_read_b32 v53, a85
    v_accvgpr_read_b32 v54, a86
    v_accvgpr_read_b32 v55, a87
    v_accvgpr_read_b32 v56, a88
    v_accvgpr_read_b32 v57, a89
    v_accvgpr_read_b32 v58, a90
    v_accvgpr_read_b32 v59, a91
    v_accvgpr_read_b32 v60, a92
    v_accvgpr_read_b32 v61, a93
    v_accvgpr_read_b32 v62, a94
    v_accvgpr_read_b32 v63, a95
    v_mfma_f32_32x32x16_bf16 a[80:95], v[20:23], v[20:23], 0
    v_pk_mul_f32 v[48:49], v[48:49], v[18:19]
    v_pk_mul_f32 v[50:51], v[50:51], v[18:19]
    v_pk_mul_f32 v[52:53], v[52:53], v[18:19]
    v_pk_mul_f32 v[54:55], v[54:55], v[18:19]
    v_pk_mul_f32 v[56:57], v[56:57], v[18:19]
    v_pk_mul_f32 v[58:59], v[58:59], v[18:19]
    v_pk_mul_f32 v[60:61], v[60:61], v[18:19]
    v_pk_mul_f32 v[62:63], v[62:63], v[18:19]
    v_cvt_pk_bf16_f32 v120, v48, v49
    v_cvt_pk_bf16_f32 v121, v50, v51
    v_cvt_pk_bf16_f32 v122, v52, v53
    v_cvt_pk_bf16_f32 v123, v54, v55
    buffer_store_dwordx4 v[120:123], v10, s[40:43], s76 offen offset:1024 sc1
    v_cvt_pk_bf16_f32 v124, v56, v57
    v_cvt_pk_bf16_f32 v125, v58, v59
    v_cvt_pk_bf16_f32 v126, v60, v61
    v_cvt_pk_bf16_f32 v127, v62, v63
    buffer_store_dwordx4 v[124:127], v10, s[40:43], s76 offen offset:1536 sc1
    v_accvgpr_read_b32 v32, a96
    v_accvgpr_read_b32 v33, a97
    v_accvgpr_read_b32 v34, a98
    v_accvgpr_read_b32 v35, a99
    v_accvgpr_read_b32 v36, a100
    v_accvgpr_read_b32 v37, a101
    v_accvgpr_read_b32 v38, a102
    v_accvgpr_read_b32 v39, a103
    v_accvgpr_read_b32 v40, a104
    v_accvgpr_read_b32 v41, a105
    v_accvgpr_read_b32 v42, a106
    v_accvgpr_read_b32 v43, a107
    v_accvgpr_read_b32 v44, a108
    v_accvgpr_read_b32 v45, a109
    v_accvgpr_read_b32 v46, a110
    v_accvgpr_read_b32 v47, a111
    v_mfma_f32_32x32x16_bf16 a[96:111], v[20:23], v[20:23], 0
    v_pk_mul_f32 v[32:33], v[32:33], v[18:19]
    v_pk_mul_f32 v[34:35], v[34:35], v[18:19]
    v_pk_mul_f32 v[36:37], v[36:37], v[18:19]
    v_pk_mul_f32 v[38:39], v[38:39], v[18:19]
    v_pk_mul_f32 v[40:41], v[40:41], v[18:19]
    v_pk_mul_f32 v[42:43], v[42:43], v[18:19]
    v_pk_mul_f32 v[44:45], v[44:45], v[18:19]
    v_pk_mul_f32 v[46:47], v[46:47], v[18:19]
    v_cvt_pk_bf16_f32 v112, v32, v33
    v_cvt_pk_bf16_f32 v113, v34, v35
    v_cvt_pk_bf16_f32 v114, v36, v37
    v_cvt_pk_bf16_f32 v115, v38, v39
    buffer_store_dwordx4 v[112:115], v10, s[40:43], s76 offen offset:2048 sc1
    v_cvt_pk_bf16_f32 v116, v40, v41
    v_cvt_pk_bf16_f32 v117, v42, v43
    v_cvt_pk_bf16_f32 v118, v44, v45
    v_cvt_pk_bf16_f32 v119, v46, v47
    buffer_store_dwordx4 v[116:119], v10, s[40:43], s76 offen offset:2560 sc1
    v_accvgpr_read_b32 v48, a112
    v_accvgpr_read_b32 v49, a113
    v_accvgpr_read_b32 v50, a114
    v_accvgpr_read_b32 v51, a115
    v_accvgpr_read_b32 v52, a116
    v_accvgpr_read_b32 v53, a117
    v_accvgpr_read_b32 v54, a118
    v_accvgpr_read_b32 v55, a119
    v_accvgpr_read_b32 v56, a120
    v_accvgpr_read_b32 v57, a121
    v_accvgpr_read_b32 v58, a122
    v_accvgpr_read_b32 v59, a123
    v_accvgpr_read_b32 v60, a124
    v_accvgpr_read_b32 v61, a125
    v_accvgpr_read_b32 v62, a126
    v_accvgpr_read_b32 v63, a127
    v_mfma_f32_32x32x16_bf16 a[112:127], v[20:23], v[20:23], 0
    v_pk_mul_f32 v[48:49], v[48:49], v[18:19]
    v_pk_mul_f32 v[50:51], v[50:51], v[18:19]
    v_pk_mul_f32 v[52:53], v[52:53], v[18:19]
    v_pk_mul_f32 v[54:55], v[54:55], v[18:19]
    v_pk_mul_f32 v[56:57], v[56:57], v[18:19]
    v_pk_mul_f32 v[58:59], v[58:59], v[18:19]
    v_pk_mul_f32 v[60:61], v[60:61], v[18:19]
    v_pk_mul_f32 v[62:63], v[62:63], v[18:19]
    v_cvt_pk_bf16_f32 v120, v48, v49
    v_cvt_pk_bf16_f32 v121, v50, v51
    v_cvt_pk_bf16_f32 v122, v52, v53
    v_cvt_pk_bf16_f32 v123, v54, v55
    buffer_store_dwordx4 v[120:123], v10, s[40:43], s76 offen offset:3072 sc1
    v_cvt_pk_bf16_f32 v124, v56, v57
    v_cvt_pk_bf16_f32 v125, v58, v59
    v_cvt_pk_bf16_f32 v126, v60, v61
    v_cvt_pk_bf16_f32 v127, v62, v63
    buffer_store_dwordx4 v[124:127], v10, s[40:43], s76 offen offset:3584 sc1
    s_branch main_kernel_hCa
main_kernel_hBx:
    s_cmp_lt_i32 s49, s71
    s_cbranch_scc1 main_kernel_hBr8
    s_branch main_kernel_hBr
main_kernel_hB:
    s_cmp_eq_u32 s49, 2
    s_cbranch_scc1 main_kernel_upA
    s_cmp_eq_u32 s49, 6
    s_cbranch_scc1 main_kernel_upB
    s_cmp_eq_u32 s49, 8
    s_cbranch_scc1 main_kernel_upC
    s_add_u32 s58, s49, 1
    s_cmp_lg_u32 s58, s48
    s_cbranch_scc1 main_kernel_hB1
    v_accvgpr_write_b32 a160, v32
    v_accvgpr_write_b32 a161, v33
    v_accvgpr_write_b32 a162, v34
    v_accvgpr_write_b32 a163, v35
    v_accvgpr_write_b32 a164, v36
    v_accvgpr_write_b32 a165, v37
    v_accvgpr_write_b32 a166, v38
    v_accvgpr_write_b32 a167, v39
    v_accvgpr_write_b32 a168, v40
    v_accvgpr_write_b32 a169, v41
    v_accvgpr_write_b32 a170, v42
    v_accvgpr_write_b32 a171, v43
    v_accvgpr_write_b32 a172, v44
    v_accvgpr_write_b32 a173, v45
    v_accvgpr_write_b32 a174, v46
    v_accvgpr_write_b32 a175, v47
    v_accvgpr_write_b32 a176, v48
    v_accvgpr_write_b32 a177, v49
    v_accvgpr_write_b32 a178, v50
    v_accvgpr_write_b32 a179, v51
    v_accvgpr_write_b32 a180, v52
    v_accvgpr_write_b32 a181, v53
    v_accvgpr_write_b32 a182, v54
    v_accvgpr_write_b32 a183, v55
    v_accvgpr_write_b32 a184, v56
    v_accvgpr_write_b32 a185, v57
    v_accvgpr_write_b32 a186, v58
    v_accvgpr_write_b32 a187, v59
    v_accvgpr_write_b32 a188, v60
    v_accvgpr_write_b32 a189, v61
    v_accvgpr_write_b32 a190, v62
    v_accvgpr_write_b32 a191, v63
    v_mov_b32 v14, v13
    v_mov_b32 v13, 0
    v_mov_b32 v80, v11
    v_mov_b32 v81, v11
    v_pk_mov_b32 v[82:83], v[80:81], v[80:81]
    v_pk_mov_b32 v[84:85], v[80:81], v[80:81]
    v_pk_mov_b32 v[86:87], v[80:81], v[80:81]
    v_pk_mov_b32 v[88:89], v[80:81], v[80:81]
    v_pk_mov_b32 v[90:91], v[80:81], v[80:81]
    v_pk_mov_b32 v[92:93], v[80:81], v[80:81]
    v_pk_mov_b32 v[94:95], v[80:81], v[80:81]
    s_lshl_b32 s76, s57, 18
    s_xor_b32 s57, s56, 1
    s_lshl_b32 s58, s67, 14
    v_add_u32 v9, s58, v9
main_kernel_hB1:
    s_cmp_lt_u32 s49, 14
    s_cbranch_scc1 main_kernel_hBr
    s_cmp_eq_u32 s49, 15
    s_cbranch_scc1 main_kernel_hB2
    s_mov_b32 s53, s45
    s_mov_b32 s52, s45
    v_mov_b32 v5, v6
    s_mov_b32 s30, 32768
    s_mov_b32 s34, 24576
    s_and_b32 s58, s2, 6
    s_bfe_u32 s59, s2, 0x10005
    s_add_u32 s58, s58, s59
    s_lshr_b32 s59, s2, 6
    s_lshl_b32 s59, s59, 3
    s_add_u32 s58, s58, s59
    s_lshl_b32 s58, s58, 2
    s_bfe_u32 s59, s2, 0x20003
    s_add_u32 s58, s58, s59
    s_mul_i32 s58, s58, 40960
    s_add_u32 s28, s78, s58
    s_addc_u32 s29, s79, 0
    s_add_u32 s32, s28, 16384
    s_addc_u32 s33, s29, 0
    s_cmp_lg_u32 s44, 0
    s_cbranch_scc1 main_kernel_hBr
    v_mov_b32 v20, 128
    v_mov_b32 v21, 1
    s_mov_b64 exec, 1
    global_atomic_add v3, v20, v21, s[84:85] sc0 sc1
    s_mov_b64 exec, -1
    s_branch main_kernel_hBr
main_kernel_hB2:
    s_cmp_lg_u32 s44, 0
    s_cbranch_scc1 main_kernel_hB3
    v_mov_b32 v20, 162816
    s_mov_b64 exec, 1
    ds_write_b32 v20, v3
    s_mov_b64 exec, -1
main_kernel_hB3:
    s_getpc_b64 s[28:29]
main_kernel_pc3:
    s_sub_u32 s28, s28, main_kernel_pc3-main_kernel
    s_subb_u32 s29, s29, 0
    s_mov_b32 s30, all_code_end-main_kernel
    s_lshr_b32 s58, s2, 3
    s_and_b32 s58, s58, 3
    s_lshl_b32 s58, s58, 15
    s_add_u32 s53, s58, s45
    s_sub_u32 s58, 32, s48
    s_add_u32 s58, s58, s67
    s_lshl_b32 s58, s58, 1
    s_sub_u32 s58, s58, s56
    s_cmp_lt_i32 s58, -1
    s_cbranch_scc1 main_kernel_mXr
    s_cmp_eq_i32 s58, -1
    s_cbranch_scc1 main_kernel_mXa
    v_mov_b32 v144, v15
    v_mov_b32 v145, v15
    v_pk_mov_b32 v[146:147], v[144:145], v[144:145]
    v_pk_mov_b32 v[148:149], v[144:145], v[144:145]
    v_pk_mov_b32 v[150:151], v[144:145], v[144:145]
    v_pk_mov_b32 v[152:153], v[144:145], v[144:145]
    v_pk_mov_b32 v[154:155], v[144:145], v[144:145]
    v_pk_mov_b32 v[156:157], v[144:145], v[144:145]
    v_pk_mov_b32 v[158:159], v[144:145], v[144:145]
    s_cmp_eq_i32 s58, 0
    s_cbranch_scc1 main_kernel_mXb
    v_pk_mov_b32 v[128:129], v[144:145], v[144:145]
    v_pk_mov_b32 v[130:131], v[144:145], v[144:145]
    v_pk_mov_b32 v[132:133], v[144:145], v[144:145]
    v_pk_mov_b32 v[134:135], v[144:145], v[144:145]
    v_pk_mov_b32 v[136:137], v[144:145], v[144:145]
    v_pk_mov_b32 v[138:139], v[144:145], v[144:145]
    v_pk_mov_b32 v[140:141], v[144:145], v[144:145]
    v_pk_mov_b32 v[142:143], v[144:145], v[144:145]
    s_branch main_kernel_mXr
main_kernel_mXa:
    v_cndmask_b32 v144, v15, v144, s[4:5]
    v_cndmask_b32 v145, v15, v145, s[6:7]
    v_cndmask_b32 v146, v15, v146, s[8:9]
    v_cndmask_b32 v147, v15, v147, s[10:11]
    v_cndmask_b32 v148, v15, v148, s[12:13]
    v_cndmask_b32 v149, v15, v149, s[14:15]
    v_cndmask_b32 v150, v15, v150, s[16:17]
    v_cndmask_b32 v151, v15, v151, s[18:19]
    v_cndmask_b32 v152, v15, v152, s[20:21]
    v_cndmask_b32 v153, v15, v153, s[22:23]
    v_cndmask_b32 v154, v15, v154, s[24:25]
    v_cndmask_b32 v155, v15, v155, s[26:27]
    v_cndmask_b32 v156, v15, v156, s[36:37]
    v_cndmask_b32 v157, v15, v157, s[38:39]
    v_cndmask_b32 v158, v15, v158, s[60:61]
    v_cndmask_b32 v159, v15, v159, s[62:63]
    s_branch main_kernel_mXr
main_kernel_mXb:
    v_cndmask_b32 v128, v15, v128, s[4:5]
    v_cndmask_b32 v129, v15, v129, s[6:7]
    v_cndmask_b32 v130, v15, v130, s[8:9]
    v_cndmask_b32 v131, v15, v131, s[10:11]
    v_cndmask_b32 v132, v15, v132, s[12:13]
    v_cndmask_b32 v133, v15, v133, s[14:15]
    v_cndmask_b32 v134, v15, v134, s[16:17]
    v_cndmask_b32 v135, v15, v135, s[18:19]
    v_cndmask_b32 v136, v15, v136, s[20:21]
    v_cndmask_b32 v137, v15, v137, s[22:23]
    v_cndmask_b32 v138, v15, v138, s[24:25]
    v_cndmask_b32 v139, v15, v139, s[26:27]
    v_cndmask_b32 v140, v15, v140, s[36:37]
    v_cndmask_b32 v141, v15, v141, s[38:39]
    v_cndmask_b32 v142, v15, v142, s[60:61]
    v_cndmask_b32 v143, v15, v143, s[62:63]
main_kernel_mXr:
    s_branch main_kernel_hBr
main_kernel_upA:
    s_and_b32 s3, s2, 7
    s_lshl_b32 s3, s3, 5
    s_lshr_b32 s58, s2, 3
    s_add_u32 s3, s3, s58
    s_mul_i32 s3, s3, 10240
    s_cmp_eq_u32 s3, 0
    s_cselect_b32 s58, 0, 3840
    s_sub_u32 s59, s3, s58
    s_add_u32 s74, s58, 10240
    s_mov_b32 s75, 0x00020000
    s_mul_i32 s58, s44, 3584
    s_add_u32 m0, s58, 131072
    s_add_u32 s72, s80, s59
    s_addc_u32 s73, s81, 0
    buffer_load_dwordx4 v4, s[72:75], s58 offen offset:0 lds
    buffer_load_dwordx4 v4, s[72:75], s58 offen offset:1024 lds
    buffer_load_dwordx4 v4, s[72:75], s58 offen offset:2048 lds
    s_mov_b32 exec_hi, 0
    buffer_load_dwordx4 v4, s[72:75], s58 offen offset:3072 lds
    s_mov_b32 s74, 10240
    s_mul_i32 s58, s44, 2560
    s_add_u32 m0, s58, 145408
    s_add_u32 s72, s82, s3
    s_addc_u32 s73, s83, 0
    buffer_load_dwordx4 v4, s[72:75], s58 offen offset:2048 lds
    s_mov_b32 exec_hi, -1
    buffer_load_dwordx4 v4, s[72:75], s58 offen lds
    buffer_load_dwordx4 v4, s[72:75], s58 offen offset:1024 lds
    s_mov_b32 s74, 5120
    s_mul_i32 s58, s44, 1280
    s_add_u32 m0, s58, 155648
    s_mov_b32 s72, s78
    s_mov_b32 s73, s79
    buffer_load_dwordx4 v4, s[72:75], s58 offen lds
    s_mov_b64 exec, 0xffff
    buffer_load_dwordx4 v4, s[72:75], s58 offen offset:1024 lds
    s_mov_b64 exec, -1
    s_load_dwordx4 s[80:83], s[0:1], 80
    s_load_dwordx2 s[78:79], s[0:1], 40
    s_branch main_kernel_hBx
main_kernel_upB:
    s_and_b32 s3, s2, 7
    s_lshl_b32 s3, s3, 5
    s_lshr_b32 s58, s2, 3
    s_add_u32 s3, s3, s58
    v_min_u32 v3, 39, v1
    s_mul_i32 s58, s44, 40
    v_add_u32 v3, s58, v3
    v_lshlrev_b32 v18, 3, v3
    v_lshlrev_b32 v19, 5, v3
    v_add_u32 v19, 155648, v19
    s_cmp_eq_u32 s3, 0
    s_cselect_b32 s58, 0, 3840
    s_cselect_b32 s59, 10240, 0
    s_add_u32 s58, s58, 131072
    s_add_u32 s59, s59, 131072
    v_add_u32 v16, s58, v18
    v_add_u32 v17, s59, v18
    v_add_u32 v18, 145408, v18
    v_lshlrev_b32 v3, 14, v3
    s_lshl_b32 s58, s3, 4
    s_add_u32 s58, s58, 0x4000000
    ds_read_b128 v[20:23], v19 offset:0
    ds_read_b32 v161, v17 offset:0
    ds_read_b32 v163, v17 offset:1280
    ds_read_b32 v165, v17 offset:2560
    ds_read_b32 v167, v16 offset:0
    ds_read_b32 v169, v16 offset:1280
    ds_read_b32 v171, v16 offset:2560
    ds_read_b32 v173, v16 offset:3840
    ds_read_b32 v175, v16 offset:5120
    ds_read_b32 v177, v16 offset:6400
    ds_read_b32 v179, v16 offset:7680
    ds_read_b32 v181, v16 offset:8960
    ds_read_b32 v97, v18 offset:0
    ds_read_b32 v99, v18 offset:1280
    ds_read_b32 v101, v18 offset:2560
    ds_read_b32 v103, v18 offset:3840
    ds_read_b32 v105, v18 offset:5120
    ds_read_b32 v107, v18 offset:6400
    ds_read_b32 v109, v18 offset:7680
    ds_read_b32 v111, v18 offset:8960
    s_waitcnt lgkmcnt(8)
    v_lshlrev_b32 v182, 16, v20
    v_lshlrev_b32 v183, 16, v22
    v_and_b32 v184, s50, v20
    v_and_b32 v185, s50, v22
    v_lshlrev_b32 v186, 16, v21
    v_lshlrev_b32 v187, 16, v23
    v_and_b32 v188, s50, v21
    v_and_b32 v189, s50, v23
    v_lshlrev_b32 v160, 16, v161
    v_and_b32 v161, s50, v161
    v_lshlrev_b32 v162, 16, v163
    v_and_b32 v163, s50, v163
    v_lshlrev_b32 v164, 16, v165
    v_and_b32 v165, s50, v165
    v_lshlrev_b32 v166, 16, v167
    v_and_b32 v167, s50, v167
    v_lshlrev_b32 v168, 16, v169
    v_and_b32 v169, s50, v169
    v_lshlrev_b32 v170, 16, v171
    v_and_b32 v171, s50, v171
    v_lshlrev_b32 v172, 16, v173
    v_and_b32 v173, s50, v173
    v_lshlrev_b32 v174, 16, v175
    v_and_b32 v175, s50, v175
    v_lshlrev_b32 v176, 16, v177
    v_and_b32 v177, s50, v177
    v_lshlrev_b32 v178, 16, v179
    v_and_b32 v179, s50, v179
    v_lshlrev_b32 v180, 16, v181
    v_and_b32 v181, s50, v181
    s_waitcnt lgkmcnt(0)
    v_lshlrev_b32 v96, 16, v97
    v_and_b32 v97, s50, v97
    v_lshlrev_b32 v98, 16, v99
    v_and_b32 v99, s50, v99
    v_lshlrev_b32 v100, 16, v101
    v_and_b32 v101, s50, v101
    v_lshlrev_b32 v102, 16, v103
    v_and_b32 v103, s50, v103
    v_lshlrev_b32 v104, 16, v105
    v_and_b32 v105, s50, v105
    v_lshlrev_b32 v106, 16, v107
    v_and_b32 v107, s50, v107
    v_lshlrev_b32 v108, 16, v109
    v_and_b32 v109, s50, v109
    v_lshlrev_b32 v110, 16, v111
    v_and_b32 v111, s50, v111
    v_pk_mul_f32 v[190:191], v[188:189], v[160:161]
    v_pk_fma_f32 v[190:191], v[186:187], v[162:163], v[190:191]
    v_pk_fma_f32 v[190:191], v[184:185], v[164:165], v[190:191]
    v_pk_fma_f32 v[190:191], v[182:183], v[166:167], v[190:191]
    v_pk_mul_f32 v[96:97], v[190:191], v[96:97]
    v_pk_mul_f32 v[20:21], v[188:189], v[162:163]
    v_pk_fma_f32 v[20:21], v[186:187], v[164:165], v[20:21]
    v_pk_fma_f32 v[20:21], v[184:185], v[166:167], v[20:21]
    v_pk_fma_f32 v[20:21], v[182:183], v[168:169], v[20:21]
    v_pk_mul_f32 v[98:99], v[20:21], v[98:99]
    v_pk_mul_f32 v[190:191], v[188:189], v[164:165]
    v_pk_fma_f32 v[190:191], v[186:187], v[166:167], v[190:191]
    v_pk_fma_f32 v[190:191], v[184:185], v[168:169], v[190:191]
    v_pk_fma_f32 v[190:191], v[182:183], v[170:171], v[190:191]
    v_pk_mul_f32 v[100:101], v[190:191], v[100:101]
    v_pk_mul_f32 v[20:21], v[188:189], v[166:167]
    v_pk_fma_f32 v[20:21], v[186:187], v[168:169], v[20:21]
    v_pk_fma_f32 v[20:21], v[184:185], v[170:171], v[20:21]
    v_pk_fma_f32 v[20:21], v[182:183], v[172:173], v[20:21]
    v_pk_mul_f32 v[102:103], v[20:21], v[102:103]
    v_pk_mul_f32 v[190:191], v[188:189], v[168:169]
    v_pk_fma_f32 v[190:191], v[186:187], v[170:171], v[190:191]
    v_pk_fma_f32 v[190:191], v[184:185], v[172:173], v[190:191]
    v_pk_fma_f32 v[190:191], v[182:183], v[174:175], v[190:191]
    v_pk_mul_f32 v[104:105], v[190:191], v[104:105]
    v_pk_mul_f32 v[20:21], v[188:189], v[170:171]
    v_pk_fma_f32 v[20:21], v[186:187], v[172:173], v[20:21]
    v_pk_fma_f32 v[20:21], v[184:185], v[174:175], v[20:21]
    v_pk_fma_f32 v[20:21], v[182:183], v[176:177], v[20:21]
    v_pk_mul_f32 v[106:107], v[20:21], v[106:107]
    v_pk_mul_f32 v[190:191], v[188:189], v[172:173]
    v_pk_fma_f32 v[190:191], v[186:187], v[174:175], v[190:191]
    v_pk_fma_f32 v[190:191], v[184:185], v[176:177], v[190:191]
    v_pk_fma_f32 v[190:191], v[182:183], v[178:179], v[190:191]
    v_pk_mul_f32 v[108:109], v[190:191], v[108:109]
    v_pk_mul_f32 v[20:21], v[188:189], v[174:175]
    v_pk_fma_f32 v[20:21], v[186:187], v[176:177], v[20:21]
    v_pk_fma_f32 v[20:21], v[184:185], v[178:179], v[20:21]
    v_pk_fma_f32 v[20:21], v[182:183], v[180:181], v[20:21]
    v_pk_mul_f32 v[110:111], v[20:21], v[110:111]
    v_cvt_pk_bf16_f32 v24, v110, v108
    v_cvt_pk_bf16_f32 v25, v106, v104
    v_cvt_pk_bf16_f32 v26, v102, v100
    v_cvt_pk_bf16_f32 v27, v98, v96
    buffer_store_dwordx4 v[24:27], v3, s[40:43], s58 offen sc1
    s_add_u32 s58, s58, 4096
    v_cvt_pk_bf16_f32 v28, v111, v109
    v_cvt_pk_bf16_f32 v29, v107, v105
    v_cvt_pk_bf16_f32 v30, v103, v101
    v_cvt_pk_bf16_f32 v31, v99, v97
    buffer_store_dwordx4 v[28:31], v3, s[40:43], s58 offen sc1
    s_add_u32 s58, s58, 4096
    ds_read_b128 v[20:23], v19 offset:16
    ds_read_b32 v161, v17 offset:4
    ds_read_b32 v163, v17 offset:1284
    ds_read_b32 v165, v17 offset:2564
    ds_read_b32 v167, v16 offset:4
    ds_read_b32 v169, v16 offset:1284
    ds_read_b32 v171, v16 offset:2564
    ds_read_b32 v173, v16 offset:3844
    ds_read_b32 v175, v16 offset:5124
    ds_read_b32 v177, v16 offset:6404
    ds_read_b32 v179, v16 offset:7684
    ds_read_b32 v181, v16 offset:8964
    ds_read_b32 v97, v18 offset:4
    ds_read_b32 v99, v18 offset:1284
    ds_read_b32 v101, v18 offset:2564
    ds_read_b32 v103, v18 offset:3844
    ds_read_b32 v105, v18 offset:5124
    ds_read_b32 v107, v18 offset:6404
    ds_read_b32 v109, v18 offset:7684
    ds_read_b32 v111, v18 offset:8964
    s_waitcnt lgkmcnt(8)
    v_lshlrev_b32 v182, 16, v20
    v_lshlrev_b32 v183, 16, v22
    v_and_b32 v184, s50, v20
    v_and_b32 v185, s50, v22
    v_lshlrev_b32 v186, 16, v21
    v_lshlrev_b32 v187, 16, v23
    v_and_b32 v188, s50, v21
    v_and_b32 v189, s50, v23
    v_lshlrev_b32 v160, 16, v161
    v_and_b32 v161, s50, v161
    v_lshlrev_b32 v162, 16, v163
    v_and_b32 v163, s50, v163
    v_lshlrev_b32 v164, 16, v165
    v_and_b32 v165, s50, v165
    v_lshlrev_b32 v166, 16, v167
    v_and_b32 v167, s50, v167
    v_lshlrev_b32 v168, 16, v169
    v_and_b32 v169, s50, v169
    v_lshlrev_b32 v170, 16, v171
    v_and_b32 v171, s50, v171
    v_lshlrev_b32 v172, 16, v173
    v_and_b32 v173, s50, v173
    v_lshlrev_b32 v174, 16, v175
    v_and_b32 v175, s50, v175
    v_lshlrev_b32 v176, 16, v177
    v_and_b32 v177, s50, v177
    v_lshlrev_b32 v178, 16, v179
    v_and_b32 v179, s50, v179
    v_lshlrev_b32 v180, 16, v181
    v_and_b32 v181, s50, v181
    s_waitcnt lgkmcnt(0)
    v_lshlrev_b32 v96, 16, v97
    v_and_b32 v97, s50, v97
    v_lshlrev_b32 v98, 16, v99
    v_and_b32 v99, s50, v99
    v_lshlrev_b32 v100, 16, v101
    v_and_b32 v101, s50, v101
    v_lshlrev_b32 v102, 16, v103
    v_and_b32 v103, s50, v103
    v_lshlrev_b32 v104, 16, v105
    v_and_b32 v105, s50, v105
    v_lshlrev_b32 v106, 16, v107
    v_and_b32 v107, s50, v107
    v_lshlrev_b32 v108, 16, v109
    v_and_b32 v109, s50, v109
    v_lshlrev_b32 v110, 16, v111
    v_and_b32 v111, s50, v111
    v_pk_mul_f32 v[190:191], v[188:189], v[160:161]
    v_pk_fma_f32 v[190:191], v[186:187], v[162:163], v[190:191]
    v_pk_fma_f32 v[190:191], v[184:185], v[164:165], v[190:191]
    v_pk_fma_f32 v[190:191], v[182:183], v[166:167], v[190:191]
    v_pk_mul_f32 v[96:97], v[190:191], v[96:97]
    v_pk_mul_f32 v[20:21], v[188:189], v[162:163]
    v_pk_fma_f32 v[20:21], v[186:187], v[164:165], v[20:21]
    v_pk_fma_f32 v[20:21], v[184:185], v[166:167], v[20:21]
    v_pk_fma_f32 v[20:21], v[182:183], v[168:169], v[20:21]
    v_pk_mul_f32 v[98:99], v[20:21], v[98:99]
    v_pk_mul_f32 v[190:191], v[188:189], v[164:165]
    v_pk_fma_f32 v[190:191], v[186:187], v[166:167], v[190:191]
    v_pk_fma_f32 v[190:191], v[184:185], v[168:169], v[190:191]
    v_pk_fma_f32 v[190:191], v[182:183], v[170:171], v[190:191]
    v_pk_mul_f32 v[100:101], v[190:191], v[100:101]
    v_pk_mul_f32 v[20:21], v[188:189], v[166:167]
    v_pk_fma_f32 v[20:21], v[186:187], v[168:169], v[20:21]
    v_pk_fma_f32 v[20:21], v[184:185], v[170:171], v[20:21]
    v_pk_fma_f32 v[20:21], v[182:183], v[172:173], v[20:21]
    v_pk_mul_f32 v[102:103], v[20:21], v[102:103]
    v_pk_mul_f32 v[190:191], v[188:189], v[168:169]
    v_pk_fma_f32 v[190:191], v[186:187], v[170:171], v[190:191]
    v_pk_fma_f32 v[190:191], v[184:185], v[172:173], v[190:191]
    v_pk_fma_f32 v[190:191], v[182:183], v[174:175], v[190:191]
    v_pk_mul_f32 v[104:105], v[190:191], v[104:105]
    v_pk_mul_f32 v[20:21], v[188:189], v[170:171]
    v_pk_fma_f32 v[20:21], v[186:187], v[172:173], v[20:21]
    v_pk_fma_f32 v[20:21], v[184:185], v[174:175], v[20:21]
    v_pk_fma_f32 v[20:21], v[182:183], v[176:177], v[20:21]
    v_pk_mul_f32 v[106:107], v[20:21], v[106:107]
    v_pk_mul_f32 v[190:191], v[188:189], v[172:173]
    v_pk_fma_f32 v[190:191], v[186:187], v[174:175], v[190:191]
    v_pk_fma_f32 v[190:191], v[184:185], v[176:177], v[190:191]
    v_pk_fma_f32 v[190:191], v[182:183], v[178:179], v[190:191]
    v_pk_mul_f32 v[108:109], v[190:191], v[108:109]
    v_pk_mul_f32 v[20:21], v[188:189], v[174:175]
    v_pk_fma_f32 v[20:21], v[186:187], v[176:177], v[20:21]
    v_pk_fma_f32 v[20:21], v[184:185], v[178:179], v[20:21]
    v_pk_fma_f32 v[20:21], v[182:183], v[180:181], v[20:21]
    v_pk_mul_f32 v[110:111], v[20:21], v[110:111]
    v_cvt_pk_bf16_f32 v24, v110, v108
    v_cvt_pk_bf16_f32 v25, v106, v104
    v_cvt_pk_bf16_f32 v26, v102, v100
    v_cvt_pk_bf16_f32 v27, v98, v96
    buffer_store_dwordx4 v[24:27], v3, s[40:43], s58 offen sc1
    s_add_u32 s58, s58, 4096
    v_cvt_pk_bf16_f32 v28, v111, v109
    v_cvt_pk_bf16_f32 v29, v107, v105
    v_cvt_pk_bf16_f32 v30, v103, v101
    v_cvt_pk_bf16_f32 v31, v99, v97
    buffer_store_dwordx4 v[28:31], v3, s[40:43], s58 offen sc1
    s_add_u32 s58, s58, 4096
    s_branch main_kernel_hBx
main_kernel_upC:
    s_cmp_lg_u32 s44, 0
    s_cbranch_scc1 main_kernel_hBx
    v_mov_b32 v20, 128
    v_mov_b32 v21, 0x10000
    s_mov_b64 exec, 1
    global_atomic_add v20, v21, s[84:85] sc1
    s_mov_b64 exec, -1
    s_branch main_kernel_hBx
main_kernel_cvld:
    s_lshl_b32 s4, s52, 2
    s_add_u32 s4, s4, s44
    s_mul_i32 s5, s44, 21504
    s_lshl_b32 s6, s4, 12
    s_mov_b32 s12, s80
    s_mov_b32 s13, s81
    s_mov_b32 s14, 2621440
    s_mov_b32 s15, 0x00020000
    s_lshr_b32 s58, s4, 1
    s_lshl_b32 s58, s58, 2
    s_load_dword s7, s[82:83], s58
    s_add_u32 m0, s5, 32
    s_add_u32 s58, s6, 0
    buffer_load_dwordx4 v4, s[12:15], s58 offen offset:0 lds
    buffer_load_dwordx4 v4, s[12:15], s58 offen offset:1024 lds
    buffer_load_dwordx4 v4, s[12:15], s58 offen offset:2048 lds
    buffer_load_dwordx4 v4, s[12:15], s58 offen offset:3072 lds
    s_add_u32 m0, s5, 17152
    s_add_u32 s58, s6, 0x4000000
    buffer_load_dwordx4 v4, s[40:43], s58 offen offset:0 sc1 lds
    buffer_load_dwordx4 v4, s[40:43], s58 offen offset:1024 sc1 lds
    buffer_load_dwordx4 v4, s[40:43], s58 offen offset:2048 sc1 lds
    buffer_load_dwordx4 v4, s[40:43], s58 offen offset:3072 sc1 lds
    v_lshrrev_b32 v5, 4, v1
    v_and_b32 v6, 15, v1
    v_add_u32 v7, v5, v6
    v_subrev_u32 v7, 16, v7
    v_cmp_gt_i32 vcc, 0, v7
    v_lshlrev_b32 v7, 1, v7
    v_add_u32 v7, s6, v7
    v_mov_b32 v8, 0x7ffffff0
    v_cndmask_b32 v7, v7, v8, vcc
    buffer_load_ushort v9, v7, s[12:15], 0 offen
    s_branch main_kernel_cvldr
main_kernel_uspin:
    s_mov_b32 s59, 0x100000
    v_mov_b32 v5, 128
main_kernel_uspl:
    global_load_dword v6, v5, s[84:85] sc1
    s_waitcnt vmcnt(0)
    v_readfirstlane_b32 s58, v6
    s_lshr_b32 s58, s58, 16
    s_cmp_ge_u32 s58, 256
    s_cbranch_scc1 main_kernel_uok
    s_sub_u32 s59, s59, 1
    s_cmp_eq_u32 s59, 0
    s_cbranch_scc1 main_kernel_uok
    s_sleep 8
    s_branch main_kernel_uspl
main_kernel_conv:
    v_add_u32 v16, s5, v4
    v_mov_b32 v14, 0
    v_mov_b32 v15, 0
    v_lshlrev_b32 v13, 3, v1
    v_add_u32 v13, s5, v13
    ds_write_b64 v13, v[14:15] offset:16640
    ds_read_b128 v[64:67], v16 offset:32
    ds_read_b64 v[68:69], v16 offset:48
    ds_read_b128 v[72:75], v16 offset:1056
    ds_read_b64 v[76:77], v16 offset:1072
    ds_read_b128 v[80:83], v16 offset:2080
    ds_read_b64 v[84:85], v16 offset:2096
    ds_read_b128 v[88:91], v16 offset:3104
    ds_read_b64 v[92:93], v16 offset:3120
    v_lshrrev_b32 v10, 1, v5
    v_sub_u32 v10, v6, v10
    v_lshlrev_b32 v10, 5, v10
    v_and_b32 v11, 1, v5
    v_lshlrev_b32 v12, 4, v11
    v_add_u32 v10, v10, v12
    v_add_u32 v10, s5, v10
    v_add_u32 v10, 16704, v10
    v_mul_u32_u24 v17, 4160, v5
    v_lshlrev_b32 v13, 1, v6
    v_add_u32 v17, v17, v13
    v_add_u32 v17, s5, v17
    ds_write_b16 v17, v9
    s_waitcnt lgkmcnt(1)
    v_alignbit_b32 v96, v65, v64, 16
    v_alignbit_b32 v97, v66, v65, 16
    v_alignbit_b32 v98, v67, v66, 16
    v_alignbit_b32 v99, v68, v67, 16
    ds_write_b128 v16, v[96:99] offset:4192
    v_mov_b32 v100, v65
    v_mov_b32 v101, v66
    v_mov_b32 v102, v67
    v_mov_b32 v103, v68
    ds_write_b128 v16, v[100:103] offset:8352
    v_alignbit_b32 v104, v66, v65, 16
    v_alignbit_b32 v105, v67, v66, 16
    v_alignbit_b32 v106, v68, v67, 16
    v_alignbit_b32 v107, v69, v68, 16
    ds_write_b128 v16, v[104:107] offset:12512
    v_alignbit_b32 v108, v73, v72, 16
    v_alignbit_b32 v109, v74, v73, 16
    v_alignbit_b32 v110, v75, v74, 16
    v_alignbit_b32 v111, v76, v75, 16
    ds_write_b128 v16, v[108:111] offset:5216
    v_mov_b32 v112, v73
    v_mov_b32 v113, v74
    v_mov_b32 v114, v75
    v_mov_b32 v115, v76
    ds_write_b128 v16, v[112:115] offset:9376
    v_alignbit_b32 v116, v74, v73, 16
    v_alignbit_b32 v117, v75, v74, 16
    v_alignbit_b32 v118, v76, v75, 16
    v_alignbit_b32 v119, v77, v76, 16
    ds_write_b128 v16, v[116:119] offset:13536
    v_alignbit_b32 v120, v81, v80, 16
    v_alignbit_b32 v121, v82, v81, 16
    v_alignbit_b32 v122, v83, v82, 16
    v_alignbit_b32 v123, v84, v83, 16
    ds_write_b128 v16, v[120:123] offset:6240
    v_mov_b32 v124, v81
    v_mov_b32 v125, v82
    v_mov_b32 v126, v83
    v_mov_b32 v127, v84
    ds_write_b128 v16, v[124:127] offset:10400
    v_alignbit_b32 v128, v82, v81, 16
    v_alignbit_b32 v129, v83, v82, 16
    v_alignbit_b32 v130, v84, v83, 16
    v_alignbit_b32 v131, v85, v84, 16
    ds_write_b128 v16, v[128:131] offset:14560
    v_alignbit_b32 v132, v89, v88, 16
    v_alignbit_b32 v133, v90, v89, 16
    v_alignbit_b32 v134, v91, v90, 16
    v_alignbit_b32 v135, v92, v91, 16
    ds_write_b128 v16, v[132:135] offset:7264
    v_mov_b32 v136, v89
    v_mov_b32 v137, v90
    v_mov_b32 v138, v91
    v_mov_b32 v139, v92
    ds_write_b128 v16, v[136:139] offset:11424
    v_alignbit_b32 v140, v90, v89, 16
    v_alignbit_b32 v141, v91, v90, 16
    v_alignbit_b32 v142, v92, v91, 16
    v_alignbit_b32 v143, v93, v92, 16
    ds_write_b128 v16, v[140:143] offset:15584
    v_add_u32 v12, 1, v6
    ds_read_b128 a[28:31], v10 offset:448
    v_and_b32 v13, 3, v12
    ds_read_b128 a[60:63], v10 offset:960
    v_sub_u32 v12, v12, v13
    ds_read_b128 a[92:95], v10 offset:1472
    v_lshrrev_b32 v14, 1, v5
    ds_read_b128 a[124:127], v10 offset:1984
    v_lshlrev_b32 v14, 4, v14
    ds_read_b128 a[156:159], v10 offset:2496
    v_add_u32 v12, v12, v14
    ds_read_b128 a[188:191], v10 offset:3008
    v_lshlrev_b32 v14, 3, v11
    ds_read_b128 a[220:223], v10 offset:3520
    v_sub_u32 v12, v12, v14
    ds_read_b128 a[252:255], v10 offset:4032
    v_add_u32 v12, 8, v12
    ds_read_b128 a[24:27], v10 offset:384
    v_lshlrev_b32 v12, 1, v12
    ds_read_b128 a[56:59], v10 offset:896
    v_mul_u32_u24 v13, 4160, v13
    ds_read_b128 a[88:91], v10 offset:1408
    v_add_u32 v12, v12, v13
    ds_read_b128 a[120:123], v10 offset:1920
    v_add_u32 v12, s5, v12
    ds_read_b128 a[152:155], v10 offset:2432
    v_lshlrev_b32 v13, 5, v6
    ds_read_b128 a[184:187], v10 offset:2944
    v_lshrrev_b32 v14, 1, v5
    ds_read_b128 a[216:219], v10 offset:3456
    v_lshlrev_b32 v14, 4, v14
    ds_read_b128 a[248:251], v10 offset:3968
    v_add_u32 v13, v13, v14
    ds_read_b128 a[20:23], v10 offset:320
    v_xor_b32 v14, 1, v11
    ds_read_b128 a[52:55], v10 offset:832
    v_lshlrev_b32 v14, 3, v14
    ds_read_b128 a[84:87], v10 offset:1344
    v_add_u32 v13, v13, v14
    ds_read_b128 a[116:119], v10 offset:1856
    v_add_u32 v13, s5, v13
    ds_read_b128 a[148:151], v10 offset:2368
    v_lshlrev_b32 v14, 5, v6
    ds_read_b128 a[180:183], v10 offset:2880
    v_lshlrev_b32 v15, 3, v5
    ds_read_b128 a[212:215], v10 offset:3392
    v_add_u32 v14, v14, v15
    ds_read_b128 a[244:247], v10 offset:3904
    s_and_b32 s58, s4, 1
    ds_read_b128 a[16:19], v10 offset:256
    s_cmp_eq_u32 s58, 0
    ds_read_b128 a[48:51], v10 offset:768
    s_cselect_b32 s58, 16, 0
    ds_read_b128 a[80:83], v10 offset:1280
    s_lshl_b32 s7, s7, s58
    ds_read_b128 a[112:115], v10 offset:1792
    s_and_b32 s7, s7, 0xffff0000
    ds_read_b128 a[144:147], v10 offset:2304
    s_add_u32 s59, s6, 0x4400000
    ds_read_b128 a[176:179], v10 offset:2816
    ds_read_b64 v[96:97], v12 offset:0
    ds_read_b64 v[98:99], v12 offset:8
    ds_read_b64 v[100:101], v12 offset:64
    ds_read_b64 v[102:103], v12 offset:72
    ds_read_b64 v[104:105], v12 offset:128
    ds_read_b64 v[106:107], v12 offset:136
    s_waitcnt lgkmcnt(4)
    v_mfma_f32_16x16x32_bf16 v[64:67], v[96:99], a[28:31], 0
    ds_read_b64 v[108:109], v12 offset:192
    ds_read_b64 v[110:111], v12 offset:200
    v_mfma_f32_16x16x32_bf16 v[68:71], v[96:99], a[60:63], 0
    ds_read_b128 a[208:211], v10 offset:3328
    v_mfma_f32_16x16x32_bf16 v[72:75], v[96:99], a[92:95], 0
    ds_read_b128 a[240:243], v10 offset:3840
    v_mfma_f32_16x16x32_bf16 v[76:79], v[96:99], a[124:127], 0
    ds_read_b128 a[12:15], v10 offset:192
    v_mfma_f32_16x16x32_bf16 v[80:83], v[96:99], a[156:159], 0
    ds_read_b128 a[44:47], v10 offset:704
    v_mfma_f32_16x16x32_bf16 v[84:87], v[96:99], a[188:191], 0
    ds_read_b128 a[76:79], v10 offset:1216
    v_mfma_f32_16x16x32_bf16 v[88:91], v[96:99], a[220:223], 0
    ds_read_b128 a[108:111], v10 offset:1728
    v_mfma_f32_16x16x32_bf16 v[92:95], v[96:99], a[252:255], 0
    ds_read_b128 a[140:143], v10 offset:2240
    s_waitcnt lgkmcnt(11)
    v_mfma_f32_16x16x32_bf16 v[64:67], v[100:103], a[24:27], v[64:67]
    ds_read_b64 v[112:113], v12 offset:256
    ds_read_b64 v[114:115], v12 offset:264
    v_mfma_f32_16x16x32_bf16 v[68:71], v[100:103], a[56:59], v[68:71]
    ds_read_b128 a[172:175], v10 offset:2752
    v_mfma_f32_16x16x32_bf16 v[72:75], v[100:103], a[88:91], v[72:75]
    ds_read_b128 a[204:207], v10 offset:3264
    v_mfma_f32_16x16x32_bf16 v[76:79], v[100:103], a[120:123], v[76:79]
    ds_read_b128 a[236:239], v10 offset:3776
    v_mfma_f32_16x16x32_bf16 v[80:83], v[100:103], a[152:155], v[80:83]
    ds_read_b128 a[8:11], v10 offset:128
    v_mfma_f32_16x16x32_bf16 v[84:87], v[100:103], a[184:187], v[84:87]
    ds_read_b128 a[40:43], v10 offset:640
    v_mfma_f32_16x16x32_bf16 v[88:91], v[100:103], a[216:219], v[88:91]
    ds_read_b128 a[72:75], v10 offset:1152
    v_mfma_f32_16x16x32_bf16 v[92:95], v[100:103], a[248:251], v[92:95]
    ds_read_b128 a[104:107], v10 offset:1664
    s_waitcnt lgkmcnt(15)
    v_mfma_f32_16x16x32_bf16 v[64:67], v[104:107], a[20:23], v[64:67]
    ds_read_b64 v[116:117], v12 offset:320
    ds_read_b64 v[118:119], v12 offset:328
    v_mfma_f32_16x16x32_bf16 v[68:71], v[104:107], a[52:55], v[68:71]
    ds_read_b128 a[136:139], v10 offset:2176
    v_mfma_f32_16x16x32_bf16 v[72:75], v[104:107], a[84:87], v[72:75]
    ds_read_b128 a[168:171], v10 offset:2688
    v_mfma_f32_16x16x32_bf16 v[76:79], v[104:107], a[116:119], v[76:79]
    ds_read_b128 a[200:203], v10 offset:3200
    v_mfma_f32_16x16x32_bf16 v[80:83], v[104:107], a[148:151], v[80:83]
    ds_read_b128 a[232:235], v10 offset:3712
    v_mfma_f32_16x16x32_bf16 v[84:87], v[104:107], a[180:183], v[84:87]
    ds_read_b128 a[4:7], v10 offset:64
    v_mfma_f32_16x16x32_bf16 v[88:91], v[104:107], a[212:215], v[88:91]
    ds_read_b128 a[36:39], v10 offset:576
    v_mfma_f32_16x16x32_bf16 v[92:95], v[104:107], a[244:247], v[92:95]
    ds_read_b128 a[68:71], v10 offset:1088
    s_waitcnt lgkmcnt(15)
    v_mfma_f32_16x16x32_bf16 v[64:67], v[108:111], a[16:19], v[64:67]
    ds_read_b64 v[120:121], v12 offset:384
    ds_read_b64 v[122:123], v12 offset:392
    v_mfma_f32_16x16x32_bf16 v[68:71], v[108:111], a[48:51], v[68:71]
    ds_read_b128 a[100:103], v10 offset:1600
    v_mfma_f32_16x16x32_bf16 v[72:75], v[108:111], a[80:83], v[72:75]
    ds_read_b128 a[132:135], v10 offset:2112
    v_mfma_f32_16x16x32_bf16 v[76:79], v[108:111], a[112:115], v[76:79]
    ds_read_b128 a[164:167], v10 offset:2624
    v_mfma_f32_16x16x32_bf16 v[80:83], v[108:111], a[144:147], v[80:83]
    ds_read_b128 a[196:199], v10 offset:3136
    v_mfma_f32_16x16x32_bf16 v[84:87], v[108:111], a[176:179], v[84:87]
    ds_read_b128 a[228:231], v10 offset:3648
    v_mfma_f32_16x16x32_bf16 v[88:91], v[108:111], a[208:211], v[88:91]
    ds_read_b128 a[0:3], v10 offset:0
    v_mfma_f32_16x16x32_bf16 v[92:95], v[108:111], a[240:243], v[92:95]
    ds_read_b128 a[32:35], v10 offset:512
    s_waitcnt lgkmcnt(15)
    v_mfma_f32_16x16x32_bf16 v[64:67], v[112:115], a[12:15], v[64:67]
    ds_read_b64 v[124:125], v12 offset:448
    ds_read_b64 v[126:127], v12 offset:456
    v_mfma_f32_16x16x32_bf16 v[68:71], v[112:115], a[44:47], v[68:71]
    ds_read_b128 a[64:67], v10 offset:1024
    v_mfma_f32_16x16x32_bf16 v[72:75], v[112:115], a[76:79], v[72:75]
    ds_read_b128 a[96:99], v10 offset:1536
    v_mfma_f32_16x16x32_bf16 v[76:79], v[112:115], a[108:111], v[76:79]
    ds_read_b128 a[128:131], v10 offset:2048
    v_mfma_f32_16x16x32_bf16 v[80:83], v[112:115], a[140:143], v[80:83]
    ds_read_b128 a[160:163], v10 offset:2560
    v_mfma_f32_16x16x32_bf16 v[84:87], v[112:115], a[172:175], v[84:87]
    ds_read_b128 a[192:195], v10 offset:3072
    v_mfma_f32_16x16x32_bf16 v[88:91], v[112:115], a[204:207], v[88:91]
    ds_read_b128 a[224:227], v10 offset:3584
    v_mfma_f32_16x16x32_bf16 v[92:95], v[112:115], a[236:239], v[92:95]
    s_waitcnt lgkmcnt(15)
    v_mfma_f32_16x16x32_bf16 v[64:67], v[116:119], a[8:11], v[64:67]
    ds_read_b64 v[128:129], v12 offset:512
    ds_read_b64 v[130:131], v12 offset:520
    v_mfma_f32_16x16x32_bf16 v[68:71], v[116:119], a[40:43], v[68:71]
    v_mfma_f32_16x16x32_bf16 v[72:75], v[116:119], a[72:75], v[72:75]
    v_mfma_f32_16x16x32_bf16 v[76:79], v[116:119], a[104:107], v[76:79]
    v_mfma_f32_16x16x32_bf16 v[80:83], v[116:119], a[136:139], v[80:83]
    v_mfma_f32_16x16x32_bf16 v[84:87], v[116:119], a[168:171], v[84:87]
    v_mfma_f32_16x16x32_bf16 v[88:91], v[116:119], a[200:203], v[88:91]
    v_mfma_f32_16x16x32_bf16 v[92:95], v[116:119], a[232:235], v[92:95]
    s_waitcnt lgkmcnt(12)
    v_mfma_f32_16x16x32_bf16 v[64:67], v[120:123], a[4:7], v[64:67]
    ds_read_b64 v[132:133], v12 offset:576
    ds_read_b64 v[134:135], v12 offset:584
    v_mfma_f32_16x16x32_bf16 v[68:71], v[120:123], a[36:39], v[68:71]
    v_mfma_f32_16x16x32_bf16 v[72:75], v[120:123], a[68:71], v[72:75]
    v_mfma_f32_16x16x32_bf16 v[76:79], v[120:123], a[100:103], v[76:79]
    v_mfma_f32_16x16x32_bf16 v[80:83], v[120:123], a[132:135], v[80:83]
    v_mfma_f32_16x16x32_bf16 v[84:87], v[120:123], a[164:167], v[84:87]
    v_mfma_f32_16x16x32_bf16 v[88:91], v[120:123], a[196:199], v[88:91]
    v_mfma_f32_16x16x32_bf16 v[92:95], v[120:123], a[228:231], v[92:95]
    s_waitcnt lgkmcnt(4)
    v_mfma_f32_16x16x32_bf16 v[64:67], v[124:127], a[0:3], v[64:67]
    ds_read_b64 v[136:137], v12 offset:640
    ds_read_b64 v[138:139], v12 offset:648
    v_mfma_f32_16x16x32_bf16 v[68:71], v[124:127], a[32:35], v[68:71]
    v_mfma_f32_16x16x32_bf16 v[72:75], v[124:127], a[64:67], v[72:75]
    v_mfma_f32_16x16x32_bf16 v[76:79], v[124:127], a[96:99], v[76:79]
    v_mfma_f32_16x16x32_bf16 v[80:83], v[124:127], a[128:131], v[80:83]
    v_mfma_f32_16x16x32_bf16 v[84:87], v[124:127], a[160:163], v[84:87]
    v_mfma_f32_16x16x32_bf16 v[88:91], v[124:127], a[192:195], v[88:91]
    v_mfma_f32_16x16x32_bf16 v[92:95], v[124:127], a[224:227], v[92:95]
    s_waitcnt lgkmcnt(4)
    v_mfma_f32_16x16x32_bf16 v[68:71], v[128:131], a[28:31], v[68:71]
    ds_read_b64 v[140:141], v12 offset:704
    ds_read_b64 v[142:143], v12 offset:712
    v_mfma_f32_16x16x32_bf16 v[72:75], v[128:131], a[60:63], v[72:75]
    v_mfma_f32_16x16x32_bf16 v[76:79], v[128:131], a[92:95], v[76:79]
    v_mfma_f32_16x16x32_bf16 v[80:83], v[128:131], a[124:127], v[80:83]
    v_mfma_f32_16x16x32_bf16 v[84:87], v[128:131], a[156:159], v[84:87]
    v_mfma_f32_16x16x32_bf16 v[88:91], v[128:131], a[188:191], v[88:91]
    v_mfma_f32_16x16x32_bf16 v[92:95], v[128:131], a[220:223], v[92:95]
    s_waitcnt lgkmcnt(4)
    v_mfma_f32_16x16x32_bf16 v[68:71], v[132:135], a[24:27], v[68:71]
    ds_read_b64 v[96:97], v12 offset:768
    ds_read_b64 v[98:99], v12 offset:776
    v_mfma_f32_16x16x32_bf16 v[72:75], v[132:135], a[56:59], v[72:75]
    v_mfma_f32_16x16x32_bf16 v[76:79], v[132:135], a[88:91], v[76:79]
    v_mfma_f32_16x16x32_bf16 v[80:83], v[132:135], a[120:123], v[80:83]
    v_mfma_f32_16x16x32_bf16 v[84:87], v[132:135], a[152:155], v[84:87]
    v_mfma_f32_16x16x32_bf16 v[88:91], v[132:135], a[184:187], v[88:91]
    v_mfma_f32_16x16x32_bf16 v[92:95], v[132:135], a[216:219], v[92:95]
    ds_read_b64 v[160:161], v13 offset:17152
    ds_read_b64 v[162:163], v13 offset:17664
    ds_read_b64 v[164:165], v13 offset:18176
    ds_read_b64 v[166:167], v13 offset:18688
    ds_read_b64 v[168:169], v13 offset:19200
    ds_read_b64 v[170:171], v13 offset:19712
    ds_read_b64 v[172:173], v13 offset:20224
    ds_read_b64 v[174:175], v13 offset:20736
    s_add_u32 m0, s21, 102400
    s_add_u32 s23, s20, 0
    buffer_load_dwordx4 v20, s[16:19], s23 offen lds
    s_waitcnt lgkmcnt(12)
    v_mfma_f32_16x16x32_bf16 v[68:71], v[136:139], a[20:23], v[68:71]
    ds_read_b64 v[100:101], v12 offset:832
    ds_read_b64 v[102:103], v12 offset:840
    v_mfma_f32_16x16x32_bf16 v[72:75], v[136:139], a[52:55], v[72:75]
    v_mfma_f32_16x16x32_bf16 v[76:79], v[136:139], a[84:87], v[76:79]
    v_mfma_f32_16x16x32_bf16 v[80:83], v[136:139], a[116:119], v[80:83]
    v_mfma_f32_16x16x32_bf16 v[84:87], v[136:139], a[148:151], v[84:87]
    v_mfma_f32_16x16x32_bf16 v[88:91], v[136:139], a[180:183], v[88:91]
    v_mfma_f32_16x16x32_bf16 v[92:95], v[136:139], a[212:215], v[92:95]
    s_waitcnt lgkmcnt(12)
    v_mfma_f32_16x16x32_bf16 v[68:71], v[140:143], a[16:19], v[68:71]
    ds_read_b64 v[104:105], v12 offset:896
    ds_read_b64 v[106:107], v12 offset:904
    v_mfma_f32_16x16x32_bf16 v[72:75], v[140:143], a[48:51], v[72:75]
    v_mfma_f32_16x16x32_bf16 v[76:79], v[140:143], a[80:83], v[76:79]
    v_mfma_f32_16x16x32_bf16 v[80:83], v[140:143], a[112:115], v[80:83]
    v_mfma_f32_16x16x32_bf16 v[84:87], v[140:143], a[144:147], v[84:87]
    v_mfma_f32_16x16x32_bf16 v[88:91], v[140:143], a[176:179], v[88:91]
    v_mfma_f32_16x16x32_bf16 v[92:95], v[140:143], a[208:211], v[92:95]
    buffer_load_dwordx4 v21, s[16:19], s23 offen offset:1024 lds
    s_waitcnt lgkmcnt(12)
    v_mfma_f32_16x16x32_bf16 v[68:71], v[96:99], a[12:15], v[68:71]
    ds_read_b64 v[108:109], v12 offset:960
    ds_read_b64 v[110:111], v12 offset:968
    v_mfma_f32_16x16x32_bf16 v[72:75], v[96:99], a[44:47], v[72:75]
    v_mfma_f32_16x16x32_bf16 v[76:79], v[96:99], a[76:79], v[76:79]
    v_mfma_f32_16x16x32_bf16 v[80:83], v[96:99], a[108:111], v[80:83]
    v_mfma_f32_16x16x32_bf16 v[84:87], v[96:99], a[140:143], v[84:87]
    v_mfma_f32_16x16x32_bf16 v[88:91], v[96:99], a[172:175], v[88:91]
    v_mfma_f32_16x16x32_bf16 v[92:95], v[96:99], a[204:207], v[92:95]
    s_waitcnt lgkmcnt(4)
    v_mfma_f32_16x16x32_bf16 v[68:71], v[100:103], a[8:11], v[68:71]
    ds_read_b64 v[112:113], v12 offset:1024
    ds_read_b64 v[114:115], v12 offset:1032
    v_mfma_f32_16x16x32_bf16 v[72:75], v[100:103], a[40:43], v[72:75]
    v_mfma_f32_16x16x32_bf16 v[76:79], v[100:103], a[72:75], v[76:79]
    v_mfma_f32_16x16x32_bf16 v[80:83], v[100:103], a[104:107], v[80:83]
    v_mfma_f32_16x16x32_bf16 v[84:87], v[100:103], a[136:139], v[84:87]
    v_mfma_f32_16x16x32_bf16 v[88:91], v[100:103], a[168:171], v[88:91]
    v_mfma_f32_16x16x32_bf16 v[92:95], v[100:103], a[200:203], v[92:95]
    buffer_load_dwordx4 v22, s[16:19], s23 offen offset:2048 lds
    s_waitcnt lgkmcnt(4)
    v_mfma_f32_16x16x32_bf16 v[68:71], v[104:107], a[4:7], v[68:71]
    ds_read_b64 v[116:117], v12 offset:1088
    ds_read_b64 v[118:119], v12 offset:1096
    v_mfma_f32_16x16x32_bf16 v[72:75], v[104:107], a[36:39], v[72:75]
    v_mfma_f32_16x16x32_bf16 v[76:79], v[104:107], a[68:71], v[76:79]
    v_mfma_f32_16x16x32_bf16 v[80:83], v[104:107], a[100:103], v[80:83]
    v_mfma_f32_16x16x32_bf16 v[84:87], v[104:107], a[132:135], v[84:87]
    v_mfma_f32_16x16x32_bf16 v[88:91], v[104:107], a[164:167], v[88:91]
    v_mfma_f32_16x16x32_bf16 v[92:95], v[104:107], a[196:199], v[92:95]
    s_waitcnt lgkmcnt(4)
    v_mfma_f32_16x16x32_bf16 v[68:71], v[108:111], a[0:3], v[68:71]
    ds_read_b64 v[120:121], v12 offset:1152
    ds_read_b64 v[122:123], v12 offset:1160
    v_mfma_f32_16x16x32_bf16 v[72:75], v[108:111], a[32:35], v[72:75]
    v_and_b32 v192, s50, v161
    v_mfma_f32_16x16x32_bf16 v[76:79], v[108:111], a[64:67], v[76:79]
    v_lshlrev_b32 v193, 16, v161
    v_mfma_f32_16x16x32_bf16 v[80:83], v[108:111], a[96:99], v[80:83]
    v_and_b32 v194, s50, v160
    v_mfma_f32_16x16x32_bf16 v[84:87], v[108:111], a[128:131], v[84:87]
    v_lshlrev_b32 v195, 16, v160
    v_mfma_f32_16x16x32_bf16 v[88:91], v[108:111], a[160:163], v[88:91]
    v_fma_f32 v192, s7, v192, v64
    v_mfma_f32_16x16x32_bf16 v[92:95], v[108:111], a[192:195], v[92:95]
    v_fma_f32 v193, s7, v193, v65
    buffer_load_dwordx4 v23, s[16:19], s23 offen offset:3072 lds
    s_waitcnt lgkmcnt(4)
    v_mfma_f32_16x16x32_bf16 v[72:75], v[112:115], a[28:31], v[72:75]
    ds_read_b64 v[124:125], v12 offset:1216
    ds_read_b64 v[126:127], v12 offset:1224
    v_mfma_f32_16x16x32_bf16 v[76:79], v[112:115], a[60:63], v[76:79]
    v_fma_f32 v194, s7, v194, v66
    v_mfma_f32_16x16x32_bf16 v[80:83], v[112:115], a[92:95], v[80:83]
    v_fma_f32 v195, s7, v195, v67
    v_mfma_f32_16x16x32_bf16 v[84:87], v[112:115], a[124:127], v[84:87]
    v_cvt_pk_bf16_f32 v198, v192, v193
    v_mfma_f32_16x16x32_bf16 v[88:91], v[112:115], a[156:159], v[88:91]
    v_cvt_pk_bf16_f32 v199, v194, v195
    v_mfma_f32_16x16x32_bf16 v[92:95], v[112:115], a[188:191], v[92:95]
    buffer_store_dwordx2 v[198:199], v14, s[40:43], s59 offen offset:0 sc1
    s_waitcnt lgkmcnt(4)
    v_mfma_f32_16x16x32_bf16 v[72:75], v[116:119], a[24:27], v[72:75]
    ds_read_b64 v[128:129], v12 offset:1280
    ds_read_b64 v[130:131], v12 offset:1288
    v_mfma_f32_16x16x32_bf16 v[76:79], v[116:119], a[56:59], v[76:79]
    v_mfma_f32_16x16x32_bf16 v[80:83], v[116:119], a[88:91], v[80:83]
    v_mfma_f32_16x16x32_bf16 v[84:87], v[116:119], a[120:123], v[84:87]
    v_mfma_f32_16x16x32_bf16 v[88:91], v[116:119], a[152:155], v[88:91]
    v_mfma_f32_16x16x32_bf16 v[92:95], v[116:119], a[184:187], v[92:95]
    s_add_u32 m0, s21, 106496
    s_nop 0
    buffer_load_dwordx4 v24, s[16:19], s23 offen lds
    s_waitcnt lgkmcnt(4)
    v_mfma_f32_16x16x32_bf16 v[72:75], v[120:123], a[20:23], v[72:75]
    ds_read_b64 v[132:133], v12 offset:1344
    ds_read_b64 v[134:135], v12 offset:1352
    v_mfma_f32_16x16x32_bf16 v[76:79], v[120:123], a[52:55], v[76:79]
    v_mfma_f32_16x16x32_bf16 v[80:83], v[120:123], a[84:87], v[80:83]
    v_mfma_f32_16x16x32_bf16 v[84:87], v[120:123], a[116:119], v[84:87]
    v_mfma_f32_16x16x32_bf16 v[88:91], v[120:123], a[148:151], v[88:91]
    v_mfma_f32_16x16x32_bf16 v[92:95], v[120:123], a[180:183], v[92:95]
    s_waitcnt lgkmcnt(4)
    v_mfma_f32_16x16x32_bf16 v[72:75], v[124:127], a[16:19], v[72:75]
    ds_read_b64 v[136:137], v12 offset:1408
    ds_read_b64 v[138:139], v12 offset:1416
    v_mfma_f32_16x16x32_bf16 v[76:79], v[124:127], a[48:51], v[76:79]
    v_and_b32 v200, s50, v163
    v_mfma_f32_16x16x32_bf16 v[80:83], v[124:127], a[80:83], v[80:83]
    v_lshlrev_b32 v201, 16, v163
    v_mfma_f32_16x16x32_bf16 v[84:87], v[124:127], a[112:115], v[84:87]
    v_and_b32 v202, s50, v162
    v_mfma_f32_16x16x32_bf16 v[88:91], v[124:127], a[144:147], v[88:91]
    v_lshlrev_b32 v203, 16, v162
    v_mfma_f32_16x16x32_bf16 v[92:95], v[124:127], a[176:179], v[92:95]
    v_fma_f32 v200, s7, v200, v68
    s_add_u32 m0, s21, 122880
    s_add_u32 s23, s20, 81920
    buffer_load_dwordx4 v20, s[16:19], s23 offen lds
    s_waitcnt lgkmcnt(4)
    v_mfma_f32_16x16x32_bf16 v[72:75], v[128:131], a[12:15], v[72:75]
    ds_read_b64 v[140:141], v12 offset:1472
    ds_read_b64 v[142:143], v12 offset:1480
    v_mfma_f32_16x16x32_bf16 v[76:79], v[128:131], a[44:47], v[76:79]
    v_fma_f32 v201, s7, v201, v69
    v_mfma_f32_16x16x32_bf16 v[80:83], v[128:131], a[76:79], v[80:83]
    v_fma_f32 v202, s7, v202, v70
    v_mfma_f32_16x16x32_bf16 v[84:87], v[128:131], a[108:111], v[84:87]
    v_fma_f32 v203, s7, v203, v71
    v_mfma_f32_16x16x32_bf16 v[88:91], v[128:131], a[140:143], v[88:91]
    v_cvt_pk_bf16_f32 v206, v200, v201
    v_mfma_f32_16x16x32_bf16 v[92:95], v[128:131], a[172:175], v[92:95]
    v_cvt_pk_bf16_f32 v207, v202, v203
    s_waitcnt lgkmcnt(4)
    v_mfma_f32_16x16x32_bf16 v[72:75], v[132:135], a[8:11], v[72:75]
    ds_read_b64 v[96:97], v12 offset:1536
    ds_read_b64 v[98:99], v12 offset:1544
    v_mfma_f32_16x16x32_bf16 v[76:79], v[132:135], a[40:43], v[76:79]
    buffer_store_dwordx2 v[206:207], v14, s[40:43], s59 offen offset:512 sc1
    v_mfma_f32_16x16x32_bf16 v[80:83], v[132:135], a[72:75], v[80:83]
    v_mfma_f32_16x16x32_bf16 v[84:87], v[132:135], a[104:107], v[84:87]
    v_mfma_f32_16x16x32_bf16 v[88:91], v[132:135], a[136:139], v[88:91]
    v_mfma_f32_16x16x32_bf16 v[92:95], v[132:135], a[168:171], v[92:95]
    buffer_load_dwordx4 v21, s[16:19], s23 offen offset:1024 lds
    s_waitcnt lgkmcnt(4)
    v_mfma_f32_16x16x32_bf16 v[72:75], v[136:139], a[4:7], v[72:75]
    ds_read_b64 v[100:101], v12 offset:1600
    ds_read_b64 v[102:103], v12 offset:1608
    v_mfma_f32_16x16x32_bf16 v[76:79], v[136:139], a[36:39], v[76:79]
    v_mfma_f32_16x16x32_bf16 v[80:83], v[136:139], a[68:71], v[80:83]
    v_mfma_f32_16x16x32_bf16 v[84:87], v[136:139], a[100:103], v[84:87]
    v_mfma_f32_16x16x32_bf16 v[88:91], v[136:139], a[132:135], v[88:91]
    v_mfma_f32_16x16x32_bf16 v[92:95], v[136:139], a[164:167], v[92:95]
    s_waitcnt lgkmcnt(4)
    v_mfma_f32_16x16x32_bf16 v[72:75], v[140:143], a[0:3], v[72:75]
    ds_read_b64 v[104:105], v12 offset:1664
    ds_read_b64 v[106:107], v12 offset:1672
    v_mfma_f32_16x16x32_bf16 v[76:79], v[140:143], a[32:35], v[76:79]
    v_mfma_f32_16x16x32_bf16 v[80:83], v[140:143], a[64:67], v[80:83]
    v_mfma_f32_16x16x32_bf16 v[84:87], v[140:143], a[96:99], v[84:87]
    v_mfma_f32_16x16x32_bf16 v[88:91], v[140:143], a[128:131], v[88:91]
    v_mfma_f32_16x16x32_bf16 v[92:95], v[140:143], a[160:163], v[92:95]
    buffer_load_dwordx4 v22, s[16:19], s23 offen offset:2048 lds
    s_waitcnt lgkmcnt(4)
    v_mfma_f32_16x16x32_bf16 v[76:79], v[96:99], a[28:31], v[76:79]
    ds_read_b64 v[108:109], v12 offset:1728
    ds_read_b64 v[110:111], v12 offset:1736
    v_mfma_f32_16x16x32_bf16 v[80:83], v[96:99], a[60:63], v[80:83]
    v_mfma_f32_16x16x32_bf16 v[84:87], v[96:99], a[92:95], v[84:87]
    v_mfma_f32_16x16x32_bf16 v[88:91], v[96:99], a[124:127], v[88:91]
    v_mfma_f32_16x16x32_bf16 v[92:95], v[96:99], a[156:159], v[92:95]
    s_waitcnt lgkmcnt(4)
    v_mfma_f32_16x16x32_bf16 v[76:79], v[100:103], a[24:27], v[76:79]
    ds_read_b64 v[112:113], v12 offset:1792
    ds_read_b64 v[114:115], v12 offset:1800
    v_mfma_f32_16x16x32_bf16 v[80:83], v[100:103], a[56:59], v[80:83]
    v_mfma_f32_16x16x32_bf16 v[84:87], v[100:103], a[88:91], v[84:87]
    v_mfma_f32_16x16x32_bf16 v[88:91], v[100:103], a[120:123], v[88:91]
    v_mfma_f32_16x16x32_bf16 v[92:95], v[100:103], a[152:155], v[92:95]
    buffer_load_dwordx4 v23, s[16:19], s23 offen offset:3072 lds
    s_waitcnt lgkmcnt(4)
    v_mfma_f32_16x16x32_bf16 v[76:79], v[104:107], a[20:23], v[76:79]
    ds_read_b64 v[116:117], v12 offset:1856
    ds_read_b64 v[118:119], v12 offset:1864
    v_mfma_f32_16x16x32_bf16 v[80:83], v[104:107], a[52:55], v[80:83]
    v_mfma_f32_16x16x32_bf16 v[84:87], v[104:107], a[84:87], v[84:87]
    v_mfma_f32_16x16x32_bf16 v[88:91], v[104:107], a[116:119], v[88:91]
    v_mfma_f32_16x16x32_bf16 v[92:95], v[104:107], a[148:151], v[92:95]
    s_waitcnt lgkmcnt(4)
    v_mfma_f32_16x16x32_bf16 v[76:79], v[108:111], a[16:19], v[76:79]
    ds_read_b64 v[120:121], v12 offset:1920
    ds_read_b64 v[122:123], v12 offset:1928
    v_mfma_f32_16x16x32_bf16 v[80:83], v[108:111], a[48:51], v[80:83]
    v_and_b32 v208, s50, v165
    v_mfma_f32_16x16x32_bf16 v[84:87], v[108:111], a[80:83], v[84:87]
    v_lshlrev_b32 v209, 16, v165
    v_mfma_f32_16x16x32_bf16 v[88:91], v[108:111], a[112:115], v[88:91]
    v_and_b32 v210, s50, v164
    v_mfma_f32_16x16x32_bf16 v[92:95], v[108:111], a[144:147], v[92:95]
    v_lshlrev_b32 v211, 16, v164
    s_add_u32 m0, s21, 126976
    s_nop 0
    buffer_load_dwordx4 v24, s[16:19], s23 offen lds
    s_waitcnt lgkmcnt(4)
    v_mfma_f32_16x16x32_bf16 v[76:79], v[112:115], a[12:15], v[76:79]
    ds_read_b64 v[124:125], v12 offset:1984
    ds_read_b64 v[126:127], v12 offset:1992
    v_mfma_f32_16x16x32_bf16 v[80:83], v[112:115], a[44:47], v[80:83]
    v_fma_f32 v208, s7, v208, v72
    v_mfma_f32_16x16x32_bf16 v[84:87], v[112:115], a[76:79], v[84:87]
    v_fma_f32 v209, s7, v209, v73
    v_mfma_f32_16x16x32_bf16 v[88:91], v[112:115], a[108:111], v[88:91]
    v_fma_f32 v210, s7, v210, v74
    v_mfma_f32_16x16x32_bf16 v[92:95], v[112:115], a[140:143], v[92:95]
    v_fma_f32 v211, s7, v211, v75
    s_waitcnt lgkmcnt(4)
    v_mfma_f32_16x16x32_bf16 v[76:79], v[116:119], a[8:11], v[76:79]
    ds_read_b64 v[128:129], v12 offset:2048
    ds_read_b64 v[130:131], v12 offset:2056
    v_mfma_f32_16x16x32_bf16 v[80:83], v[116:119], a[40:43], v[80:83]
    v_cvt_pk_bf16_f32 v214, v208, v209
    v_mfma_f32_16x16x32_bf16 v[84:87], v[116:119], a[72:75], v[84:87]
    v_cvt_pk_bf16_f32 v215, v210, v211
    v_mfma_f32_16x16x32_bf16 v[88:91], v[116:119], a[104:107], v[88:91]
    buffer_store_dwordx2 v[214:215], v14, s[40:43], s59 offen offset:1024 sc1
    v_mfma_f32_16x16x32_bf16 v[92:95], v[116:119], a[136:139], v[92:95]
    s_add_u32 m0, s21, 143360
    s_add_u32 s23, s20, 163840
    buffer_load_dwordx4 v20, s[16:19], s23 offen lds
    s_waitcnt lgkmcnt(4)
    v_mfma_f32_16x16x32_bf16 v[76:79], v[120:123], a[4:7], v[76:79]
    ds_read_b64 v[132:133], v12 offset:2112
    ds_read_b64 v[134:135], v12 offset:2120
    v_mfma_f32_16x16x32_bf16 v[80:83], v[120:123], a[36:39], v[80:83]
    v_mfma_f32_16x16x32_bf16 v[84:87], v[120:123], a[68:71], v[84:87]
    v_mfma_f32_16x16x32_bf16 v[88:91], v[120:123], a[100:103], v[88:91]
    v_mfma_f32_16x16x32_bf16 v[92:95], v[120:123], a[132:135], v[92:95]
    s_waitcnt lgkmcnt(4)
    v_mfma_f32_16x16x32_bf16 v[76:79], v[124:127], a[0:3], v[76:79]
    ds_read_b64 v[136:137], v12 offset:2176
    ds_read_b64 v[138:139], v12 offset:2184
    v_mfma_f32_16x16x32_bf16 v[80:83], v[124:127], a[32:35], v[80:83]
    v_mfma_f32_16x16x32_bf16 v[84:87], v[124:127], a[64:67], v[84:87]
    v_mfma_f32_16x16x32_bf16 v[88:91], v[124:127], a[96:99], v[88:91]
    v_mfma_f32_16x16x32_bf16 v[92:95], v[124:127], a[128:131], v[92:95]
    buffer_load_dwordx4 v21, s[16:19], s23 offen offset:1024 lds
    s_waitcnt lgkmcnt(4)
    v_mfma_f32_16x16x32_bf16 v[80:83], v[128:131], a[28:31], v[80:83]
    ds_read_b64 v[140:141], v12 offset:2240
    ds_read_b64 v[142:143], v12 offset:2248
    v_mfma_f32_16x16x32_bf16 v[84:87], v[128:131], a[60:63], v[84:87]
    v_mfma_f32_16x16x32_bf16 v[88:91], v[128:131], a[92:95], v[88:91]
    v_mfma_f32_16x16x32_bf16 v[92:95], v[128:131], a[124:127], v[92:95]
    s_waitcnt lgkmcnt(4)
    v_mfma_f32_16x16x32_bf16 v[80:83], v[132:135], a[24:27], v[80:83]
    ds_read_b64 v[96:97], v12 offset:2304
    ds_read_b64 v[98:99], v12 offset:2312
    v_mfma_f32_16x16x32_bf16 v[84:87], v[132:135], a[56:59], v[84:87]
    v_mfma_f32_16x16x32_bf16 v[88:91], v[132:135], a[88:91], v[88:91]
    v_mfma_f32_16x16x32_bf16 v[92:95], v[132:135], a[120:123], v[92:95]
    buffer_load_dwordx4 v22, s[16:19], s23 offen offset:2048 lds
    s_waitcnt lgkmcnt(4)
    v_mfma_f32_16x16x32_bf16 v[80:83], v[136:139], a[20:23], v[80:83]
    ds_read_b64 v[100:101], v12 offset:2368
    ds_read_b64 v[102:103], v12 offset:2376
    v_mfma_f32_16x16x32_bf16 v[84:87], v[136:139], a[52:55], v[84:87]
    v_mfma_f32_16x16x32_bf16 v[88:91], v[136:139], a[84:87], v[88:91]
    v_mfma_f32_16x16x32_bf16 v[92:95], v[136:139], a[116:119], v[92:95]
    s_waitcnt lgkmcnt(4)
    v_mfma_f32_16x16x32_bf16 v[80:83], v[140:143], a[16:19], v[80:83]
    ds_read_b64 v[104:105], v12 offset:2432
    ds_read_b64 v[106:107], v12 offset:2440
    v_mfma_f32_16x16x32_bf16 v[84:87], v[140:143], a[48:51], v[84:87]
    v_and_b32 v216, s50, v167
    v_mfma_f32_16x16x32_bf16 v[88:91], v[140:143], a[80:83], v[88:91]
    v_lshlrev_b32 v217, 16, v167
    v_mfma_f32_16x16x32_bf16 v[92:95], v[140:143], a[112:115], v[92:95]
    v_and_b32 v218, s50, v166
    buffer_load_dwordx4 v23, s[16:19], s23 offen offset:3072 lds
    s_waitcnt lgkmcnt(4)
    v_mfma_f32_16x16x32_bf16 v[80:83], v[96:99], a[12:15], v[80:83]
    ds_read_b64 v[108:109], v12 offset:2496
    ds_read_b64 v[110:111], v12 offset:2504
    v_mfma_f32_16x16x32_bf16 v[84:87], v[96:99], a[44:47], v[84:87]
    v_lshlrev_b32 v219, 16, v166
    v_mfma_f32_16x16x32_bf16 v[88:91], v[96:99], a[76:79], v[88:91]
    v_fma_f32 v216, s7, v216, v76
    v_mfma_f32_16x16x32_bf16 v[92:95], v[96:99], a[108:111], v[92:95]
    v_fma_f32 v217, s7, v217, v77
    s_waitcnt lgkmcnt(4)
    v_mfma_f32_16x16x32_bf16 v[80:83], v[100:103], a[8:11], v[80:83]
    ds_read_b64 v[112:113], v12 offset:2560
    ds_read_b64 v[114:115], v12 offset:2568
    v_mfma_f32_16x16x32_bf16 v[84:87], v[100:103], a[40:43], v[84:87]
    v_fma_f32 v218, s7, v218, v78
    v_mfma_f32_16x16x32_bf16 v[88:91], v[100:103], a[72:75], v[88:91]
    v_fma_f32 v219, s7, v219, v79
    v_mfma_f32_16x16x32_bf16 v[92:95], v[100:103], a[104:107], v[92:95]
    v_cvt_pk_bf16_f32 v222, v216, v217
    s_add_u32 m0, s21, 147456
    s_nop 0
    buffer_load_dwordx4 v24, s[16:19], s23 offen lds
    s_waitcnt lgkmcnt(4)
    v_mfma_f32_16x16x32_bf16 v[80:83], v[104:107], a[4:7], v[80:83]
    ds_read_b64 v[116:117], v12 offset:2624
    ds_read_b64 v[118:119], v12 offset:2632
    v_mfma_f32_16x16x32_bf16 v[84:87], v[104:107], a[36:39], v[84:87]
    v_cvt_pk_bf16_f32 v223, v218, v219
    v_mfma_f32_16x16x32_bf16 v[88:91], v[104:107], a[68:71], v[88:91]
    buffer_store_dwordx2 v[222:223], v14, s[40:43], s59 offen offset:1536 sc1
    v_mfma_f32_16x16x32_bf16 v[92:95], v[104:107], a[100:103], v[92:95]
    s_waitcnt lgkmcnt(4)
    v_mfma_f32_16x16x32_bf16 v[80:83], v[108:111], a[0:3], v[80:83]
    ds_read_b64 v[120:121], v12 offset:2688
    ds_read_b64 v[122:123], v12 offset:2696
    v_mfma_f32_16x16x32_bf16 v[84:87], v[108:111], a[32:35], v[84:87]
    v_mfma_f32_16x16x32_bf16 v[88:91], v[108:111], a[64:67], v[88:91]
    v_mfma_f32_16x16x32_bf16 v[92:95], v[108:111], a[96:99], v[92:95]
    s_waitcnt lgkmcnt(4)
    v_mfma_f32_16x16x32_bf16 v[84:87], v[112:115], a[28:31], v[84:87]
    ds_read_b64 v[124:125], v12 offset:2752
    ds_read_b64 v[126:127], v12 offset:2760
    ds_read_b64 v[128:129], v12 offset:2816
    ds_read_b64 v[130:131], v12 offset:2824
    ds_read_b64 v[132:133], v12 offset:2880
    ds_read_b64 v[134:135], v12 offset:2888
    ds_read_b64 v[136:137], v12 offset:2944
    ds_read_b64 v[138:139], v12 offset:2952
    ds_read_b64 v[140:141], v12 offset:3008
    ds_read_b64 v[142:143], v12 offset:3016
    ds_read_b64 v[96:97], v12 offset:3072
    ds_read_b64 v[98:99], v12 offset:3080
    v_mfma_f32_16x16x32_bf16 v[88:91], v[112:115], a[60:63], v[88:91]
    v_mfma_f32_16x16x32_bf16 v[92:95], v[112:115], a[92:95], v[92:95]
    s_waitcnt lgkmcnt(14)
    v_mfma_f32_16x16x32_bf16 v[84:87], v[116:119], a[24:27], v[84:87]
    ds_read_b64 v[100:101], v12 offset:3136
    ds_read_b64 v[102:103], v12 offset:3144
    v_mfma_f32_16x16x32_bf16 v[88:91], v[116:119], a[56:59], v[88:91]
    v_mfma_f32_16x16x32_bf16 v[92:95], v[116:119], a[88:91], v[92:95]
    s_waitcnt lgkmcnt(14)
    v_mfma_f32_16x16x32_bf16 v[84:87], v[120:123], a[20:23], v[84:87]
    ds_read_b64 v[104:105], v12 offset:3200
    ds_read_b64 v[106:107], v12 offset:3208
    v_mfma_f32_16x16x32_bf16 v[88:91], v[120:123], a[52:55], v[88:91]
    v_mfma_f32_16x16x32_bf16 v[92:95], v[120:123], a[84:87], v[92:95]
    s_waitcnt lgkmcnt(14)
    v_mfma_f32_16x16x32_bf16 v[84:87], v[124:127], a[16:19], v[84:87]
    ds_read_b64 v[108:109], v12 offset:3264
    ds_read_b64 v[110:111], v12 offset:3272
    v_mfma_f32_16x16x32_bf16 v[88:91], v[124:127], a[48:51], v[88:91]
    v_and_b32 v192, s50, v169
    v_mfma_f32_16x16x32_bf16 v[92:95], v[124:127], a[80:83], v[92:95]
    v_lshlrev_b32 v193, 16, v169
    s_waitcnt lgkmcnt(14)
    v_mfma_f32_16x16x32_bf16 v[84:87], v[128:131], a[12:15], v[84:87]
    ds_read_b64 v[112:113], v12 offset:3328
    ds_read_b64 v[114:115], v12 offset:3336
    v_mfma_f32_16x16x32_bf16 v[88:91], v[128:131], a[44:47], v[88:91]
    v_and_b32 v194, s50, v168
    v_mfma_f32_16x16x32_bf16 v[92:95], v[128:131], a[76:79], v[92:95]
    v_lshlrev_b32 v195, 16, v168
    s_waitcnt lgkmcnt(14)
    v_mfma_f32_16x16x32_bf16 v[84:87], v[132:135], a[8:11], v[84:87]
    ds_read_b64 v[116:117], v12 offset:3392
    ds_read_b64 v[118:119], v12 offset:3400
    v_mfma_f32_16x16x32_bf16 v[88:91], v[132:135], a[40:43], v[88:91]
    v_fma_f32 v192, s7, v192, v80
    v_mfma_f32_16x16x32_bf16 v[92:95], v[132:135], a[72:75], v[92:95]
    v_fma_f32 v193, s7, v193, v81
    buffer_load_dword v8, v18, s[40:43], 0 offen sc1
    s_waitcnt lgkmcnt(14)
    v_mfma_f32_16x16x32_bf16 v[84:87], v[136:139], a[4:7], v[84:87]
    ds_read_b64 v[120:121], v12 offset:3456
    ds_read_b64 v[122:123], v12 offset:3464
    v_mfma_f32_16x16x32_bf16 v[88:91], v[136:139], a[36:39], v[88:91]
    v_fma_f32 v194, s7, v194, v82
    v_mfma_f32_16x16x32_bf16 v[92:95], v[136:139], a[68:71], v[92:95]
    v_fma_f32 v195, s7, v195, v83
    s_waitcnt lgkmcnt(14)
    v_mfma_f32_16x16x32_bf16 v[84:87], v[140:143], a[0:3], v[84:87]
    ds_read_b64 v[124:125], v12 offset:3520
    ds_read_b64 v[126:127], v12 offset:3528
    v_mfma_f32_16x16x32_bf16 v[88:91], v[140:143], a[32:35], v[88:91]
    v_cvt_pk_bf16_f32 v198, v192, v193
    v_mfma_f32_16x16x32_bf16 v[92:95], v[140:143], a[64:67], v[92:95]
    v_cvt_pk_bf16_f32 v199, v194, v195
    s_waitcnt lgkmcnt(14)
    v_mfma_f32_16x16x32_bf16 v[88:91], v[96:99], a[28:31], v[88:91]
    ds_read_b64 v[128:129], v12 offset:3584
    ds_read_b64 v[130:131], v12 offset:3592
    v_mfma_f32_16x16x32_bf16 v[92:95], v[96:99], a[60:63], v[92:95]
    buffer_store_dwordx2 v[198:199], v14, s[40:43], s59 offen offset:2048 sc1
    s_waitcnt lgkmcnt(14)
    v_mfma_f32_16x16x32_bf16 v[88:91], v[100:103], a[24:27], v[88:91]
    ds_read_b64 v[132:133], v12 offset:3648
    ds_read_b64 v[134:135], v12 offset:3656
    v_mfma_f32_16x16x32_bf16 v[92:95], v[100:103], a[56:59], v[92:95]
    s_waitcnt lgkmcnt(14)
    v_mfma_f32_16x16x32_bf16 v[88:91], v[104:107], a[20:23], v[88:91]
    ds_read_b64 v[136:137], v12 offset:3712
    ds_read_b64 v[138:139], v12 offset:3720
    v_mfma_f32_16x16x32_bf16 v[92:95], v[104:107], a[52:55], v[92:95]
    s_waitcnt lgkmcnt(14)
    v_mfma_f32_16x16x32_bf16 v[88:91], v[108:111], a[16:19], v[88:91]
    ds_read_b64 v[140:141], v12 offset:3776
    ds_read_b64 v[142:143], v12 offset:3784
    v_mfma_f32_16x16x32_bf16 v[92:95], v[108:111], a[48:51], v[92:95]
    v_and_b32 v200, s50, v171
    s_waitcnt lgkmcnt(14)
    v_mfma_f32_16x16x32_bf16 v[88:91], v[112:115], a[12:15], v[88:91]
    ds_read_b64 v[96:97], v12 offset:3840
    ds_read_b64 v[98:99], v12 offset:3848
    v_mfma_f32_16x16x32_bf16 v[92:95], v[112:115], a[44:47], v[92:95]
    v_lshlrev_b32 v201, 16, v171
    s_waitcnt lgkmcnt(14)
    v_mfma_f32_16x16x32_bf16 v[88:91], v[116:119], a[8:11], v[88:91]
    ds_read_b64 v[100:101], v12 offset:3904
    ds_read_b64 v[102:103], v12 offset:3912
    v_mfma_f32_16x16x32_bf16 v[92:95], v[116:119], a[40:43], v[92:95]
    v_and_b32 v202, s50, v170
    s_waitcnt lgkmcnt(14)
    v_mfma_f32_16x16x32_bf16 v[88:91], v[120:123], a[4:7], v[88:91]
    ds_read_b64 v[104:105], v12 offset:3968
    ds_read_b64 v[106:107], v12 offset:3976
    v_mfma_f32_16x16x32_bf16 v[92:95], v[120:123], a[36:39], v[92:95]
    v_lshlrev_b32 v203, 16, v170
    s_waitcnt lgkmcnt(14)
    v_mfma_f32_16x16x32_bf16 v[88:91], v[124:127], a[0:3], v[88:91]
    ds_read_b64 v[108:109], v12 offset:4032
    ds_read_b64 v[110:111], v12 offset:4040
    v_mfma_f32_16x16x32_bf16 v[92:95], v[124:127], a[32:35], v[92:95]
    v_fma_f32 v200, s7, v200, v84
    s_waitcnt lgkmcnt(14)
    v_mfma_f32_16x16x32_bf16 v[92:95], v[128:131], a[28:31], v[92:95]
    s_waitcnt lgkmcnt(12)
    v_mfma_f32_16x16x32_bf16 v[92:95], v[132:135], a[24:27], v[92:95]
    s_waitcnt lgkmcnt(10)
    v_mfma_f32_16x16x32_bf16 v[92:95], v[136:139], a[20:23], v[92:95]
    s_waitcnt lgkmcnt(8)
    v_mfma_f32_16x16x32_bf16 v[92:95], v[140:143], a[16:19], v[92:95]
    s_waitcnt lgkmcnt(6)
    v_mfma_f32_16x16x32_bf16 v[92:95], v[96:99], a[12:15], v[92:95]
    s_waitcnt lgkmcnt(4)
    v_mfma_f32_16x16x32_bf16 v[92:95], v[100:103], a[8:11], v[92:95]
    s_waitcnt lgkmcnt(2)
    v_mfma_f32_16x16x32_bf16 v[92:95], v[104:107], a[4:7], v[92:95]
    s_waitcnt lgkmcnt(0)
    v_mfma_f32_16x16x32_bf16 v[92:95], v[108:111], a[0:3], v[92:95]
    s_nop 7
    v_fma_f32 v201, s7, v201, v85
    v_fma_f32 v202, s7, v202, v86
    v_fma_f32 v203, s7, v203, v87
    v_cvt_pk_bf16_f32 v206, v200, v201
    v_cvt_pk_bf16_f32 v207, v202, v203
    buffer_store_dwordx2 v[206:207], v14, s[40:43], s59 offen offset:2560 sc1
    v_and_b32 v208, s50, v173
    v_lshlrev_b32 v209, 16, v173
    v_and_b32 v210, s50, v172
    v_lshlrev_b32 v211, 16, v172
    v_fma_f32 v208, s7, v208, v88
    v_fma_f32 v209, s7, v209, v89
    v_fma_f32 v210, s7, v210, v90
    v_fma_f32 v211, s7, v211, v91
    v_cvt_pk_bf16_f32 v214, v208, v209
    v_cvt_pk_bf16_f32 v215, v210, v211
    buffer_store_dwordx2 v[214:215], v14, s[40:43], s59 offen offset:3072 sc1
    v_and_b32 v216, s50, v175
    v_lshlrev_b32 v217, 16, v175
    v_and_b32 v218, s50, v174
    v_lshlrev_b32 v219, 16, v174
    v_fma_f32 v216, s7, v216, v92
    v_fma_f32 v217, s7, v217, v93
    v_fma_f32 v218, s7, v218, v94
    v_fma_f32 v219, s7, v219, v95
    v_cvt_pk_bf16_f32 v222, v216, v217
    v_cvt_pk_bf16_f32 v223, v218, v219
    buffer_store_dwordx2 v[222:223], v14, s[40:43], s59 offen offset:3584 sc1
    s_waitcnt vmcnt(4)
    s_lshl_b32 s58, s4, 2
    s_add_u32 s58, s58, 0x4810000
    v_mov_b32 v2, s58
    s_branch main_kernel_fin
main_kernel_yspin:
    s_mov_b32 s59, 0x100000
main_kernel_yspl:
    s_sleep 4
    buffer_load_dwordx4 v[192:195], v7, s[40:43], 0 offen sc1
    s_waitcnt vmcnt(0)
    v_and_b32 v192, v192, v193
    v_and_b32 v194, v194, v195
    v_and_b32 v192, v192, v194
    v_cmp_ne_u32 vcc, 1, v192
    s_sub_u32 s59, s59, 1
    s_cmp_eq_u32 s59, 0
    s_cbranch_scc1 main_kernel_yok
    s_cbranch_vccnz main_kernel_yspl
    s_branch main_kernel_yok
main_kernel_spin:
    s_mov_b32 s59, 0x100000
main_kernel_spinl:
    buffer_load_dword v3, v2, s[40:43], 0 offen sc1
    s_waitcnt vmcnt(0)
    v_cmp_ne_u32 vcc, 1, v3
    s_sub_u32 s59, s59, 1
    s_cmp_eq_u32 s59, 0
    s_cbranch_scc1 main_kernel_spinx
    s_cbranch_vccz main_kernel_spinx
    s_sleep 2
    s_branch main_kernel_spinl
main_kernel_spinx:
    s_mov_b32 m0, s55
    s_nop 0
    buffer_load_dwordx4 v4, s[28:31], s53 offen sc1 lds
    buffer_load_dwordx4 v4, s[28:31], s53 offen offset:1024 sc1 lds
    buffer_load_dwordx4 v4, s[28:31], s53 offen offset:2048 sc1 lds
    buffer_load_dwordx4 v4, s[28:31], s53 offen offset:3072 sc1 lds
    s_cmp_lg_u32 s48, 2
    s_cbranch_scc1 main_kernel_nok2b
    s_add_u32 m0, s55, 0x4000
    s_nop 0
    buffer_load_dwordx4 v5, s[28:31], s53 offen sc1 lds
    buffer_load_dwordx4 v5, s[28:31], s53 offen offset:1024 sc1 lds
    buffer_load_dwordx4 v5, s[28:31], s53 offen offset:2048 sc1 lds
    buffer_load_dwordx4 v5, s[28:31], s53 offen offset:3072 sc1 lds
main_kernel_nok2b:
    s_branch main_kernel_spinr
main_kernel_slowpub:
    s_mov_b32 s3, 0x100000
main_kernel_slowl:
    global_load_dword v3, v7, s[72:73] sc1
    s_waitcnt vmcnt(0)
    v_readfirstlane_b32 s58, v3
    s_cmp_ge_u32 s58, 8
    s_cbranch_scc1 main_kernel_slowx
    s_sub_u32 s3, s3, 1
    s_cmp_eq_u32 s3, 0
    s_cbranch_scc1 main_kernel_slowx
    s_sleep 8
    s_branch main_kernel_slowl
main_kernel_slowx:
    s_branch main_kernel_noat
main_kernel_rdXp:
    v_max3_f32 v18, v128, v129, v130
    v_max3_f32 v19, v131, v132, v133
    v_max3_f32 v18, v18, v134, v135
    v_max3_f32 v19, v19, v136, v137
    v_max3_f32 v18, v18, v138, v139
    v_max3_f32 v19, v19, v140, v141
    v_max3_f32 v18, v18, v142, v143
    v_max3_f32 v19, v19, v144, v145
    v_max3_f32 v18, v18, v146, v147
    v_max3_f32 v19, v19, v148, v149
    v_max3_f32 v18, v18, v150, v151
    v_max3_f32 v19, v19, v152, v153
    v_max3_f32 v18, v18, v154, v155
    v_max3_f32 v19, v19, v156, v157
    v_max3_f32 v18, v18, v158, v159
    v_max_f32 v18, v18, v19
    v_mov_b32 v19, v18
    s_nop 1
    v_permlane32_swap_b32 v19, v18
    s_nop 1
    v_max_f32 v18, v18, v19
    v_max_f32 v18, 0, v18
    v_sub_f32 v64, v64, v18
    v_sub_f32 v19, 0, v18
    v_exp_f32 v19, v19
    v_sub_f32 v128, v128, v18
    v_sub_f32 v129, v129, v18
    v_sub_f32 v130, v130, v18
    v_sub_f32 v131, v131, v18
    v_sub_f32 v132, v132, v18
    v_sub_f32 v133, v133, v18
    v_sub_f32 v134, v134, v18
    v_sub_f32 v135, v135, v18
    v_sub_f32 v136, v136, v18
    v_sub_f32 v137, v137, v18
    v_sub_f32 v138, v138, v18
    v_sub_f32 v139, v139, v18
    v_sub_f32 v140, v140, v18
    v_sub_f32 v141, v141, v18
    v_sub_f32 v142, v142, v18
    v_sub_f32 v143, v143, v18
    v_sub_f32 v144, v144, v18
    v_sub_f32 v145, v145, v18
    v_sub_f32 v146, v146, v18
    v_sub_f32 v147, v147, v18
    v_sub_f32 v148, v148, v18
    v_sub_f32 v149, v149, v18
    v_sub_f32 v150, v150, v18
    v_sub_f32 v151, v151, v18
    v_sub_f32 v152, v152, v18
    v_sub_f32 v153, v153, v18
    v_sub_f32 v154, v154, v18
    v_sub_f32 v155, v155, v18
    v_sub_f32 v156, v156, v18
    v_sub_f32 v157, v157, v18
    v_sub_f32 v158, v158, v18
    v_sub_f32 v159, v159, v18
    v_mov_b32 v65, v64
    v_mov_b32 v66, v64
    v_mov_b32 v67, v64
    v_mov_b32 v68, v64
    v_mov_b32 v69, v64
    v_mov_b32 v70, v64
    v_mov_b32 v71, v64
    v_mov_b32 v72, v64
    v_mov_b32 v73, v64
    v_mov_b32 v74, v64
    v_mov_b32 v75, v64
    v_mov_b32 v76, v64
    v_mov_b32 v77, v64
    v_mov_b32 v78, v64
    v_mov_b32 v79, v64
    v_mul_f32 v12, v12, v19
    v_accvgpr_read_b32 v24, a0
    v_accvgpr_read_b32 v25, a1
    v_accvgpr_read_b32 v26, a2
    v_accvgpr_read_b32 v27, a3
    v_accvgpr_read_b32 v28, a4
    v_accvgpr_read_b32 v29, a5
    v_accvgpr_read_b32 v30, a6
    v_accvgpr_read_b32 v31, a7
    v_mul_f32 v24, v24, v19
    v_mul_f32 v25, v25, v19
    v_mul_f32 v26, v26, v19
    v_mul_f32 v27, v27, v19
    v_mul_f32 v28, v28, v19
    v_mul_f32 v29, v29, v19
    v_mul_f32 v30, v30, v19
    v_mul_f32 v31, v31, v19
    v_accvgpr_write_b32 a0, v24
    v_accvgpr_write_b32 a1, v25
    v_accvgpr_write_b32 a2, v26
    v_accvgpr_write_b32 a3, v27
    v_accvgpr_write_b32 a4, v28
    v_accvgpr_write_b32 a5, v29
    v_accvgpr_write_b32 a6, v30
    v_accvgpr_write_b32 a7, v31
    v_accvgpr_read_b32 v24, a8
    v_accvgpr_read_b32 v25, a9
    v_accvgpr_read_b32 v26, a10
    v_accvgpr_read_b32 v27, a11
    v_accvgpr_read_b32 v28, a12
    v_accvgpr_read_b32 v29, a13
    v_accvgpr_read_b32 v30, a14
    v_accvgpr_read_b32 v31, a15
    v_mul_f32 v24, v24, v19
    v_mul_f32 v25, v25, v19
    v_mul_f32 v26, v26, v19
    v_mul_f32 v27, v27, v19
    v_mul_f32 v28, v28, v19
    v_mul_f32 v29, v29, v19
    v_mul_f32 v30, v30, v19
    v_mul_f32 v31, v31, v19
    v_accvgpr_write_b32 a8, v24
    v_accvgpr_write_b32 a9, v25
    v_accvgpr_write_b32 a10, v26
    v_accvgpr_write_b32 a11, v27
    v_accvgpr_write_b32 a12, v28
    v_accvgpr_write_b32 a13, v29
    v_accvgpr_write_b32 a14, v30
    v_accvgpr_write_b32 a15, v31
    v_accvgpr_read_b32 v24, a16
    v_accvgpr_read_b32 v25, a17
    v_accvgpr_read_b32 v26, a18
    v_accvgpr_read_b32 v27, a19
    v_accvgpr_read_b32 v28, a20
    v_accvgpr_read_b32 v29, a21
    v_accvgpr_read_b32 v30, a22
    v_accvgpr_read_b32 v31, a23
    v_mul_f32 v24, v24, v19
    v_mul_f32 v25, v25, v19
    v_mul_f32 v26, v26, v19
    v_mul_f32 v27, v27, v19
    v_mul_f32 v28, v28, v19
    v_mul_f32 v29, v29, v19
    v_mul_f32 v30, v30, v19
    v_mul_f32 v31, v31, v19
    v_accvgpr_write_b32 a16, v24
    v_accvgpr_write_b32 a17, v25
    v_accvgpr_write_b32 a18, v26
    v_accvgpr_write_b32 a19, v27
    v_accvgpr_write_b32 a20, v28
    v_accvgpr_write_b32 a21, v29
    v_accvgpr_write_b32 a22, v30
    v_accvgpr_write_b32 a23, v31
    v_accvgpr_read_b32 v24, a24
    v_accvgpr_read_b32 v25, a25
    v_accvgpr_read_b32 v26, a26
    v_accvgpr_read_b32 v27, a27
    v_accvgpr_read_b32 v28, a28
    v_accvgpr_read_b32 v29, a29
    v_accvgpr_read_b32 v30, a30
    v_accvgpr_read_b32 v31, a31
    v_mul_f32 v24, v24, v19
    v_mul_f32 v25, v25, v19
    v_mul_f32 v26, v26, v19
    v_mul_f32 v27, v27, v19
    v_mul_f32 v28, v28, v19
    v_mul_f32 v29, v29, v19
    v_mul_f32 v30, v30, v19
    v_mul_f32 v31, v31, v19
    v_accvgpr_write_b32 a24, v24
    v_accvgpr_write_b32 a25, v25
    v_accvgpr_write_b32 a26, v26
    v_accvgpr_write_b32 a27, v27
    v_accvgpr_write_b32 a28, v28
    v_accvgpr_write_b32 a29, v29
    v_accvgpr_write_b32 a30, v30
    v_accvgpr_write_b32 a31, v31
    v_accvgpr_read_b32 v24, a32
    v_accvgpr_read_b32 v25, a33
    v_accvgpr_read_b32 v26, a34
    v_accvgpr_read_b32 v27, a35
    v_accvgpr_read_b32 v28, a36
    v_accvgpr_read_b32 v29, a37
    v_accvgpr_read_b32 v30, a38
    v_accvgpr_read_b32 v31, a39
    v_mul_f32 v24, v24, v19
    v_mul_f32 v25, v25, v19
    v_mul_f32 v26, v26, v19
    v_mul_f32 v27, v27, v19
    v_mul_f32 v28, v28, v19
    v_mul_f32 v29, v29, v19
    v_mul_f32 v30, v30, v19
    v_mul_f32 v31, v31, v19
    v_accvgpr_write_b32 a32, v24
    v_accvgpr_write_b32 a33, v25
    v_accvgpr_write_b32 a34, v26
    v_accvgpr_write_b32 a35, v27
    v_accvgpr_write_b32 a36, v28
    v_accvgpr_write_b32 a37, v29
    v_accvgpr_write_b32 a38, v30
    v_accvgpr_write_b32 a39, v31
    v_accvgpr_read_b32 v24, a40
    v_accvgpr_read_b32 v25, a41
    v_accvgpr_read_b32 v26, a42
    v_accvgpr_read_b32 v27, a43
    v_accvgpr_read_b32 v28, a44
    v_accvgpr_read_b32 v29, a45
    v_accvgpr_read_b32 v30, a46
    v_accvgpr_read_b32 v31, a47
    v_mul_f32 v24, v24, v19
    v_mul_f32 v25, v25, v19
    v_mul_f32 v26, v26, v19
    v_mul_f32 v27, v27, v19
    v_mul_f32 v28, v28, v19
    v_mul_f32 v29, v29, v19
    v_mul_f32 v30, v30, v19
    v_mul_f32 v31, v31, v19
    v_accvgpr_write_b32 a40, v24
    v_accvgpr_write_b32 a41, v25
    v_accvgpr_write_b32 a42, v26
    v_accvgpr_write_b32 a43, v27
    v_accvgpr_write_b32 a44, v28
    v_accvgpr_write_b32 a45, v29
    v_accvgpr_write_b32 a46, v30
    v_accvgpr_write_b32 a47, v31
    v_accvgpr_read_b32 v24, a48
    v_accvgpr_read_b32 v25, a49
    v_accvgpr_read_b32 v26, a50
    v_accvgpr_read_b32 v27, a51
    v_accvgpr_read_b32 v28, a52
    v_accvgpr_read_b32 v29, a53
    v_accvgpr_read_b32 v30, a54
    v_accvgpr_read_b32 v31, a55
    v_mul_f32 v24, v24, v19
    v_mul_f32 v25, v25, v19
    v_mul_f32 v26, v26, v19
    v_mul_f32 v27, v27, v19
    v_mul_f32 v28, v28, v19
    v_mul_f32 v29, v29, v19
    v_mul_f32 v30, v30, v19
    v_mul_f32 v31, v31, v19
    v_accvgpr_write_b32 a48, v24
    v_accvgpr_write_b32 a49, v25
    v_accvgpr_write_b32 a50, v26
    v_accvgpr_write_b32 a51, v27
    v_accvgpr_write_b32 a52, v28
    v_accvgpr_write_b32 a53, v29
    v_accvgpr_write_b32 a54, v30
    v_accvgpr_write_b32 a55, v31
    v_accvgpr_read_b32 v24, a56
    v_accvgpr_read_b32 v25, a57
    v_accvgpr_read_b32 v26, a58
    v_accvgpr_read_b32 v27, a59
    v_accvgpr_read_b32 v28, a60
    v_accvgpr_read_b32 v29, a61
    v_accvgpr_read_b32 v30, a62
    v_accvgpr_read_b32 v31, a63
    v_mul_f32 v24, v24, v19
    v_mul_f32 v25, v25, v19
    v_mul_f32 v26, v26, v19
    v_mul_f32 v27, v27, v19
    v_mul_f32 v28, v28, v19
    v_mul_f32 v29, v29, v19
    v_mul_f32 v30, v30, v19
    v_mul_f32 v31, v31, v19
    v_accvgpr_write_b32 a56, v24
    v_accvgpr_write_b32 a57, v25
    v_accvgpr_write_b32 a58, v26
    v_accvgpr_write_b32 a59, v27
    v_accvgpr_write_b32 a60, v28
    v_accvgpr_write_b32 a61, v29
    v_accvgpr_write_b32 a62, v30
    v_accvgpr_write_b32 a63, v31
    v_exp_f32 v24, v128
    v_exp_f32 v25, v129
    v_exp_f32 v26, v130
    v_cvt_pk_bf16_f32 v96, v24, v25
    v_exp_f32 v27, v131
    v_exp_f32 v28, v132
    v_add_f32 v17, v25, v27
    v_exp_f32 v29, v133
    v_cvt_pk_bf16_f32 v97, v26, v27
    v_add_f32 v16, v24, v26
    v_exp_f32 v30, v134
    v_add_f32 v17, v17, v29
    v_exp_f32 v31, v135
    v_cvt_pk_bf16_f32 v98, v28, v29
    v_add_f32 v16, v16, v28
    v_exp_f32 v24, v136
    v_add_f32 v17, v17, v31
    v_exp_f32 v25, v137
    v_cvt_pk_bf16_f32 v99, v30, v31
    v_add_f32 v16, v16, v30
    v_exp_f32 v26, v138
    v_add_f32 v17, v17, v25
    v_exp_f32 v27, v139
    v_cvt_pk_bf16_f32 v100, v24, v25
    v_add_f32 v16, v16, v24
    v_exp_f32 v28, v140
    v_add_f32 v17, v17, v27
    v_exp_f32 v29, v141
    v_cvt_pk_bf16_f32 v101, v26, v27
    v_add_f32 v16, v16, v26
    v_exp_f32 v30, v142
    v_add_f32 v17, v17, v29
    v_exp_f32 v31, v143
    v_cvt_pk_bf16_f32 v102, v28, v29
    v_add_f32 v16, v16, v28
    v_exp_f32 v24, v144
    v_add_f32 v17, v17, v31
    v_exp_f32 v25, v145
    v_cvt_pk_bf16_f32 v103, v30, v31
    v_add_f32 v16, v16, v30
    v_exp_f32 v26, v146
    v_add_f32 v17, v17, v25
    v_exp_f32 v27, v147
    v_cvt_pk_bf16_f32 v104, v24, v25
    v_add_f32 v16, v16, v24
    v_exp_f32 v28, v148
    v_add_f32 v17, v17, v27
    v_exp_f32 v29, v149
    v_cvt_pk_bf16_f32 v105, v26, v27
    v_add_f32 v16, v16, v26
    v_exp_f32 v30, v150
    v_add_f32 v17, v17, v29
    v_exp_f32 v31, v151
    v_cvt_pk_bf16_f32 v106, v28, v29
    v_add_f32 v16, v16, v28
    v_exp_f32 v24, v152
    v_add_f32 v17, v17, v31
    v_exp_f32 v25, v153
    v_cvt_pk_bf16_f32 v107, v30, v31
    v_add_f32 v16, v16, v30
    v_exp_f32 v26, v154
    v_add_f32 v17, v17, v25
    v_exp_f32 v27, v155
    v_cvt_pk_bf16_f32 v108, v24, v25
    v_add_f32 v16, v16, v24
    v_exp_f32 v28, v156
    v_add_f32 v17, v17, v27
    v_exp_f32 v29, v157
    v_cvt_pk_bf16_f32 v109, v26, v27
    v_add_f32 v16, v16, v26
    v_exp_f32 v30, v158
    v_add_f32 v17, v17, v29
    v_exp_f32 v31, v159
    v_cvt_pk_bf16_f32 v110, v28, v29
    v_add_f32 v16, v16, v28
    v_cvt_pk_bf16_f32 v111, v30, v31
    v_add_f32 v16, v16, v30
    v_add_f32 v17, v17, v31
    v_add_f32 v16, v16, v17
    s_nop 1
    s_branch main_kernel_rdXpr
main_kernel_rdYa:
    v_max3_f32 v18, v160, v161, v162
    v_max3_f32 v19, v163, v164, v165
    v_max3_f32 v18, v18, v166, v167
    v_max3_f32 v19, v19, v168, v169
    v_max3_f32 v18, v18, v170, v171
    v_max3_f32 v19, v19, v172, v173
    v_max3_f32 v18, v18, v174, v175
    v_max3_f32 v19, v19, v176, v177
    v_max3_f32 v18, v18, v178, v179
    v_max3_f32 v19, v19, v180, v181
    v_max3_f32 v18, v18, v182, v183
    v_max3_f32 v19, v19, v184, v185
    v_max3_f32 v18, v18, v186, v187
    v_max3_f32 v19, v19, v188, v189
    v_max3_f32 v18, v18, v190, v191
    v_max_f32 v18, v18, v19
    v_mov_b32 v19, v18
    s_nop 1
    v_permlane32_swap_b32 v19, v18
    s_nop 1
    v_max_f32 v18, v18, v19
    v_max_f32 v18, 0, v18
    v_sub_f32 v80, v80, v18
    v_sub_f32 v19, 0, v18
    v_exp_f32 v19, v19
    v_sub_f32 v160, v160, v18
    v_sub_f32 v161, v161, v18
    v_sub_f32 v162, v162, v18
    v_sub_f32 v163, v163, v18
    v_sub_f32 v164, v164, v18
    v_sub_f32 v165, v165, v18
    v_sub_f32 v166, v166, v18
    v_sub_f32 v167, v167, v18
    v_sub_f32 v168, v168, v18
    v_sub_f32 v169, v169, v18
    v_sub_f32 v170, v170, v18
    v_sub_f32 v171, v171, v18
    v_sub_f32 v172, v172, v18
    v_sub_f32 v173, v173, v18
    v_sub_f32 v174, v174, v18
    v_sub_f32 v175, v175, v18
    v_sub_f32 v176, v176, v18
    v_sub_f32 v177, v177, v18
    v_sub_f32 v178, v178, v18
    v_sub_f32 v179, v179, v18
    v_sub_f32 v180, v180, v18
    v_sub_f32 v181, v181, v18
    v_sub_f32 v182, v182, v18
    v_sub_f32 v183, v183, v18
    v_sub_f32 v184, v184, v18
    v_sub_f32 v185, v185, v18
    v_sub_f32 v186, v186, v18
    v_sub_f32 v187, v187, v18
    v_sub_f32 v188, v188, v18
    v_sub_f32 v189, v189, v18
    v_sub_f32 v190, v190, v18
    v_sub_f32 v191, v191, v18
    v_mov_b32 v81, v80
    v_mov_b32 v82, v80
    v_mov_b32 v83, v80
    v_mov_b32 v84, v80
    v_mov_b32 v85, v80
    v_mov_b32 v86, v80
    v_mov_b32 v87, v80
    v_mov_b32 v88, v80
    v_mov_b32 v89, v80
    v_mov_b32 v90, v80
    v_mov_b32 v91, v80
    v_mov_b32 v92, v80
    v_mov_b32 v93, v80
    v_mov_b32 v94, v80
    v_mov_b32 v95, v80
    v_mul_f32 v13, v13, v19
    v_accvgpr_read_b32 v24, a64
    v_accvgpr_read_b32 v25, a65
    v_accvgpr_read_b32 v26, a66
    v_accvgpr_read_b32 v27, a67
    v_accvgpr_read_b32 v28, a68
    v_accvgpr_read_b32 v29, a69
    v_accvgpr_read_b32 v30, a70
    v_accvgpr_read_b32 v31, a71
    v_mul_f32 v24, v24, v19
    v_mul_f32 v25, v25, v19
    v_mul_f32 v26, v26, v19
    v_mul_f32 v27, v27, v19
    v_mul_f32 v28, v28, v19
    v_mul_f32 v29, v29, v19
    v_mul_f32 v30, v30, v19
    v_mul_f32 v31, v31, v19
    v_accvgpr_write_b32 a64, v24
    v_accvgpr_write_b32 a65, v25
    v_accvgpr_write_b32 a66, v26
    v_accvgpr_write_b32 a67, v27
    v_accvgpr_write_b32 a68, v28
    v_accvgpr_write_b32 a69, v29
    v_accvgpr_write_b32 a70, v30
    v_accvgpr_write_b32 a71, v31
    v_accvgpr_read_b32 v24, a72
    v_accvgpr_read_b32 v25, a73
    v_accvgpr_read_b32 v26, a74
    v_accvgpr_read_b32 v27, a75
    v_accvgpr_read_b32 v28, a76
    v_accvgpr_read_b32 v29, a77
    v_accvgpr_read_b32 v30, a78
    v_accvgpr_read_b32 v31, a79
    v_mul_f32 v24, v24, v19
    v_mul_f32 v25, v25, v19
    v_mul_f32 v26, v26, v19
    v_mul_f32 v27, v27, v19
    v_mul_f32 v28, v28, v19
    v_mul_f32 v29, v29, v19
    v_mul_f32 v30, v30, v19
    v_mul_f32 v31, v31, v19
    v_accvgpr_write_b32 a72, v24
    v_accvgpr_write_b32 a73, v25
    v_accvgpr_write_b32 a74, v26
    v_accvgpr_write_b32 a75, v27
    v_accvgpr_write_b32 a76, v28
    v_accvgpr_write_b32 a77, v29
    v_accvgpr_write_b32 a78, v30
    v_accvgpr_write_b32 a79, v31
    v_accvgpr_read_b32 v24, a80
    v_accvgpr_read_b32 v25, a81
    v_accvgpr_read_b32 v26, a82
    v_accvgpr_read_b32 v27, a83
    v_accvgpr_read_b32 v28, a84
    v_accvgpr_read_b32 v29, a85
    v_accvgpr_read_b32 v30, a86
    v_accvgpr_read_b32 v31, a87
    v_mul_f32 v24, v24, v19
    v_mul_f32 v25, v25, v19
    v_mul_f32 v26, v26, v19
    v_mul_f32 v27, v27, v19
    v_mul_f32 v28, v28, v19
    v_mul_f32 v29, v29, v19
    v_mul_f32 v30, v30, v19
    v_mul_f32 v31, v31, v19
    v_accvgpr_write_b32 a80, v24
    v_accvgpr_write_b32 a81, v25
    v_accvgpr_write_b32 a82, v26
    v_accvgpr_write_b32 a83, v27
    v_accvgpr_write_b32 a84, v28
    v_accvgpr_write_b32 a85, v29
    v_accvgpr_write_b32 a86, v30
    v_accvgpr_write_b32 a87, v31
    v_accvgpr_read_b32 v24, a88
    v_accvgpr_read_b32 v25, a89
    v_accvgpr_read_b32 v26, a90
    v_accvgpr_read_b32 v27, a91
    v_accvgpr_read_b32 v28, a92
    v_accvgpr_read_b32 v29, a93
    v_accvgpr_read_b32 v30, a94
    v_accvgpr_read_b32 v31, a95
    v_mul_f32 v24, v24, v19
    v_mul_f32 v25, v25, v19
    v_mul_f32 v26, v26, v19
    v_mul_f32 v27, v27, v19
    v_mul_f32 v28, v28, v19
    v_mul_f32 v29, v29, v19
    v_mul_f32 v30, v30, v19
    v_mul_f32 v31, v31, v19
    v_accvgpr_write_b32 a88, v24
    v_accvgpr_write_b32 a89, v25
    v_accvgpr_write_b32 a90, v26
    v_accvgpr_write_b32 a91, v27
    v_accvgpr_write_b32 a92, v28
    v_accvgpr_write_b32 a93, v29
    v_accvgpr_write_b32 a94, v30
    v_accvgpr_write_b32 a95, v31
    v_accvgpr_read_b32 v24, a96
    v_accvgpr_read_b32 v25, a97
    v_accvgpr_read_b32 v26, a98
    v_accvgpr_read_b32 v27, a99
    v_accvgpr_read_b32 v28, a100
    v_accvgpr_read_b32 v29, a101
    v_accvgpr_read_b32 v30, a102
    v_accvgpr_read_b32 v31, a103
    v_mul_f32 v24, v24, v19
    v_mul_f32 v25, v25, v19
    v_mul_f32 v26, v26, v19
    v_mul_f32 v27, v27, v19
    v_mul_f32 v28, v28, v19
    v_mul_f32 v29, v29, v19
    v_mul_f32 v30, v30, v19
    v_mul_f32 v31, v31, v19
    v_accvgpr_write_b32 a96, v24
    v_accvgpr_write_b32 a97, v25
    v_accvgpr_write_b32 a98, v26
    v_accvgpr_write_b32 a99, v27
    v_accvgpr_write_b32 a100, v28
    v_accvgpr_write_b32 a101, v29
    v_accvgpr_write_b32 a102, v30
    v_accvgpr_write_b32 a103, v31
    v_accvgpr_read_b32 v24, a104
    v_accvgpr_read_b32 v25, a105
    v_accvgpr_read_b32 v26, a106
    v_accvgpr_read_b32 v27, a107
    v_accvgpr_read_b32 v28, a108
    v_accvgpr_read_b32 v29, a109
    v_accvgpr_read_b32 v30, a110
    v_accvgpr_read_b32 v31, a111
    v_mul_f32 v24, v24, v19
    v_mul_f32 v25, v25, v19
    v_mul_f32 v26, v26, v19
    v_mul_f32 v27, v27, v19
    v_mul_f32 v28, v28, v19
    v_mul_f32 v29, v29, v19
    v_mul_f32 v30, v30, v19
    v_mul_f32 v31, v31, v19
    v_accvgpr_write_b32 a104, v24
    v_accvgpr_write_b32 a105, v25
    v_accvgpr_write_b32 a106, v26
    v_accvgpr_write_b32 a107, v27
    v_accvgpr_write_b32 a108, v28
    v_accvgpr_write_b32 a109, v29
    v_accvgpr_write_b32 a110, v30
    v_accvgpr_write_b32 a111, v31
    v_accvgpr_read_b32 v24, a112
    v_accvgpr_read_b32 v25, a113
    v_accvgpr_read_b32 v26, a114
    v_accvgpr_read_b32 v27, a115
    v_accvgpr_read_b32 v28, a116
    v_accvgpr_read_b32 v29, a117
    v_accvgpr_read_b32 v30, a118
    v_accvgpr_read_b32 v31, a119
    v_mul_f32 v24, v24, v19
    v_mul_f32 v25, v25, v19
    v_mul_f32 v26, v26, v19
    v_mul_f32 v27, v27, v19
    v_mul_f32 v28, v28, v19
    v_mul_f32 v29, v29, v19
    v_mul_f32 v30, v30, v19
    v_mul_f32 v31, v31, v19
    v_accvgpr_write_b32 a112, v24
    v_accvgpr_write_b32 a113, v25
    v_accvgpr_write_b32 a114, v26
    v_accvgpr_write_b32 a115, v27
    v_accvgpr_write_b32 a116, v28
    v_accvgpr_write_b32 a117, v29
    v_accvgpr_write_b32 a118, v30
    v_accvgpr_write_b32 a119, v31
    v_accvgpr_read_b32 v24, a120
    v_accvgpr_read_b32 v25, a121
    v_accvgpr_read_b32 v26, a122
    v_accvgpr_read_b32 v27, a123
    v_accvgpr_read_b32 v28, a124
    v_accvgpr_read_b32 v29, a125
    v_accvgpr_read_b32 v30, a126
    v_accvgpr_read_b32 v31, a127
    v_mul_f32 v24, v24, v19
    v_mul_f32 v25, v25, v19
    v_mul_f32 v26, v26, v19
    v_mul_f32 v27, v27, v19
    v_mul_f32 v28, v28, v19
    v_mul_f32 v29, v29, v19
    v_mul_f32 v30, v30, v19
    v_mul_f32 v31, v31, v19
    v_accvgpr_write_b32 a120, v24
    v_accvgpr_write_b32 a121, v25
    v_accvgpr_write_b32 a122, v26
    v_accvgpr_write_b32 a123, v27
    v_accvgpr_write_b32 a124, v28
    v_accvgpr_write_b32 a125, v29
    v_accvgpr_write_b32 a126, v30
    v_accvgpr_write_b32 a127, v31
    v_exp_f32 v24, v160
    v_exp_f32 v25, v161
    v_exp_f32 v26, v162
    v_cvt_pk_bf16_f32 v112, v24, v25
    v_exp_f32 v27, v163
    v_exp_f32 v28, v164
    v_add_f32 v17, v25, v27
    v_exp_f32 v29, v165
    v_cvt_pk_bf16_f32 v113, v26, v27
    v_add_f32 v16, v24, v26
    v_exp_f32 v30, v166
    v_add_f32 v17, v17, v29
    v_exp_f32 v31, v167
    v_cvt_pk_bf16_f32 v114, v28, v29
    v_add_f32 v16, v16, v28
    v_exp_f32 v24, v168
    v_add_f32 v17, v17, v31
    v_exp_f32 v25, v169
    v_cvt_pk_bf16_f32 v115, v30, v31
    v_add_f32 v16, v16, v30
    v_exp_f32 v26, v170
    v_add_f32 v17, v17, v25
    v_exp_f32 v27, v171
    v_cvt_pk_bf16_f32 v116, v24, v25
    v_add_f32 v16, v16, v24
    v_exp_f32 v28, v172
    v_add_f32 v17, v17, v27
    v_exp_f32 v29, v173
    v_cvt_pk_bf16_f32 v117, v26, v27
    v_add_f32 v16, v16, v26
    v_exp_f32 v30, v174
    v_add_f32 v17, v17, v29
    v_exp_f32 v31, v175
    v_cvt_pk_bf16_f32 v118, v28, v29
    v_add_f32 v16, v16, v28
    v_exp_f32 v24, v176
    v_add_f32 v17, v17, v31
    v_exp_f32 v25, v177
    v_cvt_pk_bf16_f32 v119, v30, v31
    v_add_f32 v16, v16, v30
    v_exp_f32 v26, v178
    v_add_f32 v17, v17, v25
    v_exp_f32 v27, v179
    v_cvt_pk_bf16_f32 v120, v24, v25
    v_add_f32 v16, v16, v24
    v_exp_f32 v28, v180
    v_add_f32 v17, v17, v27
    v_exp_f32 v29, v181
    v_cvt_pk_bf16_f32 v121, v26, v27
    v_add_f32 v16, v16, v26
    v_exp_f32 v30, v182
    v_add_f32 v17, v17, v29
    v_exp_f32 v31, v183
    v_cvt_pk_bf16_f32 v122, v28, v29
    v_add_f32 v16, v16, v28
    v_exp_f32 v24, v184
    v_add_f32 v17, v17, v31
    v_exp_f32 v25, v185
    v_cvt_pk_bf16_f32 v123, v30, v31
    v_add_f32 v16, v16, v30
    v_exp_f32 v26, v186
    v_add_f32 v17, v17, v25
    v_exp_f32 v27, v187
    v_cvt_pk_bf16_f32 v124, v24, v25
    v_add_f32 v16, v16, v24
    v_exp_f32 v28, v188
    v_add_f32 v17, v17, v27
    v_exp_f32 v29, v189
    v_cvt_pk_bf16_f32 v125, v26, v27
    v_add_f32 v16, v16, v26
    v_exp_f32 v30, v190
    v_add_f32 v17, v17, v29
    v_exp_f32 v31, v191
    v_cvt_pk_bf16_f32 v126, v28, v29
    v_add_f32 v16, v16, v28
    v_cvt_pk_bf16_f32 v127, v30, v31
    v_add_f32 v16, v16, v30
    v_add_f32 v17, v17, v31
    v_add_f32 v16, v16, v17
    s_nop 1
    s_branch main_kernel_rdYar
main_kernel_rdXa:
    v_max3_f32 v18, v128, v129, v130
    v_max3_f32 v19, v131, v132, v133
    v_max3_f32 v18, v18, v134, v135
    v_max3_f32 v19, v19, v136, v137
    v_max3_f32 v18, v18, v138, v139
    v_max3_f32 v19, v19, v140, v141
    v_max3_f32 v18, v18, v142, v143
    v_max3_f32 v19, v19, v144, v145
    v_max3_f32 v18, v18, v146, v147
    v_max3_f32 v19, v19, v148, v149
    v_max3_f32 v18, v18, v150, v151
    v_max3_f32 v19, v19, v152, v153
    v_max3_f32 v18, v18, v154, v155
    v_max3_f32 v19, v19, v156, v157
    v_max3_f32 v18, v18, v158, v159
    v_max_f32 v18, v18, v19
    v_mov_b32 v19, v18
    s_nop 1
    v_permlane32_swap_b32 v19, v18
    s_nop 1
    v_max_f32 v18, v18, v19
    v_max_f32 v18, 0, v18
    v_sub_f32 v64, v64, v18
    v_sub_f32 v19, 0, v18
    v_exp_f32 v19, v19
    v_sub_f32 v128, v128, v18
    v_sub_f32 v129, v129, v18
    v_sub_f32 v130, v130, v18
    v_sub_f32 v131, v131, v18
    v_sub_f32 v132, v132, v18
    v_sub_f32 v133, v133, v18
    v_sub_f32 v134, v134, v18
    v_sub_f32 v135, v135, v18
    v_sub_f32 v136, v136, v18
    v_sub_f32 v137, v137, v18
    v_sub_f32 v138, v138, v18
    v_sub_f32 v139, v139, v18
    v_sub_f32 v140, v140, v18
    v_sub_f32 v141, v141, v18
    v_sub_f32 v142, v142, v18
    v_sub_f32 v143, v143, v18
    v_sub_f32 v144, v144, v18
    v_sub_f32 v145, v145, v18
    v_sub_f32 v146, v146, v18
    v_sub_f32 v147, v147, v18
    v_sub_f32 v148, v148, v18
    v_sub_f32 v149, v149, v18
    v_sub_f32 v150, v150, v18
    v_sub_f32 v151, v151, v18
    v_sub_f32 v152, v152, v18
    v_sub_f32 v153, v153, v18
    v_sub_f32 v154, v154, v18
    v_sub_f32 v155, v155, v18
    v_sub_f32 v156, v156, v18
    v_sub_f32 v157, v157, v18
    v_sub_f32 v158, v158, v18
    v_sub_f32 v159, v159, v18
    v_mov_b32 v65, v64
    v_mov_b32 v66, v64
    v_mov_b32 v67, v64
    v_mov_b32 v68, v64
    v_mov_b32 v69, v64
    v_mov_b32 v70, v64
    v_mov_b32 v71, v64
    v_mov_b32 v72, v64
    v_mov_b32 v73, v64
    v_mov_b32 v74, v64
    v_mov_b32 v75, v64
    v_mov_b32 v76, v64
    v_mov_b32 v77, v64
    v_mov_b32 v78, v64
    v_mov_b32 v79, v64
    v_mul_f32 v12, v12, v19
    v_accvgpr_read_b32 v24, a0
    v_accvgpr_read_b32 v25, a1
    v_accvgpr_read_b32 v26, a2
    v_accvgpr_read_b32 v27, a3
    v_accvgpr_read_b32 v28, a4
    v_accvgpr_read_b32 v29, a5
    v_accvgpr_read_b32 v30, a6
    v_accvgpr_read_b32 v31, a7
    v_mul_f32 v24, v24, v19
    v_mul_f32 v25, v25, v19
    v_mul_f32 v26, v26, v19
    v_mul_f32 v27, v27, v19
    v_mul_f32 v28, v28, v19
    v_mul_f32 v29, v29, v19
    v_mul_f32 v30, v30, v19
    v_mul_f32 v31, v31, v19
    v_accvgpr_write_b32 a0, v24
    v_accvgpr_write_b32 a1, v25
    v_accvgpr_write_b32 a2, v26
    v_accvgpr_write_b32 a3, v27
    v_accvgpr_write_b32 a4, v28
    v_accvgpr_write_b32 a5, v29
    v_accvgpr_write_b32 a6, v30
    v_accvgpr_write_b32 a7, v31
    v_accvgpr_read_b32 v24, a8
    v_accvgpr_read_b32 v25, a9
    v_accvgpr_read_b32 v26, a10
    v_accvgpr_read_b32 v27, a11
    v_accvgpr_read_b32 v28, a12
    v_accvgpr_read_b32 v29, a13
    v_accvgpr_read_b32 v30, a14
    v_accvgpr_read_b32 v31, a15
    v_mul_f32 v24, v24, v19
    v_mul_f32 v25, v25, v19
    v_mul_f32 v26, v26, v19
    v_mul_f32 v27, v27, v19
    v_mul_f32 v28, v28, v19
    v_mul_f32 v29, v29, v19
    v_mul_f32 v30, v30, v19
    v_mul_f32 v31, v31, v19
    v_accvgpr_write_b32 a8, v24
    v_accvgpr_write_b32 a9, v25
    v_accvgpr_write_b32 a10, v26
    v_accvgpr_write_b32 a11, v27
    v_accvgpr_write_b32 a12, v28
    v_accvgpr_write_b32 a13, v29
    v_accvgpr_write_b32 a14, v30
    v_accvgpr_write_b32 a15, v31
    v_accvgpr_read_b32 v24, a16
    v_accvgpr_read_b32 v25, a17
    v_accvgpr_read_b32 v26, a18
    v_accvgpr_read_b32 v27, a19
    v_accvgpr_read_b32 v28, a20
    v_accvgpr_read_b32 v29, a21
    v_accvgpr_read_b32 v30, a22
    v_accvgpr_read_b32 v31, a23
    v_mul_f32 v24, v24, v19
    v_mul_f32 v25, v25, v19
    v_mul_f32 v26, v26, v19
    v_mul_f32 v27, v27, v19
    v_mul_f32 v28, v28, v19
    v_mul_f32 v29, v29, v19
    v_mul_f32 v30, v30, v19
    v_mul_f32 v31, v31, v19
    v_accvgpr_write_b32 a16, v24
    v_accvgpr_write_b32 a17, v25
    v_accvgpr_write_b32 a18, v26
    v_accvgpr_write_b32 a19, v27
    v_accvgpr_write_b32 a20, v28
    v_accvgpr_write_b32 a21, v29
    v_accvgpr_write_b32 a22, v30
    v_accvgpr_write_b32 a23, v31
    v_accvgpr_read_b32 v24, a24
    v_accvgpr_read_b32 v25, a25
    v_accvgpr_read_b32 v26, a26
    v_accvgpr_read_b32 v27, a27
    v_accvgpr_read_b32 v28, a28
    v_accvgpr_read_b32 v29, a29
    v_accvgpr_read_b32 v30, a30
    v_accvgpr_read_b32 v31, a31
    v_mul_f32 v24, v24, v19
    v_mul_f32 v25, v25, v19
    v_mul_f32 v26, v26, v19
    v_mul_f32 v27, v27, v19
    v_mul_f32 v28, v28, v19
    v_mul_f32 v29, v29, v19
    v_mul_f32 v30, v30, v19
    v_mul_f32 v31, v31, v19
    v_accvgpr_write_b32 a24, v24
    v_accvgpr_write_b32 a25, v25
    v_accvgpr_write_b32 a26, v26
    v_accvgpr_write_b32 a27, v27
    v_accvgpr_write_b32 a28, v28
    v_accvgpr_write_b32 a29, v29
    v_accvgpr_write_b32 a30, v30
    v_accvgpr_write_b32 a31, v31
    v_accvgpr_read_b32 v24, a32
    v_accvgpr_read_b32 v25, a33
    v_accvgpr_read_b32 v26, a34
    v_accvgpr_read_b32 v27, a35
    v_accvgpr_read_b32 v28, a36
    v_accvgpr_read_b32 v29, a37
    v_accvgpr_read_b32 v30, a38
    v_accvgpr_read_b32 v31, a39
    v_mul_f32 v24, v24, v19
    v_mul_f32 v25, v25, v19
    v_mul_f32 v26, v26, v19
    v_mul_f32 v27, v27, v19
    v_mul_f32 v28, v28, v19
    v_mul_f32 v29, v29, v19
    v_mul_f32 v30, v30, v19
    v_mul_f32 v31, v31, v19
    v_accvgpr_write_b32 a32, v24
    v_accvgpr_write_b32 a33, v25
    v_accvgpr_write_b32 a34, v26
    v_accvgpr_write_b32 a35, v27
    v_accvgpr_write_b32 a36, v28
    v_accvgpr_write_b32 a37, v29
    v_accvgpr_write_b32 a38, v30
    v_accvgpr_write_b32 a39, v31
    v_accvgpr_read_b32 v24, a40
    v_accvgpr_read_b32 v25, a41
    v_accvgpr_read_b32 v26, a42
    v_accvgpr_read_b32 v27, a43
    v_accvgpr_read_b32 v28, a44
    v_accvgpr_read_b32 v29, a45
    v_accvgpr_read_b32 v30, a46
    v_accvgpr_read_b32 v31, a47
    v_mul_f32 v24, v24, v19
    v_mul_f32 v25, v25, v19
    v_mul_f32 v26, v26, v19
    v_mul_f32 v27, v27, v19
    v_mul_f32 v28, v28, v19
    v_mul_f32 v29, v29, v19
    v_mul_f32 v30, v30, v19
    v_mul_f32 v31, v31, v19
    v_accvgpr_write_b32 a40, v24
    v_accvgpr_write_b32 a41, v25
    v_accvgpr_write_b32 a42, v26
    v_accvgpr_write_b32 a43, v27
    v_accvgpr_write_b32 a44, v28
    v_accvgpr_write_b32 a45, v29
    v_accvgpr_write_b32 a46, v30
    v_accvgpr_write_b32 a47, v31
    v_accvgpr_read_b32 v24, a48
    v_accvgpr_read_b32 v25, a49
    v_accvgpr_read_b32 v26, a50
    v_accvgpr_read_b32 v27, a51
    v_accvgpr_read_b32 v28, a52
    v_accvgpr_read_b32 v29, a53
    v_accvgpr_read_b32 v30, a54
    v_accvgpr_read_b32 v31, a55
    v_mul_f32 v24, v24, v19
    v_mul_f32 v25, v25, v19
    v_mul_f32 v26, v26, v19
    v_mul_f32 v27, v27, v19
    v_mul_f32 v28, v28, v19
    v_mul_f32 v29, v29, v19
    v_mul_f32 v30, v30, v19
    v_mul_f32 v31, v31, v19
    v_accvgpr_write_b32 a48, v24
    v_accvgpr_write_b32 a49, v25
    v_accvgpr_write_b32 a50, v26
    v_accvgpr_write_b32 a51, v27
    v_accvgpr_write_b32 a52, v28
    v_accvgpr_write_b32 a53, v29
    v_accvgpr_write_b32 a54, v30
    v_accvgpr_write_b32 a55, v31
    v_accvgpr_read_b32 v24, a56
    v_accvgpr_read_b32 v25, a57
    v_accvgpr_read_b32 v26, a58
    v_accvgpr_read_b32 v27, a59
    v_accvgpr_read_b32 v28, a60
    v_accvgpr_read_b32 v29, a61
    v_accvgpr_read_b32 v30, a62
    v_accvgpr_read_b32 v31, a63
    v_mul_f32 v24, v24, v19
    v_mul_f32 v25, v25, v19
    v_mul_f32 v26, v26, v19
    v_mul_f32 v27, v27, v19
    v_mul_f32 v28, v28, v19
    v_mul_f32 v29, v29, v19
    v_mul_f32 v30, v30, v19
    v_mul_f32 v31, v31, v19
    v_accvgpr_write_b32 a56, v24
    v_accvgpr_write_b32 a57, v25
    v_accvgpr_write_b32 a58, v26
    v_accvgpr_write_b32 a59, v27
    v_accvgpr_write_b32 a60, v28
    v_accvgpr_write_b32 a61, v29
    v_accvgpr_write_b32 a62, v30
    v_accvgpr_write_b32 a63, v31
    v_exp_f32 v24, v128
    v_exp_f32 v25, v129
    v_exp_f32 v26, v130
    v_cvt_pk_bf16_f32 v96, v24, v25
    v_exp_f32 v27, v131
    v_exp_f32 v28, v132
    v_add_f32 v17, v25, v27
    v_exp_f32 v29, v133
    v_cvt_pk_bf16_f32 v97, v26, v27
    v_add_f32 v16, v24, v26
    v_exp_f32 v30, v134
    v_add_f32 v17, v17, v29
    v_exp_f32 v31, v135
    v_cvt_pk_bf16_f32 v98, v28, v29
    v_add_f32 v16, v16, v28
    v_exp_f32 v24, v136
    v_add_f32 v17, v17, v31
    v_exp_f32 v25, v137
    v_cvt_pk_bf16_f32 v99, v30, v31
    v_add_f32 v16, v16, v30
    v_exp_f32 v26, v138
    v_add_f32 v17, v17, v25
    v_exp_f32 v27, v139
    v_cvt_pk_bf16_f32 v100, v24, v25
    v_add_f32 v16, v16, v24
    v_exp_f32 v28, v140
    v_add_f32 v17, v17, v27
    v_exp_f32 v29, v141
    v_cvt_pk_bf16_f32 v101, v26, v27
    v_add_f32 v16, v16, v26
    v_exp_f32 v30, v142
    v_add_f32 v17, v17, v29
    v_exp_f32 v31, v143
    v_cvt_pk_bf16_f32 v102, v28, v29
    v_add_f32 v16, v16, v28
    v_exp_f32 v24, v144
    v_add_f32 v17, v17, v31
    v_exp_f32 v25, v145
    v_cvt_pk_bf16_f32 v103, v30, v31
    v_add_f32 v16, v16, v30
    v_exp_f32 v26, v146
    v_add_f32 v17, v17, v25
    v_exp_f32 v27, v147
    v_cvt_pk_bf16_f32 v104, v24, v25
    v_add_f32 v16, v16, v24
    v_exp_f32 v28, v148
    v_add_f32 v17, v17, v27
    v_exp_f32 v29, v149
    v_cvt_pk_bf16_f32 v105, v26, v27
    v_add_f32 v16, v16, v26
    v_exp_f32 v30, v150
    v_add_f32 v17, v17, v29
    v_exp_f32 v31, v151
    v_cvt_pk_bf16_f32 v106, v28, v29
    v_add_f32 v16, v16, v28
    v_exp_f32 v24, v152
    v_add_f32 v17, v17, v31
    v_exp_f32 v25, v153
    v_cvt_pk_bf16_f32 v107, v30, v31
    v_add_f32 v16, v16, v30
    v_exp_f32 v26, v154
    v_add_f32 v17, v17, v25
    v_exp_f32 v27, v155
    v_cvt_pk_bf16_f32 v108, v24, v25
    v_add_f32 v16, v16, v24
    v_exp_f32 v28, v156
    v_add_f32 v17, v17, v27
    v_exp_f32 v29, v157
    v_cvt_pk_bf16_f32 v109, v26, v27
    v_add_f32 v16, v16, v26
    v_exp_f32 v30, v158
    v_add_f32 v17, v17, v29
    v_exp_f32 v31, v159
    v_cvt_pk_bf16_f32 v110, v28, v29
    v_add_f32 v16, v16, v28
    v_cvt_pk_bf16_f32 v111, v30, v31
    v_add_f32 v16, v16, v30
    v_add_f32 v17, v17, v31
    v_add_f32 v16, v16, v17
    s_nop 1
    s_branch main_kernel_rdXar
main_kernel_rdYb:
    v_max3_f32 v18, v160, v161, v162
    v_max3_f32 v19, v163, v164, v165
    v_max3_f32 v18, v18, v166, v167
    v_max3_f32 v19, v19, v168, v169
    v_max3_f32 v18, v18, v170, v171
    v_max3_f32 v19, v19, v172, v173
    v_max3_f32 v18, v18, v174, v175
    v_max3_f32 v19, v19, v176, v177
    v_max3_f32 v18, v18, v178, v179
    v_max3_f32 v19, v19, v180, v181
    v_max3_f32 v18, v18, v182, v183
    v_max3_f32 v19, v19, v184, v185
    v_max3_f32 v18, v18, v186, v187
    v_max3_f32 v19, v19, v188, v189
    v_max3_f32 v18, v18, v190, v191
    v_max_f32 v18, v18, v19
    v_mov_b32 v19, v18
    s_nop 1
    v_permlane32_swap_b32 v19, v18
    s_nop 1
    v_max_f32 v18, v18, v19
    v_max_f32 v18, 0, v18
    v_sub_f32 v80, v80, v18
    v_sub_f32 v19, 0, v18
    v_exp_f32 v19, v19
    v_sub_f32 v160, v160, v18
    v_sub_f32 v161, v161, v18
    v_sub_f32 v162, v162, v18
    v_sub_f32 v163, v163, v18
    v_sub_f32 v164, v164, v18
    v_sub_f32 v165, v165, v18
    v_sub_f32 v166, v166, v18
    v_sub_f32 v167, v167, v18
    v_sub_f32 v168, v168, v18
    v_sub_f32 v169, v169, v18
    v_sub_f32 v170, v170, v18
    v_sub_f32 v171, v171, v18
    v_sub_f32 v172, v172, v18
    v_sub_f32 v173, v173, v18
    v_sub_f32 v174, v174, v18
    v_sub_f32 v175, v175, v18
    v_sub_f32 v176, v176, v18
    v_sub_f32 v177, v177, v18
    v_sub_f32 v178, v178, v18
    v_sub_f32 v179, v179, v18
    v_sub_f32 v180, v180, v18
    v_sub_f32 v181, v181, v18
    v_sub_f32 v182, v182, v18
    v_sub_f32 v183, v183, v18
    v_sub_f32 v184, v184, v18
    v_sub_f32 v185, v185, v18
    v_sub_f32 v186, v186, v18
    v_sub_f32 v187, v187, v18
    v_sub_f32 v188, v188, v18
    v_sub_f32 v189, v189, v18
    v_sub_f32 v190, v190, v18
    v_sub_f32 v191, v191, v18
    v_mov_b32 v81, v80
    v_mov_b32 v82, v80
    v_mov_b32 v83, v80
    v_mov_b32 v84, v80
    v_mov_b32 v85, v80
    v_mov_b32 v86, v80
    v_mov_b32 v87, v80
    v_mov_b32 v88, v80
    v_mov_b32 v89, v80
    v_mov_b32 v90, v80
    v_mov_b32 v91, v80
    v_mov_b32 v92, v80
    v_mov_b32 v93, v80
    v_mov_b32 v94, v80
    v_mov_b32 v95, v80
    v_mul_f32 v13, v13, v19
    v_accvgpr_read_b32 v24, a64
    v_accvgpr_read_b32 v25, a65
    v_accvgpr_read_b32 v26, a66
    v_accvgpr_read_b32 v27, a67
    v_accvgpr_read_b32 v28, a68
    v_accvgpr_read_b32 v29, a69
    v_accvgpr_read_b32 v30, a70
    v_accvgpr_read_b32 v31, a71
    v_mul_f32 v24, v24, v19
    v_mul_f32 v25, v25, v19
    v_mul_f32 v26, v26, v19
    v_mul_f32 v27, v27, v19
    v_mul_f32 v28, v28, v19
    v_mul_f32 v29, v29, v19
    v_mul_f32 v30, v30, v19
    v_mul_f32 v31, v31, v19
    v_accvgpr_write_b32 a64, v24
    v_accvgpr_write_b32 a65, v25
    v_accvgpr_write_b32 a66, v26
    v_accvgpr_write_b32 a67, v27
    v_accvgpr_write_b32 a68, v28
    v_accvgpr_write_b32 a69, v29
    v_accvgpr_write_b32 a70, v30
    v_accvgpr_write_b32 a71, v31
    v_accvgpr_read_b32 v24, a72
    v_accvgpr_read_b32 v25, a73
    v_accvgpr_read_b32 v26, a74
    v_accvgpr_read_b32 v27, a75
    v_accvgpr_read_b32 v28, a76
    v_accvgpr_read_b32 v29, a77
    v_accvgpr_read_b32 v30, a78
    v_accvgpr_read_b32 v31, a79
    v_mul_f32 v24, v24, v19
    v_mul_f32 v25, v25, v19
    v_mul_f32 v26, v26, v19
    v_mul_f32 v27, v27, v19
    v_mul_f32 v28, v28, v19
    v_mul_f32 v29, v29, v19
    v_mul_f32 v30, v30, v19
    v_mul_f32 v31, v31, v19
    v_accvgpr_write_b32 a72, v24
    v_accvgpr_write_b32 a73, v25
    v_accvgpr_write_b32 a74, v26
    v_accvgpr_write_b32 a75, v27
    v_accvgpr_write_b32 a76, v28
    v_accvgpr_write_b32 a77, v29
    v_accvgpr_write_b32 a78, v30
    v_accvgpr_write_b32 a79, v31
    v_accvgpr_read_b32 v24, a80
    v_accvgpr_read_b32 v25, a81
    v_accvgpr_read_b32 v26, a82
    v_accvgpr_read_b32 v27, a83
    v_accvgpr_read_b32 v28, a84
    v_accvgpr_read_b32 v29, a85
    v_accvgpr_read_b32 v30, a86
    v_accvgpr_read_b32 v31, a87
    v_mul_f32 v24, v24, v19
    v_mul_f32 v25, v25, v19
    v_mul_f32 v26, v26, v19
    v_mul_f32 v27, v27, v19
    v_mul_f32 v28, v28, v19
    v_mul_f32 v29, v29, v19
    v_mul_f32 v30, v30, v19
    v_mul_f32 v31, v31, v19
    v_accvgpr_write_b32 a80, v24
    v_accvgpr_write_b32 a81, v25
    v_accvgpr_write_b32 a82, v26
    v_accvgpr_write_b32 a83, v27
    v_accvgpr_write_b32 a84, v28
    v_accvgpr_write_b32 a85, v29
    v_accvgpr_write_b32 a86, v30
    v_accvgpr_write_b32 a87, v31
    v_accvgpr_read_b32 v24, a88
    v_accvgpr_read_b32 v25, a89
    v_accvgpr_read_b32 v26, a90
    v_accvgpr_read_b32 v27, a91
    v_accvgpr_read_b32 v28, a92
    v_accvgpr_read_b32 v29, a93
    v_accvgpr_read_b32 v30, a94
    v_accvgpr_read_b32 v31, a95
    v_mul_f32 v24, v24, v19
    v_mul_f32 v25, v25, v19
    v_mul_f32 v26, v26, v19
    v_mul_f32 v27, v27, v19
    v_mul_f32 v28, v28, v19
    v_mul_f32 v29, v29, v19
    v_mul_f32 v30, v30, v19
    v_mul_f32 v31, v31, v19
    v_accvgpr_write_b32 a88, v24
    v_accvgpr_write_b32 a89, v25
    v_accvgpr_write_b32 a90, v26
    v_accvgpr_write_b32 a91, v27
    v_accvgpr_write_b32 a92, v28
    v_accvgpr_write_b32 a93, v29
    v_accvgpr_write_b32 a94, v30
    v_accvgpr_write_b32 a95, v31
    v_accvgpr_read_b32 v24, a96
    v_accvgpr_read_b32 v25, a97
    v_accvgpr_read_b32 v26, a98
    v_accvgpr_read_b32 v27, a99
    v_accvgpr_read_b32 v28, a100
    v_accvgpr_read_b32 v29, a101
    v_accvgpr_read_b32 v30, a102
    v_accvgpr_read_b32 v31, a103
    v_mul_f32 v24, v24, v19
    v_mul_f32 v25, v25, v19
    v_mul_f32 v26, v26, v19
    v_mul_f32 v27, v27, v19
    v_mul_f32 v28, v28, v19
    v_mul_f32 v29, v29, v19
    v_mul_f32 v30, v30, v19
    v_mul_f32 v31, v31, v19
    v_accvgpr_write_b32 a96, v24
    v_accvgpr_write_b32 a97, v25
    v_accvgpr_write_b32 a98, v26
    v_accvgpr_write_b32 a99, v27
    v_accvgpr_write_b32 a100, v28
    v_accvgpr_write_b32 a101, v29
    v_accvgpr_write_b32 a102, v30
    v_accvgpr_write_b32 a103, v31
    v_accvgpr_read_b32 v24, a104
    v_accvgpr_read_b32 v25, a105
    v_accvgpr_read_b32 v26, a106
    v_accvgpr_read_b32 v27, a107
    v_accvgpr_read_b32 v28, a108
    v_accvgpr_read_b32 v29, a109
    v_accvgpr_read_b32 v30, a110
    v_accvgpr_read_b32 v31, a111
    v_mul_f32 v24, v24, v19
    v_mul_f32 v25, v25, v19
    v_mul_f32 v26, v26, v19
    v_mul_f32 v27, v27, v19
    v_mul_f32 v28, v28, v19
    v_mul_f32 v29, v29, v19
    v_mul_f32 v30, v30, v19
    v_mul_f32 v31, v31, v19
    v_accvgpr_write_b32 a104, v24
    v_accvgpr_write_b32 a105, v25
    v_accvgpr_write_b32 a106, v26
    v_accvgpr_write_b32 a107, v27
    v_accvgpr_write_b32 a108, v28
    v_accvgpr_write_b32 a109, v29
    v_accvgpr_write_b32 a110, v30
    v_accvgpr_write_b32 a111, v31
    v_accvgpr_read_b32 v24, a112
    v_accvgpr_read_b32 v25, a113
    v_accvgpr_read_b32 v26, a114
    v_accvgpr_read_b32 v27, a115
    v_accvgpr_read_b32 v28, a116
    v_accvgpr_read_b32 v29, a117
    v_accvgpr_read_b32 v30, a118
    v_accvgpr_read_b32 v31, a119
    v_mul_f32 v24, v24, v19
    v_mul_f32 v25, v25, v19
    v_mul_f32 v26, v26, v19
    v_mul_f32 v27, v27, v19
    v_mul_f32 v28, v28, v19
    v_mul_f32 v29, v29, v19
    v_mul_f32 v30, v30, v19
    v_mul_f32 v31, v31, v19
    v_accvgpr_write_b32 a112, v24
    v_accvgpr_write_b32 a113, v25
    v_accvgpr_write_b32 a114, v26
    v_accvgpr_write_b32 a115, v27
    v_accvgpr_write_b32 a116, v28
    v_accvgpr_write_b32 a117, v29
    v_accvgpr_write_b32 a118, v30
    v_accvgpr_write_b32 a119, v31
    v_accvgpr_read_b32 v24, a120
    v_accvgpr_read_b32 v25, a121
    v_accvgpr_read_b32 v26, a122
    v_accvgpr_read_b32 v27, a123
    v_accvgpr_read_b32 v28, a124
    v_accvgpr_read_b32 v29, a125
    v_accvgpr_read_b32 v30, a126
    v_accvgpr_read_b32 v31, a127
    v_mul_f32 v24, v24, v19
    v_mul_f32 v25, v25, v19
    v_mul_f32 v26, v26, v19
    v_mul_f32 v27, v27, v19
    v_mul_f32 v28, v28, v19
    v_mul_f32 v29, v29, v19
    v_mul_f32 v30, v30, v19
    v_mul_f32 v31, v31, v19
    v_accvgpr_write_b32 a120, v24
    v_accvgpr_write_b32 a121, v25
    v_accvgpr_write_b32 a122, v26
    v_accvgpr_write_b32 a123, v27
    v_accvgpr_write_b32 a124, v28
    v_accvgpr_write_b32 a125, v29
    v_accvgpr_write_b32 a126, v30
    v_accvgpr_write_b32 a127, v31
    v_exp_f32 v24, v160
    v_exp_f32 v25, v161
    v_exp_f32 v26, v162
    v_cvt_pk_bf16_f32 v112, v24, v25
    v_exp_f32 v27, v163
    v_exp_f32 v28, v164
    v_add_f32 v17, v25, v27
    v_exp_f32 v29, v165
    v_cvt_pk_bf16_f32 v113, v26, v27
    v_add_f32 v16, v24, v26
    v_exp_f32 v30, v166
    v_add_f32 v17, v17, v29
    v_exp_f32 v31, v167
    v_cvt_pk_bf16_f32 v114, v28, v29
    v_add_f32 v16, v16, v28
    v_exp_f32 v24, v168
    v_add_f32 v17, v17, v31
    v_exp_f32 v25, v169
    v_cvt_pk_bf16_f32 v115, v30, v31
    v_add_f32 v16, v16, v30
    v_exp_f32 v26, v170
    v_add_f32 v17, v17, v25
    v_exp_f32 v27, v171
    v_cvt_pk_bf16_f32 v116, v24, v25
    v_add_f32 v16, v16, v24
    v_exp_f32 v28, v172
    v_add_f32 v17, v17, v27
    v_exp_f32 v29, v173
    v_cvt_pk_bf16_f32 v117, v26, v27
    v_add_f32 v16, v16, v26
    v_exp_f32 v30, v174
    v_add_f32 v17, v17, v29
    v_exp_f32 v31, v175
    v_cvt_pk_bf16_f32 v118, v28, v29
    v_add_f32 v16, v16, v28
    v_exp_f32 v24, v176
    v_add_f32 v17, v17, v31
    v_exp_f32 v25, v177
    v_cvt_pk_bf16_f32 v119, v30, v31
    v_add_f32 v16, v16, v30
    v_exp_f32 v26, v178
    v_add_f32 v17, v17, v25
    v_exp_f32 v27, v179
    v_cvt_pk_bf16_f32 v120, v24, v25
    v_add_f32 v16, v16, v24
    v_exp_f32 v28, v180
    v_add_f32 v17, v17, v27
    v_exp_f32 v29, v181
    v_cvt_pk_bf16_f32 v121, v26, v27
    v_add_f32 v16, v16, v26
    v_exp_f32 v30, v182
    v_add_f32 v17, v17, v29
    v_exp_f32 v31, v183
    v_cvt_pk_bf16_f32 v122, v28, v29
    v_add_f32 v16, v16, v28
    v_exp_f32 v24, v184
    v_add_f32 v17, v17, v31
    v_exp_f32 v25, v185
    v_cvt_pk_bf16_f32 v123, v30, v31
    v_add_f32 v16, v16, v30
    v_exp_f32 v26, v186
    v_add_f32 v17, v17, v25
    v_exp_f32 v27, v187
    v_cvt_pk_bf16_f32 v124, v24, v25
    v_add_f32 v16, v16, v24
    v_exp_f32 v28, v188
    v_add_f32 v17, v17, v27
    v_exp_f32 v29, v189
    v_cvt_pk_bf16_f32 v125, v26, v27
    v_add_f32 v16, v16, v26
    v_exp_f32 v30, v190
    v_add_f32 v17, v17, v29
    v_exp_f32 v31, v191
    v_cvt_pk_bf16_f32 v126, v28, v29
    v_add_f32 v16, v16, v28
    v_cvt_pk_bf16_f32 v127, v30, v31
    v_add_f32 v16, v16, v30
    v_add_f32 v17, v17, v31
    v_add_f32 v16, v16, v17
    s_nop 1
    s_branch main_kernel_rdYbr
main_kernel_rdXb:
    v_max3_f32 v18, v128, v129, v130
    v_max3_f32 v19, v131, v132, v133
    v_max3_f32 v18, v18, v134, v135
    v_max3_f32 v19, v19, v136, v137
    v_max3_f32 v18, v18, v138, v139
    v_max3_f32 v19, v19, v140, v141
    v_max3_f32 v18, v18, v142, v143
    v_max3_f32 v19, v19, v144, v145
    v_max3_f32 v18, v18, v146, v147
    v_max3_f32 v19, v19, v148, v149
    v_max3_f32 v18, v18, v150, v151
    v_max3_f32 v19, v19, v152, v153
    v_max3_f32 v18, v18, v154, v155
    v_max3_f32 v19, v19, v156, v157
    v_max3_f32 v18, v18, v158, v159
    v_max_f32 v18, v18, v19
    v_mov_b32 v19, v18
    s_nop 1
    v_permlane32_swap_b32 v19, v18
    s_nop 1
    v_max_f32 v18, v18, v19
    v_max_f32 v18, 0, v18
    v_sub_f32 v64, v64, v18
    v_sub_f32 v19, 0, v18
    v_exp_f32 v19, v19
    v_sub_f32 v128, v128, v18
    v_sub_f32 v129, v129, v18
    v_sub_f32 v130, v130, v18
    v_sub_f32 v131, v131, v18
    v_sub_f32 v132, v132, v18
    v_sub_f32 v133, v133, v18
    v_sub_f32 v134, v134, v18
    v_sub_f32 v135, v135, v18
    v_sub_f32 v136, v136, v18
    v_sub_f32 v137, v137, v18
    v_sub_f32 v138, v138, v18
    v_sub_f32 v139, v139, v18
    v_sub_f32 v140, v140, v18
    v_sub_f32 v141, v141, v18
    v_sub_f32 v142, v142, v18
    v_sub_f32 v143, v143, v18
    v_sub_f32 v144, v144, v18
    v_sub_f32 v145, v145, v18
    v_sub_f32 v146, v146, v18
    v_sub_f32 v147, v147, v18
    v_sub_f32 v148, v148, v18
    v_sub_f32 v149, v149, v18
    v_sub_f32 v150, v150, v18
    v_sub_f32 v151, v151, v18
    v_sub_f32 v152, v152, v18
    v_sub_f32 v153, v153, v18
    v_sub_f32 v154, v154, v18
    v_sub_f32 v155, v155, v18
    v_sub_f32 v156, v156, v18
    v_sub_f32 v157, v157, v18
    v_sub_f32 v158, v158, v18
    v_sub_f32 v159, v159, v18
    v_mov_b32 v65, v64
    v_mov_b32 v66, v64
    v_mov_b32 v67, v64
    v_mov_b32 v68, v64
    v_mov_b32 v69, v64
    v_mov_b32 v70, v64
    v_mov_b32 v71, v64
    v_mov_b32 v72, v64
    v_mov_b32 v73, v64
    v_mov_b32 v74, v64
    v_mov_b32 v75, v64
    v_mov_b32 v76, v64
    v_mov_b32 v77, v64
    v_mov_b32 v78, v64
    v_mov_b32 v79, v64
    v_mul_f32 v12, v12, v19
    v_accvgpr_read_b32 v24, a0
    v_accvgpr_read_b32 v25, a1
    v_accvgpr_read_b32 v26, a2
    v_accvgpr_read_b32 v27, a3
    v_accvgpr_read_b32 v28, a4
    v_accvgpr_read_b32 v29, a5
    v_accvgpr_read_b32 v30, a6
    v_accvgpr_read_b32 v31, a7
    v_mul_f32 v24, v24, v19
    v_mul_f32 v25, v25, v19
    v_mul_f32 v26, v26, v19
    v_mul_f32 v27, v27, v19
    v_mul_f32 v28, v28, v19
    v_mul_f32 v29, v29, v19
    v_mul_f32 v30, v30, v19
    v_mul_f32 v31, v31, v19
    v_accvgpr_write_b32 a0, v24
    v_accvgpr_write_b32 a1, v25
    v_accvgpr_write_b32 a2, v26
    v_accvgpr_write_b32 a3, v27
    v_accvgpr_write_b32 a4, v28
    v_accvgpr_write_b32 a5, v29
    v_accvgpr_write_b32 a6, v30
    v_accvgpr_write_b32 a7, v31
    v_accvgpr_read_b32 v24, a8
    v_accvgpr_read_b32 v25, a9
    v_accvgpr_read_b32 v26, a10
    v_accvgpr_read_b32 v27, a11
    v_accvgpr_read_b32 v28, a12
    v_accvgpr_read_b32 v29, a13
    v_accvgpr_read_b32 v30, a14
    v_accvgpr_read_b32 v31, a15
    v_mul_f32 v24, v24, v19
    v_mul_f32 v25, v25, v19
    v_mul_f32 v26, v26, v19
    v_mul_f32 v27, v27, v19
    v_mul_f32 v28, v28, v19
    v_mul_f32 v29, v29, v19
    v_mul_f32 v30, v30, v19
    v_mul_f32 v31, v31, v19
    v_accvgpr_write_b32 a8, v24
    v_accvgpr_write_b32 a9, v25
    v_accvgpr_write_b32 a10, v26
    v_accvgpr_write_b32 a11, v27
    v_accvgpr_write_b32 a12, v28
    v_accvgpr_write_b32 a13, v29
    v_accvgpr_write_b32 a14, v30
    v_accvgpr_write_b32 a15, v31
    v_accvgpr_read_b32 v24, a16
    v_accvgpr_read_b32 v25, a17
    v_accvgpr_read_b32 v26, a18
    v_accvgpr_read_b32 v27, a19
    v_accvgpr_read_b32 v28, a20
    v_accvgpr_read_b32 v29, a21
    v_accvgpr_read_b32 v30, a22
    v_accvgpr_read_b32 v31, a23
    v_mul_f32 v24, v24, v19
    v_mul_f32 v25, v25, v19
    v_mul_f32 v26, v26, v19
    v_mul_f32 v27, v27, v19
    v_mul_f32 v28, v28, v19
    v_mul_f32 v29, v29, v19
    v_mul_f32 v30, v30, v19
    v_mul_f32 v31, v31, v19
    v_accvgpr_write_b32 a16, v24
    v_accvgpr_write_b32 a17, v25
    v_accvgpr_write_b32 a18, v26
    v_accvgpr_write_b32 a19, v27
    v_accvgpr_write_b32 a20, v28
    v_accvgpr_write_b32 a21, v29
    v_accvgpr_write_b32 a22, v30
    v_accvgpr_write_b32 a23, v31
    v_accvgpr_read_b32 v24, a24
    v_accvgpr_read_b32 v25, a25
    v_accvgpr_read_b32 v26, a26
    v_accvgpr_read_b32 v27, a27
    v_accvgpr_read_b32 v28, a28
    v_accvgpr_read_b32 v29, a29
    v_accvgpr_read_b32 v30, a30
    v_accvgpr_read_b32 v31, a31
    v_mul_f32 v24, v24, v19
    v_mul_f32 v25, v25, v19
    v_mul_f32 v26, v26, v19
    v_mul_f32 v27, v27, v19
    v_mul_f32 v28, v28, v19
    v_mul_f32 v29, v29, v19
    v_mul_f32 v30, v30, v19
    v_mul_f32 v31, v31, v19
    v_accvgpr_write_b32 a24, v24
    v_accvgpr_write_b32 a25, v25
    v_accvgpr_write_b32 a26, v26
    v_accvgpr_write_b32 a27, v27
    v_accvgpr_write_b32 a28, v28
    v_accvgpr_write_b32 a29, v29
    v_accvgpr_write_b32 a30, v30
    v_accvgpr_write_b32 a31, v31
    v_accvgpr_read_b32 v24, a32
    v_accvgpr_read_b32 v25, a33
    v_accvgpr_read_b32 v26, a34
    v_accvgpr_read_b32 v27, a35
    v_accvgpr_read_b32 v28, a36
    v_accvgpr_read_b32 v29, a37
    v_accvgpr_read_b32 v30, a38
    v_accvgpr_read_b32 v31, a39
    v_mul_f32 v24, v24, v19
    v_mul_f32 v25, v25, v19
    v_mul_f32 v26, v26, v19
    v_mul_f32 v27, v27, v19
    v_mul_f32 v28, v28, v19
    v_mul_f32 v29, v29, v19
    v_mul_f32 v30, v30, v19
    v_mul_f32 v31, v31, v19
    v_accvgpr_write_b32 a32, v24
    v_accvgpr_write_b32 a33, v25
    v_accvgpr_write_b32 a34, v26
    v_accvgpr_write_b32 a35, v27
    v_accvgpr_write_b32 a36, v28
    v_accvgpr_write_b32 a37, v29
    v_accvgpr_write_b32 a38, v30
    v_accvgpr_write_b32 a39, v31
    v_accvgpr_read_b32 v24, a40
    v_accvgpr_read_b32 v25, a41
    v_accvgpr_read_b32 v26, a42
    v_accvgpr_read_b32 v27, a43
    v_accvgpr_read_b32 v28, a44
    v_accvgpr_read_b32 v29, a45
    v_accvgpr_read_b32 v30, a46
    v_accvgpr_read_b32 v31, a47
    v_mul_f32 v24, v24, v19
    v_mul_f32 v25, v25, v19
    v_mul_f32 v26, v26, v19
    v_mul_f32 v27, v27, v19
    v_mul_f32 v28, v28, v19
    v_mul_f32 v29, v29, v19
    v_mul_f32 v30, v30, v19
    v_mul_f32 v31, v31, v19
    v_accvgpr_write_b32 a40, v24
    v_accvgpr_write_b32 a41, v25
    v_accvgpr_write_b32 a42, v26
    v_accvgpr_write_b32 a43, v27
    v_accvgpr_write_b32 a44, v28
    v_accvgpr_write_b32 a45, v29
    v_accvgpr_write_b32 a46, v30
    v_accvgpr_write_b32 a47, v31
    v_accvgpr_read_b32 v24, a48
    v_accvgpr_read_b32 v25, a49
    v_accvgpr_read_b32 v26, a50
    v_accvgpr_read_b32 v27, a51
    v_accvgpr_read_b32 v28, a52
    v_accvgpr_read_b32 v29, a53
    v_accvgpr_read_b32 v30, a54
    v_accvgpr_read_b32 v31, a55
    v_mul_f32 v24, v24, v19
    v_mul_f32 v25, v25, v19
    v_mul_f32 v26, v26, v19
    v_mul_f32 v27, v27, v19
    v_mul_f32 v28, v28, v19
    v_mul_f32 v29, v29, v19
    v_mul_f32 v30, v30, v19
    v_mul_f32 v31, v31, v19
    v_accvgpr_write_b32 a48, v24
    v_accvgpr_write_b32 a49, v25
    v_accvgpr_write_b32 a50, v26
    v_accvgpr_write_b32 a51, v27
    v_accvgpr_write_b32 a52, v28
    v_accvgpr_write_b32 a53, v29
    v_accvgpr_write_b32 a54, v30
    v_accvgpr_write_b32 a55, v31
    v_accvgpr_read_b32 v24, a56
    v_accvgpr_read_b32 v25, a57
    v_accvgpr_read_b32 v26, a58
    v_accvgpr_read_b32 v27, a59
    v_accvgpr_read_b32 v28, a60
    v_accvgpr_read_b32 v29, a61
    v_accvgpr_read_b32 v30, a62
    v_accvgpr_read_b32 v31, a63
    v_mul_f32 v24, v24, v19
    v_mul_f32 v25, v25, v19
    v_mul_f32 v26, v26, v19
    v_mul_f32 v27, v27, v19
    v_mul_f32 v28, v28, v19
    v_mul_f32 v29, v29, v19
    v_mul_f32 v30, v30, v19
    v_mul_f32 v31, v31, v19
    v_accvgpr_write_b32 a56, v24
    v_accvgpr_write_b32 a57, v25
    v_accvgpr_write_b32 a58, v26
    v_accvgpr_write_b32 a59, v27
    v_accvgpr_write_b32 a60, v28
    v_accvgpr_write_b32 a61, v29
    v_accvgpr_write_b32 a62, v30
    v_accvgpr_write_b32 a63, v31
    v_exp_f32 v24, v128
    v_exp_f32 v25, v129
    v_exp_f32 v26, v130
    v_cvt_pk_bf16_f32 v96, v24, v25
    v_exp_f32 v27, v131
    v_exp_f32 v28, v132
    v_add_f32 v17, v25, v27
    v_exp_f32 v29, v133
    v_cvt_pk_bf16_f32 v97, v26, v27
    v_add_f32 v16, v24, v26
    v_exp_f32 v30, v134
    v_add_f32 v17, v17, v29
    v_exp_f32 v31, v135
    v_cvt_pk_bf16_f32 v98, v28, v29
    v_add_f32 v16, v16, v28
    v_exp_f32 v24, v136
    v_add_f32 v17, v17, v31
    v_exp_f32 v25, v137
    v_cvt_pk_bf16_f32 v99, v30, v31
    v_add_f32 v16, v16, v30
    v_exp_f32 v26, v138
    v_add_f32 v17, v17, v25
    v_exp_f32 v27, v139
    v_cvt_pk_bf16_f32 v100, v24, v25
    v_add_f32 v16, v16, v24
    v_exp_f32 v28, v140
    v_add_f32 v17, v17, v27
    v_exp_f32 v29, v141
    v_cvt_pk_bf16_f32 v101, v26, v27
    v_add_f32 v16, v16, v26
    v_exp_f32 v30, v142
    v_add_f32 v17, v17, v29
    v_exp_f32 v31, v143
    v_cvt_pk_bf16_f32 v102, v28, v29
    v_add_f32 v16, v16, v28
    v_exp_f32 v24, v144
    v_add_f32 v17, v17, v31
    v_exp_f32 v25, v145
    v_cvt_pk_bf16_f32 v103, v30, v31
    v_add_f32 v16, v16, v30
    v_exp_f32 v26, v146
    v_add_f32 v17, v17, v25
    v_exp_f32 v27, v147
    v_cvt_pk_bf16_f32 v104, v24, v25
    v_add_f32 v16, v16, v24
    v_exp_f32 v28, v148
    v_add_f32 v17, v17, v27
    v_exp_f32 v29, v149
    v_cvt_pk_bf16_f32 v105, v26, v27
    v_add_f32 v16, v16, v26
    v_exp_f32 v30, v150
    v_add_f32 v17, v17, v29
    v_exp_f32 v31, v151
    v_cvt_pk_bf16_f32 v106, v28, v29
    v_add_f32 v16, v16, v28
    v_exp_f32 v24, v152
    v_add_f32 v17, v17, v31
    v_exp_f32 v25, v153
    v_cvt_pk_bf16_f32 v107, v30, v31
    v_add_f32 v16, v16, v30
    v_exp_f32 v26, v154
    v_add_f32 v17, v17, v25
    v_exp_f32 v27, v155
    v_cvt_pk_bf16_f32 v108, v24, v25
    v_add_f32 v16, v16, v24
    v_exp_f32 v28, v156
    v_add_f32 v17, v17, v27
    v_exp_f32 v29, v157
    v_cvt_pk_bf16_f32 v109, v26, v27
    v_add_f32 v16, v16, v26
    v_exp_f32 v30, v158
    v_add_f32 v17, v17, v29
    v_exp_f32 v31, v159
    v_cvt_pk_bf16_f32 v110, v28, v29
    v_add_f32 v16, v16, v28
    v_cvt_pk_bf16_f32 v111, v30, v31
    v_add_f32 v16, v16, v30
    v_add_f32 v17, v17, v31
    v_add_f32 v16, v16, v17
    s_nop 1
    s_branch main_kernel_rdXbr
main_kernel_rdYe:
    v_max3_f32 v18, v160, v161, v162
    v_max3_f32 v19, v163, v164, v165
    v_max3_f32 v18, v18, v166, v167
    v_max3_f32 v19, v19, v168, v169
    v_max3_f32 v18, v18, v170, v171
    v_max3_f32 v19, v19, v172, v173
    v_max3_f32 v18, v18, v174, v175
    v_max3_f32 v19, v19, v176, v177
    v_max3_f32 v18, v18, v178, v179
    v_max3_f32 v19, v19, v180, v181
    v_max3_f32 v18, v18, v182, v183
    v_max3_f32 v19, v19, v184, v185
    v_max3_f32 v18, v18, v186, v187
    v_max3_f32 v19, v19, v188, v189
    v_max3_f32 v18, v18, v190, v191
    v_max_f32 v18, v18, v19
    v_mov_b32 v19, v18
    s_nop 1
    v_permlane32_swap_b32 v19, v18
    s_nop 1
    v_max_f32 v18, v18, v19
    v_max_f32 v18, 0, v18
    v_sub_f32 v80, v80, v18
    v_sub_f32 v19, 0, v18
    v_exp_f32 v19, v19
    v_sub_f32 v160, v160, v18
    v_sub_f32 v161, v161, v18
    v_sub_f32 v162, v162, v18
    v_sub_f32 v163, v163, v18
    v_sub_f32 v164, v164, v18
    v_sub_f32 v165, v165, v18
    v_sub_f32 v166, v166, v18
    v_sub_f32 v167, v167, v18
    v_sub_f32 v168, v168, v18
    v_sub_f32 v169, v169, v18
    v_sub_f32 v170, v170, v18
    v_sub_f32 v171, v171, v18
    v_sub_f32 v172, v172, v18
    v_sub_f32 v173, v173, v18
    v_sub_f32 v174, v174, v18
    v_sub_f32 v175, v175, v18
    v_sub_f32 v176, v176, v18
    v_sub_f32 v177, v177, v18
    v_sub_f32 v178, v178, v18
    v_sub_f32 v179, v179, v18
    v_sub_f32 v180, v180, v18
    v_sub_f32 v181, v181, v18
    v_sub_f32 v182, v182, v18
    v_sub_f32 v183, v183, v18
    v_sub_f32 v184, v184, v18
    v_sub_f32 v185, v185, v18
    v_sub_f32 v186, v186, v18
    v_sub_f32 v187, v187, v18
    v_sub_f32 v188, v188, v18
    v_sub_f32 v189, v189, v18
    v_sub_f32 v190, v190, v18
    v_sub_f32 v191, v191, v18
    v_mov_b32 v81, v80
    v_mov_b32 v82, v80
    v_mov_b32 v83, v80
    v_mov_b32 v84, v80
    v_mov_b32 v85, v80
    v_mov_b32 v86, v80
    v_mov_b32 v87, v80
    v_mov_b32 v88, v80
    v_mov_b32 v89, v80
    v_mov_b32 v90, v80
    v_mov_b32 v91, v80
    v_mov_b32 v92, v80
    v_mov_b32 v93, v80
    v_mov_b32 v94, v80
    v_mov_b32 v95, v80
    v_mul_f32 v13, v13, v19
    v_accvgpr_read_b32 v24, a64
    v_accvgpr_read_b32 v25, a65
    v_accvgpr_read_b32 v26, a66
    v_accvgpr_read_b32 v27, a67
    v_accvgpr_read_b32 v28, a68
    v_accvgpr_read_b32 v29, a69
    v_accvgpr_read_b32 v30, a70
    v_accvgpr_read_b32 v31, a71
    v_mul_f32 v24, v24, v19
    v_mul_f32 v25, v25, v19
    v_mul_f32 v26, v26, v19
    v_mul_f32 v27, v27, v19
    v_mul_f32 v28, v28, v19
    v_mul_f32 v29, v29, v19
    v_mul_f32 v30, v30, v19
    v_mul_f32 v31, v31, v19
    v_accvgpr_write_b32 a64, v24
    v_accvgpr_write_b32 a65, v25
    v_accvgpr_write_b32 a66, v26
    v_accvgpr_write_b32 a67, v27
    v_accvgpr_write_b32 a68, v28
    v_accvgpr_write_b32 a69, v29
    v_accvgpr_write_b32 a70, v30
    v_accvgpr_write_b32 a71, v31
    v_accvgpr_read_b32 v24, a72
    v_accvgpr_read_b32 v25, a73
    v_accvgpr_read_b32 v26, a74
    v_accvgpr_read_b32 v27, a75
    v_accvgpr_read_b32 v28, a76
    v_accvgpr_read_b32 v29, a77
    v_accvgpr_read_b32 v30, a78
    v_accvgpr_read_b32 v31, a79
    v_mul_f32 v24, v24, v19
    v_mul_f32 v25, v25, v19
    v_mul_f32 v26, v26, v19
    v_mul_f32 v27, v27, v19
    v_mul_f32 v28, v28, v19
    v_mul_f32 v29, v29, v19
    v_mul_f32 v30, v30, v19
    v_mul_f32 v31, v31, v19
    v_accvgpr_write_b32 a72, v24
    v_accvgpr_write_b32 a73, v25
    v_accvgpr_write_b32 a74, v26
    v_accvgpr_write_b32 a75, v27
    v_accvgpr_write_b32 a76, v28
    v_accvgpr_write_b32 a77, v29
    v_accvgpr_write_b32 a78, v30
    v_accvgpr_write_b32 a79, v31
    v_accvgpr_read_b32 v24, a80
    v_accvgpr_read_b32 v25, a81
    v_accvgpr_read_b32 v26, a82
    v_accvgpr_read_b32 v27, a83
    v_accvgpr_read_b32 v28, a84
    v_accvgpr_read_b32 v29, a85
    v_accvgpr_read_b32 v30, a86
    v_accvgpr_read_b32 v31, a87
    v_mul_f32 v24, v24, v19
    v_mul_f32 v25, v25, v19
    v_mul_f32 v26, v26, v19
    v_mul_f32 v27, v27, v19
    v_mul_f32 v28, v28, v19
    v_mul_f32 v29, v29, v19
    v_mul_f32 v30, v30, v19
    v_mul_f32 v31, v31, v19
    v_accvgpr_write_b32 a80, v24
    v_accvgpr_write_b32 a81, v25
    v_accvgpr_write_b32 a82, v26
    v_accvgpr_write_b32 a83, v27
    v_accvgpr_write_b32 a84, v28
    v_accvgpr_write_b32 a85, v29
    v_accvgpr_write_b32 a86, v30
    v_accvgpr_write_b32 a87, v31
    v_accvgpr_read_b32 v24, a88
    v_accvgpr_read_b32 v25, a89
    v_accvgpr_read_b32 v26, a90
    v_accvgpr_read_b32 v27, a91
    v_accvgpr_read_b32 v28, a92
    v_accvgpr_read_b32 v29, a93
    v_accvgpr_read_b32 v30, a94
    v_accvgpr_read_b32 v31, a95
    v_mul_f32 v24, v24, v19
    v_mul_f32 v25, v25, v19
    v_mul_f32 v26, v26, v19
    v_mul_f32 v27, v27, v19
    v_mul_f32 v28, v28, v19
    v_mul_f32 v29, v29, v19
    v_mul_f32 v30, v30, v19
    v_mul_f32 v31, v31, v19
    v_accvgpr_write_b32 a88, v24
    v_accvgpr_write_b32 a89, v25
    v_accvgpr_write_b32 a90, v26
    v_accvgpr_write_b32 a91, v27
    v_accvgpr_write_b32 a92, v28
    v_accvgpr_write_b32 a93, v29
    v_accvgpr_write_b32 a94, v30
    v_accvgpr_write_b32 a95, v31
    v_accvgpr_read_b32 v24, a96
    v_accvgpr_read_b32 v25, a97
    v_accvgpr_read_b32 v26, a98
    v_accvgpr_read_b32 v27, a99
    v_accvgpr_read_b32 v28, a100
    v_accvgpr_read_b32 v29, a101
    v_accvgpr_read_b32 v30, a102
    v_accvgpr_read_b32 v31, a103
    v_mul_f32 v24, v24, v19
    v_mul_f32 v25, v25, v19
    v_mul_f32 v26, v26, v19
    v_mul_f32 v27, v27, v19
    v_mul_f32 v28, v28, v19
    v_mul_f32 v29, v29, v19
    v_mul_f32 v30, v30, v19
    v_mul_f32 v31, v31, v19
    v_accvgpr_write_b32 a96, v24
    v_accvgpr_write_b32 a97, v25
    v_accvgpr_write_b32 a98, v26
    v_accvgpr_write_b32 a99, v27
    v_accvgpr_write_b32 a100, v28
    v_accvgpr_write_b32 a101, v29
    v_accvgpr_write_b32 a102, v30
    v_accvgpr_write_b32 a103, v31
    v_accvgpr_read_b32 v24, a104
    v_accvgpr_read_b32 v25, a105
    v_accvgpr_read_b32 v26, a106
    v_accvgpr_read_b32 v27, a107
    v_accvgpr_read_b32 v28, a108
    v_accvgpr_read_b32 v29, a109
    v_accvgpr_read_b32 v30, a110
    v_accvgpr_read_b32 v31, a111
    v_mul_f32 v24, v24, v19
    v_mul_f32 v25, v25, v19
    v_mul_f32 v26, v26, v19
    v_mul_f32 v27, v27, v19
    v_mul_f32 v28, v28, v19
    v_mul_f32 v29, v29, v19
    v_mul_f32 v30, v30, v19
    v_mul_f32 v31, v31, v19
    v_accvgpr_write_b32 a104, v24
    v_accvgpr_write_b32 a105, v25
    v_accvgpr_write_b32 a106, v26
    v_accvgpr_write_b32 a107, v27
    v_accvgpr_write_b32 a108, v28
    v_accvgpr_write_b32 a109, v29
    v_accvgpr_write_b32 a110, v30
    v_accvgpr_write_b32 a111, v31
    v_accvgpr_read_b32 v24, a112
    v_accvgpr_read_b32 v25, a113
    v_accvgpr_read_b32 v26, a114
    v_accvgpr_read_b32 v27, a115
    v_accvgpr_read_b32 v28, a116
    v_accvgpr_read_b32 v29, a117
    v_accvgpr_read_b32 v30, a118
    v_accvgpr_read_b32 v31, a119
    v_mul_f32 v24, v24, v19
    v_mul_f32 v25, v25, v19
    v_mul_f32 v26, v26, v19
    v_mul_f32 v27, v27, v19
    v_mul_f32 v28, v28, v19
    v_mul_f32 v29, v29, v19
    v_mul_f32 v30, v30, v19
    v_mul_f32 v31, v31, v19
    v_accvgpr_write_b32 a112, v24
    v_accvgpr_write_b32 a113, v25
    v_accvgpr_write_b32 a114, v26
    v_accvgpr_write_b32 a115, v27
    v_accvgpr_write_b32 a116, v28
    v_accvgpr_write_b32 a117, v29
    v_accvgpr_write_b32 a118, v30
    v_accvgpr_write_b32 a119, v31
    v_accvgpr_read_b32 v24, a120
    v_accvgpr_read_b32 v25, a121
    v_accvgpr_read_b32 v26, a122
    v_accvgpr_read_b32 v27, a123
    v_accvgpr_read_b32 v28, a124
    v_accvgpr_read_b32 v29, a125
    v_accvgpr_read_b32 v30, a126
    v_accvgpr_read_b32 v31, a127
    v_mul_f32 v24, v24, v19
    v_mul_f32 v25, v25, v19
    v_mul_f32 v26, v26, v19
    v_mul_f32 v27, v27, v19
    v_mul_f32 v28, v28, v19
    v_mul_f32 v29, v29, v19
    v_mul_f32 v30, v30, v19
    v_mul_f32 v31, v31, v19
    v_accvgpr_write_b32 a120, v24
    v_accvgpr_write_b32 a121, v25
    v_accvgpr_write_b32 a122, v26
    v_accvgpr_write_b32 a123, v27
    v_accvgpr_write_b32 a124, v28
    v_accvgpr_write_b32 a125, v29
    v_accvgpr_write_b32 a126, v30
    v_accvgpr_write_b32 a127, v31
    v_exp_f32 v24, v160
    v_exp_f32 v25, v161
    v_exp_f32 v26, v162
    v_cvt_pk_bf16_f32 v112, v24, v25
    v_exp_f32 v27, v163
    v_exp_f32 v28, v164
    v_add_f32 v17, v25, v27
    v_exp_f32 v29, v165
    v_cvt_pk_bf16_f32 v113, v26, v27
    v_add_f32 v16, v24, v26
    v_exp_f32 v30, v166
    v_add_f32 v17, v17, v29
    v_exp_f32 v31, v167
    v_cvt_pk_bf16_f32 v114, v28, v29
    v_add_f32 v16, v16, v28
    v_exp_f32 v24, v168
    v_add_f32 v17, v17, v31
    v_exp_f32 v25, v169
    v_cvt_pk_bf16_f32 v115, v30, v31
    v_add_f32 v16, v16, v30
    v_exp_f32 v26, v170
    v_add_f32 v17, v17, v25
    v_exp_f32 v27, v171
    v_cvt_pk_bf16_f32 v116, v24, v25
    v_add_f32 v16, v16, v24
    v_exp_f32 v28, v172
    v_add_f32 v17, v17, v27
    v_exp_f32 v29, v173
    v_cvt_pk_bf16_f32 v117, v26, v27
    v_add_f32 v16, v16, v26
    v_exp_f32 v30, v174
    v_add_f32 v17, v17, v29
    v_exp_f32 v31, v175
    v_cvt_pk_bf16_f32 v118, v28, v29
    v_add_f32 v16, v16, v28
    v_exp_f32 v24, v176
    v_add_f32 v17, v17, v31
    v_exp_f32 v25, v177
    v_cvt_pk_bf16_f32 v119, v30, v31
    v_add_f32 v16, v16, v30
    v_exp_f32 v26, v178
    v_add_f32 v17, v17, v25
    v_exp_f32 v27, v179
    v_cvt_pk_bf16_f32 v120, v24, v25
    v_add_f32 v16, v16, v24
    v_exp_f32 v28, v180
    v_add_f32 v17, v17, v27
    v_exp_f32 v29, v181
    v_cvt_pk_bf16_f32 v121, v26, v27
    v_add_f32 v16, v16, v26
    v_exp_f32 v30, v182
    v_add_f32 v17, v17, v29
    v_exp_f32 v31, v183
    v_cvt_pk_bf16_f32 v122, v28, v29
    v_add_f32 v16, v16, v28
    v_exp_f32 v24, v184
    v_add_f32 v17, v17, v31
    v_exp_f32 v25, v185
    v_cvt_pk_bf16_f32 v123, v30, v31
    v_add_f32 v16, v16, v30
    v_exp_f32 v26, v186
    v_add_f32 v17, v17, v25
    v_exp_f32 v27, v187
    v_cvt_pk_bf16_f32 v124, v24, v25
    v_add_f32 v16, v16, v24
    v_exp_f32 v28, v188
    v_add_f32 v17, v17, v27
    v_exp_f32 v29, v189
    v_cvt_pk_bf16_f32 v125, v26, v27
    v_add_f32 v16, v16, v26
    v_exp_f32 v30, v190
    v_add_f32 v17, v17, v29
    v_exp_f32 v31, v191
    v_cvt_pk_bf16_f32 v126, v28, v29
    v_add_f32 v16, v16, v28
    v_cvt_pk_bf16_f32 v127, v30, v31
    v_add_f32 v16, v16, v30
    v_add_f32 v17, v17, v31
    v_add_f32 v16, v16, v17
    s_nop 1
    s_branch main_kernel_rdYer
all_code_end:
.section .rodata,"a"
.p2align 6
.amdhsa_kernel main_kernel
  .amdhsa_next_free_vgpr 512
  .amdhsa_next_free_sgpr 102
  .amdhsa_accum_offset 256
  .amdhsa_group_segment_fixed_size 0
  .amdhsa_kernarg_size 128
  .amdhsa_user_sgpr_count 2
  .amdhsa_user_sgpr_kernarg_segment_ptr 1
  .amdhsa_system_sgpr_workgroup_id_x 1
  .amdhsa_float_denorm_mode_32 3
.end_amdhsa_kernel
```
